```python
import torch

def _softmax(x, axis=-1):
    return torch.softmax(x, dim=axis)
def _gelu(x):
    return torch.nn.functional.gelu(x, approximate="tanh")
def _silu(x):
    return torch.nn.functional.silu(x)
def _sigmoid(x):
    return torch.sigmoid(x)
def _layernorm(x, axis=-1, eps=1e-5):
    m = x.mean(dim=axis, keepdim=True)
    v = x.var(dim=axis, keepdim=True, unbiased=False)
    return (x - m) / torch.sqrt(v + eps)
def _scatter_add(tgt, idx, src, axis=0):
    return tgt.clone().index_add_(axis, idx, src)
def _segment_sum(src, seg, n):
    out = torch.zeros((n,) + src.shape[1:], dtype=src.dtype)
    return out.index_add_(0, seg, src)
def _pad(x, pw):
    flat = tuple(v for pair in reversed(pw) for v in pair)
    return torch.nn.functional.pad(x, flat)

kernel_name = 'gated_mix__ssm_conv_s4d__spectral_gfnet__prompt'

def setup_inputs():

    _w = (lambda a: (lambda t: t.to(torch.bfloat16) if t.is_floating_point() else t)(torch.as_tensor(a)))
    def _A_setup():
        Bsz, L, D, N = 1, 2048, 640, 128
        return {
            "u": _w((lambda *s: torch.randn(*s, dtype=torch.bfloat16) * 0.05)(Bsz, L, D)),
            "log_A_real": _w((lambda *s: torch.randn(*s, dtype=torch.bfloat16) * 3.2)(D, N) * 0.5),
            "A_imag": _w((lambda *s: torch.randn(*s, dtype=torch.bfloat16) * 0.05)(D, N) * 3.14),
            "C_real": _w((lambda *s: torch.randn(*s, dtype=torch.bfloat16) * 0.1)(D, N) / N ** 0.5),
            "C_imag": _w((lambda *s: torch.randn(*s, dtype=torch.bfloat16) * 0.1)(D, N) / N ** 0.5),
            "log_dt": _w((lambda *s: torch.randn(*s, dtype=torch.bfloat16) * 0.05)(D) * 0.5 - 4.0),
            "D_skip": _w((lambda *s: torch.randn(*s, dtype=torch.bfloat16) * 0.05)(D)),
        }
    _A_in = _A_setup()

    def _B_setup():
        B, S, D = 1, 2048, 640
        Df = D // 2 + 1
        return {
            "x": _w((lambda *s: torch.randn(*s, dtype=torch.bfloat16) * 0.05)(B, S, D)),
            "w_r": _w((lambda *s: torch.randn(*s, dtype=torch.bfloat16) * 0.8)(S, Df) * 0.02),
            "w_i": _w((lambda *s: torch.randn(*s, dtype=torch.bfloat16) * 0.8)(S, Df) * 0.02),
        }
    _B_in = _B_setup()

    return {
        "A_u": _A_in["u"],
        "A_log_A_real": _A_in["log_A_real"],
        "A_A_imag": _A_in["A_imag"],
        "A_C_real": _A_in["C_real"],
        "A_C_imag": _A_in["C_imag"],
        "A_log_dt": _A_in["log_dt"],
        "A_D_skip": _A_in["D_skip"],
        "B_x": _B_in["x"],
        "B_w_r": _B_in["w_r"],
        "B_w_i": _B_in["w_i"],
        "gate_w": _w((lambda *s: torch.randn(*s, dtype=torch.bfloat16) * 0.05)(640) * 16.0),
    }

def reference(A_u, A_log_A_real, A_A_imag, A_C_real, A_C_imag, A_log_dt, A_D_skip, B_x, B_w_r, B_w_i, gate_w):
    def _A_ref(u, log_A_real, A_imag, C_real, C_imag, log_dt, D_skip):
        L = u.shape[1]
        dt = torch.exp(log_dt)
        A = -torch.exp(log_A_real) + 1j * A_imag
        C = (C_real + 1j * C_imag) * dt[:, None]
        pos = (lambda x, dt: x.to(dt))(torch.arange(L), log_dt.dtype)
        P = torch.exp((A * dt[:, None])[:, :, None] * pos[None, None, :])
        K = 2.0 * torch.einsum("dn,dnl->dl", C, P).real
        L2 = 2 * L
        u_t = (lambda x, *d: x.permute(*d))(u, 0, 2, 1)
        Kf = (lambda x, *a, **k: torch.fft.rfft(x.float(), *a, **k))(K, L2)
        Uf = (lambda x, *a, **k: torch.fft.rfft(x.float(), *a, **k))(u_t, L2)
        y = (lambda x, *a, **k: torch.fft.irfft(x, *a, **k).to(torch.bfloat16))(Uf * Kf[None, :, :], L2)[:, :, :L]
        y = (lambda x, *d: x.permute(*d))(y, 0, 2, 1)
        return y + u * D_skip[None, None, :]

    def _B_ref(x, w_r, w_i):
        B, S, D = x.shape
        X = (lambda x, axes=(-2,-1): torch.fft.rfft2(x.float(), dim=axes))(x, axes=(-2, -1))
        W = w_r + 1j * w_i
        X = X * W
        y = (lambda x, s, axes=(-2,-1): torch.fft.irfft2(x, s=s, dim=axes).to(torch.bfloat16))(X, (S, D), axes=(-2, -1))
        return y

    x = A_u
    g = _sigmoid((x * gate_w).sum(-1, keepdims=True))
    a = _A_ref(x, A_log_A_real, A_A_imag, A_C_real, A_C_imag, A_log_dt, A_D_skip)
    b = _B_ref(x, B_w_r, B_w_i)
    return g * a + (1 - g) * b
```

```asm
; @launch grid=(256,1,1) block=(512,1,1) lds=156544
.amdgcn_target "amdgcn-amd-amdhsa--gfx950"
.text
.globl gated_mix__ssm_conv_s4d__spectral_gfnet__prompt_kernel
.p2align 8
.type gated_mix__ssm_conv_s4d__spectral_gfnet__prompt_kernel,@function
gated_mix__ssm_conv_s4d__spectral_gfnet__prompt_kernel:
    s_cmp_ge_u32 s2, 256
    s_cbranch_scc1 L_end
    s_getpc_b64 s[62:63]
L_pc1:
    s_lshr_b32 s59, s2, 3
    v_lshl_add_u32 v4, v0, 5, s59
    v_lshlrev_b32 v4, 7, v4
    v_cmp_gt_u32 vcc, L_end-L_pc1, v4
    v_mov_b32 v5, s63
    s_and_saveexec_b64 s[60:61], vcc
    s_cbranch_execz L_nopf1
    v_add_co_u32 v4, vcc, s62, v4
    s_nop 1
    v_addc_co_u32 v5, vcc, 0, v5, vcc
    global_load_dword v255, v[4:5], off
L_nopf1:
    s_mov_b64 exec, -1
    v_and_b32 v2, 15, v0
    v_lshlrev_b32_e64 v4, 2, v2
    v_add_u32 v4, 156480, v4
    v_mov_b32 v5, 0
    ds_write_b32 v4, v5
    s_waitcnt lgkmcnt(0)
    s_load_dwordx16 s[4:19], s[0:1], 0
    s_load_dwordx2 s[28:29], s[0:1], 104
    s_load_dwordx8 s[20:27], s[0:1], 64
    s_getpc_b64 s[30:31]
    s_add_u32 s30, s30, L_tab@rel32@lo+4100
    s_addc_u32 s31, s31, L_tab@rel32@hi+4108
    v_lshrrev_b32 v4, 6, v0
    v_and_b32 v1, 63, v0
    v_readfirstlane_b32 s57, v4
    v_lshrrev_b32_e64 v3, 4, v1
    s_and_b32 s58, s2, 7
    s_lshr_b32 s59, s2, 3
    s_barrier
    s_cmp_ge_u32 s57, 4
    s_cbranch_scc1 L_A
    s_setprio 0
    s_lshr_b32 s64, s59, 2
    s_lshl_b32 s60, s58, 3
    s_add_u32 s64, s64, s60
    s_and_b32 s65, s59, 3
    s_mul_i32 s66, s65, 3
    s_add_u32 s66, s66, s57
    s_and_b32 s3, s59, 1
    s_bfe_u32 s60, s59, 131073
    s_mul_i32 s88, s60, 5
    s_add_u32 s88, s88, 1
    s_lshr_b32 s88, s88, 1
    s_and_b32 s60, s60, 1
    s_sub_u32 s89, 3, s60
    s_and_b32 s60, s59, 7
    s_cmp_eq_u32 s60, 6
    s_cselect_b32 s89, 3, s89
    s_lshr_b32 s90, s59, 4
    s_lshl_b32 s61, s58, 1
    s_add_u32 s90, s90, s61
    s_sub_u32 s61, 32, s90
    s_cmp_eq_u32 s90, 0
    s_cselect_b32 s61, 16, s61
    s_bitcmp1_b32 s59, 3
    s_cselect_b32 s90, s61, s90
    s_sub_u32 s60, 1, s90
    s_cmp_eq_u32 s3, 0
    s_cselect_b32 s92, s90, s60
    s_and_b32 s92, s92, 7
    s_cmp_lt_u32 s57, s89
    s_cselect_b32 s91, 1, 0
    s_lshr_b32 s62, s90, 3
    s_mul_i32 s62, s62, 576
    s_bfe_u32 s63, s59, 131073
    s_mul_i32 s63, s63, 128
    s_add_u32 s62, s62, s63
    s_add_u32 s98, s62, 18874368
    s_cmp_eq_u32 s57, 3
    s_cbranch_scc1 L_gate
    s_min_u32 s61, s66, 10
    s_mul_i32 s62, s61, 5120
    s_add_u32 s62, s62, 46592
    s_add_u32 s60, s30, s62
    s_addc_u32 s61, s31, 0
    v_lshlrev_b32 v10, 4, v1
    v_mov_b32 v11, s61
    v_add_co_u32 v10, vcc, s60, v10
    s_nop 1
    v_addc_co_u32_e64 v11, vcc, 0, v11, vcc
    global_load_dwordx4 v[56:59], v[10:11], off offset:-4096
    global_load_dwordx4 v[60:63], v[10:11], off offset:-3072
    global_load_dwordx4 v[64:67], v[10:11], off offset:-2048
    global_load_dwordx4 v[68:71], v[10:11], off offset:-1024
    global_load_dwordx4 v[72:75], v[10:11], off offset:0
    s_cmp_gt_u32 s66, 10
    s_cbranch_scc1 L_p1skip
    s_lshl_b32 s61, s66, 3
    v_lshlrev_b32 v4, 6, v3
    v_add_u32 v4, s64, v4
    v_cvt_f32_u32 v4, v4
    v_cvt_f32_u32_e64 v5, v2
    v_mul_f32 v6, 0x3a000000, v4
    v_mul_f32_e64 v6, v6, v5
    v_mul_f32 v5, 0x3e000000, v5
    v_mul_f32 v4, 0x3c000000, v4
    v_cos_f32 v24, v6
    v_sin_f32 v25, v6
    v_cos_f32 v8, v5
    v_sin_f32 v9, v5
    v_cos_f32 v10, v4
    v_sin_f32 v11, v4
    v_pk_mul_f32 v[26:27], v[24:25], v[8:9] op_sel:[0,0] op_sel_hi:[1,0]
    v_pk_fma_f32 v[26:27], v[24:25], v[8:9], v[26:27] op_sel:[1,1,0] op_sel_hi:[0,1,1] neg_lo:[1,0,0]
    v_pk_mul_f32 v[28:29], v[26:27], v[8:9] op_sel:[0,0] op_sel_hi:[1,0]
    v_pk_fma_f32 v[28:29], v[26:27], v[8:9], v[28:29] op_sel:[1,1,0] op_sel_hi:[0,1,1] neg_lo:[1,0,0]
    v_pk_mul_f32 v[30:31], v[28:29], v[8:9] op_sel:[0,0] op_sel_hi:[1,0]
    v_pk_fma_f32 v[30:31], v[28:29], v[8:9], v[30:31] op_sel:[1,1,0] op_sel_hi:[0,1,1] neg_lo:[1,0,0]
    v_pk_mul_f32 v[32:33], v[30:31], v[8:9] op_sel:[0,0] op_sel_hi:[1,0]
    v_pk_fma_f32 v[32:33], v[30:31], v[8:9], v[32:33] op_sel:[1,1,0] op_sel_hi:[0,1,1] neg_lo:[1,0,0]
    v_pk_mul_f32 v[34:35], v[32:33], v[8:9] op_sel:[0,0] op_sel_hi:[1,0]
    v_pk_fma_f32 v[34:35], v[32:33], v[8:9], v[34:35] op_sel:[1,1,0] op_sel_hi:[0,1,1] neg_lo:[1,0,0]
    v_pk_mul_f32 v[36:37], v[34:35], v[8:9] op_sel:[0,0] op_sel_hi:[1,0]
    v_pk_fma_f32 v[36:37], v[34:35], v[8:9], v[36:37] op_sel:[1,1,0] op_sel_hi:[0,1,1] neg_lo:[1,0,0]
    v_pk_mul_f32 v[38:39], v[36:37], v[8:9] op_sel:[0,0] op_sel_hi:[1,0]
    v_pk_fma_f32 v[38:39], v[36:37], v[8:9], v[38:39] op_sel:[1,1,0] op_sel_hi:[0,1,1] neg_lo:[1,0,0]
    v_cvt_pk_bf16_f32 v76, v24, v26
    v_cvt_pk_bf16_f32 v80, v25, v27
    v_cvt_pk_bf16_f32 v77, v28, v30
    v_cvt_pk_bf16_f32 v81, v29, v31
    v_cvt_pk_bf16_f32 v78, v32, v34
    v_cvt_pk_bf16_f32 v82, v33, v35
    v_cvt_pk_bf16_f32 v79, v36, v38
    v_cvt_pk_bf16_f32 v83, v37, v39
    v_pk_mul_f32 v[4:5], v[24:25], v[10:11] op_sel:[0,0] op_sel_hi:[1,0]
    v_pk_fma_f32 v[4:5], v[24:25], v[10:11], v[4:5] op_sel:[1,1,0] op_sel_hi:[0,1,1] neg_lo:[1,0,0]
    v_pk_mul_f32 v[6:7], v[26:27], v[10:11] op_sel:[0,0] op_sel_hi:[1,0]
    v_pk_fma_f32 v[6:7], v[26:27], v[10:11], v[6:7] op_sel:[1,1,0] op_sel_hi:[0,1,1] neg_lo:[1,0,0]
    v_cvt_pk_bf16_f32 v84, v4, v6
    v_cvt_pk_bf16_f32 v88, v5, v7
    v_pk_mul_f32 v[4:5], v[28:29], v[10:11] op_sel:[0,0] op_sel_hi:[1,0]
    v_pk_fma_f32 v[4:5], v[28:29], v[10:11], v[4:5] op_sel:[1,1,0] op_sel_hi:[0,1,1] neg_lo:[1,0,0]
    v_pk_mul_f32 v[6:7], v[30:31], v[10:11] op_sel:[0,0] op_sel_hi:[1,0]
    v_pk_fma_f32 v[6:7], v[30:31], v[10:11], v[6:7] op_sel:[1,1,0] op_sel_hi:[0,1,1] neg_lo:[1,0,0]
    v_cvt_pk_bf16_f32 v85, v4, v6
    v_cvt_pk_bf16_f32 v89, v5, v7
    v_pk_mul_f32 v[4:5], v[32:33], v[10:11] op_sel:[0,0] op_sel_hi:[1,0]
    v_pk_fma_f32 v[4:5], v[32:33], v[10:11], v[4:5] op_sel:[1,1,0] op_sel_hi:[0,1,1] neg_lo:[1,0,0]
    v_pk_mul_f32 v[6:7], v[34:35], v[10:11] op_sel:[0,0] op_sel_hi:[1,0]
    v_pk_fma_f32 v[6:7], v[34:35], v[10:11], v[6:7] op_sel:[1,1,0] op_sel_hi:[0,1,1] neg_lo:[1,0,0]
    v_cvt_pk_bf16_f32 v86, v4, v6
    v_cvt_pk_bf16_f32 v90, v5, v7
    v_pk_mul_f32 v[4:5], v[36:37], v[10:11] op_sel:[0,0] op_sel_hi:[1,0]
    v_pk_fma_f32 v[4:5], v[36:37], v[10:11], v[4:5] op_sel:[1,1,0] op_sel_hi:[0,1,1] neg_lo:[1,0,0]
    v_pk_mul_f32 v[6:7], v[38:39], v[10:11] op_sel:[0,0] op_sel_hi:[1,0]
    v_pk_fma_f32 v[6:7], v[38:39], v[10:11], v[6:7] op_sel:[1,1,0] op_sel_hi:[0,1,1] neg_lo:[1,0,0]
    v_cvt_pk_bf16_f32 v87, v4, v6
    v_cvt_pk_bf16_f32 v91, v5, v7
    v_add_u32 v4, 0, v3
    v_add_u32 v4, s61, v4
    v_cvt_f32_u32_e64 v4, v4
    v_mul_f32 v5, 0xbacccccd, v4
    v_cos_f32 v92, v5
    v_sin_f32 v93, v5
    v_mul_f32 v5, 0xbb4ccccd, v4
    v_cos_f32 v94, v5
    v_sin_f32 v95, v5
    v_mul_f32 v5, 0xbb99999a, v4
    v_cos_f32 v96, v5
    v_sin_f32 v97, v5
    v_add_u32 v4, 4, v3
    v_add_u32 v4, s61, v4
    v_cvt_f32_u32_e64 v4, v4
    v_mul_f32 v5, 0xbacccccd, v4
    v_cos_f32 v98, v5
    v_sin_f32 v99, v5
    v_mul_f32 v5, 0xbb4ccccd, v4
    v_cos_f32 v100, v5
    v_sin_f32 v101, v5
    v_mul_f32 v5, 0xbb99999a, v4
    v_cos_f32 v102, v5
    v_sin_f32 v103, v5
    v_and_b32 v4, 3, v1
    v_lshrrev_b32 v5, 1, v3
    v_xor_b32 v5, v5, v4
    v_lshlrev_b32 v5, 6, v5
    v_and_b32_e64 v6, 1, v3
    v_lshl_add_u32 v5, v6, 5, v5
    v_lshlrev_b32_e64 v6, 1, v2
    v_and_or_b32 v5, v6, 24, v5
    v_lshl_add_u32 v6, v4, 10, v5
    v_add_u32 v104, 86784, v6
    v_xor_b32 v105, 128, v104
    v_lshl_add_u32 v6, v4, 8, v5
    v_add_u32 v106, 119552, v6
    v_xor_b32 v107, 128, v106
    v_mul_u32_u24 v21, 1280, v2
    v_lshl_add_u32 v21, v3, 4, v21
    s_waitcnt lgkmcnt(0)
    s_nop 0
    s_load_dword s56, s[28:29], 0
    s_mov_b32 s32, s28
    s_mov_b32 s33, s29
    s_mov_b32 s34, 268435456
    s_mov_b32 s35, 0x00020000
    s_mov_b32 s52, s26
    s_mov_b32 s53, s27
    s_mov_b32 s54, 2621440
    s_mov_b32 s55, 0x00020000
    s_mul_i32 s60, s64, 40960
    s_lshl_b32 s61, s66, 7
    s_add_u32 s60, s60, s61
    s_add_u32 s14, s60, 1048576
    s_add_u32 s15, s14, 20480
    s_add_u32 s60, s88, s57
    s_lshl_b32 s60, s60, 3
    s_mul_i32 s61, s3, 320
    s_add_u32 s60, s60, s61
    v_lshrrev_b32 v6, 2, v2
    v_and_b32_e64 v4, 1, v2
    v_lshl_add_u32 v6, v4, 2, v6
    v_and_b32_e64 v7, 2, v2
    v_mul_u32_u24 v4, 80, v7
    v_add3_u32 v12, v6, v4, s60
    s_lshl_b32 s60, s57, 3
    v_add_u32 v6, s60, v6
    s_sub_u32 s60, 0, s3
    v_xor_b32 v6, s60, v6
    s_and_b32 s61, s60, 24
    s_add_u32 s61, s61, s92
    v_add_u32 v6, s61, v6
    v_lshlrev_b32 v6, 1, v6
    v_lshl_add_u32 v6, v7, 5, v6
    v_lshl_add_u32 v6, v3, 8, v6
    v_add_u32 v20, 127744, v6
    s_add_u32 s60, s88, s57
    s_cmp_lt_u32 s60, 10
    s_cbranch_scc1 L_p2r1
    s_mov_b32 s16, 2048
    s_lshl_b32 s17, s90, 6
    s_add_u32 s18, s17, 4194304
    s_add_u32 s19, s17, 8388608
    v_and_b32_e64 v4, 13, v2
    v_cmp_eq_u32 vcc, 0, v4
    v_mov_b32 v4, 480
    s_nop 0
    v_cndmask_b32 v12, v4, v12, vcc
    s_branch L_p2g2
L_p2r1:
    s_mov_b32 s16, 40960
    s_mul_i32 s17, s90, 1280
    s_lshl_b32 s61, s60, 7
    s_add_u32 s17, s17, s61
    s_lshl_b32 s61, s3, 6
    s_add_u32 s17, s17, s61
    s_add_u32 s18, s17, 1048576
    s_add_u32 s19, s17, 5242880
L_p2g2:
    s_lshl_b32 s60, s60, 4
    s_lshr_b32 s61, s90, 1
    s_add_u32 s60, s60, s61
    s_mul_i32 s6, s60, 1088
    v_mov_b32 v14, 0x35cccccd
    v_mov_b32 v4, 0x354ccccd
    v_cmp_eq_u32 vcc, 0, v12
    s_nop 1
    v_cndmask_b32 v14, v14, v4, vcc
    v_cmp_eq_u32 vcc, 320, v12
    s_nop 1
    v_cndmask_b32 v14, v14, v4, vcc
    v_cmp_ne_u32 vcc, 480, v12
    s_nop 1
    v_cndmask_b32 v14, 0, v14, vcc
    s_lshl_b32 s60, s3, 31
    v_xor_b32 v15, s60, v14
    v_lshlrev_b32_e64 v16, 4, v1
    s_add_u32 s6, s6, 17825792
    v_add_u32_e64 v16, s6, v16
    v_lshrrev_b32 v4, 2, v1
    s_lshl_b32 s60, s16, 2
    v_mul_lo_u32 v4, v4, s60
    v_and_b32_e64 v5, 3, v1
    v_lshl_add_u32 v17, v5, 4, v4
    v_mul_lo_u32 v4, v2, s60
    v_lshl_add_u32 v19, v3, 4, v4
    s_lshl_b32 s11, s57, 12
    s_add_u32 s11, s11, 144128
    v_lshrrev_b32 v4, 3, v2
    v_lshl_add_u32 v4, v3, 1, v4
    v_lshlrev_b32_e64 v4, 6, v4
    v_lshl_add_u32 v4, v5, 4, v4
    v_lshlrev_b32 v5, 1, v2
    v_and_b32 v5, 8, v5
    v_add3_u32 v18, v4, v5, s11
    v_lshlrev_b32 v232, 4, v1
    v_xor_b32 v233, 16, v232
    v_xor_b32 v234, 32, v232
    v_xor_b32 v235, 48, v232
    v_lshlrev_b32 v4, 0, v3
    v_xor_b32 v4, v4, v2
    v_mul_u32_u24 v5, 1280, v3
    v_lshl_add_u32 v4, v4, 4, v5
    v_add_u32 v236, 1024, v4
    v_lshrrev_b32 v4, 1, v2
    v_and_b32 v5, 3, v4
    v_lshlrev_b32_e64 v5, 3, v5
    v_lshrrev_b32 v4, 2, v4
    s_lshl_b32 s60, s65, 1
    v_add3_u32 v4, v4, v5, s60
    v_lshlrev_b32 v4, 6, v4
    v_add_u32 v4, s64, v4
    v_cvt_f32_u32_e64 v8, v4
    v_mul_f32 v8, 0x3a000000, v8
    v_and_b32_e64 v4, 1, v2
    v_cmp_eq_u32 s[12:13], 1, v4
    v_cvt_f32_u32_e64 v10, v4
    v_mul_f32 v4, 0xbe800000, v10
    v_cvt_f32_u32 v5, v3
    v_add_f32 v5, v5, v5
    v_fma_f32 v9, v8, v5, v4
    v_fma_f32 v243, v10, -2.0, 1.0
    v_fmamk_f32 v4, v8, 0x00000000, v9
    v_sin_f32_e64 v5, v4
    v_cos_f32 v4, v4
    s_nop 0
    v_cvt_pk_bf16_f32 v200, v4, -v5
    v_fmamk_f32 v4, v8, 0x3f800000, v9
    v_sin_f32_e64 v5, v4
    v_cos_f32 v4, v4
    s_nop 0
    v_cvt_pk_bf16_f32 v201, v4, -v5
    v_fmamk_f32 v4, v8, 0x41000000, v9
    v_sin_f32_e64 v5, v4
    v_cos_f32 v4, v4
    s_nop 0
    v_cvt_pk_bf16_f32 v202, v4, -v5
    v_fmamk_f32 v4, v8, 0x41100000, v9
    v_sin_f32_e64 v5, v4
    v_cos_f32 v4, v4
    s_nop 0
    v_cvt_pk_bf16_f32 v203, v4, -v5
    v_fmamk_f32 v4, v8, 0x41800000, v9
    v_sin_f32_e64 v5, v4
    v_cos_f32 v4, v4
    s_nop 0
    v_cvt_pk_bf16_f32 v204, v4, -v5
    v_fmamk_f32 v4, v8, 0x41880000, v9
    v_sin_f32_e64 v5, v4
    v_cos_f32 v4, v4
    s_nop 0
    v_cvt_pk_bf16_f32 v205, v4, -v5
    v_fmamk_f32 v4, v8, 0x41c00000, v9
    v_sin_f32_e64 v5, v4
    v_cos_f32 v4, v4
    s_nop 0
    v_cvt_pk_bf16_f32 v206, v4, -v5
    v_fmamk_f32 v4, v8, 0x41c80000, v9
    v_sin_f32_e64 v5, v4
    v_cos_f32 v4, v4
    s_nop 0
    v_cvt_pk_bf16_f32 v207, v4, -v5
    s_lshl_b32 s60, s57, 3
    v_lshrrev_b32 v4, 1, v2
    v_add_u32_e64 v4, s60, v4
    v_sub_u32 v5, 160, v4
    v_cndmask_b32 v4, v4, v5, s[12:13]
    v_cvt_f32_u32 v6, v4
    v_lshlrev_b32 v8, 2, v3
    v_add_u32 v8, 86784, v8
    v_lshl_add_u32 v240, v4, 4, v8
    v_mul_f32 v7, 0xbe800000, v10
    v_cvt_i32_f32 v9, v243
    v_lshlrev_b32 v9, 9, v9
    v_fmamk_f32 v4, v6, 0x3acccccd, v7
    v_cos_f32 v208, v4
    v_sin_f32 v209, v4
    v_fmamk_f32 v4, v6, 0x3b4ccccd, v7
    v_cos_f32 v210, v4
    v_sin_f32 v211, v4
    v_fmamk_f32 v4, v6, 0x3b99999a, v7
    v_cos_f32 v212, v4
    v_sin_f32 v213, v4
    v_fmamk_f32 v6, v243, 0x42000000, v6
    v_add_u32_e64 v241, v240, v9
    v_fmamk_f32 v4, v6, 0x3acccccd, v7
    v_cos_f32 v214, v4
    v_sin_f32 v215, v4
    v_fmamk_f32 v4, v6, 0x3b4ccccd, v7
    v_cos_f32 v216, v4
    v_sin_f32 v217, v4
    v_fmamk_f32 v4, v6, 0x3b99999a, v7
    v_cos_f32 v218, v4
    v_sin_f32 v219, v4
    v_fmamk_f32 v6, v243, 0x42000000, v6
    v_add_u32_e64 v242, v241, v9
    s_cmp_lt_u32 s57, 2
    s_cbranch_scc1 L_u103
    v_mov_b32 v6, 0x42a00000
    v_add_u32 v242, 1280, v8
L_u103:
    v_fmamk_f32 v4, v6, 0x3acccccd, v7
    v_cos_f32 v220, v4
    v_sin_f32 v221, v4
    v_fmamk_f32 v4, v6, 0x3b4ccccd, v7
    v_cos_f32 v222, v4
    v_sin_f32 v223, v4
    v_fmamk_f32 v4, v6, 0x3b99999a, v7
    v_cos_f32_e64 v224, v4
    v_sin_f32 v225, v4
    s_lshr_b32 s60, s64, 0
    s_lshl_b32 s60, s60, 2
    s_add_u32 s60, s60, s57
    s_mul_i32 s60, s60, 576
    s_add_u32 s24, s60, 18874368
    s_add_u32 s25, s60, 19922944
    v_lshlrev_b32 v251, 6, v1
    v_lshrrev_b32 v4, 3, v2
    v_lshl_add_u32 v4, v3, 1, v4
    v_and_b32 v5, 3, v4
    v_xor_b32 v5, s57, v5
    v_lshlrev_b32 v5, 4, v5
    v_lshlrev_b32 v6, 1, v2
    v_and_b32 v6, 8, v6
    v_and_b32 v7, 3, v1
    v_lshl_add_u32 v5, v7, 6, v5
    v_add_u32_e64 v5, v5, v6
    v_lshl_add_u32 v7, v4, 10, v5
    v_add_u32 v244, 86784, v7
    v_lshl_add_u32 v7, v4, 8, v5
    v_add_u32 v248, 119552, v7
    v_lshl_add_u32 v4, v4, 4, v6
    v_add_u32 v245, 140032, v4
    v_lshlrev_b32_e64 v4, 4, v1
    v_add_u32 v247, 127744, v4
    s_mul_i32 s60, s57, 3072
    v_add_u32 v246, s60, v247
    v_lshrrev_b32 v6, 1, v3
    v_and_b32 v7, 1, v3
    v_and_b32 v8, 3, v1
    v_lshrrev_b32 v9, 2, v2
    v_lshlrev_b32 v10, 5, v6
    v_lshl_add_u32 v10, v8, 3, v10
    v_add_u32 v10, v10, v9
    v_lshlrev_b32 v10, 4, v10
    v_lshl_add_u32 v10, v7, 3, v10
    s_lshl_b32 s60, s57, 10
    s_add_u32 s60, s60, 86784
    v_add_u32 v237, s60, v10
    v_lshl_add_u32 v10, v7, 2, v8
    v_lshlrev_b32_e64 v10, 2, v10
    v_add_u32 v239, 156416, v10
    v_lshl_add_u32 v8, v8, 3, v7
    v_mul_u32_u24 v8, 81920, v8
    v_lshlrev_b32_e64 v6, 6, v6
    v_lshl_add_u32 v6, v9, 4, v6
    v_add_u32_e64 v238, v8, v6
    s_mul_i32 s62, s57, 3072
    s_add_u32 s62, s62, 12288
    s_add_u32 s60, s30, s62
    s_addc_u32 s61, s31, 0
    v_lshlrev_b32 v226, 4, v1
    v_mov_b32 v227, s61
    v_add_co_u32 v226, vcc, s60, v226
    s_nop 1
    v_addc_co_u32 v227, vcc, 0, v227, vcc
    s_mov_b32 s61, 12288
    s_cmp_eq_u32 s57, 3
    s_cselect_b32 s60, 9216, s61
    v_add_co_u32 v228, vcc, 12288, v226
    s_nop 1
    v_addc_co_u32 v229, vcc, 0, v227, vcc
    v_add_co_u32 v230, vcc, s60, v228
    s_nop 1
    v_addc_co_u32 v231, vcc, 0, v229, vcc
    s_waitcnt vmcnt(0)
    s_setprio 3
    s_mov_b64 exec, 1
    v_mov_b32 v4, 156480
    s_mov_b32 s61, 0
L_sy4:
    ds_read_b32 v5, v4
    s_add_u32 s61, s61, 1
    s_waitcnt lgkmcnt(0)
    v_readfirstlane_b32 s60, v5
    s_cmp_ge_u32 s61, 1048576
    s_cbranch_scc1 L_syd5
    s_cmp_lt_u32 s60, 2
    s_cbranch_scc1 L_sy4
L_syd5:
    s_mov_b64 exec, -1
    s_add_u32 s56, s56, 2654435769
    ds_read_b64_tr_b16 v[108:109], v104 offset:0
    ds_read_b64_tr_b16 v[110:111], v105 offset:0
    ds_read_b64_tr_b16 v[112:113], v104 offset:4096
    ds_read_b64_tr_b16 v[114:115], v105 offset:4096
    ds_read_b64_tr_b16 v[116:117], v104 offset:256
    ds_read_b64_tr_b16 v[118:119], v105 offset:256
    ds_read_b64_tr_b16 v[120:121], v104 offset:4352
    ds_read_b64_tr_b16 v[122:123], v105 offset:4352
    ds_read_b64_tr_b16 v[124:125], v104 offset:512
    ds_read_b64_tr_b16 v[126:127], v105 offset:512
    ds_read_b64_tr_b16 v[128:129], v104 offset:4608
    ds_read_b64_tr_b16 v[130:131], v105 offset:4608
    s_waitcnt lgkmcnt(10)
    s_nop 0
    v_mfma_f32_16x16x32_bf16 v[24:27], v[108:111], v[56:59], 0
    ds_read_b64_tr_b16 v[108:109], v104 offset:768
    ds_read_b64_tr_b16 v[110:111], v105 offset:768
    s_waitcnt lgkmcnt(10)
    v_mfma_f32_16x16x32_bf16 v[28:31], v[112:115], v[56:59], 0
    ds_read_b64_tr_b16 v[112:113], v104 offset:4864
    ds_read_b64_tr_b16 v[114:115], v105 offset:4864
    s_waitcnt lgkmcnt(10)
    v_mfma_f32_16x16x32_bf16 v[24:27], v[116:119], v[60:63], v[24:27]
    ds_read_b64_tr_b16 v[116:117], v106 offset:0
    ds_read_b64_tr_b16 v[118:119], v107 offset:0
    s_waitcnt lgkmcnt(10)
    v_mfma_f32_16x16x32_bf16 v[28:31], v[120:123], v[60:63], v[28:31]
    ds_read_b64_tr_b16 v[120:121], v106 offset:1024
    ds_read_b64_tr_b16 v[122:123], v107 offset:1024
    s_waitcnt lgkmcnt(10)
    v_mfma_f32_16x16x32_bf16 v[24:27], v[124:127], v[64:67], v[24:27]
    ds_read_b64_tr_b16 v[124:125], v104 offset:8192
    ds_read_b64_tr_b16 v[126:127], v105 offset:8192
    s_waitcnt lgkmcnt(10)
    v_mfma_f32_16x16x32_bf16 v[28:31], v[128:131], v[64:67], v[28:31]
    ds_read_b64_tr_b16 v[128:129], v104 offset:12288
    ds_read_b64_tr_b16 v[130:131], v105 offset:12288
    s_waitcnt lgkmcnt(10)
    v_mfma_f32_16x16x32_bf16 v[24:27], v[108:111], v[68:71], v[24:27]
    ds_read_b64_tr_b16 v[108:109], v104 offset:8448
    ds_read_b64_tr_b16 v[110:111], v105 offset:8448
    s_waitcnt lgkmcnt(10)
    v_mfma_f32_16x16x32_bf16 v[28:31], v[112:115], v[68:71], v[28:31]
    ds_read_b64_tr_b16 v[112:113], v104 offset:12544
    ds_read_b64_tr_b16 v[114:115], v105 offset:12544
    s_waitcnt lgkmcnt(10)
    v_mfma_f32_16x16x32_bf16 v[24:27], v[116:119], v[72:75], v[24:27]
    ds_read_b64_tr_b16 v[116:117], v104 offset:8704
    ds_read_b64_tr_b16 v[118:119], v105 offset:8704
    s_waitcnt lgkmcnt(10)
    v_mfma_f32_16x16x32_bf16 v[28:31], v[120:123], v[72:75], v[28:31]
    ds_read_b64_tr_b16 v[120:121], v104 offset:12800
    ds_read_b64_tr_b16 v[122:123], v105 offset:12800
    s_waitcnt lgkmcnt(10)
    v_mfma_f32_16x16x32_bf16 v[32:35], v[124:127], v[56:59], 0
    ds_read_b64_tr_b16 v[124:125], v104 offset:8960
    ds_read_b64_tr_b16 v[126:127], v105 offset:8960
    s_waitcnt lgkmcnt(10)
    v_mfma_f32_16x16x32_bf16 v[36:39], v[128:131], v[56:59], 0
    ds_read_b64_tr_b16 v[128:129], v104 offset:13056
    ds_read_b64_tr_b16 v[130:131], v105 offset:13056
    s_waitcnt lgkmcnt(10)
    v_mfma_f32_16x16x32_bf16 v[32:35], v[108:111], v[60:63], v[32:35]
    ds_read_b64_tr_b16 v[108:109], v106 offset:2048
    ds_read_b64_tr_b16 v[110:111], v107 offset:2048
    s_waitcnt lgkmcnt(10)
    v_mfma_f32_16x16x32_bf16 v[36:39], v[112:115], v[60:63], v[36:39]
    ds_read_b64_tr_b16 v[112:113], v106 offset:3072
    ds_read_b64_tr_b16 v[114:115], v107 offset:3072
    s_waitcnt lgkmcnt(10)
    v_mfma_f32_16x16x32_bf16 v[32:35], v[116:119], v[64:67], v[32:35]
    v_cvt_pk_bf16_f32 v164, v24, v28
    ds_read_b64_tr_b16 v[116:117], v104 offset:16384
    ds_read_b64_tr_b16 v[118:119], v105 offset:16384
    s_waitcnt lgkmcnt(10)
    v_mfma_f32_16x16x32_bf16 v[36:39], v[120:123], v[64:67], v[36:39]
    v_cvt_pk_bf16_f32 v168, v25, v29
    ds_read_b64_tr_b16 v[120:121], v104 offset:20480
    ds_read_b64_tr_b16 v[122:123], v105 offset:20480
    s_waitcnt lgkmcnt(10)
    v_mfma_f32_16x16x32_bf16 v[32:35], v[124:127], v[68:71], v[32:35]
    v_cvt_pk_bf16_f32 v172, v26, v30
    ds_read_b64_tr_b16 v[124:125], v104 offset:16640
    ds_read_b64_tr_b16 v[126:127], v105 offset:16640
    s_waitcnt lgkmcnt(10)
    v_mfma_f32_16x16x32_bf16 v[36:39], v[128:131], v[68:71], v[36:39]
    v_cvt_pk_bf16_f32 v176, v27, v31
    ds_read_b64_tr_b16 v[128:129], v104 offset:20736
    ds_read_b64_tr_b16 v[130:131], v105 offset:20736
    s_waitcnt lgkmcnt(10)
    v_mfma_f32_16x16x32_bf16 v[32:35], v[108:111], v[72:75], v[32:35]
    ds_read_b64_tr_b16 v[108:109], v104 offset:16896
    ds_read_b64_tr_b16 v[110:111], v105 offset:16896
    s_waitcnt lgkmcnt(10)
    v_mfma_f32_16x16x32_bf16 v[36:39], v[112:115], v[72:75], v[36:39]
    ds_read_b64_tr_b16 v[112:113], v104 offset:20992
    ds_read_b64_tr_b16 v[114:115], v105 offset:20992
    s_waitcnt lgkmcnt(10)
    v_mfma_f32_16x16x32_bf16 v[40:43], v[116:119], v[56:59], 0
    ds_read_b64_tr_b16 v[116:117], v104 offset:17152
    ds_read_b64_tr_b16 v[118:119], v105 offset:17152
    s_waitcnt lgkmcnt(10)
    v_mfma_f32_16x16x32_bf16 v[44:47], v[120:123], v[56:59], 0
    ds_read_b64_tr_b16 v[120:121], v104 offset:21248
    ds_read_b64_tr_b16 v[122:123], v105 offset:21248
    s_waitcnt lgkmcnt(10)
    v_mfma_f32_16x16x32_bf16 v[40:43], v[124:127], v[60:63], v[40:43]
    ds_read_b64_tr_b16 v[124:125], v106 offset:4096
    ds_read_b64_tr_b16 v[126:127], v107 offset:4096
    s_waitcnt lgkmcnt(10)
    v_mfma_f32_16x16x32_bf16 v[44:47], v[128:131], v[60:63], v[44:47]
    ds_read_b64_tr_b16 v[128:129], v106 offset:5120
    ds_read_b64_tr_b16 v[130:131], v107 offset:5120
    s_waitcnt lgkmcnt(10)
    v_mfma_f32_16x16x32_bf16 v[40:43], v[108:111], v[64:67], v[40:43]
    v_cvt_pk_bf16_f32 v165, v32, v36
    ds_read_b64_tr_b16 v[108:109], v104 offset:24576
    ds_read_b64_tr_b16 v[110:111], v105 offset:24576
    s_waitcnt lgkmcnt(10)
    v_mfma_f32_16x16x32_bf16 v[44:47], v[112:115], v[64:67], v[44:47]
    v_cvt_pk_bf16_f32 v169, v33, v37
    ds_read_b64_tr_b16 v[112:113], v104 offset:28672
    ds_read_b64_tr_b16 v[114:115], v105 offset:28672
    s_waitcnt lgkmcnt(10)
    v_mfma_f32_16x16x32_bf16 v[40:43], v[116:119], v[68:71], v[40:43]
    v_cvt_pk_bf16_f32 v173, v34, v38
    ds_read_b64_tr_b16 v[116:117], v104 offset:24832
    ds_read_b64_tr_b16 v[118:119], v105 offset:24832
    s_waitcnt lgkmcnt(10)
    v_mfma_f32_16x16x32_bf16 v[44:47], v[120:123], v[68:71], v[44:47]
    v_cvt_pk_bf16_f32 v177, v35, v39
    ds_read_b64_tr_b16 v[120:121], v104 offset:28928
    ds_read_b64_tr_b16 v[122:123], v105 offset:28928
    s_waitcnt lgkmcnt(10)
    v_mfma_f32_16x16x32_bf16 v[40:43], v[124:127], v[72:75], v[40:43]
    ds_read_b64_tr_b16 v[124:125], v104 offset:25088
    ds_read_b64_tr_b16 v[126:127], v105 offset:25088
    s_waitcnt lgkmcnt(10)
    v_mfma_f32_16x16x32_bf16 v[44:47], v[128:131], v[72:75], v[44:47]
    ds_read_b64_tr_b16 v[128:129], v104 offset:29184
    ds_read_b64_tr_b16 v[130:131], v105 offset:29184
    s_waitcnt lgkmcnt(10)
    v_mfma_f32_16x16x32_bf16 v[48:51], v[108:111], v[56:59], 0
    ds_read_b64_tr_b16 v[108:109], v104 offset:25344
    ds_read_b64_tr_b16 v[110:111], v105 offset:25344
    s_waitcnt lgkmcnt(10)
    v_mfma_f32_16x16x32_bf16 v[52:55], v[112:115], v[56:59], 0
    ds_read_b64_tr_b16 v[112:113], v104 offset:29440
    ds_read_b64_tr_b16 v[114:115], v105 offset:29440
    s_waitcnt lgkmcnt(10)
    v_mfma_f32_16x16x32_bf16 v[48:51], v[116:119], v[60:63], v[48:51]
    ds_read_b64_tr_b16 v[116:117], v106 offset:6144
    ds_read_b64_tr_b16 v[118:119], v107 offset:6144
    s_waitcnt lgkmcnt(10)
    v_mfma_f32_16x16x32_bf16 v[52:55], v[120:123], v[60:63], v[52:55]
    ds_read_b64_tr_b16 v[120:121], v106 offset:7168
    ds_read_b64_tr_b16 v[122:123], v107 offset:7168
    s_waitcnt lgkmcnt(10)
    v_mfma_f32_16x16x32_bf16 v[48:51], v[124:127], v[64:67], v[48:51]
    v_cvt_pk_bf16_f32 v166, v40, v44
    s_waitcnt lgkmcnt(8)
    v_mfma_f32_16x16x32_bf16 v[52:55], v[128:131], v[64:67], v[52:55]
    v_cvt_pk_bf16_f32 v170, v41, v45
    s_waitcnt lgkmcnt(6)
    v_mfma_f32_16x16x32_bf16 v[48:51], v[108:111], v[68:71], v[48:51]
    v_cvt_pk_bf16_f32 v174, v42, v46
    s_waitcnt lgkmcnt(4)
    v_mfma_f32_16x16x32_bf16 v[52:55], v[112:115], v[68:71], v[52:55]
    v_cvt_pk_bf16_f32 v178, v43, v47
    s_waitcnt lgkmcnt(2)
    v_mfma_f32_16x16x32_bf16 v[48:51], v[116:119], v[72:75], v[48:51]
    s_waitcnt lgkmcnt(0)
    v_mfma_f32_16x16x32_bf16 v[52:55], v[120:123], v[72:75], v[52:55]
    s_nop 7
    v_cvt_pk_bf16_f32 v167, v48, v52
    v_cvt_pk_bf16_f32 v171, v49, v53
    v_cvt_pk_bf16_f32 v175, v50, v54
    v_cvt_pk_bf16_f32 v179, v51, v55
    v_mfma_f32_16x16x32_bf16 v[132:135], v[164:167], v[76:79], 0
    v_mfma_f32_16x16x32_bf16 v[136:139], v[164:167], v[80:83], 0
    v_mfma_f32_16x16x32_bf16 v[140:143], v[168:171], v[76:79], 0
    v_mfma_f32_16x16x32_bf16 v[144:147], v[168:171], v[80:83], 0
    v_mfma_f32_16x16x32_bf16 v[148:151], v[172:175], v[76:79], 0
    v_mfma_f32_16x16x32_bf16 v[152:155], v[172:175], v[80:83], 0
    v_mfma_f32_16x16x32_bf16 v[156:159], v[176:179], v[76:79], 0
    v_mfma_f32_16x16x32_bf16 v[160:163], v[176:179], v[80:83], 0
    v_mfma_f32_16x16x32_bf16 v[24:27], v[164:167], v[84:87], 0
    v_mfma_f32_16x16x32_bf16 v[28:31], v[164:167], v[88:91], 0
    v_mfma_f32_16x16x32_bf16 v[32:35], v[168:171], v[84:87], 0
    v_mfma_f32_16x16x32_bf16 v[36:39], v[168:171], v[88:91], 0
    v_mfma_f32_16x16x32_bf16 v[40:43], v[172:175], v[84:87], 0
    v_mfma_f32_16x16x32_bf16 v[44:47], v[172:175], v[88:91], 0
    v_mfma_f32_16x16x32_bf16 v[48:51], v[176:179], v[84:87], 0
    v_mfma_f32_16x16x32_bf16 v[52:55], v[176:179], v[88:91], 0
    v_pk_add_f32 v[132:133], v[136:137], v[132:133] op_sel:[1,0] op_sel_hi:[0,1] neg_hi:[1,0]
    v_pk_add_f32 v[140:141], v[144:145], v[140:141] op_sel:[1,0] op_sel_hi:[0,1] neg_hi:[1,0]
    v_pk_add_f32 v[148:149], v[152:153], v[148:149] op_sel:[1,0] op_sel_hi:[0,1] neg_hi:[1,0]
    v_pk_add_f32 v[156:157], v[160:161], v[156:157] op_sel:[1,0] op_sel_hi:[0,1] neg_hi:[1,0]
    v_pk_mul_f32 v[144:145], v[140:141], v[92:93] op_sel:[0,0] op_sel_hi:[1,0]
    v_pk_mul_f32 v[152:153], v[148:149], v[94:95] op_sel:[0,0] op_sel_hi:[1,0]
    v_pk_mul_f32 v[160:161], v[156:157], v[96:97] op_sel:[0,0] op_sel_hi:[1,0]
    v_pk_fma_f32 v[144:145], v[140:141], v[92:93], v[144:145] op_sel:[1,1,0] op_sel_hi:[0,1,1] neg_lo:[1,0,0]
    v_pk_fma_f32 v[152:153], v[148:149], v[94:95], v[152:153] op_sel:[1,1,0] op_sel_hi:[0,1,1] neg_lo:[1,0,0]
    v_pk_fma_f32 v[160:161], v[156:157], v[96:97], v[160:161] op_sel:[1,1,0] op_sel_hi:[0,1,1] neg_lo:[1,0,0]
    v_pk_add_f32 v[136:137], v[132:133], v[152:153]
    v_pk_add_f32 v[140:141], v[132:133], v[152:153] neg_lo:[0,1] neg_hi:[0,1]
    v_pk_add_f32 v[148:149], v[144:145], v[160:161]
    v_pk_add_f32 v[156:157], v[144:145], v[160:161] neg_lo:[0,1] neg_hi:[0,1]
    v_pk_add_f32 v[108:109], v[136:137], v[148:149]
    v_pk_add_f32 v[112:113], v[156:157], v[140:141] op_sel:[1,0] op_sel_hi:[0,1] neg_hi:[1,0]
    v_pk_add_f32 v[116:117], v[136:137], v[148:149] neg_lo:[0,1] neg_hi:[0,1]
    v_pk_add_f32 v[120:121], v[156:157], v[140:141] op_sel:[1,0] op_sel_hi:[0,1] neg_lo:[1,0]
    v_pk_add_f32 v[134:135], v[138:139], v[134:135] op_sel:[1,0] op_sel_hi:[0,1] neg_hi:[1,0]
    v_pk_add_f32 v[142:143], v[146:147], v[142:143] op_sel:[1,0] op_sel_hi:[0,1] neg_hi:[1,0]
    v_pk_add_f32 v[150:151], v[154:155], v[150:151] op_sel:[1,0] op_sel_hi:[0,1] neg_hi:[1,0]
    v_pk_add_f32 v[158:159], v[162:163], v[158:159] op_sel:[1,0] op_sel_hi:[0,1] neg_hi:[1,0]
    v_pk_mul_f32 v[146:147], v[142:143], v[98:99] op_sel:[0,0] op_sel_hi:[1,0]
    v_pk_mul_f32 v[154:155], v[150:151], v[100:101] op_sel:[0,0] op_sel_hi:[1,0]
    v_pk_mul_f32 v[162:163], v[158:159], v[102:103] op_sel:[0,0] op_sel_hi:[1,0]
    v_pk_fma_f32 v[146:147], v[142:143], v[98:99], v[146:147] op_sel:[1,1,0] op_sel_hi:[0,1,1] neg_lo:[1,0,0]
    v_pk_fma_f32 v[154:155], v[150:151], v[100:101], v[154:155] op_sel:[1,1,0] op_sel_hi:[0,1,1] neg_lo:[1,0,0]
    v_pk_fma_f32 v[162:163], v[158:159], v[102:103], v[162:163] op_sel:[1,1,0] op_sel_hi:[0,1,1] neg_lo:[1,0,0]
    v_pk_add_f32 v[138:139], v[134:135], v[154:155]
    v_pk_add_f32 v[142:143], v[134:135], v[154:155] neg_lo:[0,1] neg_hi:[0,1]
    v_pk_add_f32 v[150:151], v[146:147], v[162:163]
    v_pk_add_f32 v[158:159], v[146:147], v[162:163] neg_lo:[0,1] neg_hi:[0,1]
    v_pk_add_f32 v[110:111], v[138:139], v[150:151]
    v_pk_add_f32 v[114:115], v[158:159], v[142:143] op_sel:[1,0] op_sel_hi:[0,1] neg_hi:[1,0]
    v_pk_add_f32 v[118:119], v[138:139], v[150:151] neg_lo:[0,1] neg_hi:[0,1]
    v_pk_add_f32 v[122:123], v[158:159], v[142:143] op_sel:[1,0] op_sel_hi:[0,1] neg_lo:[1,0]
    v_cvt_pk_bf16_f32 v164, v108, v110
    v_cvt_pk_bf16_f32 v165, v112, v114
    v_cvt_pk_bf16_f32 v166, v109, v111
    v_cvt_pk_bf16_f32 v167, v113, v115
    v_cvt_pk_bf16_f32 v168, v116, v118
    v_cvt_pk_bf16_f32 v169, v120, v122
    v_cvt_pk_bf16_f32 v170, v117, v119
    v_cvt_pk_bf16_f32 v171, v121, v123
    s_cmp_eq_u32 s66, 10
    s_cbranch_scc1 L_px6
    buffer_store_dwordx4 v[164:167], v21, s[32:35], s14 offen offset:0 sc1
    buffer_store_dwordx4 v[168:171], v21, s[32:35], s14 offen offset:64 sc1
    s_branch L_pn7
L_px6:
    s_lshl_b32 s60, s64, 11
    s_add_u32 s60, s60, 4194304
    v_lshlrev_b32_e64 v4, 6, v2
    v_lshl_add_u32 v4, v3, 4, v4
    buffer_store_dwordx4 v[164:167], v4, s[32:35], s60 offen sc1
L_pn7:
    v_pk_add_f32 v[24:25], v[28:29], v[24:25] op_sel:[1,0] op_sel_hi:[0,1] neg_hi:[1,0]
    v_pk_add_f32 v[32:33], v[36:37], v[32:33] op_sel:[1,0] op_sel_hi:[0,1] neg_hi:[1,0]
    v_pk_add_f32 v[40:41], v[44:45], v[40:41] op_sel:[1,0] op_sel_hi:[0,1] neg_hi:[1,0]
    v_pk_add_f32 v[48:49], v[52:53], v[48:49] op_sel:[1,0] op_sel_hi:[0,1] neg_hi:[1,0]
    v_pk_mul_f32 v[36:37], v[32:33], v[92:93] op_sel:[0,0] op_sel_hi:[1,0]
    v_pk_mul_f32 v[44:45], v[40:41], v[94:95] op_sel:[0,0] op_sel_hi:[1,0]
    v_pk_mul_f32 v[52:53], v[48:49], v[96:97] op_sel:[0,0] op_sel_hi:[1,0]
    v_pk_fma_f32 v[36:37], v[32:33], v[92:93], v[36:37] op_sel:[1,1,0] op_sel_hi:[0,1,1] neg_lo:[1,0,0]
    v_pk_fma_f32 v[44:45], v[40:41], v[94:95], v[44:45] op_sel:[1,1,0] op_sel_hi:[0,1,1] neg_lo:[1,0,0]
    v_pk_fma_f32 v[52:53], v[48:49], v[96:97], v[52:53] op_sel:[1,1,0] op_sel_hi:[0,1,1] neg_lo:[1,0,0]
    v_pk_add_f32 v[28:29], v[24:25], v[44:45]
    v_pk_add_f32 v[32:33], v[24:25], v[44:45] neg_lo:[0,1] neg_hi:[0,1]
    v_pk_add_f32 v[40:41], v[36:37], v[52:53]
    v_pk_add_f32 v[48:49], v[36:37], v[52:53] neg_lo:[0,1] neg_hi:[0,1]
    v_pk_add_f32 v[108:109], v[28:29], v[40:41]
    v_pk_add_f32 v[112:113], v[48:49], v[32:33] op_sel:[1,0] op_sel_hi:[0,1] neg_hi:[1,0]
    v_pk_add_f32 v[116:117], v[28:29], v[40:41] neg_lo:[0,1] neg_hi:[0,1]
    v_pk_add_f32 v[120:121], v[48:49], v[32:33] op_sel:[1,0] op_sel_hi:[0,1] neg_lo:[1,0]
    v_pk_add_f32 v[26:27], v[30:31], v[26:27] op_sel:[1,0] op_sel_hi:[0,1] neg_hi:[1,0]
    v_pk_add_f32 v[34:35], v[38:39], v[34:35] op_sel:[1,0] op_sel_hi:[0,1] neg_hi:[1,0]
    v_pk_add_f32 v[42:43], v[46:47], v[42:43] op_sel:[1,0] op_sel_hi:[0,1] neg_hi:[1,0]
    v_pk_add_f32 v[50:51], v[54:55], v[50:51] op_sel:[1,0] op_sel_hi:[0,1] neg_hi:[1,0]
    v_pk_mul_f32 v[38:39], v[34:35], v[98:99] op_sel:[0,0] op_sel_hi:[1,0]
    v_pk_mul_f32 v[46:47], v[42:43], v[100:101] op_sel:[0,0] op_sel_hi:[1,0]
    v_pk_mul_f32 v[54:55], v[50:51], v[102:103] op_sel:[0,0] op_sel_hi:[1,0]
    v_pk_fma_f32 v[38:39], v[34:35], v[98:99], v[38:39] op_sel:[1,1,0] op_sel_hi:[0,1,1] neg_lo:[1,0,0]
    v_pk_fma_f32 v[46:47], v[42:43], v[100:101], v[46:47] op_sel:[1,1,0] op_sel_hi:[0,1,1] neg_lo:[1,0,0]
    v_pk_fma_f32 v[54:55], v[50:51], v[102:103], v[54:55] op_sel:[1,1,0] op_sel_hi:[0,1,1] neg_lo:[1,0,0]
    v_pk_add_f32 v[30:31], v[26:27], v[46:47]
    v_pk_add_f32 v[34:35], v[26:27], v[46:47] neg_lo:[0,1] neg_hi:[0,1]
    v_pk_add_f32 v[42:43], v[38:39], v[54:55]
    v_pk_add_f32 v[50:51], v[38:39], v[54:55] neg_lo:[0,1] neg_hi:[0,1]
    v_pk_add_f32 v[110:111], v[30:31], v[42:43]
    v_pk_add_f32 v[114:115], v[50:51], v[34:35] op_sel:[1,0] op_sel_hi:[0,1] neg_hi:[1,0]
    v_pk_add_f32 v[118:119], v[30:31], v[42:43] neg_lo:[0,1] neg_hi:[0,1]
    v_pk_add_f32 v[122:123], v[50:51], v[34:35] op_sel:[1,0] op_sel_hi:[0,1] neg_lo:[1,0]
    v_cvt_pk_bf16_f32 v172, v108, v110
    v_cvt_pk_bf16_f32 v173, v112, v114
    v_cvt_pk_bf16_f32 v174, v109, v111
    v_cvt_pk_bf16_f32 v175, v113, v115
    v_cvt_pk_bf16_f32 v176, v116, v118
    v_cvt_pk_bf16_f32 v177, v120, v122
    v_cvt_pk_bf16_f32 v178, v117, v119
    v_cvt_pk_bf16_f32 v179, v121, v123
    s_cmp_eq_u32 s66, 10
    s_cbranch_scc1 L_px8
    buffer_store_dwordx4 v[172:175], v21, s[32:35], s15 offen offset:0 sc1
    buffer_store_dwordx4 v[176:179], v21, s[32:35], s15 offen offset:64 sc1
    s_branch L_pn9
L_px8:
    s_lshl_b32 s60, s64, 11
    s_add_u32 s60, s60, 4195328
    v_lshlrev_b32_e64 v4, 6, v2
    v_lshl_add_u32 v4, v3, 4, v4
    buffer_store_dwordx4 v[172:175], v4, s[32:35], s60 offen sc1
L_pn9:
    s_lshr_b32 s60, 0x129, s66
    s_and_b32 s61, s64, 0
    s_cselect_b32 s60, 0, s60
    s_bitcmp1_b32 s60, 0
    s_cbranch_scc0 L_noz
    s_mul_i32 s60, s66, 3
    s_lshr_b32 s60, s60, 3
    s_cmp_eq_u32 s66, 5
    s_cselect_b32 s60, 2, s60
    s_mul_i32 s60, s60, 128
    s_lshr_b32 s61, s64, 0
    s_mul_i32 s61, s61, 2304
    s_add_u32 s60, s60, s61
    s_add_u32 s60, s60, 18874368
    v_and_b32_e64 v4, 3, v1
    v_mul_u32_u24 v4, 576, v4
    v_lshrrev_b32_e64 v5, 2, v1
    v_mul_u32_u24 v5, 512, v5
    v_add_u32_e64 v4, v4, v5
    v_mov_b32 v5, s56
    s_mov_b64 exec, 15
    buffer_store_dword v5, v4, s[32:35], s60 offen sc1
    s_mov_b64 exec, -1
L_noz:
    s_mov_b64 exec, 1
    v_mov_b32 v4, 156528
    v_mov_b32 v5, 1
    ds_add_u32 v4, v5
    s_mov_b64 exec, -1
    s_mul_i32 s60, s66, 17408
    s_lshl_b32 s61, s64, 4
    s_add_u32 s60, s60, s61
    s_add_u32 s60, s60, 17825792
    s_waitcnt vmcnt(0)
    v_mul_u32_u24 v4, 1088, v1
    v_mov_b32 v5, s56
    s_mov_b64 exec, 0xffff
    buffer_store_dword v5, v4, s[32:35], s60 offen sc1
    s_mov_b64 exec, -1
    s_setprio 2
    s_cmp_lg_u32 s91, 1
    s_cbranch_scc1 L_p1done
    v_lshlrev_b32_e64 v7, 4, v1
    v_add_u32 v7, 144128, v7
    s_mov_b64 exec, 1
    v_mov_b32 v4, 156500
    s_mov_b32 s61, 0
L_sy10:
    s_sleep 1
    ds_read_b32 v5, v4
    s_add_u32 s61, s61, 1
    s_waitcnt lgkmcnt(0)
    v_readfirstlane_b32 s60, v5
    s_cmp_ge_u32 s61, 1048576
    s_cbranch_scc1 L_syd11
    s_cmp_lt_u32 s60, 1
    s_cbranch_scc1 L_sy10
L_syd11:
    s_mov_b64 exec, -1
    ds_read_b128 v[88:91], v7 offset:8192
    ds_read_b128 v[96:99], v7 offset:9216
    ds_read_b128 v[104:107], v7 offset:10240
    ds_read_b128 v[112:115], v7 offset:11264
    ds_read_b128 v[56:59], v7 offset:0
    ds_read_b128 v[60:63], v7 offset:1024
    ds_read_b128 v[64:67], v7 offset:2048
    ds_read_b128 v[68:71], v7 offset:3072
    ds_read_b128 v[72:75], v7 offset:4096
    ds_read_b128 v[76:79], v7 offset:5120
    ds_read_b128 v[80:83], v7 offset:6144
    ds_read_b128 v[84:87], v7 offset:7168
    s_waitcnt lgkmcnt(0)
    s_mov_b64 exec, 1
    v_mov_b32 v4, 156516
    v_mov_b32 v5, 1
    ds_add_u32 v4, v5
    s_mov_b64 exec, -1
    ds_read_u16_d16_hi v24, v20 offset:0
    ds_read_u16_d16_hi v25, v20 offset:8192
    ds_read_u16_d16_hi v26, v20 offset:2048
    ds_read_u16_d16_hi v27, v20 offset:10240
    ds_read_u16_d16_hi v28, v20 offset:4096
    ds_read_u16_d16_hi v29, v20 offset:12288
    ds_read_u16_d16_hi v30, v20 offset:6144
    ds_read_u16_d16_hi v31, v20 offset:14336
    ds_read_u16_d16_hi v32, v20 offset:128
    ds_read_u16_d16_hi v33, v20 offset:8320
    ds_read_u16_d16_hi v34, v20 offset:2176
    ds_read_u16_d16_hi v35, v20 offset:10368
    ds_read_u16_d16_hi v36, v20 offset:4224
    ds_read_u16_d16_hi v37, v20 offset:12416
    ds_read_u16_d16_hi v38, v20 offset:6272
    ds_read_u16_d16_hi v39, v20 offset:14464
    ds_read_u16_d16_hi v40, v20 offset:1024
    ds_read_u16_d16_hi v41, v20 offset:9216
    ds_read_u16_d16_hi v42, v20 offset:3072
    ds_read_u16_d16_hi v43, v20 offset:11264
    ds_read_u16_d16_hi v44, v20 offset:5120
    ds_read_u16_d16_hi v45, v20 offset:13312
    ds_read_u16_d16_hi v46, v20 offset:7168
    ds_read_u16_d16_hi v47, v20 offset:15360
    ds_read_u16_d16_hi v48, v20 offset:1152
    ds_read_u16_d16_hi v49, v20 offset:9344
    ds_read_u16_d16_hi v50, v20 offset:3200
    ds_read_u16_d16_hi v51, v20 offset:11392
    ds_read_u16_d16_hi v52, v20 offset:5248
    ds_read_u16_d16_hi v53, v20 offset:13440
    ds_read_u16_d16_hi v54, v20 offset:7296
    ds_read_u16_d16_hi v55, v20 offset:15488
    v_alignbit_b32 v92, v88, v88, 16
    v_alignbit_b32 v93, v89, v89, 16
    v_alignbit_b32 v94, v90, v90, 16
    v_alignbit_b32 v95, v91, v91, 16
    v_xor_b32 v92, 0x8000, v92
    v_xor_b32 v93, 0x8000, v93
    v_xor_b32 v94, 0x8000, v94
    v_xor_b32 v95, 0x8000, v95
    v_alignbit_b32 v100, v96, v96, 16
    v_alignbit_b32 v101, v97, v97, 16
    v_alignbit_b32 v102, v98, v98, 16
    v_alignbit_b32 v103, v99, v99, 16
    v_xor_b32 v100, 0x8000, v100
    v_xor_b32 v101, 0x8000, v101
    v_xor_b32 v102, 0x8000, v102
    v_xor_b32 v103, 0x8000, v103
    v_alignbit_b32 v108, v104, v104, 16
    v_alignbit_b32 v109, v105, v105, 16
    v_alignbit_b32 v110, v106, v106, 16
    v_alignbit_b32 v111, v107, v107, 16
    v_xor_b32 v108, 0x8000, v108
    v_xor_b32 v109, 0x8000, v109
    v_xor_b32 v110, 0x8000, v110
    v_xor_b32 v111, 0x8000, v111
    v_alignbit_b32 v116, v112, v112, 16
    v_alignbit_b32 v117, v113, v113, 16
    v_alignbit_b32 v118, v114, v114, 16
    v_alignbit_b32 v119, v115, v115, 16
    v_xor_b32 v116, 0x8000, v116
    v_xor_b32 v117, 0x8000, v117
    v_xor_b32 v118, 0x8000, v118
    v_xor_b32 v119, 0x8000, v119
    s_branch L_p1done
L_gate:
    s_mul_i32 s60, s59, 1536
    s_sub_u32 s60, s60, 4096
    s_ashr_i32 s61, s60, 31
    s_add_u32 s60, s60, s30
    s_addc_u32 s61, s61, s31
    v_min_u32 v4, 11, v1
    v_lshlrev_b32 v4, 7, v4
    v_mov_b32 v5, s61
    v_add_co_u32 v4, vcc, s60, v4
    s_nop 1
    v_addc_co_u32 v5, vcc, 0, v5, vcc
    global_load_dword v64, v[4:5], off
    v_lshlrev_b32 v24, 4, v1
    v_xor_b32 v25, 64, v24
    v_xor_b32 v26, 128, v24
    v_xor_b32 v27, 192, v24
    v_lshlrev_b32 v4, 2, v3
    v_xor_b32 v4, v4, v2
    v_mul_u32_u24 v5, 81920, v3
    v_lshl_add_u32 v4, v4, 4, v5
    v_add_u32 v28, 1024, v4
    s_waitcnt lgkmcnt(0)
    s_mov_b32 s36, s4
    s_mov_b32 s37, s5
    s_mov_b32 s38, 2621440
    s_mov_b32 s39, 0x00020000
    s_add_u32 s60, s64, 0
    s_mul_i32 s67, s60, 1280
    s_mov_b32 s68, 86784
    s_mov_b32 s69, 119552
    s_mov_b32 s60, s67
    s_add_u32 m0, s68, 0
    s_nop 0
    buffer_load_dwordx4 v24, s[36:39], s60 offen  lds
    s_add_u32 s60, s60, 81920
    s_add_u32 m0, s68, 1024
    s_nop 0
    buffer_load_dwordx4 v25, s[36:39], s60 offen  lds
    s_add_u32 s60, s60, 81920
    s_add_u32 m0, s68, 2048
    s_nop 0
    buffer_load_dwordx4 v26, s[36:39], s60 offen  lds
    s_add_u32 s60, s60, 81920
    s_add_u32 m0, s68, 3072
    s_nop 0
    buffer_load_dwordx4 v27, s[36:39], s60 offen  lds
    s_add_u32 s60, s60, 81920
    s_add_u32 m0, s68, 4096
    s_nop 0
    buffer_load_dwordx4 v24, s[36:39], s60 offen  lds
    s_add_u32 s60, s60, 81920
    s_add_u32 m0, s68, 5120
    s_nop 0
    buffer_load_dwordx4 v25, s[36:39], s60 offen  lds
    s_add_u32 s60, s60, 81920
    s_add_u32 m0, s68, 6144
    s_nop 0
    buffer_load_dwordx4 v26, s[36:39], s60 offen  lds
    s_add_u32 s60, s60, 81920
    s_add_u32 m0, s68, 7168
    s_nop 0
    buffer_load_dwordx4 v27, s[36:39], s60 offen  lds
    s_add_u32 m0, s69, 0
    s_nop 0
    buffer_load_dwordx4 v28, s[36:39], s67 offen  lds
    s_add_u32 s67, s67, 327680
    s_add_u32 m0, s69, 1024
    s_nop 0
    s_nop 0
    buffer_load_dwordx4 v28, s[36:39], s67 offen  lds
    s_add_u32 s60, s64, 512
    s_mul_i32 s67, s60, 1280
    s_mov_b32 s68, 94976
    s_mov_b32 s69, 121600
    s_mov_b32 s60, s67
    s_add_u32 m0, s68, 0
    s_nop 0
    buffer_load_dwordx4 v24, s[36:39], s60 offen  lds
    s_add_u32 s60, s60, 81920
    s_add_u32 m0, s68, 1024
    s_nop 0
    buffer_load_dwordx4 v25, s[36:39], s60 offen  lds
    s_add_u32 s60, s60, 81920
    s_add_u32 m0, s68, 2048
    s_nop 0
    buffer_load_dwordx4 v26, s[36:39], s60 offen  lds
    s_add_u32 s60, s60, 81920
    s_add_u32 m0, s68, 3072
    s_nop 0
    buffer_load_dwordx4 v27, s[36:39], s60 offen  lds
    s_add_u32 s60, s60, 81920
    s_add_u32 m0, s68, 4096
    s_nop 0
    buffer_load_dwordx4 v24, s[36:39], s60 offen  lds
    s_add_u32 s60, s60, 81920
    s_add_u32 m0, s68, 5120
    s_nop 0
    buffer_load_dwordx4 v25, s[36:39], s60 offen  lds
    s_add_u32 s60, s60, 81920
    s_add_u32 m0, s68, 6144
    s_nop 0
    buffer_load_dwordx4 v26, s[36:39], s60 offen  lds
    s_add_u32 s60, s60, 81920
    s_add_u32 m0, s68, 7168
    s_nop 0
    buffer_load_dwordx4 v27, s[36:39], s60 offen  lds
    s_add_u32 m0, s69, 0
    s_nop 0
    buffer_load_dwordx4 v28, s[36:39], s67 offen  lds
    s_add_u32 s67, s67, 327680
    s_add_u32 m0, s69, 1024
    s_nop 0
    buffer_load_dwordx4 v28, s[36:39], s67 offen  lds
    s_waitcnt lgkmcnt(0)
    s_load_dword s56, s[28:29], 0
    s_mov_b32 s32, s28
    s_mov_b32 s33, s29
    s_mov_b32 s34, 268435456
    s_mov_b32 s35, 0x00020000
    s_mov_b32 s52, s26
    s_mov_b32 s53, s27
    s_mov_b32 s54, 2621440
    s_mov_b32 s55, 0x00020000
    s_mov_b32 s40, s20
    s_mov_b32 s41, s21
    s_mov_b32 s42, 1314816
    s_mov_b32 s43, 0x00020000
    s_mov_b32 s44, s22
    s_mov_b32 s45, s23
    s_mov_b32 s46, 1314816
    s_mov_b32 s47, 0x00020000
    s_mov_b32 s48, s24
    s_mov_b32 s49, s25
    s_mov_b32 s50, 1280
    s_mov_b32 s51, 0x00020000
    v_and_b32 v4, 7, v1
    v_lshlrev_b32 v11, 4, v4
    v_lshrrev_b32_e64 v5, 3, v1
    s_sub_u32 s60, 0, s3
    s_or_b32 s7, s60, 1
    v_lshl_add_u32 v104, v5, 5, s90
    v_mul_lo_u32 v104, v104, s7
    s_and_b32 s61, s60, 256
    v_add_u32_e64 v105, s61, v104
    v_and_b32 v104, 2047, v104
    v_mul_u32_u24 v104, 642, v104
    v_mul_u32_u24 v105, 642, v105
    s_lshl_b32 s61, s88, 3
    s_mul_i32 s61, s61, s7
    s_and_b32 s62, s60, 297
    s_add_u32 s61, s61, s62
    s_lshl_b32 s61, s61, 1
    s_mul_i32 s62, s7, 80
    v_and_b32_e64 v6, 4, v1
    v_mul_lo_u32 v6, v6, s62
    v_and_b32_e64 v7, 3, v1
    v_lshl_add_u32 v6, v7, 4, v6
    v_add3_u32 v104, v104, v6, s61
    v_add3_u32 v105, v105, v6, s61
    v_and_b32 v104, -16, v104
    v_and_b32 v105, -16, v105
    s_and_b32 s8, s60, 1150464
    s_mul_i32 s9, s7, 164352
    v_and_b32 v6, 3, v5
    v_lshlrev_b32 v6, 3, v6
    v_lshrrev_b32 v7, 2, v5
    s_lshl_b32 s60, s65, 1
    v_add3_u32 v6, v6, v7, s60
    v_and_b32 v7, 3, v6
    v_lshlrev_b32 v7, 2, v7
    v_xor_b32 v4, v4, v7
    v_lshlrev_b32 v4, 4, v4
    v_lshl_add_u32 v8, v6, 10, v4
    v_add_u32 v8, 86784, v8
    v_xor_b32 v9, 128, v8
    v_lshl_add_u32 v6, v6, 8, v4
    v_add_u32 v6, 119552, v6
    v_xor_b32 v7, 128, v6
    v_lshlrev_b32_e64 v10, 2, v5
    v_add_u32 v10, 156416, v10
    v_lshrrev_b32_e64 v4, 2, v2
    v_lshl_add_u32 v110, v3, 3, v4
    v_and_b32 v5, 3, v1
    v_lshlrev_b32 v5, 3, v5
    v_lshl_add_u32 v5, v4, 6, v5
    v_lshl_add_u32 v106, v110, 10, v5
    v_lshl_add_u32 v110, v110, 8, v5
    v_add_u32 v106, 86784, v106
    v_add_u32 v110, 119552, v110
    v_lshlrev_b32_e64 v114, 6, v2
    v_lshl_add_u32 v114, v3, 4, v114
    s_mul_i32 s10, s65, 10240
    s_mul_i32 s60, s64, 41088
    s_add_u32 s10, s10, s60
    s_add_u32 s10, s10, 9437184
    v_xor_b32 v107, 64, v106
    v_xor_b32_e64 v111, 64, v110
    v_xor_b32 v108, 128, v106
    v_xor_b32 v112, 128, v110
    v_xor_b32 v109, 192, v106
    v_xor_b32 v113, 192, v110
    s_and_b32 s60, s59, 7
    s_lshl_b32 s60, s60, 8
    s_add_u32 s60, s60, s90
    v_lshrrev_b32 v4, 3, v1
    v_lshlrev_b32 v4, 5, v4
    v_add_u32 v4, s60, v4
    v_mul_u32_u24 v4, 642, v4
    v_and_b32 v5, 7, v1
    v_min_u32 v5, 5, v5
    v_lshl_add_u32 v4, v5, 7, v4
    v_and_b32 v4, -4, v4
    s_mov_b32 m0, 127744
    s_nop 0
    buffer_load_dword v4, s[40:43], 0 offen lds
    buffer_load_dword v4, s[44:47], 0 offen lds
    s_add_u32 s60, s30, 4294963200
    s_addc_u32 s61, s31, -1
    v_lshlrev_b32 v24, 4, v1
    v_mov_b32_e64 v25, s61
    v_add_co_u32 v24, vcc, s60, v24
    s_nop 1
    v_addc_co_u32 v25, vcc, 0, v25, vcc
    s_mov_b32 m0, 144128
    s_nop 0
    global_load_lds_dwordx4 v[24:25], off offset:0
    global_load_lds_dwordx4 v[24:25], off offset:1024
    global_load_lds_dwordx4 v[24:25], off offset:2048
    global_load_lds_dwordx4 v[24:25], off offset:3072
    s_mov_b32 m0, 148224
    v_add_co_u32 v24, vcc, 0x1000, v24
    s_nop 1
    v_addc_co_u32 v25, vcc, 0, v25, vcc
    global_load_lds_dwordx4 v[24:25], off offset:0
    global_load_lds_dwordx4 v[24:25], off offset:1024
    global_load_lds_dwordx4 v[24:25], off offset:2048
    global_load_lds_dwordx4 v[24:25], off offset:3072
    s_mov_b32 m0, 152320
    v_add_co_u32 v24, vcc, 0x1000, v24
    s_nop 1
    v_addc_co_u32 v25, vcc, 0, v25, vcc
    global_load_lds_dwordx4 v[24:25], off offset:0
    global_load_lds_dwordx4 v[24:25], off offset:1024
    global_load_lds_dwordx4 v[24:25], off offset:2048
    global_load_lds_dwordx4 v[24:25], off offset:3072
    s_waitcnt vmcnt(14)
    s_setprio 3
    s_mov_b64 exec, 1
    v_mov_b32 v4, 156480
    v_mov_b32 v5, 1
    ds_add_u32 v4, v5
    s_mov_b64 exec, -1
    s_mov_b64 exec, 1
    v_mov_b32 v4, 156480
    s_mov_b32 s61, 0
L_sy12:
    ds_read_b32 v5, v4
    s_add_u32 s61, s61, 1
    s_waitcnt lgkmcnt(0)
    v_readfirstlane_b32 s60, v5
    s_cmp_ge_u32 s61, 1048576
    s_cbranch_scc1 L_syd13
    s_cmp_lt_u32 s60, 2
    s_cbranch_scc1 L_sy12
L_syd13:
    s_mov_b64 exec, -1
    s_add_u32 s56, s56, 2654435769
    s_cmp_lg_u32 s65, 0
    s_cbranch_scc1 L_tr1
    ds_read_b64_tr_b16 v[64:65], v106 offset:0
    ds_read_b64_tr_b16 v[66:67], v106 offset:4096
    ds_read_b64_tr_b16 v[68:69], v106 offset:32
    ds_read_b64_tr_b16 v[70:71], v106 offset:4128
    ds_read_b64_tr_b16 v[72:73], v107 offset:0
    ds_read_b64_tr_b16 v[74:75], v107 offset:4096
    ds_read_b64_tr_b16 v[76:77], v107 offset:32
    ds_read_b64_tr_b16 v[78:79], v107 offset:4128
    ds_read_b64_tr_b16 v[80:81], v108 offset:0
    ds_read_b64_tr_b16 v[82:83], v108 offset:4096
    ds_read_b64_tr_b16 v[84:85], v108 offset:32
    ds_read_b64_tr_b16 v[86:87], v108 offset:4128
    s_waitcnt lgkmcnt(10)
    buffer_store_dwordx4 v[64:67], v114, s[32:35], s10 offen sc1
    s_add_u32 s10, s10, 1024
    ds_read_b64_tr_b16 v[88:89], v109 offset:0
    ds_read_b64_tr_b16 v[90:91], v109 offset:4096
    s_waitcnt lgkmcnt(10)
    buffer_store_dwordx4 v[68:71], v114, s[32:35], s10 offen sc1
    s_add_u32 s10, s10, 1024
    ds_read_b64_tr_b16 v[92:93], v109 offset:32
    ds_read_b64_tr_b16 v[94:95], v109 offset:4128
    s_waitcnt lgkmcnt(10)
    buffer_store_dwordx4 v[72:75], v114, s[32:35], s10 offen sc1
    s_add_u32 s10, s10, 1024
    ds_read_b64_tr_b16 v[96:97], v106 offset:256
    ds_read_b64_tr_b16 v[98:99], v106 offset:4352
    s_waitcnt lgkmcnt(10)
    buffer_store_dwordx4 v[76:79], v114, s[32:35], s10 offen sc1
    s_add_u32 s10, s10, 1024
    ds_read_b64_tr_b16 v[100:101], v106 offset:288
    ds_read_b64_tr_b16 v[102:103], v106 offset:4384
    s_waitcnt lgkmcnt(10)
    buffer_store_dwordx4 v[80:83], v114, s[32:35], s10 offen sc1
    s_add_u32 s10, s10, 1024
    s_branch L_trd
L_tr1:
    s_cmp_lg_u32 s65, 1
    s_cbranch_scc1 L_tr2
    ds_read_b64_tr_b16 v[64:65], v107 offset:256
    ds_read_b64_tr_b16 v[66:67], v107 offset:4352
    ds_read_b64_tr_b16 v[68:69], v107 offset:288
    ds_read_b64_tr_b16 v[70:71], v107 offset:4384
    ds_read_b64_tr_b16 v[72:73], v108 offset:256
    ds_read_b64_tr_b16 v[74:75], v108 offset:4352
    ds_read_b64_tr_b16 v[76:77], v108 offset:288
    ds_read_b64_tr_b16 v[78:79], v108 offset:4384
    ds_read_b64_tr_b16 v[80:81], v109 offset:256
    ds_read_b64_tr_b16 v[82:83], v109 offset:4352
    ds_read_b64_tr_b16 v[84:85], v109 offset:288
    ds_read_b64_tr_b16 v[86:87], v109 offset:4384
    s_waitcnt lgkmcnt(10)
    buffer_store_dwordx4 v[64:67], v114, s[32:35], s10 offen sc1
    s_add_u32 s10, s10, 1024
    ds_read_b64_tr_b16 v[88:89], v106 offset:512
    ds_read_b64_tr_b16 v[90:91], v106 offset:4608
    s_waitcnt lgkmcnt(10)
    buffer_store_dwordx4 v[68:71], v114, s[32:35], s10 offen sc1
    s_add_u32 s10, s10, 1024
    ds_read_b64_tr_b16 v[92:93], v106 offset:544
    ds_read_b64_tr_b16 v[94:95], v106 offset:4640
    s_waitcnt lgkmcnt(10)
    buffer_store_dwordx4 v[72:75], v114, s[32:35], s10 offen sc1
    s_add_u32 s10, s10, 1024
    ds_read_b64_tr_b16 v[96:97], v107 offset:512
    ds_read_b64_tr_b16 v[98:99], v107 offset:4608
    s_waitcnt lgkmcnt(10)
    buffer_store_dwordx4 v[76:79], v114, s[32:35], s10 offen sc1
    s_add_u32 s10, s10, 1024
    ds_read_b64_tr_b16 v[100:101], v107 offset:544
    ds_read_b64_tr_b16 v[102:103], v107 offset:4640
    s_waitcnt lgkmcnt(10)
    buffer_store_dwordx4 v[80:83], v114, s[32:35], s10 offen sc1
    s_add_u32 s10, s10, 1024
    s_branch L_trd
L_tr2:
    s_cmp_lg_u32 s65, 2
    s_cbranch_scc1 L_tr3
    ds_read_b64_tr_b16 v[64:65], v108 offset:512
    ds_read_b64_tr_b16 v[66:67], v108 offset:4608
    ds_read_b64_tr_b16 v[68:69], v108 offset:544
    ds_read_b64_tr_b16 v[70:71], v108 offset:4640
    ds_read_b64_tr_b16 v[72:73], v109 offset:512
    ds_read_b64_tr_b16 v[74:75], v109 offset:4608
    ds_read_b64_tr_b16 v[76:77], v109 offset:544
    ds_read_b64_tr_b16 v[78:79], v109 offset:4640
    ds_read_b64_tr_b16 v[80:81], v106 offset:768
    ds_read_b64_tr_b16 v[82:83], v106 offset:4864
    ds_read_b64_tr_b16 v[84:85], v106 offset:800
    ds_read_b64_tr_b16 v[86:87], v106 offset:4896
    s_waitcnt lgkmcnt(10)
    buffer_store_dwordx4 v[64:67], v114, s[32:35], s10 offen sc1
    s_add_u32 s10, s10, 1024
    ds_read_b64_tr_b16 v[88:89], v107 offset:768
    ds_read_b64_tr_b16 v[90:91], v107 offset:4864
    s_waitcnt lgkmcnt(10)
    buffer_store_dwordx4 v[68:71], v114, s[32:35], s10 offen sc1
    s_add_u32 s10, s10, 1024
    ds_read_b64_tr_b16 v[92:93], v107 offset:800
    ds_read_b64_tr_b16 v[94:95], v107 offset:4896
    s_waitcnt lgkmcnt(10)
    buffer_store_dwordx4 v[72:75], v114, s[32:35], s10 offen sc1
    s_add_u32 s10, s10, 1024
    ds_read_b64_tr_b16 v[96:97], v108 offset:768
    ds_read_b64_tr_b16 v[98:99], v108 offset:4864
    s_waitcnt lgkmcnt(10)
    buffer_store_dwordx4 v[76:79], v114, s[32:35], s10 offen sc1
    s_add_u32 s10, s10, 1024
    ds_read_b64_tr_b16 v[100:101], v108 offset:800
    ds_read_b64_tr_b16 v[102:103], v108 offset:4896
    s_waitcnt lgkmcnt(10)
    buffer_store_dwordx4 v[80:83], v114, s[32:35], s10 offen sc1
    s_add_u32 s10, s10, 1024
    s_branch L_trd
L_tr3:
    ds_read_b64_tr_b16 v[64:65], v109 offset:768
    ds_read_b64_tr_b16 v[66:67], v109 offset:4864
    ds_read_b64_tr_b16 v[68:69], v109 offset:800
    ds_read_b64_tr_b16 v[70:71], v109 offset:4896
    ds_read_b64_tr_b16 v[72:73], v110 offset:0
    ds_read_b64_tr_b16 v[74:75], v110 offset:1024
    ds_read_b64_tr_b16 v[76:77], v110 offset:32
    ds_read_b64_tr_b16 v[78:79], v110 offset:1056
    ds_read_b64_tr_b16 v[80:81], v111 offset:0
    ds_read_b64_tr_b16 v[82:83], v111 offset:1024
    ds_read_b64_tr_b16 v[84:85], v111 offset:32
    ds_read_b64_tr_b16 v[86:87], v111 offset:1056
    s_waitcnt lgkmcnt(10)
    buffer_store_dwordx4 v[64:67], v114, s[32:35], s10 offen sc1
    s_add_u32 s10, s10, 1024
    ds_read_b64_tr_b16 v[88:89], v112 offset:0
    ds_read_b64_tr_b16 v[90:91], v112 offset:1024
    s_waitcnt lgkmcnt(10)
    buffer_store_dwordx4 v[68:71], v114, s[32:35], s10 offen sc1
    s_add_u32 s10, s10, 1024
    ds_read_b64_tr_b16 v[92:93], v112 offset:32
    ds_read_b64_tr_b16 v[94:95], v112 offset:1056
    s_waitcnt lgkmcnt(10)
    buffer_store_dwordx4 v[72:75], v114, s[32:35], s10 offen sc1
    s_add_u32 s10, s10, 1024
    ds_read_b64_tr_b16 v[96:97], v113 offset:0
    ds_read_b64_tr_b16 v[98:99], v113 offset:1024
    s_waitcnt lgkmcnt(10)
    buffer_store_dwordx4 v[76:79], v114, s[32:35], s10 offen sc1
    s_add_u32 s10, s10, 1024
    ds_read_b64_tr_b16 v[100:101], v113 offset:32
    ds_read_b64_tr_b16 v[102:103], v113 offset:1056
    s_waitcnt lgkmcnt(10)
    buffer_store_dwordx4 v[80:83], v114, s[32:35], s10 offen sc1
    s_add_u32 s10, s10, 1024
L_trd:
    s_waitcnt lgkmcnt(8)
    buffer_store_dwordx4 v[84:87], v114, s[32:35], s10 offen sc1
    s_add_u32 s10, s10, 1024
    s_waitcnt lgkmcnt(6)
    buffer_store_dwordx4 v[88:91], v114, s[32:35], s10 offen sc1
    s_add_u32 s10, s10, 1024
    s_waitcnt lgkmcnt(4)
    buffer_store_dwordx4 v[92:95], v114, s[32:35], s10 offen sc1
    s_add_u32 s10, s10, 1024
    s_waitcnt lgkmcnt(2)
    buffer_store_dwordx4 v[96:99], v114, s[32:35], s10 offen sc1
    s_add_u32 s10, s10, 1024
    s_waitcnt lgkmcnt(0)
    buffer_store_dwordx4 v[100:103], v114, s[32:35], s10 offen sc1
    s_add_u32 s10, s10, 1024
    s_lshr_b32 s60, s64, 0
    s_lshl_b32 s60, s60, 2
    s_add_u32 s60, s60, s65
    s_mul_i32 s60, s60, 576
    s_add_u32 s60, s60, 19922944
    s_and_b32 s61, s64, 0
    s_cbranch_scc1 L_noza
    v_mul_u32_u24 v4, 128, v1
    v_mov_b32_e64 v5, s56
    s_mov_b64 exec, 15
    buffer_store_dword v5, v4, s[32:35], s60 offen sc1
    s_mov_b64 exec, -1
L_noza:
    s_mul_i32 s60, s65, 34816
    s_lshl_b32 s61, s64, 4
    s_add_u32 s60, s60, s61
    s_add_u32 s10, s60, 20971520
    s_mov_b32 m0, 127744
    s_nop 0
    buffer_load_dwordx4 v104, s[40:43], 0 offen lds
    s_mov_b32 m0, 135936
    s_nop 0
    buffer_load_dwordx4 v104, s[44:47], 0 offen lds
    s_mul_i32 s60, s9, 1
    s_add_u32 s60, s60, s8
    s_mov_b32 m0, 128768
    s_nop 0
    buffer_load_dwordx4 v105, s[40:43], s60 offen lds
    s_mov_b32 m0, 136960
    s_nop 0
    buffer_load_dwordx4 v105, s[44:47], s60 offen lds
    s_mul_i32 s60, s9, 2
    s_add_u32 s60, s60, s8
    s_mov_b32 m0, 129792
    s_nop 0
    buffer_load_dwordx4 v105, s[40:43], s60 offen lds
    s_mov_b32 m0, 137984
    s_nop 0
    buffer_load_dwordx4 v105, s[44:47], s60 offen lds
    s_mul_i32 s60, s9, 3
    s_add_u32 s60, s60, s8
    s_mov_b32 m0, 130816
    s_nop 0
    buffer_load_dwordx4 v105, s[40:43], s60 offen lds
    s_mov_b32 m0, 139008
    s_nop 0
    buffer_load_dwordx4 v105, s[44:47], s60 offen lds
    s_mul_i32 s60, s9, 4
    s_add_u32 s60, s60, s8
    s_mov_b32 m0, 131840
    s_nop 0
    buffer_load_dwordx4 v105, s[40:43], s60 offen lds
    s_mov_b32 m0, 140032
    s_nop 0
    buffer_load_dwordx4 v105, s[44:47], s60 offen lds
    s_mul_i32 s60, s9, 5
    s_add_u32 s60, s60, s8
    s_mov_b32 m0, 132864
    s_nop 0
    buffer_load_dwordx4 v105, s[40:43], s60 offen lds
    s_mov_b32 m0, 141056
    s_nop 0
    buffer_load_dwordx4 v105, s[44:47], s60 offen lds
    s_mul_i32 s60, s9, 6
    s_add_u32 s60, s60, s8
    s_mov_b32 m0, 133888
    s_nop 0
    buffer_load_dwordx4 v105, s[40:43], s60 offen lds
    s_mov_b32 m0, 142080
    s_nop 0
    buffer_load_dwordx4 v105, s[44:47], s60 offen lds
    s_mul_i32 s60, s9, 7
    s_add_u32 s60, s60, s8
    s_mov_b32 m0, 134912
    s_nop 0
    buffer_load_dwordx4 v105, s[40:43], s60 offen lds
    s_mov_b32 m0, 143104
    s_nop 0
    buffer_load_dwordx4 v105, s[44:47], s60 offen lds
    s_waitcnt vmcnt(0)
    v_mul_u32_u24 v4, 1088, v1
    v_mov_b32 v5, s56
    s_mov_b32 exec_hi, 0x0
    buffer_store_dword v5, v4, s[32:35], s10 offen sc1
    s_mov_b64 exec, -1
    s_mov_b64 exec, 1
    v_mov_b32 v4, 156500
    v_mov_b32_e64 v5, 1
    ds_add_u32 v4, v5
    s_mov_b64 exec, -1
    s_setprio 2
    buffer_load_dwordx4 v[24:27], v11, s[48:51], 0 offen offset:0
    buffer_load_dwordx4 v[28:31], v11, s[48:51], 0 offen offset:128
    buffer_load_dwordx4 v[32:35], v11, s[48:51], 0 offen offset:256
    buffer_load_dwordx4 v[36:39], v11, s[48:51], 0 offen offset:384
    buffer_load_dwordx4 v[40:43], v11, s[48:51], 0 offen offset:512
    buffer_load_dwordx4 v[44:47], v11, s[48:51], 0 offen offset:640
    buffer_load_dwordx4 v[48:51], v11, s[48:51], 0 offen offset:768
    buffer_load_dwordx4 v[52:55], v11, s[48:51], 0 offen offset:896
    buffer_load_dwordx4 v[56:59], v11, s[48:51], 0 offen offset:1024
    buffer_load_dwordx4 v[60:63], v11, s[48:51], 0 offen offset:1152
    ds_read_b128 v[64:67], v8 offset:0
    ds_read_b128 v[68:71], v9 offset:0
    ds_read_b128 v[72:75], v8 offset:256
    ds_read_b128 v[76:79], v9 offset:256
    ds_read_b128 v[80:83], v8 offset:512
    ds_read_b128 v[84:87], v9 offset:512
    ds_read_b128 v[88:91], v8 offset:768
    ds_read_b128 v[92:95], v9 offset:768
    ds_read_b128 v[96:99], v6
    ds_read_b128 v[100:103], v7
    s_waitcnt vmcnt(0)
    v_mov_b32_e64 v4, 0
    s_waitcnt lgkmcnt(0)
    v_dot2_f32_bf16 v4, v64, v24, v4
    v_dot2_f32_bf16 v4, v65, v25, v4
    v_dot2_f32_bf16 v4, v66, v26, v4
    v_dot2_f32_bf16 v4, v67, v27, v4
    v_dot2_f32_bf16 v4, v68, v28, v4
    v_dot2_f32_bf16 v4, v69, v29, v4
    v_dot2_f32_bf16 v4, v70, v30, v4
    v_dot2_f32_bf16 v4, v71, v31, v4
    v_dot2_f32_bf16 v4, v72, v32, v4
    v_dot2_f32_bf16 v4, v73, v33, v4
    v_dot2_f32_bf16 v4, v74, v34, v4
    v_dot2_f32_bf16 v4, v75, v35, v4
    v_dot2_f32_bf16 v4, v76, v36, v4
    v_dot2_f32_bf16 v4, v77, v37, v4
    v_dot2_f32_bf16 v4, v78, v38, v4
    v_dot2_f32_bf16 v4, v79, v39, v4
    v_dot2_f32_bf16 v4, v80, v40, v4
    v_dot2_f32_bf16 v4, v81, v41, v4
    v_dot2_f32_bf16 v4, v82, v42, v4
    v_dot2_f32_bf16 v4, v83, v43, v4
    v_dot2_f32_bf16 v4, v84, v44, v4
    v_dot2_f32_bf16 v4, v85, v45, v4
    v_dot2_f32_bf16 v4, v86, v46, v4
    v_dot2_f32_bf16 v4, v87, v47, v4
    v_dot2_f32_bf16 v4, v88, v48, v4
    v_dot2_f32_bf16 v4, v89, v49, v4
    v_dot2_f32_bf16 v4, v90, v50, v4
    v_dot2_f32_bf16 v4, v91, v51, v4
    v_dot2_f32_bf16 v4, v92, v52, v4
    v_dot2_f32_bf16 v4, v93, v53, v4
    v_dot2_f32_bf16 v4, v94, v54, v4
    v_dot2_f32_bf16 v4, v95, v55, v4
    v_dot2_f32_bf16 v4, v96, v56, v4
    v_dot2_f32_bf16 v4, v97, v57, v4
    v_dot2_f32_bf16 v4, v98, v58, v4
    v_dot2_f32_bf16 v4, v99, v59, v4
    v_dot2_f32_bf16 v4, v100, v60, v4
    v_dot2_f32_bf16 v4, v101, v61, v4
    v_dot2_f32_bf16 v4, v102, v62, v4
    v_dot2_f32_bf16 v4, v103, v63, v4
    s_nop 2
    v_add_f32_dpp v4, v4, v4 quad_perm:[1,0,3,2] row_mask:0xf bank_mask:0xf
    s_nop 1
    v_add_f32_dpp v4, v4, v4 quad_perm:[2,3,0,1] row_mask:0xf bank_mask:0xf
    s_nop 1
    v_add_f32_dpp v4, v4, v4 row_half_mirror row_mask:0xf bank_mask:0xf
    v_cvt_pk_bf16_f32 v4, v4, v4
    v_lshlrev_b32 v4, 16, v4
    v_mul_f32 v4, 0xbfb8aa3b, v4
    v_exp_f32 v4, v4
    s_nop 0
    v_add_f32_e64 v4, 1.0, v4
    v_rcp_f32 v4, v4
    s_nop 0
    v_cvt_pk_bf16_f32 v4, v4, v4
    v_lshlrev_b32 v4, 16, v4
    v_sub_f32 v5, 1.0, v4
    v_cvt_pk_bf16_f32 v5, v5, v5
    v_lshlrev_b32 v5, 16, v5
    ds_write_b32 v10, v4
    ds_write_b32 v10, v5 offset:32
    s_waitcnt lgkmcnt(0)
    s_branch L_late
L_p1skip:
    s_waitcnt lgkmcnt(0)
    s_load_dword s56, s[28:29], 0
    s_mov_b32 s32, s28
    s_mov_b32 s33, s29
    s_mov_b32 s34, 268435456
    s_mov_b32 s35, 0x00020000
    s_mov_b32 s52, s26
    s_mov_b32 s53, s27
    s_mov_b32 s54, 2621440
    s_mov_b32 s55, 0x00020000
    s_waitcnt vmcnt(0) lgkmcnt(0)
    s_add_u32 s56, s56, 2654435769
L_late:
    s_add_u32 s60, s88, s57
    s_lshl_b32 s60, s60, 3
    s_mul_i32 s61, s3, 320
    s_add_u32 s60, s60, s61
    v_lshrrev_b32 v6, 2, v2
    v_and_b32 v4, 1, v2
    v_lshl_add_u32 v6, v4, 2, v6
    v_and_b32_e64 v7, 2, v2
    v_mul_u32_u24 v4, 80, v7
    v_add3_u32 v12, v6, v4, s60
    s_lshl_b32 s60, s57, 3
    v_add_u32 v6, s60, v6
    s_sub_u32 s60, 0, s3
    v_xor_b32 v6, s60, v6
    s_and_b32 s61, s60, 24
    s_add_u32 s61, s61, s92
    v_add_u32 v6, s61, v6
    v_lshlrev_b32 v6, 1, v6
    v_lshl_add_u32 v6, v7, 5, v6
    v_lshl_add_u32 v6, v3, 8, v6
    v_add_u32 v20, 127744, v6
    s_add_u32 s60, s88, s57
    s_cmp_lt_u32 s60, 10
    s_cbranch_scc1 L_p2r14
    s_mov_b32 s16, 2048
    s_lshl_b32 s17, s90, 6
    s_add_u32 s18, s17, 4194304
    s_add_u32 s19, s17, 8388608
    v_and_b32 v4, 13, v2
    v_cmp_eq_u32 vcc, 0, v4
    v_mov_b32 v4, 480
    s_nop 0
    v_cndmask_b32 v12, v4, v12, vcc
    s_branch L_p2g15
L_p2r14:
    s_mov_b32 s16, 40960
    s_mul_i32 s17, s90, 1280
    s_lshl_b32 s61, s60, 7
    s_add_u32 s17, s17, s61
    s_lshl_b32 s61, s3, 6
    s_add_u32 s17, s17, s61
    s_add_u32 s18, s17, 1048576
    s_add_u32 s19, s17, 5242880
L_p2g15:
    s_lshl_b32 s60, s60, 4
    s_lshr_b32 s61, s90, 1
    s_add_u32 s60, s60, s61
    s_mul_i32 s6, s60, 1088
    v_mov_b32 v14, 0x35cccccd
    v_mov_b32 v4, 0x354ccccd
    v_cmp_eq_u32 vcc, 0, v12
    s_nop 1
    v_cndmask_b32_e64 v14, v14, v4, vcc
    v_cmp_eq_u32 vcc, 320, v12
    s_nop 1
    v_cndmask_b32 v14, v14, v4, vcc
    v_cmp_ne_u32 vcc, 480, v12
    s_nop 1
    v_cndmask_b32 v14, 0, v14, vcc
    s_lshl_b32 s60, s3, 31
    v_xor_b32 v15, s60, v14
    v_lshlrev_b32_e64 v16, 4, v1
    s_add_u32 s6, s6, 17825792
    v_add_u32_e64 v16, s6, v16
    v_lshrrev_b32 v4, 2, v1
    s_lshl_b32 s60, s16, 2
    v_mul_lo_u32 v4, v4, s60
    v_and_b32_e64 v5, 3, v1
    v_lshl_add_u32 v17, v5, 4, v4
    v_mul_lo_u32 v4, v2, s60
    v_lshl_add_u32 v19, v3, 4, v4
    s_lshl_b32 s11, s57, 12
    s_add_u32 s11, s11, 144128
    v_lshrrev_b32 v4, 3, v2
    v_lshl_add_u32 v4, v3, 1, v4
    v_lshlrev_b32_e64 v4, 6, v4
    v_lshl_add_u32 v4, v5, 4, v4
    v_lshlrev_b32 v5, 1, v2
    v_and_b32 v5, 8, v5
    v_add3_u32 v18, v4, v5, s11
    v_lshlrev_b32 v232, 4, v1
    v_xor_b32 v233, 16, v232
    v_xor_b32 v234, 32, v232
    v_xor_b32 v235, 48, v232
    v_lshlrev_b32 v4, 0, v3
    v_xor_b32 v4, v4, v2
    v_mul_u32_u24 v5, 1280, v3
    v_lshl_add_u32 v4, v4, 4, v5
    v_add_u32 v236, 1024, v4
    v_lshrrev_b32 v4, 1, v2
    v_and_b32 v5, 3, v4
    v_lshlrev_b32_e64 v5, 3, v5
    v_lshrrev_b32 v4, 2, v4
    s_lshl_b32 s60, s65, 1
    v_add3_u32 v4, v4, v5, s60
    v_lshlrev_b32 v4, 6, v4
    v_add_u32 v4, s64, v4
    v_cvt_f32_u32_e64 v8, v4
    v_mul_f32 v8, 0x3a000000, v8
    v_and_b32_e64 v4, 1, v2
    v_cmp_eq_u32 s[12:13], 1, v4
    v_cvt_f32_u32_e64 v10, v4
    v_mul_f32 v4, 0xbe800000, v10
    v_cvt_f32_u32 v5, v3
    v_add_f32 v5, v5, v5
    v_fma_f32 v9, v8, v5, v4
    v_fma_f32 v243, v10, -2.0, 1.0
    v_fmamk_f32 v4, v8, 0x00000000, v9
    v_sin_f32_e64 v5, v4
    v_cos_f32 v4, v4
    s_nop 0
    v_cvt_pk_bf16_f32 v200, v4, -v5
    v_fmamk_f32 v4, v8, 0x3f800000, v9
    v_sin_f32_e64 v5, v4
    v_cos_f32 v4, v4
    s_nop 0
    v_cvt_pk_bf16_f32 v201, v4, -v5
    v_fmamk_f32 v4, v8, 0x41000000, v9
    v_sin_f32_e64 v5, v4
    v_cos_f32 v4, v4
    s_nop 0
    v_cvt_pk_bf16_f32 v202, v4, -v5
    v_fmamk_f32 v4, v8, 0x41100000, v9
    v_sin_f32_e64 v5, v4
    v_cos_f32 v4, v4
    s_nop 0
    v_cvt_pk_bf16_f32 v203, v4, -v5
    v_fmamk_f32 v4, v8, 0x41800000, v9
    v_sin_f32_e64 v5, v4
    v_cos_f32 v4, v4
    s_nop 0
    v_cvt_pk_bf16_f32 v204, v4, -v5
    v_fmamk_f32 v4, v8, 0x41880000, v9
    v_sin_f32_e64 v5, v4
    v_cos_f32 v4, v4
    s_nop 0
    v_cvt_pk_bf16_f32 v205, v4, -v5
    v_fmamk_f32 v4, v8, 0x41c00000, v9
    v_sin_f32_e64 v5, v4
    v_cos_f32 v4, v4
    s_nop 0
    v_cvt_pk_bf16_f32 v206, v4, -v5
    v_fmamk_f32 v4, v8, 0x41c80000, v9
    v_sin_f32_e64 v5, v4
    v_cos_f32 v4, v4
    s_nop 0
    v_cvt_pk_bf16_f32 v207, v4, -v5
    s_lshl_b32 s60, s57, 3
    v_lshrrev_b32 v4, 1, v2
    v_add_u32_e64 v4, s60, v4
    v_sub_u32 v5, 160, v4
    v_cndmask_b32 v4, v4, v5, s[12:13]
    v_cvt_f32_u32 v6, v4
    v_lshlrev_b32 v8, 2, v3
    v_add_u32 v8, 86784, v8
    v_lshl_add_u32 v240, v4, 4, v8
    v_mul_f32 v7, 0xbe800000, v10
    v_cvt_i32_f32 v9, v243
    v_lshlrev_b32 v9, 9, v9
    v_fmamk_f32 v4, v6, 0x3acccccd, v7
    v_cos_f32 v208, v4
    v_sin_f32 v209, v4
    v_fmamk_f32 v4, v6, 0x3b4ccccd, v7
    v_cos_f32 v210, v4
    v_sin_f32 v211, v4
    v_fmamk_f32 v4, v6, 0x3b99999a, v7
    v_cos_f32 v212, v4
    v_sin_f32 v213, v4
    v_fmamk_f32 v6, v243, 0x42000000, v6
    v_add_u32_e64 v241, v240, v9
    v_fmamk_f32 v4, v6, 0x3acccccd, v7
    v_cos_f32 v214, v4
    v_sin_f32 v215, v4
    v_fmamk_f32 v4, v6, 0x3b4ccccd, v7
    v_cos_f32 v216, v4
    v_sin_f32 v217, v4
    v_fmamk_f32 v4, v6, 0x3b99999a, v7
    v_cos_f32 v218, v4
    v_sin_f32 v219, v4
    v_fmamk_f32 v6, v243, 0x42000000, v6
    v_add_u32_e64 v242, v241, v9
    s_cmp_lt_u32 s57, 2
    s_cbranch_scc1 L_u1016
    v_mov_b32 v6, 0x42a00000
    v_add_u32 v242, 1280, v8
L_u1016:
    v_fmamk_f32 v4, v6, 0x3acccccd, v7
    v_cos_f32 v220, v4
    v_sin_f32 v221, v4
    v_fmamk_f32 v4, v6, 0x3b4ccccd, v7
    v_cos_f32 v222, v4
    v_sin_f32 v223, v4
    v_fmamk_f32 v4, v6, 0x3b99999a, v7
    v_cos_f32_e64 v224, v4
    v_sin_f32 v225, v4
    s_lshr_b32 s60, s64, 0
    s_lshl_b32 s60, s60, 2
    s_add_u32 s60, s60, s57
    s_mul_i32 s60, s60, 576
    s_add_u32 s24, s60, 18874368
    s_add_u32 s25, s60, 19922944
    v_lshlrev_b32 v251, 6, v1
    v_lshrrev_b32 v4, 3, v2
    v_lshl_add_u32 v4, v3, 1, v4
    v_and_b32 v5, 3, v4
    v_xor_b32 v5, s57, v5
    v_lshlrev_b32 v5, 4, v5
    v_lshlrev_b32 v6, 1, v2
    v_and_b32 v6, 8, v6
    v_and_b32 v7, 3, v1
    v_lshl_add_u32 v5, v7, 6, v5
    v_add_u32_e64 v5, v5, v6
    v_lshl_add_u32 v7, v4, 10, v5
    v_add_u32 v244, 86784, v7
    v_lshl_add_u32 v7, v4, 8, v5
    v_add_u32 v248, 119552, v7
    v_lshl_add_u32 v4, v4, 4, v6
    v_add_u32 v245, 140032, v4
    v_lshlrev_b32_e64 v4, 4, v1
    v_add_u32 v247, 127744, v4
    s_mul_i32 s60, s57, 3072
    v_add_u32 v246, s60, v247
    v_lshrrev_b32 v6, 1, v3
    v_and_b32 v7, 1, v3
    v_and_b32 v8, 3, v1
    v_lshrrev_b32 v9, 2, v2
    v_lshlrev_b32 v10, 5, v6
    v_lshl_add_u32 v10, v8, 3, v10
    v_add_u32 v10, v10, v9
    v_lshlrev_b32 v10, 4, v10
    v_lshl_add_u32 v10, v7, 3, v10
    s_lshl_b32 s60, s57, 10
    s_add_u32 s60, s60, 86784
    v_add_u32 v237, s60, v10
    v_lshl_add_u32 v10, v7, 2, v8
    v_lshlrev_b32_e64 v10, 2, v10
    v_add_u32 v239, 156416, v10
    v_lshl_add_u32 v8, v8, 3, v7
    v_mul_u32_u24 v8, 81920, v8
    v_lshlrev_b32_e64 v6, 6, v6
    v_lshl_add_u32 v6, v9, 4, v6
    v_add_u32_e64 v238, v8, v6
    s_mul_i32 s62, s57, 3072
    s_add_u32 s62, s62, 12288
    s_add_u32 s60, s30, s62
    s_addc_u32 s61, s31, 0
    v_lshlrev_b32 v226, 4, v1
    v_mov_b32 v227, s61
    v_add_co_u32 v226, vcc, s60, v226
    s_nop 1
    v_addc_co_u32 v227, vcc, 0, v227, vcc
    s_mov_b32 s61, 12288
    s_cmp_eq_u32 s57, 3
    s_cselect_b32 s60, 9216, s61
    v_add_co_u32 v228, vcc, 12288, v226
    s_nop 1
    v_addc_co_u32 v229, vcc, 0, v227, vcc
    v_add_co_u32 v230, vcc, s60, v228
    s_nop 1
    v_addc_co_u32 v231, vcc, 0, v229, vcc
L_p1done:
    s_cmp_eq_u32 s91, 0
    s_cbranch_scc1 L_p2flag
    s_waitcnt lgkmcnt(0)
    v_mul_f32 v24, v24, v14
    v_mul_f32 v25, v25, v15
    v_mul_f32 v26, v26, v14
    v_mul_f32 v27, v27, v15
    v_mul_f32 v28, v28, v14
    v_mul_f32 v29, v29, v15
    v_mul_f32 v30, v30, v14
    v_mul_f32 v31, v31, v15
    v_mul_f32 v32, v32, v14
    v_mul_f32 v33, v33, v15
    v_mul_f32 v34, v34, v14
    v_mul_f32 v35, v35, v15
    v_mul_f32 v36, v36, v14
    v_mul_f32 v37, v37, v15
    v_mul_f32 v38, v38, v14
    v_mul_f32 v39, v39, v15
    v_mul_f32 v40, v40, v14
    v_mul_f32 v41, v41, v15
    v_mul_f32 v42, v42, v14
    v_mul_f32 v43, v43, v15
    v_mul_f32 v44, v44, v14
    v_mul_f32 v45, v45, v15
    v_mul_f32 v46, v46, v14
    v_mul_f32 v47, v47, v15
    v_mul_f32 v48, v48, v14
    v_mul_f32 v49, v49, v15
    v_mul_f32 v50, v50, v14
    v_mul_f32 v51, v51, v15
    v_mul_f32 v52, v52, v14
    v_mul_f32 v53, v53, v15
    v_mul_f32_e64 v54, v54, v14
    v_mul_f32 v55, v55, v15
    s_mov_b64 exec, 1
    v_mov_b32 v4, 156516
    s_mov_b32 s61, 0
L_sy17:
    s_sleep 1
    ds_read_b32 v5, v4
    s_add_u32 s61, s61, 1
    s_waitcnt lgkmcnt(0)
    v_readfirstlane_b32 s60, v5
    s_cmp_ge_u32 s61, 1048576
    s_cbranch_scc1 L_syd18
    s_cmp_lt_u32 s60, s89
    s_cbranch_scc1 L_sy17
L_syd18:
    s_mov_b64 exec, -1
    s_mov_b32 s61, 0
L_po19:
    v_mov_b32_e64 v4, 0
    buffer_atomic_or v4, v16, s[32:35], 0 offen sc0 sc1
    s_add_u32 s61, s61, 1
    s_waitcnt vmcnt(0)
    v_xor_b32_e64 v4, s56, v4
    v_cmp_ne_u32 vcc, 0, v4
    s_cmp_ge_u32 s61, 65536
    s_cbranch_scc1 L_pod20
    s_cbranch_vccz L_pod20
    s_mov_b64 exec, vcc
    s_sleep 2
    s_branch L_po19
L_pod20:
    s_mov_b64 exec, -1
    s_setprio 3
    s_add_u32 m0, s11, 0
    s_nop 0
    buffer_load_dwordx4 v17, s[32:35], s18 offen sc1 lds
    s_add_u32 s18, s18, s16
    s_add_u32 m0, s11, 1024
    s_nop 0
    buffer_load_dwordx4 v17, s[32:35], s18 offen sc1 lds
    s_add_u32 s18, s18, s16
    s_add_u32 m0, s11, 2048
    s_nop 0
    buffer_load_dwordx4 v17, s[32:35], s18 offen sc1 lds
    s_add_u32 s18, s18, s16
    s_add_u32 m0, s11, 3072
    s_nop 0
    buffer_load_dwordx4 v17, s[32:35], s18 offen sc1 lds
    s_waitcnt vmcnt(3)
    ds_read_b64_tr_b16 v[120:121], v18 offset:0
    ds_read_b64_tr_b16 v[122:123], v18 offset:512
    s_waitcnt vmcnt(2)
    ds_read_b64_tr_b16 v[124:125], v18 offset:1024
    ds_read_b64_tr_b16 v[126:127], v18 offset:1536
    s_waitcnt vmcnt(1)
    ds_read_b64_tr_b16 v[128:129], v18 offset:2048
    ds_read_b64_tr_b16 v[130:131], v18 offset:2560
    s_waitcnt vmcnt(0)
    ds_read_b64_tr_b16 v[132:133], v18 offset:3072
    ds_read_b64_tr_b16 v[134:135], v18 offset:3584
    s_waitcnt lgkmcnt(6)
    v_mfma_f32_16x16x32_bf16 v[136:139], v[56:59], v[120:123], 0
    s_waitcnt lgkmcnt(4)
    v_mfma_f32_16x16x32_bf16 v[144:147], v[64:67], v[124:127], 0
    s_waitcnt lgkmcnt(2)
    v_mfma_f32_16x16x32_bf16 v[152:155], v[72:75], v[128:131], 0
    s_waitcnt lgkmcnt(0)
    v_mfma_f32_16x16x32_bf16 v[160:163], v[80:83], v[132:135], 0
    v_mfma_f32_16x16x32_bf16 v[140:143], v[60:63], v[120:123], 0
    v_mfma_f32_16x16x32_bf16 v[148:151], v[68:71], v[124:127], 0
    v_mfma_f32_16x16x32_bf16 v[156:159], v[76:79], v[128:131], 0
    v_mfma_f32_16x16x32_bf16 v[164:167], v[84:87], v[132:135], 0
    s_nop 1
    v_add_f32 v168, v136, v152
    v_add_f32 v169, v137, v153
    v_sub_f32 v170, v136, v152
    v_sub_f32 v171, v137, v153
    v_add_f32 v172, v144, v160
    v_add_f32 v173, v145, v161
    v_sub_f32 v174, v144, v160
    v_sub_f32 v175, v145, v161
    v_add_f32 v136, v168, v172
    v_add_f32 v137, v169, v173
    v_add_f32 v144, v170, v175
    v_sub_f32 v145, v171, v174
    v_sub_f32 v152, v168, v172
    v_sub_f32 v153, v169, v173
    v_sub_f32 v160, v170, v175
    v_add_f32 v161, v171, v174
    v_mul_f32 v176, v136, v24
    v_mul_f32 v177, v137, v24
    v_mul_f32 v178, v144, v26
    v_mul_f32 v179, v145, v26
    v_mul_f32 v180, v152, v28
    v_mul_f32 v181, v153, v28
    v_mul_f32 v182, v160, v30
    v_mul_f32_e64 v183, v161, v30
    v_fma_f32 v176, -v137, v25, v176
    v_fmac_f32_e64 v177, v136, v25
    v_fma_f32 v178, -v145, v27, v178
    v_fmac_f32_e64 v179, v144, v27
    v_fma_f32 v180, -v153, v29, v180
    v_fmac_f32_e64 v181, v152, v29
    v_fma_f32 v182, -v161, v31, v182
    v_fmac_f32 v183, v160, v31
    v_add_f32 v168, v176, v180
    v_add_f32 v169, v177, v181
    v_sub_f32 v170, v176, v180
    v_sub_f32 v171, v177, v181
    v_add_f32 v172, v178, v182
    v_add_f32 v173, v179, v183
    v_sub_f32 v174, v178, v182
    v_sub_f32 v175, v179, v183
    v_add_f32 v136, v168, v172
    v_add_f32 v137, v169, v173
    v_sub_f32 v144, v170, v175
    v_add_f32 v145, v171, v174
    v_sub_f32 v152, v168, v172
    v_sub_f32 v153, v169, v173
    v_add_f32 v160, v170, v175
    v_sub_f32_e64 v161, v171, v174
    v_cvt_pk_bf16_f32 v120, v136, v137
    v_cvt_pk_bf16_f32 v124, v144, v145
    v_cvt_pk_bf16_f32 v128, v152, v153
    v_cvt_pk_bf16_f32 v132, v160, v161
    v_add_f32 v168, v138, v154
    v_add_f32 v169, v139, v155
    v_sub_f32 v170, v138, v154
    v_sub_f32 v171, v139, v155
    v_add_f32 v172, v146, v162
    v_add_f32 v173, v147, v163
    v_sub_f32 v174, v146, v162
    v_sub_f32 v175, v147, v163
    v_add_f32 v138, v168, v172
    v_add_f32 v139, v169, v173
    v_add_f32 v146, v170, v175
    v_sub_f32 v147, v171, v174
    v_sub_f32 v154, v168, v172
    v_sub_f32 v155, v169, v173
    v_sub_f32 v162, v170, v175
    v_add_f32 v163, v171, v174
    v_mul_f32 v176, v138, v32
    v_mul_f32 v177, v139, v32
    v_mul_f32 v178, v146, v34
    v_mul_f32 v179, v147, v34
    v_mul_f32 v180, v154, v36
    v_mul_f32 v181, v155, v36
    v_mul_f32 v182, v162, v38
    v_mul_f32 v183, v163, v38
    v_fma_f32 v176, -v139, v33, v176
    v_fmac_f32_e64 v177, v138, v33
    v_fma_f32 v178, -v147, v35, v178
    v_fmac_f32_e64 v179, v146, v35
    v_fma_f32 v180, -v155, v37, v180
    v_fmac_f32_e64 v181, v154, v37
    v_fma_f32 v182, -v163, v39, v182
    v_fmac_f32 v183, v162, v39
    v_add_f32 v168, v176, v180
    v_add_f32 v169, v177, v181
    v_sub_f32 v170, v176, v180
    v_sub_f32 v171, v177, v181
    v_add_f32 v172, v178, v182
    v_add_f32 v173, v179, v183
    v_sub_f32 v174, v178, v182
    v_sub_f32 v175, v179, v183
    v_add_f32 v138, v168, v172
    v_add_f32 v139, v169, v173
    v_sub_f32 v146, v170, v175
    v_add_f32 v147, v171, v174
    v_sub_f32 v154, v168, v172
    v_sub_f32 v155, v169, v173
    v_add_f32 v162, v170, v175
    v_sub_f32_e64 v163, v171, v174
    v_cvt_pk_bf16_f32 v121, v138, v139
    v_cvt_pk_bf16_f32 v125, v146, v147
    v_cvt_pk_bf16_f32 v129, v154, v155
    v_cvt_pk_bf16_f32 v133, v162, v163
    v_add_f32 v168, v140, v156
    v_add_f32 v169, v141, v157
    v_sub_f32 v170, v140, v156
    v_sub_f32 v171, v141, v157
    v_add_f32 v172, v148, v164
    v_add_f32 v173, v149, v165
    v_sub_f32 v174, v148, v164
    v_sub_f32 v175, v149, v165
    v_add_f32 v140, v168, v172
    v_add_f32 v141, v169, v173
    v_add_f32 v148, v170, v175
    v_sub_f32 v149, v171, v174
    v_sub_f32 v156, v168, v172
    v_sub_f32 v157, v169, v173
    v_sub_f32 v164, v170, v175
    v_add_f32 v165, v171, v174
    v_mul_f32 v176, v140, v40
    v_mul_f32 v177, v141, v40
    v_mul_f32 v178, v148, v42
    v_mul_f32 v179, v149, v42
    v_mul_f32 v180, v156, v44
    v_mul_f32 v181, v157, v44
    v_mul_f32 v182, v164, v46
    v_mul_f32 v183, v165, v46
    v_fma_f32 v176, -v141, v41, v176
    v_fmac_f32_e64 v177, v140, v41
    v_fma_f32 v178, -v149, v43, v178
    v_fmac_f32_e64 v179, v148, v43
    v_fma_f32 v180, -v157, v45, v180
    v_fmac_f32_e64 v181, v156, v45
    v_fma_f32 v182, -v165, v47, v182
    v_fmac_f32 v183, v164, v47
    v_add_f32 v168, v176, v180
    v_add_f32 v169, v177, v181
    v_sub_f32 v170, v176, v180
    v_sub_f32 v171, v177, v181
    v_add_f32 v172, v178, v182
    v_add_f32 v173, v179, v183
    v_sub_f32 v174, v178, v182
    v_sub_f32 v175, v179, v183
    v_add_f32 v140, v168, v172
    v_add_f32 v141, v169, v173
    v_sub_f32 v148, v170, v175
    v_add_f32 v149, v171, v174
    v_sub_f32 v156, v168, v172
    v_sub_f32 v157, v169, v173
    v_add_f32 v164, v170, v175
    v_sub_f32_e64 v165, v171, v174
    v_cvt_pk_bf16_f32 v122, v140, v141
    v_cvt_pk_bf16_f32 v126, v148, v149
    v_cvt_pk_bf16_f32 v130, v156, v157
    v_cvt_pk_bf16_f32 v134, v164, v165
    v_add_f32 v168, v142, v158
    v_add_f32 v169, v143, v159
    v_sub_f32 v170, v142, v158
    v_sub_f32 v171, v143, v159
    v_add_f32 v172, v150, v166
    v_add_f32 v173, v151, v167
    v_sub_f32 v174, v150, v166
    v_sub_f32 v175, v151, v167
    v_add_f32 v142, v168, v172
    v_add_f32 v143, v169, v173
    v_add_f32 v150, v170, v175
    v_sub_f32 v151, v171, v174
    v_sub_f32 v158, v168, v172
    v_sub_f32 v159, v169, v173
    v_sub_f32 v166, v170, v175
    v_add_f32 v167, v171, v174
    v_mul_f32 v176, v142, v48
    v_mul_f32 v177, v143, v48
    v_mul_f32 v178, v150, v50
    v_mul_f32 v179, v151, v50
    v_mul_f32 v180, v158, v52
    v_mul_f32 v181, v159, v52
    v_mul_f32 v182, v166, v54
    v_mul_f32 v183, v167, v54
    v_fma_f32 v176, -v143, v49, v176
    v_fmac_f32_e64 v177, v142, v49
    v_fma_f32 v178, -v151, v51, v178
    v_fmac_f32_e64 v179, v150, v51
    v_fma_f32 v180, -v159, v53, v180
    v_fmac_f32_e64 v181, v158, v53
    v_fma_f32 v182, -v167, v55, v182
    v_fmac_f32 v183, v166, v55
    v_add_f32 v168, v176, v180
    v_add_f32 v169, v177, v181
    v_sub_f32 v170, v176, v180
    v_sub_f32 v171, v177, v181
    v_add_f32 v172, v178, v182
    v_add_f32 v173, v179, v183
    v_sub_f32 v174, v178, v182
    v_sub_f32 v175, v179, v183
    v_add_f32 v142, v168, v172
    v_add_f32 v143, v169, v173
    v_sub_f32 v150, v170, v175
    v_add_f32 v151, v171, v174
    v_sub_f32 v158, v168, v172
    v_sub_f32 v159, v169, v173
    v_add_f32 v166, v170, v175
    v_sub_f32_e64 v167, v171, v174
    v_cvt_pk_bf16_f32 v123, v142, v143
    v_cvt_pk_bf16_f32 v127, v150, v151
    v_cvt_pk_bf16_f32 v131, v158, v159
    v_cvt_pk_bf16_f32 v135, v166, v167
    v_mfma_f32_16x16x32_bf16 v[136:139], v[120:123], v[88:91], 0
    v_mfma_f32_16x16x32_bf16 v[140:143], v[120:123], v[92:95], 0
    v_mfma_f32_16x16x32_bf16 v[144:147], v[124:127], v[96:99], 0
    v_mfma_f32_16x16x32_bf16 v[148:151], v[124:127], v[100:103], 0
    v_mfma_f32_16x16x32_bf16 v[152:155], v[128:131], v[104:107], 0
    v_mfma_f32_16x16x32_bf16 v[156:159], v[128:131], v[108:111], 0
    v_mfma_f32_16x16x32_bf16 v[160:163], v[132:135], v[112:115], 0
    v_mfma_f32_16x16x32_bf16 v[164:167], v[132:135], v[116:119], 0
    s_nop 0
    v_cvt_pk_bf16_f32 v168, v136, v137
    v_cvt_pk_bf16_f32 v169, v138, v139
    v_cvt_pk_bf16_f32 v170, v140, v141
    v_cvt_pk_bf16_f32 v171, v142, v143
    buffer_store_dwordx4 v[168:171], v19, s[32:35], s19 offen sc1
    s_add_u32 s19, s19, s16
    v_cvt_pk_bf16_f32 v172, v144, v145
    v_cvt_pk_bf16_f32 v173, v146, v147
    v_cvt_pk_bf16_f32 v174, v148, v149
    v_cvt_pk_bf16_f32 v175, v150, v151
    buffer_store_dwordx4 v[172:175], v19, s[32:35], s19 offen sc1
    s_add_u32 s19, s19, s16
    v_cvt_pk_bf16_f32 v176, v152, v153
    v_cvt_pk_bf16_f32 v177, v154, v155
    v_cvt_pk_bf16_f32 v178, v156, v157
    v_cvt_pk_bf16_f32 v179, v158, v159
    buffer_store_dwordx4 v[176:179], v19, s[32:35], s19 offen sc1
    s_add_u32 s19, s19, s16
    v_cvt_pk_bf16_f32 v180, v160, v161
    v_cvt_pk_bf16_f32 v181, v162, v163
    v_cvt_pk_bf16_f32 v182, v164, v165
    v_cvt_pk_bf16_f32 v183, v166, v167
    buffer_store_dwordx4 v[180:183], v19, s[32:35], s19 offen sc1
    s_waitcnt vmcnt(0)
L_p2flag:
    s_mov_b64 exec, 1
    v_mov_b32 v4, 156484
    v_mov_b32 v5, 1
    ds_add_rtn_u32 v5, v4, v5
    s_waitcnt lgkmcnt(0)
    v_readfirstlane_b32 s60, v5
    s_mov_b64 exec, -1
    s_cmp_lg_u32 s60, 3
    s_cbranch_scc1 L_p2nf
    v_mul_u32_u24 v4, 2304, v1
    v_mov_b32 v5, 1
    buffer_atomic_add v5, v4, s[32:35], s98 offen sc1
L_p2nf:
    s_setprio 2
    global_load_dwordx4 v[12:15], v[226:227], off offset:-4096
    global_load_dwordx4 v[16:19], v[226:227], off offset:-3072
    global_load_dwordx4 v[20:23], v[226:227], off offset:-2048
    global_load_dwordx4 v[24:27], v[228:229], off offset:-4096
    global_load_dwordx4 v[28:31], v[228:229], off offset:-3072
    global_load_dwordx4 v[32:35], v[228:229], off offset:-2048
    global_load_dwordx4 v[36:39], v[230:231], off offset:-4096
    global_load_dwordx4 v[40:43], v[230:231], off offset:-3072
    global_load_dwordx4 v[44:47], v[230:231], off offset:-2048
    s_mul_i32 s4, s64, 40960
    s_mul_i32 s60, s57, 10240
    s_add_u32 s5, s4, s60
    s_add_u32 s6, s5, 5242880
    s_lshl_b32 s60, s57, 13
    s_add_u32 s68, s60, 86784
    s_lshl_b32 s60, s57, 11
    s_add_u32 s69, s60, 119552
    s_lshl_b32 s61, s65, 4
    s_add_u32 s5, s5, s61
    s_add_u32 s7, s5, 12582912
    s_mul_i32 s60, s57, 2560
    s_add_u32 s9, s60, 144128
    s_lshl_b32 s60, s64, 11
    s_lshl_b32 s61, s57, 9
    s_add_u32 s60, s60, s61
    s_add_u32 s10, s60, 8388608
    s_lshl_b32 s61, s57, 7
    s_add_u32 s11, s61, 140032
    s_mov_b64 exec, 1
    v_mov_b32 v4, 156484
    s_mov_b32 s61, 0
L_sy22:
    s_sleep 2
    ds_read_b32 v5, v4
    s_add_u32 s61, s61, 1
    s_waitcnt lgkmcnt(0)
    v_readfirstlane_b32 s60, v5
    s_cmp_ge_u32 s61, 1048576
    s_cbranch_scc1 L_syd23
    s_cmp_lt_u32 s60, 4
    s_cbranch_scc1 L_sy22
L_syd23:
    s_mov_b64 exec, -1
    s_mov_b32 s61, 0
    s_add_u32 s26, s56, 16
    s_mov_b32 s27, s26
L_sp24:
    s_load_dword s40, s[28:29], s24 offset:0 glc
    s_load_dword s41, s[28:29], s24 offset:128 glc
    s_load_dword s42, s[28:29], s24 offset:256 glc
    s_load_dword s43, s[28:29], s24 offset:384 glc
    s_add_u32 s61, s61, 1
    s_cmp_ge_u32 s61, 65536
    s_waitcnt lgkmcnt(0)
    s_cbranch_scc1 L_spd25
    s_cmp_lg_u64 s[40:41], s[26:27]
    s_cbranch_scc1 L_spa26
    s_cmp_lg_u64 s[42:43], s[26:27]
    s_cbranch_scc1 L_spa26
    s_branch L_spd25
L_spa26:
    s_sleep 2
    s_branch L_sp24
L_spd25:
    s_setprio 3
    s_mov_b32 s60, s6
    s_add_u32 m0, s68, 0
    s_nop 0
    buffer_load_dwordx4 v232, s[32:35], s60 offen sc1 lds
    s_add_u32 s60, s60, 1280
    s_add_u32 m0, s68, 1024
    s_nop 0
    s_nop 0
    buffer_load_dwordx4 v233, s[32:35], s60 offen sc1 lds
    s_add_u32 s60, s60, 1280
    s_add_u32 m0, s68, 2048
    s_nop 0
    buffer_load_dwordx4 v234, s[32:35], s60 offen sc1 lds
    s_add_u32 s60, s60, 1280
    s_add_u32 m0, s68, 3072
    s_nop 0
    buffer_load_dwordx4 v235, s[32:35], s60 offen sc1 lds
    s_add_u32 s60, s60, 1280
    s_add_u32 m0, s68, 4096
    s_nop 0
    buffer_load_dwordx4 v232, s[32:35], s60 offen sc1 lds
    s_add_u32 s60, s60, 1280
    s_add_u32 m0, s68, 5120
    s_nop 0
    buffer_load_dwordx4 v233, s[32:35], s60 offen sc1 lds
    s_add_u32 s60, s60, 1280
    s_add_u32 m0, s68, 6144
    s_nop 0
    buffer_load_dwordx4 v234, s[32:35], s60 offen sc1 lds
    s_add_u32 s60, s60, 1280
    s_add_u32 m0, s68, 7168
    s_nop 0
    buffer_load_dwordx4 v235, s[32:35], s60 offen sc1 lds
    s_add_u32 m0, s69, 0
    s_nop 0
    buffer_load_dwordx4 v236, s[32:35], s6 offen sc1 lds
    s_add_u32 s6, s6, 5120
    s_add_u32 m0, s69, 1024
    s_nop 0
    buffer_load_dwordx4 v236, s[32:35], s6 offen sc1 lds
    s_mov_b32 m0, s11
    s_mov_b64 exec, 0xff
    buffer_load_dwordx4 v251, s[32:35], s10 offen sc1 lds
    s_mov_b64 exec, -1
    s_waitcnt vmcnt(0)
    s_mov_b64 exec, 1
    v_mov_b32 v4, 156488
    s_mov_b32 s61, 0
    v_mov_b32 v5, 1
    ds_add_rtn_u32 v5, v4, v5
    s_waitcnt lgkmcnt(0)
    v_readfirstlane_b32 s60, v5
    s_nop 0
    s_cmp_eq_u32 s60, 3
    s_cbranch_scc1 L_syd28
L_sy27:
    s_sleep 1
    ds_read_b32 v5, v4
    s_add_u32 s61, s61, 1
    s_waitcnt lgkmcnt(0)
    v_readfirstlane_b32 s60, v5
    s_cmp_ge_u32 s61, 1048576
    s_cbranch_scc1 L_syd28
    s_cmp_lt_u32 s60, 4
    s_cbranch_scc1 L_sy27
L_syd28:
    s_mov_b64 exec, -1
    ds_read_b64_tr_b16 v[48:49], v244 offset:0
    ds_read_b64_tr_b16 v[50:51], v244 offset:8192
    ds_read_b64_tr_b16 v[52:53], v244 offset:16384
    ds_read_b64_tr_b16 v[54:55], v244 offset:24576
    ds_read_b64_tr_b16 v[56:57], v244 offset:256
    ds_read_b64_tr_b16 v[58:59], v244 offset:8448
    ds_read_b64_tr_b16 v[60:61], v244 offset:16640
    ds_read_b64_tr_b16 v[62:63], v244 offset:24832
    ds_read_b64_tr_b16 v[64:65], v244 offset:512
    ds_read_b64_tr_b16 v[66:67], v244 offset:8704
    ds_read_b64_tr_b16 v[68:69], v244 offset:16896
    ds_read_b64_tr_b16 v[70:71], v244 offset:25088
    s_waitcnt lgkmcnt(8)
    v_mfma_f32_16x16x32_bf16 v[96:99], v[48:51], v[200:203], 0
    v_mfma_f32_16x16x32_bf16 v[96:99], v[52:55], v[204:207], v[96:99]
    ds_read_b64_tr_b16 v[72:73], v244 offset:768
    ds_read_b64_tr_b16 v[74:75], v244 offset:8960
    ds_read_b64_tr_b16 v[76:77], v244 offset:17152
    ds_read_b64_tr_b16 v[78:79], v244 offset:25344
    s_waitcnt lgkmcnt(8)
    v_mfma_f32_16x16x32_bf16 v[100:103], v[56:59], v[200:203], 0
    v_mfma_f32_16x16x32_bf16 v[100:103], v[60:63], v[204:207], v[100:103]
    ds_read_b64_tr_b16 v[80:81], v248 offset:0
    ds_read_b64_tr_b16 v[82:83], v248 offset:2048
    ds_read_b64_tr_b16 v[84:85], v248 offset:4096
    ds_read_b64_tr_b16 v[86:87], v248 offset:6144
    s_waitcnt lgkmcnt(8)
    v_mfma_f32_16x16x32_bf16 v[104:107], v[64:67], v[200:203], 0
    v_mfma_f32_16x16x32_bf16 v[104:107], v[68:71], v[204:207], v[104:107]
    ds_read_b64_tr_b16 v[88:89], v245 offset:0
    ds_read_b64_tr_b16 v[90:91], v245 offset:128
    ds_read_b64_tr_b16 v[92:93], v245 offset:256
    ds_read_b64_tr_b16 v[94:95], v245 offset:384
    s_waitcnt lgkmcnt(8)
    v_mfma_f32_16x16x32_bf16 v[108:111], v[72:75], v[200:203], 0
    v_mfma_f32_16x16x32_bf16 v[108:111], v[76:79], v[204:207], v[108:111]
    s_waitcnt lgkmcnt(4)
    v_mfma_f32_16x16x32_bf16 v[112:115], v[80:83], v[200:203], 0
    v_mfma_f32_16x16x32_bf16 v[112:115], v[84:87], v[204:207], v[112:115]
    s_waitcnt lgkmcnt(0)
    v_mfma_f32_16x16x32_bf16 v[116:119], v[88:91], v[200:203], 0
    v_mfma_f32_16x16x32_bf16 v[116:119], v[92:95], v[204:207], v[116:119]
    v_cvt_pk_bf16_f32 v48, v96, v97
    v_cvt_pk_bf16_f32 v49, v98, v99
    v_cvt_pk_bf16_f32 v50, v100, v101
    v_cvt_pk_bf16_f32 v51, v102, v103
    v_cvt_pk_bf16_f32 v52, v104, v105
    v_cvt_pk_bf16_f32 v53, v106, v107
    v_cvt_pk_bf16_f32 v54, v108, v109
    v_cvt_pk_bf16_f32 v55, v110, v111
    v_cvt_pk_bf16_f32 v56, v112, v113
    v_cvt_pk_bf16_f32 v57, v114, v115
    v_cvt_pk_bf16_f32 v58, v116, v117
    v_cvt_pk_bf16_f32 v59, v118, v119
    s_cmp_eq_u32 s57, 0
    s_cbranch_scc1 L_exz
    v_mov_b32 v58, 0
    v_mov_b32 v59, 0
L_exz:
    ds_write_b128 v246, v[48:51] offset:0
    ds_write_b128 v246, v[52:55] offset:1024
    ds_write_b128 v246, v[56:59] offset:2048
    s_waitcnt lgkmcnt(0)
    s_mov_b64 exec, 1
    v_mov_b32 v4, 156492
    s_mov_b32 s61, 0
    v_mov_b32 v5, 1
    ds_add_rtn_u32 v5, v4, v5
    s_waitcnt lgkmcnt(0)
    v_readfirstlane_b32 s60, v5
    s_nop 0
    s_cmp_eq_u32 s60, 3
    s_cbranch_scc1 L_syd30
L_sy29:
    ds_read_b32 v5, v4
    s_add_u32 s61, s61, 1
    s_waitcnt lgkmcnt(0)
    v_readfirstlane_b32 s60, v5
    s_cmp_ge_u32 s61, 1048576
    s_cbranch_scc1 L_syd30
    s_cmp_lt_u32 s60, 4
    s_cbranch_scc1 L_sy29
L_syd30:
    s_mov_b64 exec, -1
    v_lshlrev_b32_e64 v6, 3, v3
    v_add_u32 v6, 156448, v6
    ds_read_b64 v[120:121], v6
    ds_read_b128 v[48:51], v247 offset:0
    ds_read_b128 v[52:55], v247 offset:1024
    ds_read_b128 v[56:59], v247 offset:2048
    ds_read_b128 v[60:63], v247 offset:3072
    ds_read_b128 v[64:67], v247 offset:4096
    ds_read_b128 v[68:71], v247 offset:5120
    ds_read_b128 v[72:75], v247 offset:6144
    ds_read_b128 v[76:79], v247 offset:7168
    ds_read_b128 v[80:83], v247 offset:8192
    ds_read_b128 v[84:87], v247 offset:9216
    ds_read_b128 v[88:91], v247 offset:10240
    ds_read_b128 v[92:95], v247 offset:11264
    s_waitcnt lgkmcnt(11)
    v_mfma_f32_16x16x32_bf16 v[124:127], v[48:51], v[12:15], 0
    s_waitcnt lgkmcnt(10)
    v_mfma_f32_16x16x32_bf16 v[124:127], v[52:55], v[16:19], v[124:127]
    s_waitcnt lgkmcnt(9)
    v_mfma_f32_16x16x32_bf16 v[124:127], v[56:59], v[20:23], v[124:127]
    s_waitcnt lgkmcnt(8)
    v_mfma_f32_16x16x32_bf16 v[128:131], v[60:63], v[12:15], 0
    s_waitcnt lgkmcnt(7)
    v_mfma_f32_16x16x32_bf16 v[128:131], v[64:67], v[16:19], v[128:131]
    s_waitcnt lgkmcnt(6)
    v_mfma_f32_16x16x32_bf16 v[128:131], v[68:71], v[20:23], v[128:131]
    s_waitcnt lgkmcnt(5)
    v_mfma_f32_16x16x32_bf16 v[132:135], v[72:75], v[12:15], 0
    s_waitcnt lgkmcnt(4)
    v_mfma_f32_16x16x32_bf16 v[132:135], v[76:79], v[16:19], v[132:135]
    s_waitcnt lgkmcnt(3)
    v_mfma_f32_16x16x32_bf16 v[132:135], v[80:83], v[20:23], v[132:135]
    s_waitcnt lgkmcnt(2)
    v_mfma_f32_16x16x32_bf16 v[136:139], v[84:87], v[12:15], 0
    s_waitcnt lgkmcnt(1)
    v_mfma_f32_16x16x32_bf16 v[136:139], v[88:91], v[16:19], v[136:139]
    s_waitcnt lgkmcnt(0)
    v_mfma_f32_16x16x32_bf16 v[136:139], v[92:95], v[20:23], v[136:139]
    v_mfma_f32_16x16x32_bf16 v[140:143], v[48:51], v[24:27], 0
    v_mfma_f32_16x16x32_bf16 v[140:143], v[52:55], v[28:31], v[140:143]
    v_mfma_f32_16x16x32_bf16 v[140:143], v[56:59], v[32:35], v[140:143]
    v_mfma_f32_16x16x32_bf16 v[144:147], v[60:63], v[24:27], 0
    v_mfma_f32_16x16x32_bf16 v[144:147], v[64:67], v[28:31], v[144:147]
    v_mfma_f32_16x16x32_bf16 v[144:147], v[68:71], v[32:35], v[144:147]
    v_mfma_f32_16x16x32_bf16 v[148:151], v[72:75], v[24:27], 0
    v_mfma_f32_16x16x32_bf16 v[148:151], v[76:79], v[28:31], v[148:151]
    v_mfma_f32_16x16x32_bf16 v[148:151], v[80:83], v[32:35], v[148:151]
    v_mfma_f32_16x16x32_bf16 v[152:155], v[84:87], v[24:27], 0
    v_mfma_f32_16x16x32_bf16 v[152:155], v[88:91], v[28:31], v[152:155]
    v_mfma_f32_16x16x32_bf16 v[152:155], v[92:95], v[32:35], v[152:155]
    s_cmp_eq_u32 s57, 3
    s_cbranch_scc1 L_sb2
    v_mfma_f32_16x16x32_bf16 v[156:159], v[48:51], v[36:39], 0
    v_mfma_f32_16x16x32_bf16 v[156:159], v[52:55], v[40:43], v[156:159]
    v_mfma_f32_16x16x32_bf16 v[156:159], v[56:59], v[44:47], v[156:159]
    v_mfma_f32_16x16x32_bf16 v[160:163], v[60:63], v[36:39], 0
    v_mfma_f32_16x16x32_bf16 v[160:163], v[64:67], v[40:43], v[160:163]
    v_mfma_f32_16x16x32_bf16 v[160:163], v[68:71], v[44:47], v[160:163]
    v_mfma_f32_16x16x32_bf16 v[164:167], v[72:75], v[36:39], 0
    v_mfma_f32_16x16x32_bf16 v[164:167], v[76:79], v[40:43], v[164:167]
    v_mfma_f32_16x16x32_bf16 v[164:167], v[80:83], v[44:47], v[164:167]
    v_mfma_f32_16x16x32_bf16 v[168:171], v[84:87], v[36:39], 0
    v_mfma_f32_16x16x32_bf16 v[168:171], v[88:91], v[40:43], v[168:171]
    v_mfma_f32_16x16x32_bf16 v[168:171], v[92:95], v[44:47], v[168:171]
L_sb2:
    v_cndmask_b32 v96, v124, v125, s[12:13]
    v_cndmask_b32 v97, v126, v127, s[12:13]
    v_subrev_f32_dpp v98, v129, v128 quad_perm:[1,0,3,2] row_mask:0xf bank_mask:0xf
    v_add_f32_dpp v104, v128, v129 quad_perm:[1,0,3,2] row_mask:0xf bank_mask:0xf
    v_subrev_f32_dpp v99, v131, v130 quad_perm:[1,0,3,2] row_mask:0xf bank_mask:0xf
    v_add_f32_dpp v105, v130, v131 quad_perm:[1,0,3,2] row_mask:0xf bank_mask:0xf
    v_subrev_f32_dpp v100, v133, v132 quad_perm:[1,0,3,2] row_mask:0xf bank_mask:0xf
    v_add_f32_dpp v106, v132, v133 quad_perm:[1,0,3,2] row_mask:0xf bank_mask:0xf
    v_subrev_f32_dpp v101, v135, v134 quad_perm:[1,0,3,2] row_mask:0xf bank_mask:0xf
    v_add_f32_dpp v107, v134, v135 quad_perm:[1,0,3,2] row_mask:0xf bank_mask:0xf
    v_subrev_f32_dpp v102, v137, v136 quad_perm:[1,0,3,2] row_mask:0xf bank_mask:0xf
    v_add_f32_dpp v108, v136, v137 quad_perm:[1,0,3,2] row_mask:0xf bank_mask:0xf
    v_subrev_f32_dpp v103, v139, v138 quad_perm:[1,0,3,2] row_mask:0xf bank_mask:0xf
    v_add_f32_dpp v109, v138, v139 quad_perm:[1,0,3,2] row_mask:0xf bank_mask:0xf
    v_fmac_f32_dpp v96, -v96, v243 quad_perm:[1,0,3,2] row_mask:0xf bank_mask:0xf
    v_fmac_f32_dpp v97, -v97, v243 quad_perm:[1,0,3,2] row_mask:0xf bank_mask:0xf
    v_pk_mul_f32 v[112:113], v[210:211], v[100:101] op_sel:[0,0] op_sel_hi:[0,1]
    v_pk_mul_f32 v[114:115], v[208:209], v[98:99] op_sel:[0,0] op_sel_hi:[0,1]
    v_pk_mul_f32 v[116:117], v[208:209], v[98:99] op_sel:[1,0] op_sel_hi:[1,1]
    v_pk_fma_f32 v[112:113], v[210:211], v[106:107], v[112:113] op_sel:[1,0,0] op_sel_hi:[1,1,1] neg_lo:[1,0,0] neg_hi:[1,0,0]
    v_pk_fma_f32 v[114:115], v[208:209], v[104:105], v[114:115] op_sel:[1,0,0] op_sel_hi:[1,1,1] neg_lo:[1,0,0] neg_hi:[1,0,0]
    v_pk_fma_f32 v[116:117], v[208:209], v[104:105], v[116:117] op_sel:[0,0,0] op_sel_hi:[0,1,1]
    v_pk_fma_f32 v[114:115], v[212:213], v[102:103], v[114:115] op_sel:[0,0,0] op_sel_hi:[0,1,1]
    v_pk_fma_f32 v[116:117], v[212:213], v[102:103], v[116:117] op_sel:[1,0,0] op_sel_hi:[1,1,1] neg_lo:[1,0,0] neg_hi:[1,0,0]
    v_pk_add_f32 v[110:111], v[96:97], v[112:113]
    v_pk_add_f32 v[112:113], v[96:97], v[112:113] neg_lo:[0,1] neg_hi:[0,1]
    v_pk_fma_f32 v[114:115], v[212:213], v[108:109], v[114:115] op_sel:[1,0,0] op_sel_hi:[1,1,1] neg_lo:[1,0,0] neg_hi:[1,0,0]
    v_pk_fma_f32 v[116:117], v[212:213], v[108:109], v[116:117] op_sel:[0,0,0] op_sel_hi:[0,1,1] neg_lo:[1,0,0] neg_hi:[1,0,0]
    v_pk_add_f32 v[98:99], v[110:111], v[114:115]
    v_pk_add_f32 v[100:101], v[110:111], v[114:115] neg_lo:[0,1] neg_hi:[0,1]
    v_pk_add_f32 v[102:103], v[112:113], v[116:117] neg_lo:[0,1] neg_hi:[0,1]
    v_pk_add_f32 v[104:105], v[112:113], v[116:117]
    v_pk_mul_f32 v[98:99], v[98:99], v[120:121]
    v_pk_mul_f32 v[100:101], v[100:101], v[120:121]
    v_pk_mul_f32 v[102:103], v[102:103], v[120:121]
    v_pk_mul_f32 v[104:105], v[104:105], v[120:121]
    v_cvt_pk_bf16_f32 v106, v98, v99
    ds_write_b32 v240, v106 offset:0
    v_cvt_pk_bf16_f32 v107, v100, v101
    ds_write_b32 v240, v107 offset:5120
    v_cvt_pk_bf16_f32 v108, v102, v103
    ds_write_b32 v240, v108 offset:2560
    v_cvt_pk_bf16_f32 v109, v104, v105
    ds_write_b32 v240, v109 offset:7680
    v_cndmask_b32 v96, v140, v141, s[12:13]
    v_cndmask_b32 v97, v142, v143, s[12:13]
    v_subrev_f32_dpp v98, v145, v144 quad_perm:[1,0,3,2] row_mask:0xf bank_mask:0xf
    v_add_f32_dpp v104, v144, v145 quad_perm:[1,0,3,2] row_mask:0xf bank_mask:0xf
    v_subrev_f32_dpp v99, v147, v146 quad_perm:[1,0,3,2] row_mask:0xf bank_mask:0xf
    v_add_f32_dpp v105, v146, v147 quad_perm:[1,0,3,2] row_mask:0xf bank_mask:0xf
    v_subrev_f32_dpp v100, v149, v148 quad_perm:[1,0,3,2] row_mask:0xf bank_mask:0xf
    v_add_f32_dpp v106, v148, v149 quad_perm:[1,0,3,2] row_mask:0xf bank_mask:0xf
    v_subrev_f32_dpp v101, v151, v150 quad_perm:[1,0,3,2] row_mask:0xf bank_mask:0xf
    v_add_f32_dpp v107, v150, v151 quad_perm:[1,0,3,2] row_mask:0xf bank_mask:0xf
    v_subrev_f32_dpp v102, v153, v152 quad_perm:[1,0,3,2] row_mask:0xf bank_mask:0xf
    v_add_f32_dpp v108, v152, v153 quad_perm:[1,0,3,2] row_mask:0xf bank_mask:0xf
    v_subrev_f32_dpp v103, v155, v154 quad_perm:[1,0,3,2] row_mask:0xf bank_mask:0xf
    v_add_f32_dpp v109, v154, v155 quad_perm:[1,0,3,2] row_mask:0xf bank_mask:0xf
    v_fmac_f32_dpp v96, -v96, v243 quad_perm:[1,0,3,2] row_mask:0xf bank_mask:0xf
    v_fmac_f32_dpp v97, -v97, v243 quad_perm:[1,0,3,2] row_mask:0xf bank_mask:0xf
    v_pk_mul_f32 v[112:113], v[216:217], v[100:101] op_sel:[0,0] op_sel_hi:[0,1]
    v_pk_mul_f32 v[114:115], v[214:215], v[98:99] op_sel:[0,0] op_sel_hi:[0,1]
    v_pk_mul_f32 v[116:117], v[214:215], v[98:99] op_sel:[1,0] op_sel_hi:[1,1]
    v_pk_fma_f32 v[112:113], v[216:217], v[106:107], v[112:113] op_sel:[1,0,0] op_sel_hi:[1,1,1] neg_lo:[1,0,0] neg_hi:[1,0,0]
    v_pk_fma_f32 v[114:115], v[214:215], v[104:105], v[114:115] op_sel:[1,0,0] op_sel_hi:[1,1,1] neg_lo:[1,0,0] neg_hi:[1,0,0]
    v_pk_fma_f32 v[116:117], v[214:215], v[104:105], v[116:117] op_sel:[0,0,0] op_sel_hi:[0,1,1]
    v_pk_fma_f32 v[114:115], v[218:219], v[102:103], v[114:115] op_sel:[0,0,0] op_sel_hi:[0,1,1]
    v_pk_fma_f32 v[116:117], v[218:219], v[102:103], v[116:117] op_sel:[1,0,0] op_sel_hi:[1,1,1] neg_lo:[1,0,0] neg_hi:[1,0,0]
    v_pk_add_f32 v[110:111], v[96:97], v[112:113]
    v_pk_add_f32 v[112:113], v[96:97], v[112:113] neg_lo:[0,1] neg_hi:[0,1]
    v_pk_fma_f32 v[114:115], v[218:219], v[108:109], v[114:115] op_sel:[1,0,0] op_sel_hi:[1,1,1] neg_lo:[1,0,0] neg_hi:[1,0,0]
    v_pk_fma_f32 v[116:117], v[218:219], v[108:109], v[116:117] op_sel:[0,0,0] op_sel_hi:[0,1,1] neg_lo:[1,0,0] neg_hi:[1,0,0]
    v_pk_add_f32 v[98:99], v[110:111], v[114:115]
    v_pk_add_f32 v[100:101], v[110:111], v[114:115] neg_lo:[0,1] neg_hi:[0,1]
    v_pk_add_f32 v[102:103], v[112:113], v[116:117] neg_lo:[0,1] neg_hi:[0,1]
    v_pk_add_f32 v[104:105], v[112:113], v[116:117]
    v_pk_mul_f32 v[98:99], v[98:99], v[120:121]
    v_pk_mul_f32 v[100:101], v[100:101], v[120:121]
    v_pk_mul_f32 v[102:103], v[102:103], v[120:121]
    v_pk_mul_f32 v[104:105], v[104:105], v[120:121]
    v_cvt_pk_bf16_f32 v106, v98, v99
    ds_write_b32 v241, v106 offset:0
    v_cvt_pk_bf16_f32 v107, v100, v101
    ds_write_b32 v241, v107 offset:5120
    v_cvt_pk_bf16_f32 v108, v102, v103
    ds_write_b32 v241, v108 offset:2560
    v_cvt_pk_bf16_f32 v109, v104, v105
    ds_write_b32 v241, v109 offset:7680
    s_cmp_eq_u32 s57, 3
    s_cbranch_scc1 L_sb3
    v_cndmask_b32 v96, v156, v157, s[12:13]
    v_cndmask_b32 v97, v158, v159, s[12:13]
    v_subrev_f32_dpp v98, v161, v160 quad_perm:[1,0,3,2] row_mask:0xf bank_mask:0xf
    v_add_f32_dpp v104, v160, v161 quad_perm:[1,0,3,2] row_mask:0xf bank_mask:0xf
    v_subrev_f32_dpp v99, v163, v162 quad_perm:[1,0,3,2] row_mask:0xf bank_mask:0xf
    v_add_f32_dpp v105, v162, v163 quad_perm:[1,0,3,2] row_mask:0xf bank_mask:0xf
    v_subrev_f32_dpp v100, v165, v164 quad_perm:[1,0,3,2] row_mask:0xf bank_mask:0xf
    v_add_f32_dpp v106, v164, v165 quad_perm:[1,0,3,2] row_mask:0xf bank_mask:0xf
    v_subrev_f32_dpp v101, v167, v166 quad_perm:[1,0,3,2] row_mask:0xf bank_mask:0xf
    v_add_f32_dpp v107, v166, v167 quad_perm:[1,0,3,2] row_mask:0xf bank_mask:0xf
    v_subrev_f32_dpp v102, v169, v168 quad_perm:[1,0,3,2] row_mask:0xf bank_mask:0xf
    v_add_f32_dpp v108, v168, v169 quad_perm:[1,0,3,2] row_mask:0xf bank_mask:0xf
    v_subrev_f32_dpp v103, v171, v170 quad_perm:[1,0,3,2] row_mask:0xf bank_mask:0xf
    v_add_f32_dpp v109, v170, v171 quad_perm:[1,0,3,2] row_mask:0xf bank_mask:0xf
    v_fmac_f32_dpp v96, -v96, v243 quad_perm:[1,0,3,2] row_mask:0xf bank_mask:0xf
    v_fmac_f32_dpp v97, -v97, v243 quad_perm:[1,0,3,2] row_mask:0xf bank_mask:0xf
    v_pk_mul_f32 v[112:113], v[222:223], v[100:101] op_sel:[0,0] op_sel_hi:[0,1]
    v_pk_mul_f32 v[114:115], v[220:221], v[98:99] op_sel:[0,0] op_sel_hi:[0,1]
    v_pk_mul_f32 v[116:117], v[220:221], v[98:99] op_sel:[1,0] op_sel_hi:[1,1]
    v_pk_fma_f32 v[112:113], v[222:223], v[106:107], v[112:113] op_sel:[1,0,0] op_sel_hi:[1,1,1] neg_lo:[1,0,0] neg_hi:[1,0,0]
    v_pk_fma_f32 v[114:115], v[220:221], v[104:105], v[114:115] op_sel:[1,0,0] op_sel_hi:[1,1,1] neg_lo:[1,0,0] neg_hi:[1,0,0]
    v_pk_fma_f32 v[116:117], v[220:221], v[104:105], v[116:117] op_sel:[0,0,0] op_sel_hi:[0,1,1]
    v_pk_fma_f32 v[114:115], v[224:225], v[102:103], v[114:115] op_sel:[0,0,0] op_sel_hi:[0,1,1]
    v_pk_fma_f32 v[116:117], v[224:225], v[102:103], v[116:117] op_sel:[1,0,0] op_sel_hi:[1,1,1] neg_lo:[1,0,0] neg_hi:[1,0,0]
    v_pk_add_f32 v[110:111], v[96:97], v[112:113]
    v_pk_add_f32 v[112:113], v[96:97], v[112:113] neg_lo:[0,1] neg_hi:[0,1]
    v_pk_fma_f32 v[114:115], v[224:225], v[108:109], v[114:115] op_sel:[1,0,0] op_sel_hi:[1,1,1] neg_lo:[1,0,0] neg_hi:[1,0,0]
    v_pk_fma_f32 v[116:117], v[224:225], v[108:109], v[116:117] op_sel:[0,0,0] op_sel_hi:[0,1,1] neg_lo:[1,0,0] neg_hi:[1,0,0]
    v_pk_add_f32 v[98:99], v[110:111], v[114:115]
    v_pk_add_f32 v[100:101], v[110:111], v[114:115] neg_lo:[0,1] neg_hi:[0,1]
    v_pk_add_f32 v[102:103], v[112:113], v[116:117] neg_lo:[0,1] neg_hi:[0,1]
    v_pk_add_f32 v[104:105], v[112:113], v[116:117]
    v_pk_mul_f32 v[98:99], v[98:99], v[120:121]
    v_pk_mul_f32 v[100:101], v[100:101], v[120:121]
    v_pk_mul_f32 v[102:103], v[102:103], v[120:121]
    v_pk_mul_f32 v[104:105], v[104:105], v[120:121]
    v_cvt_pk_bf16_f32 v106, v98, v99
    ds_write_b32 v242, v106 offset:0
    v_cvt_pk_bf16_f32 v107, v100, v101
    ds_write_b32 v242, v107 offset:5120
    v_cvt_pk_bf16_f32 v108, v102, v103
    ds_write_b32 v242, v108 offset:2560
    v_cvt_pk_bf16_f32 v109, v104, v105
    ds_write_b32 v242, v109 offset:7680
L_sb3:
    s_waitcnt lgkmcnt(0)
    s_lshl_b32 s60, s65, 7
    s_add_u32 s60, s60, s64
    s_mul_i32 s60, s60, 1280
    s_lshl_b32 s61, s57, 7
    s_add_u32 s4, s60, s61
    s_barrier
    ds_read_b32 v80, v239
    ds_read_b64_tr_b16 v[48:49], v237 offset:57344
    ds_read_b64_tr_b16 v[52:53], v237 offset:0
    ds_read_b64_tr_b16 v[50:51], v237 offset:57408
    ds_read_b64_tr_b16 v[54:55], v237 offset:64
    s_or_b32 s60, s2, s57
    s_cmp_lg_u32 s60, 0
    s_cbranch_scc1 L_noE
    s_mov_b64 exec, 1
    v_mov_b32 v82, 0
    v_mov_b32 v83, s56
    buffer_store_dword v83, v82, s[32:35], 0 offen sc1
    s_mov_b64 exec, -1
L_noE:
    s_waitcnt lgkmcnt(0)
    v_lshlrev_b32_e64 v64, 16, v48
    v_and_b32 v65, 0xffff0000, v48
    v_lshlrev_b32_e64 v66, 16, v52
    v_and_b32 v67, 0xffff0000, v52
    v_lshlrev_b32_e64 v68, 16, v49
    v_and_b32 v69, 0xffff0000, v49
    v_lshlrev_b32_e64 v70, 16, v53
    v_and_b32 v71, 0xffff0000, v53
    v_lshlrev_b32_e64 v72, 16, v50
    v_and_b32 v73, 0xffff0000, v50
    v_lshlrev_b32_e64 v74, 16, v54
    v_and_b32 v75, 0xffff0000, v54
    v_lshlrev_b32_e64 v76, 16, v51
    v_and_b32 v77, 0xffff0000, v51
    v_lshlrev_b32_e64 v78, 16, v55
    v_and_b32 v79, 0xffff0000, v55
    v_pk_fma_f32 v[64:65], v[80:81], v[64:65], v[66:67] op_sel:[0,0,0] op_sel_hi:[0,1,1]
    v_pk_fma_f32 v[68:69], v[80:81], v[68:69], v[70:71] op_sel:[0,0,0] op_sel_hi:[0,1,1]
    v_pk_fma_f32 v[72:73], v[80:81], v[72:73], v[74:75] op_sel:[0,0,0] op_sel_hi:[0,1,1]
    v_pk_fma_f32 v[76:77], v[80:81], v[76:77], v[78:79] op_sel:[0,0,0] op_sel_hi:[0,1,1]
    v_cvt_pk_bf16_f32 v48, v64, v65
    v_cvt_pk_bf16_f32 v49, v68, v69
    v_cvt_pk_bf16_f32 v50, v72, v73
    v_cvt_pk_bf16_f32 v51, v76, v77
    buffer_store_dwordx4 v[48:51], v238, s[52:55], s4 offen offset:0 sc1
L_ff32:
    s_endpgm
L_A:
    s_setprio 2
    s_sub_u32 s64, s57, 4
    s_lshl_b32 s65, s58, 5
    s_add_u32 s65, s65, s59
    s_lshr_b32 s60, s65, 1
    s_mul_i32 s67, s60, 5
    s_and_b32 s68, s65, 1
    s_add_u32 s92, s67, 4
    s_lshl_b32 s60, s68, 1
    s_add_u32 s67, s67, s60
    s_cmp_eq_u32 s64, 0
    s_cbranch_scc1 L_help
    s_sub_u32 s91, s64, 1
    s_add_u32 s66, s67, s91
    s_cmp_eq_u32 s91, 2
    s_cselect_b32 s66, s92, s66
    s_mul_i32 s69, s91, 16896
    v_lshlrev_b32 v10, 2, v1
    s_lshl_b32 s62, s66, 8
    s_lshl_b32 s63, s66, 1
    s_and_b32 s63, s63, -4
    s_waitcnt lgkmcnt(0)
    s_mov_b32 s40, s6
    s_mov_b32 s41, s7
    s_mov_b32 s42, 163840
    s_mov_b32 s43, 0x00020000
    s_mov_b32 s44, s8
    s_mov_b32 s45, s9
    s_mov_b32 s46, 163840
    s_mov_b32 s47, 0x00020000
    s_mov_b32 s48, s10
    s_mov_b32 s49, s11
    s_mov_b32 s50, 163840
    s_mov_b32 s51, 0x00020000
    s_mov_b32 s52, s12
    s_mov_b32 s53, s13
    s_mov_b32 s54, 163840
    s_mov_b32 s55, 0x00020000
    buffer_load_dword v12, v10, s[40:43], s62 offen
    buffer_load_dword v13, v10, s[44:47], s62 offen
    buffer_load_dword v14, v10, s[48:51], s62 offen
    buffer_load_dword v15, v10, s[52:55], s62 offen
    s_load_dword s20, s[14:15], s63
    s_load_dword s21, s[16:17], s63
    s_load_dword s56, s[28:29], 0
    s_setprio 1
    s_mov_b32 s32, s28
    s_mov_b32 s33, s29
    s_mov_b32 s34, 268435456
    s_mov_b32 s35, 0x00020000
    s_add_u32 s60, s30, 46080
    s_addc_u32 s61, s31, 0
    v_lshlrev_b32 v6, 3, v1
    v_mov_b32 v7, s61
    v_add_co_u32 v6, vcc, s60, v6
    s_nop 1
    v_addc_co_u32_e64 v7, vcc, 0, v7, vcc
    global_load_dwordx2 v[20:21], v[6:7], off offset:-4096
    s_mul_i32 s22, s91, 1408
    s_add_u32 s22, s22, 66080
    s_waitcnt lgkmcnt(0)
    s_add_u32 s56, s56, 2654435769
    s_bitcmp1_b32 s66, 0
    s_cselect_b32 s60, 0, 16
    s_lshl_b32 s20, s20, s60
    s_and_b32 s20, s20, 0xffff0000
    s_lshl_b32 s21, s21, s60
    s_and_b32 s21, s21, 0xffff0000
    v_mov_b32 v22, s20
    v_mul_f32 v22, 0x3fb8aa3b, v22
    v_exp_f32 v22, v22
    s_nop 0
    v_cvt_pk_bf16_f32 v22, v22, v22
    v_lshlrev_b32 v22, 16, v22
    v_and_b32 v4, 31, v1
    v_mul_u32_u24 v4, 272, v4
    v_lshrrev_b32_e64 v5, 5, v1
    v_lshl_add_u32 v4, v5, 4, v4
    v_add_u32 v23, s69, v4
    s_mov_b32 m0, s69
    s_waitcnt vmcnt(1)
    v_lshlrev_b32 v16, 16, v12
    v_lshlrev_b32 v17, 16, v13
    v_lshlrev_b32 v18, 16, v14
    v_lshlrev_b32_e64 v19, 16, v15
    v_mul_f32 v16, 0x3fb8aa3b, v16
    v_exp_f32 v16, v16
    v_mul_f32 v17, v17, v22
    v_mul_f32_e64 v17, 0x3e22f983, v17
    v_cvt_pk_bf16_f32 v16, v16, v16
    v_rndne_f32 v4, v17
    v_lshlrev_b32 v16, 16, v16
    v_sub_f32 v17, v17, v4
    v_mul_f32 v16, v16, v22
    v_mul_f32 v16, 0xbfb8aa3b, v16
    v_add_f32 v4, v22, v22
    v_mul_f32 v46, v18, v4
    v_mul_f32 v47, -v19, v4
    v_mul_f32 v4, 0x3f800000, v16
    v_mul_f32 v5, 0x3f800000, v17
    v_exp_f32 v4, v4
    v_cos_f32 v40, v5
    v_sin_f32 v41, v5
    v_mul_f32 v40, v40, v4
    v_mul_f32_e64 v41, v41, v4
    v_mul_f32 v4, 0x41000000, v16
    v_mul_f32 v5, 0x41000000, v17
    v_exp_f32 v4, v4
    v_cos_f32 v42, v5
    v_sin_f32 v43, v5
    v_mul_f32 v42, v42, v4
    v_mul_f32_e64 v43, v43, v4
    v_mul_f32 v4, 0x43800000, v16
    v_mul_f32 v5, 0x43800000, v17
    v_exp_f32 v4, v4
    v_cos_f32 v44, v5
    v_sin_f32 v45, v5
    v_mul_f32 v44, v44, v4
    v_mul_f32_e64 v45, v45, v4
    v_mov_b32 v74, 0x3f80
    ds_write_addtid_b32 v74 offset:5712
    v_cvt_pk_bf16_f32 v75, v42, v43
    ds_write_addtid_b32 v75 offset:5984
    v_cvt_pk_bf16_f32 v76, v46, v47
    ds_write_addtid_b32 v76 offset:0
    v_pk_mul_f32 v[70:71], v[42:43], v[42:43] op_sel:[0,0] op_sel_hi:[1,0]
    v_pk_mul_f32 v[48:49], v[46:47], v[40:41] op_sel:[0,0] op_sel_hi:[1,0]
    v_pk_fma_f32 v[70:71], v[42:43], v[42:43], v[70:71] op_sel:[1,1,0] op_sel_hi:[0,1,1] neg_lo:[1,0,0]
    v_pk_fma_f32 v[48:49], v[46:47], v[40:41], v[48:49] op_sel:[1,1,0] op_sel_hi:[0,1,1] neg_hi:[1,0,0]
    v_cvt_pk_bf16_f32 v77, v70, v71
    v_cvt_pk_bf16_f32 v74, v48, v49
    ds_write_addtid_b32 v77 offset:6256
    ds_write_addtid_b32 v74 offset:272
    v_pk_mul_f32 v[72:73], v[70:71], v[42:43] op_sel:[0,0] op_sel_hi:[1,0]
    v_pk_mul_f32 v[50:51], v[48:49], v[40:41] op_sel:[0,0] op_sel_hi:[1,0]
    v_pk_fma_f32 v[72:73], v[70:71], v[42:43], v[72:73] op_sel:[1,1,0] op_sel_hi:[0,1,1] neg_lo:[1,0,0]
    v_pk_fma_f32 v[50:51], v[48:49], v[40:41], v[50:51] op_sel:[1,1,0] op_sel_hi:[0,1,1] neg_hi:[1,0,0]
    v_cvt_pk_bf16_f32 v75, v72, v73
    v_cvt_pk_bf16_f32 v76, v50, v51
    ds_write_addtid_b32 v75 offset:6528
    ds_write_addtid_b32 v76 offset:544
    v_pk_mul_f32 v[70:71], v[72:73], v[42:43] op_sel:[0,0] op_sel_hi:[1,0]
    v_pk_mul_f32 v[52:53], v[50:51], v[40:41] op_sel:[0,0] op_sel_hi:[1,0]
    v_pk_fma_f32 v[70:71], v[72:73], v[42:43], v[70:71] op_sel:[1,1,0] op_sel_hi:[0,1,1] neg_lo:[1,0,0]
    v_pk_fma_f32 v[52:53], v[50:51], v[40:41], v[52:53] op_sel:[1,1,0] op_sel_hi:[0,1,1] neg_hi:[1,0,0]
    v_cvt_pk_bf16_f32 v77, v70, v71
    v_cvt_pk_bf16_f32 v74, v52, v53
    ds_write_addtid_b32 v77 offset:6800
    ds_write_addtid_b32 v74 offset:816
    v_pk_mul_f32 v[72:73], v[70:71], v[42:43] op_sel:[0,0] op_sel_hi:[1,0]
    v_pk_mul_f32 v[54:55], v[52:53], v[40:41] op_sel:[0,0] op_sel_hi:[1,0]
    v_pk_fma_f32 v[72:73], v[70:71], v[42:43], v[72:73] op_sel:[1,1,0] op_sel_hi:[0,1,1] neg_lo:[1,0,0]
    v_pk_fma_f32 v[54:55], v[52:53], v[40:41], v[54:55] op_sel:[1,1,0] op_sel_hi:[0,1,1] neg_hi:[1,0,0]
    v_cvt_pk_bf16_f32 v75, v72, v73
    v_cvt_pk_bf16_f32 v76, v54, v55
    ds_write_addtid_b32 v75 offset:7072
    ds_write_addtid_b32 v76 offset:1088
    v_pk_mul_f32 v[70:71], v[72:73], v[42:43] op_sel:[0,0] op_sel_hi:[1,0]
    v_pk_mul_f32 v[56:57], v[54:55], v[40:41] op_sel:[0,0] op_sel_hi:[1,0]
    v_pk_fma_f32 v[70:71], v[72:73], v[42:43], v[70:71] op_sel:[1,1,0] op_sel_hi:[0,1,1] neg_lo:[1,0,0]
    v_pk_fma_f32 v[56:57], v[54:55], v[40:41], v[56:57] op_sel:[1,1,0] op_sel_hi:[0,1,1] neg_hi:[1,0,0]
    v_cvt_pk_bf16_f32 v77, v70, v71
    v_cvt_pk_bf16_f32 v74, v56, v57
    ds_write_addtid_b32 v77 offset:7344
    ds_write_addtid_b32 v74 offset:1360
    v_pk_mul_f32 v[72:73], v[70:71], v[42:43] op_sel:[0,0] op_sel_hi:[1,0]
    v_pk_mul_f32 v[58:59], v[56:57], v[40:41] op_sel:[0,0] op_sel_hi:[1,0]
    v_pk_fma_f32 v[72:73], v[70:71], v[42:43], v[72:73] op_sel:[1,1,0] op_sel_hi:[0,1,1] neg_lo:[1,0,0]
    v_pk_fma_f32 v[58:59], v[56:57], v[40:41], v[58:59] op_sel:[1,1,0] op_sel_hi:[0,1,1] neg_hi:[1,0,0]
    v_cvt_pk_bf16_f32 v75, v72, v73
    v_cvt_pk_bf16_f32 v76, v58, v59
    ds_write_addtid_b32 v75 offset:7616
    ds_write_addtid_b32 v76 offset:1632
    v_pk_mul_f32 v[70:71], v[72:73], v[42:43] op_sel:[0,0] op_sel_hi:[1,0]
    v_pk_mul_f32 v[60:61], v[58:59], v[40:41] op_sel:[0,0] op_sel_hi:[1,0]
    v_pk_fma_f32 v[70:71], v[72:73], v[42:43], v[70:71] op_sel:[1,1,0] op_sel_hi:[0,1,1] neg_lo:[1,0,0]
    v_pk_fma_f32 v[60:61], v[58:59], v[40:41], v[60:61] op_sel:[1,1,0] op_sel_hi:[0,1,1] neg_hi:[1,0,0]
    v_cvt_pk_bf16_f32 v77, v70, v71
    v_cvt_pk_bf16_f32 v74, v60, v61
    ds_write_addtid_b32 v77 offset:7888
    ds_write_addtid_b32 v74 offset:1904
    v_pk_mul_f32 v[72:73], v[70:71], v[42:43] op_sel:[0,0] op_sel_hi:[1,0]
    v_pk_mul_f32 v[62:63], v[46:47], v[44:45] op_sel:[0,0] op_sel_hi:[1,0]
    v_pk_fma_f32 v[72:73], v[70:71], v[42:43], v[72:73] op_sel:[1,1,0] op_sel_hi:[0,1,1] neg_lo:[1,0,0]
    v_pk_fma_f32 v[62:63], v[46:47], v[44:45], v[62:63] op_sel:[1,1,0] op_sel_hi:[0,1,1] neg_hi:[1,0,0]
    v_cvt_pk_bf16_f32 v75, v72, v73
    v_cvt_pk_bf16_f32 v76, v62, v63
    ds_write_addtid_b32 v75 offset:8160
    ds_write_addtid_b32 v76 offset:2176
    v_pk_mul_f32 v[70:71], v[72:73], v[42:43] op_sel:[0,0] op_sel_hi:[1,0]
    v_pk_mul_f32 v[64:65], v[50:51], v[44:45] op_sel:[0,0] op_sel_hi:[1,0]
    v_pk_fma_f32 v[70:71], v[72:73], v[42:43], v[70:71] op_sel:[1,1,0] op_sel_hi:[0,1,1] neg_lo:[1,0,0]
    v_pk_fma_f32 v[64:65], v[50:51], v[44:45], v[64:65] op_sel:[1,1,0] op_sel_hi:[0,1,1] neg_hi:[1,0,0]
    v_cvt_pk_bf16_f32 v77, v70, v71
    v_cvt_pk_bf16_f32 v74, v64, v65
    ds_write_addtid_b32 v77 offset:8432
    ds_write_addtid_b32 v74 offset:2448
    v_pk_mul_f32 v[72:73], v[70:71], v[42:43] op_sel:[0,0] op_sel_hi:[1,0]
    v_pk_mul_f32 v[66:67], v[54:55], v[44:45] op_sel:[0,0] op_sel_hi:[1,0]
    v_pk_fma_f32 v[72:73], v[70:71], v[42:43], v[72:73] op_sel:[1,1,0] op_sel_hi:[0,1,1] neg_lo:[1,0,0]
    v_pk_fma_f32 v[66:67], v[54:55], v[44:45], v[66:67] op_sel:[1,1,0] op_sel_hi:[0,1,1] neg_hi:[1,0,0]
    v_cvt_pk_bf16_f32 v75, v72, v73
    v_cvt_pk_bf16_f32 v76, v66, v67
    ds_write_addtid_b32 v75 offset:8704
    ds_write_addtid_b32 v76 offset:2720
    v_pk_mul_f32 v[70:71], v[72:73], v[42:43] op_sel:[0,0] op_sel_hi:[1,0]
    v_pk_mul_f32 v[68:69], v[58:59], v[44:45] op_sel:[0,0] op_sel_hi:[1,0]
    v_pk_fma_f32 v[70:71], v[72:73], v[42:43], v[70:71] op_sel:[1,1,0] op_sel_hi:[0,1,1] neg_lo:[1,0,0]
    v_pk_fma_f32 v[68:69], v[58:59], v[44:45], v[68:69] op_sel:[1,1,0] op_sel_hi:[0,1,1] neg_hi:[1,0,0]
    v_cvt_pk_bf16_f32 v77, v70, v71
    v_cvt_pk_bf16_f32 v74, v68, v69
    ds_write_addtid_b32 v77 offset:8976
    ds_write_addtid_b32 v74 offset:2992
    v_pk_mul_f32 v[72:73], v[70:71], v[42:43] op_sel:[0,0] op_sel_hi:[1,0]
    v_pk_mul_f32 v[46:47], v[62:63], v[44:45] op_sel:[0,0] op_sel_hi:[1,0]
    v_pk_fma_f32 v[72:73], v[70:71], v[42:43], v[72:73] op_sel:[1,1,0] op_sel_hi:[0,1,1] neg_lo:[1,0,0]
    v_pk_fma_f32 v[46:47], v[62:63], v[44:45], v[46:47] op_sel:[1,1,0] op_sel_hi:[0,1,1] neg_hi:[1,0,0]
    v_cvt_pk_bf16_f32 v75, v72, v73
    v_cvt_pk_bf16_f32 v76, v46, v47
    ds_write_addtid_b32 v75 offset:9248
    ds_write_addtid_b32 v76 offset:3264
    v_pk_mul_f32 v[70:71], v[72:73], v[42:43] op_sel:[0,0] op_sel_hi:[1,0]
    v_pk_mul_f32 v[48:49], v[66:67], v[44:45] op_sel:[0,0] op_sel_hi:[1,0]
    v_pk_fma_f32 v[70:71], v[72:73], v[42:43], v[70:71] op_sel:[1,1,0] op_sel_hi:[0,1,1] neg_lo:[1,0,0]
    v_pk_fma_f32 v[48:49], v[66:67], v[44:45], v[48:49] op_sel:[1,1,0] op_sel_hi:[0,1,1] neg_hi:[1,0,0]
    v_cvt_pk_bf16_f32 v77, v70, v71
    v_cvt_pk_bf16_f32 v74, v48, v49
    ds_write_addtid_b32 v77 offset:9520
    ds_write_addtid_b32 v74 offset:3536
    v_pk_mul_f32 v[72:73], v[70:71], v[42:43] op_sel:[0,0] op_sel_hi:[1,0]
    v_pk_mul_f32 v[62:63], v[46:47], v[44:45] op_sel:[0,0] op_sel_hi:[1,0]
    v_pk_fma_f32 v[72:73], v[70:71], v[42:43], v[72:73] op_sel:[1,1,0] op_sel_hi:[0,1,1] neg_lo:[1,0,0]
    v_pk_fma_f32 v[62:63], v[46:47], v[44:45], v[62:63] op_sel:[1,1,0] op_sel_hi:[0,1,1] neg_hi:[1,0,0]
    v_cvt_pk_bf16_f32 v75, v72, v73
    v_cvt_pk_bf16_f32 v76, v62, v63
    ds_write_addtid_b32 v75 offset:9792
    ds_write_addtid_b32 v76 offset:3808
    v_pk_mul_f32 v[70:71], v[72:73], v[42:43] op_sel:[0,0] op_sel_hi:[1,0]
    v_pk_mul_f32 v[64:65], v[48:49], v[44:45] op_sel:[0,0] op_sel_hi:[1,0]
    v_pk_fma_f32 v[70:71], v[72:73], v[42:43], v[70:71] op_sel:[1,1,0] op_sel_hi:[0,1,1] neg_lo:[1,0,0]
    v_pk_fma_f32 v[64:65], v[48:49], v[44:45], v[64:65] op_sel:[1,1,0] op_sel_hi:[0,1,1] neg_hi:[1,0,0]
    v_cvt_pk_bf16_f32 v77, v70, v71
    v_cvt_pk_bf16_f32 v74, v64, v65
    ds_write_addtid_b32 v77 offset:10064
    ds_write_addtid_b32 v74 offset:4080
    v_pk_mul_f32 v[72:73], v[70:71], v[42:43] op_sel:[0,0] op_sel_hi:[1,0]
    v_pk_mul_f32 v[46:47], v[62:63], v[44:45] op_sel:[0,0] op_sel_hi:[1,0]
    v_pk_fma_f32 v[72:73], v[70:71], v[42:43], v[72:73] op_sel:[1,1,0] op_sel_hi:[0,1,1] neg_lo:[1,0,0]
    v_pk_fma_f32 v[46:47], v[62:63], v[44:45], v[46:47] op_sel:[1,1,0] op_sel_hi:[0,1,1] neg_hi:[1,0,0]
    v_cvt_pk_bf16_f32 v75, v72, v73
    v_cvt_pk_bf16_f32 v76, v46, v47
    ds_write_addtid_b32 v75 offset:10336
    ds_write_addtid_b32 v76 offset:4352
    v_pk_mul_f32 v[70:71], v[72:73], v[42:43] op_sel:[0,0] op_sel_hi:[1,0]
    v_pk_mul_f32 v[62:63], v[46:47], v[44:45] op_sel:[0,0] op_sel_hi:[1,0]
    v_pk_fma_f32 v[70:71], v[72:73], v[42:43], v[70:71] op_sel:[1,1,0] op_sel_hi:[0,1,1] neg_lo:[1,0,0]
    v_pk_fma_f32 v[62:63], v[46:47], v[44:45], v[62:63] op_sel:[1,1,0] op_sel_hi:[0,1,1] neg_hi:[1,0,0]
    v_cvt_pk_bf16_f32 v77, v70, v71
    v_cvt_pk_bf16_f32 v74, v62, v63
    ds_write_addtid_b32 v77 offset:10608
    ds_write_addtid_b32 v74 offset:4624
    v_pk_mul_f32 v[72:73], v[70:71], v[42:43] op_sel:[0,0] op_sel_hi:[1,0]
    v_pk_mul_f32 v[46:47], v[62:63], v[44:45] op_sel:[0,0] op_sel_hi:[1,0]
    v_pk_fma_f32 v[72:73], v[70:71], v[42:43], v[72:73] op_sel:[1,1,0] op_sel_hi:[0,1,1] neg_lo:[1,0,0]
    v_pk_fma_f32 v[46:47], v[62:63], v[44:45], v[46:47] op_sel:[1,1,0] op_sel_hi:[0,1,1] neg_hi:[1,0,0]
    v_cvt_pk_bf16_f32 v75, v72, v73
    v_cvt_pk_bf16_f32 v76, v46, v47
    ds_write_addtid_b32 v75 offset:10880
    ds_write_addtid_b32 v76 offset:4896
    v_pk_mul_f32 v[70:71], v[72:73], v[42:43] op_sel:[0,0] op_sel_hi:[1,0]
    v_pk_mul_f32 v[62:63], v[46:47], v[44:45] op_sel:[0,0] op_sel_hi:[1,0]
    v_pk_fma_f32 v[70:71], v[72:73], v[42:43], v[70:71] op_sel:[1,1,0] op_sel_hi:[0,1,1] neg_lo:[1,0,0]
    v_pk_fma_f32 v[62:63], v[46:47], v[44:45], v[62:63] op_sel:[1,1,0] op_sel_hi:[0,1,1] neg_hi:[1,0,0]
    v_cvt_pk_bf16_f32 v77, v70, v71
    v_cvt_pk_bf16_f32 v74, v62, v63
    ds_write_addtid_b32 v77 offset:11152
    ds_write_addtid_b32 v74 offset:5168
    v_pk_mul_f32 v[72:73], v[70:71], v[42:43] op_sel:[0,0] op_sel_hi:[1,0]
    v_pk_mul_f32 v[46:47], v[62:63], v[44:45] op_sel:[0,0] op_sel_hi:[1,0]
    v_pk_fma_f32 v[72:73], v[70:71], v[42:43], v[72:73] op_sel:[1,1,0] op_sel_hi:[0,1,1] neg_lo:[1,0,0]
    v_pk_fma_f32 v[46:47], v[62:63], v[44:45], v[46:47] op_sel:[1,1,0] op_sel_hi:[0,1,1] neg_hi:[1,0,0]
    v_cvt_pk_bf16_f32 v75, v72, v73
    v_cvt_pk_bf16_f32 v76, v46, v47
    ds_write_addtid_b32 v75 offset:11424
    ds_write_addtid_b32 v76 offset:5440
    v_pk_mul_f32 v[70:71], v[72:73], v[42:43] op_sel:[0,0] op_sel_hi:[1,0]
    v_pk_fma_f32 v[70:71], v[72:73], v[42:43], v[70:71] op_sel:[1,1,0] op_sel_hi:[0,1,1] neg_lo:[1,0,0]
    v_cvt_pk_bf16_f32 v77, v70, v71
    ds_write_addtid_b32 v77 offset:11696
    v_pk_mul_f32 v[72:73], v[70:71], v[42:43] op_sel:[0,0] op_sel_hi:[1,0]
    v_pk_fma_f32 v[72:73], v[70:71], v[42:43], v[72:73] op_sel:[1,1,0] op_sel_hi:[0,1,1] neg_lo:[1,0,0]
    v_cvt_pk_bf16_f32 v74, v72, v73
    ds_write_addtid_b32 v74 offset:11968
    v_pk_mul_f32 v[70:71], v[72:73], v[42:43] op_sel:[0,0] op_sel_hi:[1,0]
    v_pk_fma_f32 v[70:71], v[72:73], v[42:43], v[70:71] op_sel:[1,1,0] op_sel_hi:[0,1,1] neg_lo:[1,0,0]
    v_cvt_pk_bf16_f32 v75, v70, v71
    ds_write_addtid_b32 v75 offset:12240
    v_pk_mul_f32 v[72:73], v[70:71], v[42:43] op_sel:[0,0] op_sel_hi:[1,0]
    v_pk_fma_f32 v[72:73], v[70:71], v[42:43], v[72:73] op_sel:[1,1,0] op_sel_hi:[0,1,1] neg_lo:[1,0,0]
    v_cvt_pk_bf16_f32 v76, v72, v73
    ds_write_addtid_b32 v76 offset:12512
    v_pk_mul_f32 v[70:71], v[72:73], v[42:43] op_sel:[0,0] op_sel_hi:[1,0]
    v_pk_fma_f32 v[70:71], v[72:73], v[42:43], v[70:71] op_sel:[1,1,0] op_sel_hi:[0,1,1] neg_lo:[1,0,0]
    v_cvt_pk_bf16_f32 v77, v70, v71
    ds_write_addtid_b32 v77 offset:12784
    v_pk_mul_f32 v[72:73], v[70:71], v[42:43] op_sel:[0,0] op_sel_hi:[1,0]
    v_pk_fma_f32 v[72:73], v[70:71], v[42:43], v[72:73] op_sel:[1,1,0] op_sel_hi:[0,1,1] neg_lo:[1,0,0]
    v_cvt_pk_bf16_f32 v74, v72, v73
    ds_write_addtid_b32 v74 offset:13056
    v_pk_mul_f32 v[70:71], v[72:73], v[42:43] op_sel:[0,0] op_sel_hi:[1,0]
    v_pk_fma_f32 v[70:71], v[72:73], v[42:43], v[70:71] op_sel:[1,1,0] op_sel_hi:[0,1,1] neg_lo:[1,0,0]
    v_cvt_pk_bf16_f32 v75, v70, v71
    ds_write_addtid_b32 v75 offset:13328
    v_pk_mul_f32 v[72:73], v[70:71], v[42:43] op_sel:[0,0] op_sel_hi:[1,0]
    v_pk_fma_f32 v[72:73], v[70:71], v[42:43], v[72:73] op_sel:[1,1,0] op_sel_hi:[0,1,1] neg_lo:[1,0,0]
    v_cvt_pk_bf16_f32 v76, v72, v73
    ds_write_addtid_b32 v76 offset:13600
    v_pk_mul_f32 v[70:71], v[72:73], v[42:43] op_sel:[0,0] op_sel_hi:[1,0]
    v_pk_fma_f32 v[70:71], v[72:73], v[42:43], v[70:71] op_sel:[1,1,0] op_sel_hi:[0,1,1] neg_lo:[1,0,0]
    v_cvt_pk_bf16_f32 v77, v70, v71
    ds_write_addtid_b32 v77 offset:13872
    v_pk_mul_f32 v[72:73], v[70:71], v[42:43] op_sel:[0,0] op_sel_hi:[1,0]
    v_pk_fma_f32 v[72:73], v[70:71], v[42:43], v[72:73] op_sel:[1,1,0] op_sel_hi:[0,1,1] neg_lo:[1,0,0]
    v_cvt_pk_bf16_f32 v74, v72, v73
    ds_write_addtid_b32 v74 offset:14144
    s_waitcnt lgkmcnt(0)
    s_nop 0
    ds_read_b128 v[80:83], v23 offset:0
    ds_read_b128 v[84:87], v23 offset:5712
    ds_read_b128 v[88:91], v23 offset:32
    ds_read_b128 v[92:95], v23 offset:5744
    ds_read_b128 v[96:99], v23 offset:64
    ds_read_b128 v[100:103], v23 offset:5776
    ds_read_b128 v[104:107], v23 offset:96
    ds_read_b128 v[108:111], v23 offset:5808
    s_waitcnt lgkmcnt(6)
    v_mfma_f32_32x32x16_bf16 v[24:39], v[80:83], v[84:87], 0
    s_waitcnt lgkmcnt(4)
    v_mfma_f32_32x32x16_bf16 v[24:39], v[88:91], v[92:95], v[24:39]
    s_waitcnt lgkmcnt(2)
    v_mfma_f32_32x32x16_bf16 v[24:39], v[96:99], v[100:103], v[24:39]
    s_waitcnt lgkmcnt(0)
    v_mfma_f32_32x32x16_bf16 v[24:39], v[104:107], v[108:111], v[24:39]
    ds_read_b128 v[80:83], v23 offset:128
    ds_read_b128 v[84:87], v23 offset:5840
    ds_read_b128 v[88:91], v23 offset:160
    ds_read_b128 v[92:95], v23 offset:5872
    ds_read_b128 v[96:99], v23 offset:192
    ds_read_b128 v[100:103], v23 offset:5904
    ds_read_b128 v[104:107], v23 offset:224
    ds_read_b128 v[108:111], v23 offset:5936
    s_waitcnt lgkmcnt(6)
    v_mfma_f32_32x32x16_bf16 v[24:39], v[80:83], v[84:87], v[24:39]
    s_waitcnt lgkmcnt(4)
    v_mfma_f32_32x32x16_bf16 v[24:39], v[88:91], v[92:95], v[24:39]
    s_waitcnt lgkmcnt(2)
    v_mfma_f32_32x32x16_bf16 v[24:39], v[96:99], v[100:103], v[24:39]
    s_waitcnt lgkmcnt(0)
    v_mfma_f32_32x32x16_bf16 v[24:39], v[104:107], v[108:111], v[24:39]
    v_and_b32 v16, 0xffff0000, v12
    v_and_b32 v17, 0xffff0000, v13
    v_and_b32 v18, 0xffff0000, v14
    v_and_b32 v19, 0xffff0000, v15
    v_mul_f32 v16, 0x3fb8aa3b, v16
    v_exp_f32 v16, v16
    v_mul_f32 v17, v17, v22
    v_mul_f32_e64 v17, 0x3e22f983, v17
    v_cvt_pk_bf16_f32 v16, v16, v16
    v_rndne_f32 v4, v17
    v_lshlrev_b32 v16, 16, v16
    v_sub_f32 v17, v17, v4
    v_mul_f32 v16, v16, v22
    v_mul_f32 v16, 0xbfb8aa3b, v16
    v_add_f32 v4, v22, v22
    v_mul_f32 v46, v18, v4
    v_mul_f32 v47, -v19, v4
    v_mul_f32 v4, 0x3f800000, v16
    v_mul_f32 v5, 0x3f800000, v17
    v_exp_f32 v4, v4
    v_cos_f32 v40, v5
    v_sin_f32 v41, v5
    v_mul_f32 v40, v40, v4
    v_mul_f32_e64 v41, v41, v4
    v_mul_f32 v4, 0x41000000, v16
    v_mul_f32 v5, 0x41000000, v17
    v_exp_f32 v4, v4
    v_cos_f32 v42, v5
    v_sin_f32 v43, v5
    v_mul_f32 v42, v42, v4
    v_mul_f32_e64 v43, v43, v4
    v_mul_f32 v4, 0x43800000, v16
    v_mul_f32 v5, 0x43800000, v17
    v_exp_f32 v4, v4
    v_cos_f32 v44, v5
    v_sin_f32 v45, v5
    v_mul_f32 v44, v44, v4
    v_mul_f32 v45, v45, v4
    s_waitcnt lgkmcnt(0)
    v_mov_b32 v74, 0x3f80
    ds_write_addtid_b32 v74 offset:5712
    v_cvt_pk_bf16_f32 v75, v42, v43
    ds_write_addtid_b32 v75 offset:5984
    v_cvt_pk_bf16_f32 v76, v46, v47
    ds_write_addtid_b32 v76 offset:0
    v_pk_mul_f32 v[70:71], v[42:43], v[42:43] op_sel:[0,0] op_sel_hi:[1,0]
    v_pk_mul_f32 v[48:49], v[46:47], v[40:41] op_sel:[0,0] op_sel_hi:[1,0]
    v_pk_fma_f32 v[70:71], v[42:43], v[42:43], v[70:71] op_sel:[1,1,0] op_sel_hi:[0,1,1] neg_lo:[1,0,0]
    v_pk_fma_f32 v[48:49], v[46:47], v[40:41], v[48:49] op_sel:[1,1,0] op_sel_hi:[0,1,1] neg_hi:[1,0,0]
    v_cvt_pk_bf16_f32 v77, v70, v71
    v_cvt_pk_bf16_f32 v74, v48, v49
    ds_write_addtid_b32 v77 offset:6256
    ds_write_addtid_b32 v74 offset:272
    v_pk_mul_f32 v[72:73], v[70:71], v[42:43] op_sel:[0,0] op_sel_hi:[1,0]
    v_pk_mul_f32 v[50:51], v[48:49], v[40:41] op_sel:[0,0] op_sel_hi:[1,0]
    v_pk_fma_f32 v[72:73], v[70:71], v[42:43], v[72:73] op_sel:[1,1,0] op_sel_hi:[0,1,1] neg_lo:[1,0,0]
    v_pk_fma_f32 v[50:51], v[48:49], v[40:41], v[50:51] op_sel:[1,1,0] op_sel_hi:[0,1,1] neg_hi:[1,0,0]
    v_cvt_pk_bf16_f32 v75, v72, v73
    v_cvt_pk_bf16_f32 v76, v50, v51
    ds_write_addtid_b32 v75 offset:6528
    ds_write_addtid_b32 v76 offset:544
    v_pk_mul_f32 v[70:71], v[72:73], v[42:43] op_sel:[0,0] op_sel_hi:[1,0]
    v_pk_mul_f32 v[52:53], v[50:51], v[40:41] op_sel:[0,0] op_sel_hi:[1,0]
    v_pk_fma_f32 v[70:71], v[72:73], v[42:43], v[70:71] op_sel:[1,1,0] op_sel_hi:[0,1,1] neg_lo:[1,0,0]
    v_pk_fma_f32 v[52:53], v[50:51], v[40:41], v[52:53] op_sel:[1,1,0] op_sel_hi:[0,1,1] neg_hi:[1,0,0]
    v_cvt_pk_bf16_f32 v77, v70, v71
    v_cvt_pk_bf16_f32 v74, v52, v53
    ds_write_addtid_b32 v77 offset:6800
    ds_write_addtid_b32 v74 offset:816
    v_pk_mul_f32 v[72:73], v[70:71], v[42:43] op_sel:[0,0] op_sel_hi:[1,0]
    v_pk_mul_f32 v[54:55], v[52:53], v[40:41] op_sel:[0,0] op_sel_hi:[1,0]
    v_pk_fma_f32 v[72:73], v[70:71], v[42:43], v[72:73] op_sel:[1,1,0] op_sel_hi:[0,1,1] neg_lo:[1,0,0]
    v_pk_fma_f32 v[54:55], v[52:53], v[40:41], v[54:55] op_sel:[1,1,0] op_sel_hi:[0,1,1] neg_hi:[1,0,0]
    v_cvt_pk_bf16_f32 v75, v72, v73
    v_cvt_pk_bf16_f32 v76, v54, v55
    ds_write_addtid_b32 v75 offset:7072
    ds_write_addtid_b32 v76 offset:1088
    v_pk_mul_f32 v[70:71], v[72:73], v[42:43] op_sel:[0,0] op_sel_hi:[1,0]
    v_pk_mul_f32 v[56:57], v[54:55], v[40:41] op_sel:[0,0] op_sel_hi:[1,0]
    v_pk_fma_f32 v[70:71], v[72:73], v[42:43], v[70:71] op_sel:[1,1,0] op_sel_hi:[0,1,1] neg_lo:[1,0,0]
    v_pk_fma_f32 v[56:57], v[54:55], v[40:41], v[56:57] op_sel:[1,1,0] op_sel_hi:[0,1,1] neg_hi:[1,0,0]
    v_cvt_pk_bf16_f32 v77, v70, v71
    v_cvt_pk_bf16_f32 v74, v56, v57
    ds_write_addtid_b32 v77 offset:7344
    ds_write_addtid_b32 v74 offset:1360
    v_pk_mul_f32 v[72:73], v[70:71], v[42:43] op_sel:[0,0] op_sel_hi:[1,0]
    v_pk_mul_f32 v[58:59], v[56:57], v[40:41] op_sel:[0,0] op_sel_hi:[1,0]
    v_pk_fma_f32 v[72:73], v[70:71], v[42:43], v[72:73] op_sel:[1,1,0] op_sel_hi:[0,1,1] neg_lo:[1,0,0]
    v_pk_fma_f32 v[58:59], v[56:57], v[40:41], v[58:59] op_sel:[1,1,0] op_sel_hi:[0,1,1] neg_hi:[1,0,0]
    v_cvt_pk_bf16_f32 v75, v72, v73
    v_cvt_pk_bf16_f32 v76, v58, v59
    ds_write_addtid_b32 v75 offset:7616
    ds_write_addtid_b32 v76 offset:1632
    v_pk_mul_f32 v[70:71], v[72:73], v[42:43] op_sel:[0,0] op_sel_hi:[1,0]
    v_pk_mul_f32 v[60:61], v[58:59], v[40:41] op_sel:[0,0] op_sel_hi:[1,0]
    v_pk_fma_f32 v[70:71], v[72:73], v[42:43], v[70:71] op_sel:[1,1,0] op_sel_hi:[0,1,1] neg_lo:[1,0,0]
    v_pk_fma_f32 v[60:61], v[58:59], v[40:41], v[60:61] op_sel:[1,1,0] op_sel_hi:[0,1,1] neg_hi:[1,0,0]
    v_cvt_pk_bf16_f32 v77, v70, v71
    v_cvt_pk_bf16_f32 v74, v60, v61
    ds_write_addtid_b32 v77 offset:7888
    ds_write_addtid_b32 v74 offset:1904
    v_pk_mul_f32 v[72:73], v[70:71], v[42:43] op_sel:[0,0] op_sel_hi:[1,0]
    v_pk_mul_f32 v[62:63], v[46:47], v[44:45] op_sel:[0,0] op_sel_hi:[1,0]
    v_pk_fma_f32 v[72:73], v[70:71], v[42:43], v[72:73] op_sel:[1,1,0] op_sel_hi:[0,1,1] neg_lo:[1,0,0]
    v_pk_fma_f32 v[62:63], v[46:47], v[44:45], v[62:63] op_sel:[1,1,0] op_sel_hi:[0,1,1] neg_hi:[1,0,0]
    v_cvt_pk_bf16_f32 v75, v72, v73
    v_cvt_pk_bf16_f32 v76, v62, v63
    ds_write_addtid_b32 v75 offset:8160
    ds_write_addtid_b32 v76 offset:2176
    v_pk_mul_f32 v[70:71], v[72:73], v[42:43] op_sel:[0,0] op_sel_hi:[1,0]
    v_pk_mul_f32 v[64:65], v[50:51], v[44:45] op_sel:[0,0] op_sel_hi:[1,0]
    v_pk_fma_f32 v[70:71], v[72:73], v[42:43], v[70:71] op_sel:[1,1,0] op_sel_hi:[0,1,1] neg_lo:[1,0,0]
    v_pk_fma_f32 v[64:65], v[50:51], v[44:45], v[64:65] op_sel:[1,1,0] op_sel_hi:[0,1,1] neg_hi:[1,0,0]
    v_cvt_pk_bf16_f32 v77, v70, v71
    v_cvt_pk_bf16_f32 v74, v64, v65
    ds_write_addtid_b32 v77 offset:8432
    ds_write_addtid_b32 v74 offset:2448
    v_pk_mul_f32 v[72:73], v[70:71], v[42:43] op_sel:[0,0] op_sel_hi:[1,0]
    v_pk_mul_f32 v[66:67], v[54:55], v[44:45] op_sel:[0,0] op_sel_hi:[1,0]
    v_pk_fma_f32 v[72:73], v[70:71], v[42:43], v[72:73] op_sel:[1,1,0] op_sel_hi:[0,1,1] neg_lo:[1,0,0]
    v_pk_fma_f32 v[66:67], v[54:55], v[44:45], v[66:67] op_sel:[1,1,0] op_sel_hi:[0,1,1] neg_hi:[1,0,0]
    v_cvt_pk_bf16_f32 v75, v72, v73
    v_cvt_pk_bf16_f32 v76, v66, v67
    ds_write_addtid_b32 v75 offset:8704
    ds_write_addtid_b32 v76 offset:2720
    v_pk_mul_f32 v[70:71], v[72:73], v[42:43] op_sel:[0,0] op_sel_hi:[1,0]
    v_pk_mul_f32 v[68:69], v[58:59], v[44:45] op_sel:[0,0] op_sel_hi:[1,0]
    v_pk_fma_f32 v[70:71], v[72:73], v[42:43], v[70:71] op_sel:[1,1,0] op_sel_hi:[0,1,1] neg_lo:[1,0,0]
    v_pk_fma_f32 v[68:69], v[58:59], v[44:45], v[68:69] op_sel:[1,1,0] op_sel_hi:[0,1,1] neg_hi:[1,0,0]
    v_cvt_pk_bf16_f32 v77, v70, v71
    v_cvt_pk_bf16_f32 v74, v68, v69
    ds_write_addtid_b32 v77 offset:8976
    ds_write_addtid_b32 v74 offset:2992
    v_pk_mul_f32 v[72:73], v[70:71], v[42:43] op_sel:[0,0] op_sel_hi:[1,0]
    v_pk_mul_f32 v[46:47], v[62:63], v[44:45] op_sel:[0,0] op_sel_hi:[1,0]
    v_pk_fma_f32 v[72:73], v[70:71], v[42:43], v[72:73] op_sel:[1,1,0] op_sel_hi:[0,1,1] neg_lo:[1,0,0]
    v_pk_fma_f32 v[46:47], v[62:63], v[44:45], v[46:47] op_sel:[1,1,0] op_sel_hi:[0,1,1] neg_hi:[1,0,0]
    v_cvt_pk_bf16_f32 v75, v72, v73
    v_cvt_pk_bf16_f32 v76, v46, v47
    ds_write_addtid_b32 v75 offset:9248
    ds_write_addtid_b32 v76 offset:3264
    v_pk_mul_f32 v[70:71], v[72:73], v[42:43] op_sel:[0,0] op_sel_hi:[1,0]
    v_pk_mul_f32 v[48:49], v[66:67], v[44:45] op_sel:[0,0] op_sel_hi:[1,0]
    v_pk_fma_f32 v[70:71], v[72:73], v[42:43], v[70:71] op_sel:[1,1,0] op_sel_hi:[0,1,1] neg_lo:[1,0,0]
    v_pk_fma_f32 v[48:49], v[66:67], v[44:45], v[48:49] op_sel:[1,1,0] op_sel_hi:[0,1,1] neg_hi:[1,0,0]
    v_cvt_pk_bf16_f32 v77, v70, v71
    v_cvt_pk_bf16_f32 v74, v48, v49
    ds_write_addtid_b32 v77 offset:9520
    ds_write_addtid_b32 v74 offset:3536
    v_pk_mul_f32 v[72:73], v[70:71], v[42:43] op_sel:[0,0] op_sel_hi:[1,0]
    v_pk_mul_f32 v[62:63], v[46:47], v[44:45] op_sel:[0,0] op_sel_hi:[1,0]
    v_pk_fma_f32 v[72:73], v[70:71], v[42:43], v[72:73] op_sel:[1,1,0] op_sel_hi:[0,1,1] neg_lo:[1,0,0]
    v_pk_fma_f32 v[62:63], v[46:47], v[44:45], v[62:63] op_sel:[1,1,0] op_sel_hi:[0,1,1] neg_hi:[1,0,0]
    v_cvt_pk_bf16_f32 v75, v72, v73
    v_cvt_pk_bf16_f32 v76, v62, v63
    ds_write_addtid_b32 v75 offset:9792
    ds_write_addtid_b32 v76 offset:3808
    v_pk_mul_f32 v[70:71], v[72:73], v[42:43] op_sel:[0,0] op_sel_hi:[1,0]
    v_pk_mul_f32 v[64:65], v[48:49], v[44:45] op_sel:[0,0] op_sel_hi:[1,0]
    v_pk_fma_f32 v[70:71], v[72:73], v[42:43], v[70:71] op_sel:[1,1,0] op_sel_hi:[0,1,1] neg_lo:[1,0,0]
    v_pk_fma_f32 v[64:65], v[48:49], v[44:45], v[64:65] op_sel:[1,1,0] op_sel_hi:[0,1,1] neg_hi:[1,0,0]
    v_cvt_pk_bf16_f32 v77, v70, v71
    v_cvt_pk_bf16_f32 v74, v64, v65
    ds_write_addtid_b32 v77 offset:10064
    ds_write_addtid_b32 v74 offset:4080
    v_pk_mul_f32 v[72:73], v[70:71], v[42:43] op_sel:[0,0] op_sel_hi:[1,0]
    v_pk_mul_f32 v[46:47], v[62:63], v[44:45] op_sel:[0,0] op_sel_hi:[1,0]
    v_pk_fma_f32 v[72:73], v[70:71], v[42:43], v[72:73] op_sel:[1,1,0] op_sel_hi:[0,1,1] neg_lo:[1,0,0]
    v_pk_fma_f32 v[46:47], v[62:63], v[44:45], v[46:47] op_sel:[1,1,0] op_sel_hi:[0,1,1] neg_hi:[1,0,0]
    v_cvt_pk_bf16_f32 v75, v72, v73
    v_cvt_pk_bf16_f32 v76, v46, v47
    ds_write_addtid_b32 v75 offset:10336
    ds_write_addtid_b32 v76 offset:4352
    v_pk_mul_f32 v[70:71], v[72:73], v[42:43] op_sel:[0,0] op_sel_hi:[1,0]
    v_pk_mul_f32 v[62:63], v[46:47], v[44:45] op_sel:[0,0] op_sel_hi:[1,0]
    v_pk_fma_f32 v[70:71], v[72:73], v[42:43], v[70:71] op_sel:[1,1,0] op_sel_hi:[0,1,1] neg_lo:[1,0,0]
    v_pk_fma_f32 v[62:63], v[46:47], v[44:45], v[62:63] op_sel:[1,1,0] op_sel_hi:[0,1,1] neg_hi:[1,0,0]
    v_cvt_pk_bf16_f32 v77, v70, v71
    v_cvt_pk_bf16_f32 v74, v62, v63
    ds_write_addtid_b32 v77 offset:10608
    ds_write_addtid_b32 v74 offset:4624
    v_pk_mul_f32 v[72:73], v[70:71], v[42:43] op_sel:[0,0] op_sel_hi:[1,0]
    v_pk_mul_f32 v[46:47], v[62:63], v[44:45] op_sel:[0,0] op_sel_hi:[1,0]
    v_pk_fma_f32 v[72:73], v[70:71], v[42:43], v[72:73] op_sel:[1,1,0] op_sel_hi:[0,1,1] neg_lo:[1,0,0]
    v_pk_fma_f32 v[46:47], v[62:63], v[44:45], v[46:47] op_sel:[1,1,0] op_sel_hi:[0,1,1] neg_hi:[1,0,0]
    v_cvt_pk_bf16_f32 v75, v72, v73
    v_cvt_pk_bf16_f32 v76, v46, v47
    ds_write_addtid_b32 v75 offset:10880
    ds_write_addtid_b32 v76 offset:4896
    v_pk_mul_f32 v[70:71], v[72:73], v[42:43] op_sel:[0,0] op_sel_hi:[1,0]
    v_pk_mul_f32 v[62:63], v[46:47], v[44:45] op_sel:[0,0] op_sel_hi:[1,0]
    v_pk_fma_f32 v[70:71], v[72:73], v[42:43], v[70:71] op_sel:[1,1,0] op_sel_hi:[0,1,1] neg_lo:[1,0,0]
    v_pk_fma_f32 v[62:63], v[46:47], v[44:45], v[62:63] op_sel:[1,1,0] op_sel_hi:[0,1,1] neg_hi:[1,0,0]
    v_cvt_pk_bf16_f32 v77, v70, v71
    v_cvt_pk_bf16_f32 v74, v62, v63
    ds_write_addtid_b32 v77 offset:11152
    ds_write_addtid_b32 v74 offset:5168
    v_pk_mul_f32 v[72:73], v[70:71], v[42:43] op_sel:[0,0] op_sel_hi:[1,0]
    v_pk_mul_f32 v[46:47], v[62:63], v[44:45] op_sel:[0,0] op_sel_hi:[1,0]
    v_pk_fma_f32 v[72:73], v[70:71], v[42:43], v[72:73] op_sel:[1,1,0] op_sel_hi:[0,1,1] neg_lo:[1,0,0]
    v_pk_fma_f32 v[46:47], v[62:63], v[44:45], v[46:47] op_sel:[1,1,0] op_sel_hi:[0,1,1] neg_hi:[1,0,0]
    v_cvt_pk_bf16_f32 v75, v72, v73
    v_cvt_pk_bf16_f32 v76, v46, v47
    ds_write_addtid_b32 v75 offset:11424
    ds_write_addtid_b32 v76 offset:5440
    v_pk_mul_f32 v[70:71], v[72:73], v[42:43] op_sel:[0,0] op_sel_hi:[1,0]
    v_pk_fma_f32 v[70:71], v[72:73], v[42:43], v[70:71] op_sel:[1,1,0] op_sel_hi:[0,1,1] neg_lo:[1,0,0]
    v_cvt_pk_bf16_f32 v77, v70, v71
    ds_write_addtid_b32 v77 offset:11696
    v_pk_mul_f32 v[72:73], v[70:71], v[42:43] op_sel:[0,0] op_sel_hi:[1,0]
    v_pk_fma_f32 v[72:73], v[70:71], v[42:43], v[72:73] op_sel:[1,1,0] op_sel_hi:[0,1,1] neg_lo:[1,0,0]
    v_cvt_pk_bf16_f32 v74, v72, v73
    ds_write_addtid_b32 v74 offset:11968
    v_pk_mul_f32 v[70:71], v[72:73], v[42:43] op_sel:[0,0] op_sel_hi:[1,0]
    v_pk_fma_f32 v[70:71], v[72:73], v[42:43], v[70:71] op_sel:[1,1,0] op_sel_hi:[0,1,1] neg_lo:[1,0,0]
    v_cvt_pk_bf16_f32 v75, v70, v71
    ds_write_addtid_b32 v75 offset:12240
    v_pk_mul_f32 v[72:73], v[70:71], v[42:43] op_sel:[0,0] op_sel_hi:[1,0]
    v_pk_fma_f32 v[72:73], v[70:71], v[42:43], v[72:73] op_sel:[1,1,0] op_sel_hi:[0,1,1] neg_lo:[1,0,0]
    v_cvt_pk_bf16_f32 v76, v72, v73
    ds_write_addtid_b32 v76 offset:12512
    v_pk_mul_f32 v[70:71], v[72:73], v[42:43] op_sel:[0,0] op_sel_hi:[1,0]
    v_pk_fma_f32 v[70:71], v[72:73], v[42:43], v[70:71] op_sel:[1,1,0] op_sel_hi:[0,1,1] neg_lo:[1,0,0]
    v_cvt_pk_bf16_f32 v77, v70, v71
    ds_write_addtid_b32 v77 offset:12784
    v_pk_mul_f32 v[72:73], v[70:71], v[42:43] op_sel:[0,0] op_sel_hi:[1,0]
    v_pk_fma_f32 v[72:73], v[70:71], v[42:43], v[72:73] op_sel:[1,1,0] op_sel_hi:[0,1,1] neg_lo:[1,0,0]
    v_cvt_pk_bf16_f32 v74, v72, v73
    ds_write_addtid_b32 v74 offset:13056
    v_pk_mul_f32 v[70:71], v[72:73], v[42:43] op_sel:[0,0] op_sel_hi:[1,0]
    v_pk_fma_f32 v[70:71], v[72:73], v[42:43], v[70:71] op_sel:[1,1,0] op_sel_hi:[0,1,1] neg_lo:[1,0,0]
    v_cvt_pk_bf16_f32 v75, v70, v71
    ds_write_addtid_b32 v75 offset:13328
    v_pk_mul_f32 v[72:73], v[70:71], v[42:43] op_sel:[0,0] op_sel_hi:[1,0]
    v_pk_fma_f32 v[72:73], v[70:71], v[42:43], v[72:73] op_sel:[1,1,0] op_sel_hi:[0,1,1] neg_lo:[1,0,0]
    v_cvt_pk_bf16_f32 v76, v72, v73
    ds_write_addtid_b32 v76 offset:13600
    v_pk_mul_f32 v[70:71], v[72:73], v[42:43] op_sel:[0,0] op_sel_hi:[1,0]
    v_pk_fma_f32 v[70:71], v[72:73], v[42:43], v[70:71] op_sel:[1,1,0] op_sel_hi:[0,1,1] neg_lo:[1,0,0]
    v_cvt_pk_bf16_f32 v77, v70, v71
    ds_write_addtid_b32 v77 offset:13872
    v_pk_mul_f32 v[72:73], v[70:71], v[42:43] op_sel:[0,0] op_sel_hi:[1,0]
    v_pk_fma_f32 v[72:73], v[70:71], v[42:43], v[72:73] op_sel:[1,1,0] op_sel_hi:[0,1,1] neg_lo:[1,0,0]
    v_cvt_pk_bf16_f32 v74, v72, v73
    ds_write_addtid_b32 v74 offset:14144
    s_waitcnt lgkmcnt(0)
    s_nop 0
    ds_read_b128 v[80:83], v23 offset:0
    ds_read_b128 v[84:87], v23 offset:5712
    ds_read_b128 v[88:91], v23 offset:32
    ds_read_b128 v[92:95], v23 offset:5744
    ds_read_b128 v[96:99], v23 offset:64
    ds_read_b128 v[100:103], v23 offset:5776
    ds_read_b128 v[104:107], v23 offset:96
    ds_read_b128 v[108:111], v23 offset:5808
    s_waitcnt lgkmcnt(6)
    v_mfma_f32_32x32x16_bf16 v[24:39], v[80:83], v[84:87], v[24:39]
    s_waitcnt lgkmcnt(4)
    v_mfma_f32_32x32x16_bf16 v[24:39], v[88:91], v[92:95], v[24:39]
    s_waitcnt lgkmcnt(2)
    v_mfma_f32_32x32x16_bf16 v[24:39], v[96:99], v[100:103], v[24:39]
    s_waitcnt lgkmcnt(0)
    v_mfma_f32_32x32x16_bf16 v[24:39], v[104:107], v[108:111], v[24:39]
    ds_read_b128 v[80:83], v23 offset:128
    ds_read_b128 v[84:87], v23 offset:5840
    ds_read_b128 v[88:91], v23 offset:160
    ds_read_b128 v[92:95], v23 offset:5872
    ds_read_b128 v[96:99], v23 offset:192
    ds_read_b128 v[100:103], v23 offset:5904
    ds_read_b128 v[104:107], v23 offset:224
    ds_read_b128 v[108:111], v23 offset:5936
    s_waitcnt lgkmcnt(6)
    v_mfma_f32_32x32x16_bf16 v[24:39], v[80:83], v[84:87], v[24:39]
    s_waitcnt lgkmcnt(4)
    v_mfma_f32_32x32x16_bf16 v[24:39], v[88:91], v[92:95], v[24:39]
    s_waitcnt lgkmcnt(2)
    v_mfma_f32_32x32x16_bf16 v[24:39], v[96:99], v[100:103], v[24:39]
    s_waitcnt lgkmcnt(0)
    v_mfma_f32_32x32x16_bf16 v[24:39], v[104:107], v[108:111], v[24:39]
    v_cmp_eq_u32 vcc, 0, v1
    v_mov_b32 v4, s21
    s_nop 0
    v_cndmask_b32 v4, 0, v4, vcc
    s_nop 7
    v_add_f32 v24, v24, v4
    v_and_b32 v4, 31, v1
    v_lshrrev_b32 v5, 5, v1
    v_cmp_eq_u32 vcc, 1, v5
    v_lshlrev_b32 v6, 4, v4
    v_lshl_add_u32 v6, v5, 3, v6
    v_add_u32 v6, s22, v6
    v_lshlrev_b32 v7, 3, v4
    v_add_u32 v7, 512, v7
    v_lshlrev_b32_e64 v8, 2, v4
    v_add_u32 v8, 768, v8
    v_cndmask_b32 v7, v7, v8, vcc
    v_add_u32 v7, s22, v7
    v_mov_b32 v8, 128
    v_cndmask_b32 v8, 4, v8, vcc
    v_add_u32 v8, v7, v8
    v_lshlrev_b32_e64 v9, 1, v4
    v_lshl_add_u32 v9, v5, 8, v9
    v_add_u32_e64 v9, s22, v9
    v_cvt_pk_bf16_f32 v80, v24, v25
    v_cvt_pk_bf16_f32 v81, v26, v27
    v_cvt_pk_bf16_f32 v82, v28, v29
    v_cvt_pk_bf16_f32 v83, v30, v31
    v_cvt_pk_bf16_f32 v84, v32, v33
    v_cvt_pk_bf16_f32 v85, v34, v35
    ds_write_b64 v6, v[80:81]
    ds_write_b32 v7, v82
    ds_write_b32 v8, v83
    ds_write_b16 v9, v84 offset:1024
    s_mov_b32 exec_hi, 0
    ds_write_b16_d16_hi v9, v84 offset:1088
    ds_write_b16 v9, v85 offset:1152
    ds_write_b16_d16_hi v9, v85 offset:1216
    s_mov_b64 exec, -1
    v_mov_b32 v4, 0
    v_mov_b32 v5, 0
    v_mov_b32 v6, 0
    v_mov_b32 v7, 0
    v_lshrrev_b32 v8, 3, v1
    v_and_b32 v8, 3, v8
    v_mul_u32_u24 v8, 4224, v8
    v_and_b32_e64 v9, 7, v1
    v_lshl_add_u32 v8, v9, 4, v8
    v_add_u32_e64 v8, s69, v8
    ds_write_b128 v8, v[4:7] offset:4096
    v_lshlrev_b32 v9, 4, v1
    s_sub_u32 s60, s22, 32
    v_mov_b32_e64 v8, s60
    ds_write_b128 v8, v[4:7]
    ds_write_b128 v8, v[4:7] offset:16
    v_add_u32 v9, s69, v9
    v_lshlrev_b32 v4, 1, v1
    s_add_u32 s60, s22, 1150
    v_sub_u32 v12, s60, v4
    v_lshlrev_b32 v4, 2, v1
    s_add_u32 s60, s22, 1018
    v_sub_u32 v13, s60, v4
    v_lshlrev_b32 v4, 3, v1
    v_sub_u32 v5, 748, v4
    v_lshlrev_b32_e64 v4, 4, v1
    v_sub_u32 v6, 1002, v4
    v_cmp_gt_u32 vcc, 32, v1
    s_nop 1
    v_cndmask_b32_e64 v5, v6, v5, vcc
    v_cndmask_b32 v6, 0, 2, vcc
    v_add_u32 v14, s22, v5
    v_add_u32 v15, v14, v6
    v_add_u32 v16, v15, v6
    v_add_u32 v17, v16, v6
    v_add_u32 v18, v17, v6
    s_waitcnt vmcnt(0)
    v_add_u32_e64 v20, s22, v20
    v_add_u32 v21, s69, v21
    s_mov_b32 s60, 0x05040100
    s_mov_b32 s62, 0x55555555
    s_mov_b32 s63, 0x55555555
    s_waitcnt lgkmcnt(0)
    ds_read_u16 v22, v12 offset:130
    ds_read_u16 v23, v12 offset:128
    ds_read_u16 v24, v12 offset:2
    ds_read_u16 v25, v12 offset:0
    ds_read_u16 v26, v13 offset:6
    ds_read_u16 v27, v13 offset:4
    ds_read_u16 v28, v13 offset:2
    ds_read_u16 v29, v13 offset:0
    ds_read_u16 v30, v14 offset:20
    ds_read_u16 v31, v14 offset:18
    ds_read_u16 v32, v14 offset:16
    ds_read_u16 v33, v15 offset:14
    ds_read_u16 v34, v16 offset:12
    ds_read_u16 v35, v16 offset:10
    ds_read_u16 v36, v16 offset:8
    s_waitcnt lgkmcnt(11)
    s_nop 0
    ds_read_u16 v37, v17 offset:6
    ds_read_u16 v38, v18 offset:4
    ds_read_u16 v39, v18 offset:2
    ds_read_u16 v40, v18 offset:0
    ds_read_u16 v41, v20
    v_cndmask_b32 v4, v23, v22, s[62:63]
    v_perm_b32 v44, v23, v23, s60
    v_perm_b32 v45, v23, v23, s60
    v_perm_b32 v46, v22, v22, s60
    v_perm_b32 v47, v4, v22, s60
    ds_write_b64 v9, v[46:47] offset:0
    ds_write_b64 v9, v[44:45] offset:8
    v_perm_b32 v48, v22, v22, s60
    v_perm_b32 v49, v23, v4, s60
    ds_write_b64 v9, v[48:49] offset:8448
    ds_write_b64 v9, v[44:45] offset:8456
    v_perm_b32 v50, v4, v22, s60
    v_perm_b32 v51, v23, v23, s60
    ds_write_b64 v9, v[50:51] offset:4224
    ds_write_b64 v9, v[44:45] offset:4232
    v_perm_b32 v52, v23, v4, s60
    v_perm_b32 v53, v23, v23, s60
    ds_write_b64 v9, v[52:53] offset:12672
    ds_write_b64 v9, v[44:45] offset:12680
    v_cndmask_b32 v5, v25, v24, s[62:63]
    v_perm_b32 v54, v25, v25, s60
    v_perm_b32 v55, v25, v25, s60
    v_perm_b32 v56, v24, v24, s60
    v_perm_b32 v57, v5, v24, s60
    ds_write_b64 v9, v[56:57] offset:1024
    ds_write_b64 v9, v[54:55] offset:1032
    v_perm_b32 v58, v24, v24, s60
    v_perm_b32 v59, v25, v5, s60
    ds_write_b64 v9, v[58:59] offset:9472
    ds_write_b64 v9, v[54:55] offset:9480
    v_perm_b32 v60, v5, v24, s60
    v_perm_b32 v61, v25, v25, s60
    ds_write_b64 v9, v[60:61] offset:5248
    ds_write_b64 v9, v[54:55] offset:5256
    v_perm_b32 v62, v25, v5, s60
    v_perm_b32 v63, v25, v25, s60
    ds_write_b64 v9, v[62:63] offset:13696
    ds_write_b64 v9, v[54:55] offset:13704
    s_waitcnt lgkmcnt(15)
    s_nop 0
    v_perm_b32 v64, v26, v26, s60
    v_perm_b32 v65, v27, v27, s60
    v_perm_b32 v66, v28, v27, s60
    v_perm_b32 v67, v28, v28, s60
    ds_write_b128 v9, v[64:67] offset:2048
    v_perm_b32 v68, v27, v26, s60
    v_perm_b32 v69, v27, v27, s60
    v_perm_b32 v70, v28, v28, s60
    v_perm_b32 v71, v28, v28, s60
    ds_write_b128 v9, v[68:71] offset:10496
    v_perm_b32 v72, v27, v27, s60
    v_perm_b32 v73, v28, v27, s60
    v_perm_b32 v74, v28, v28, s60
    v_perm_b32 v75, v28, v28, s60
    ds_write_b128 v9, v[72:75] offset:6272
    v_perm_b32 v76, v27, v27, s60
    v_perm_b32 v77, v28, v28, s60
    v_perm_b32 v78, v28, v28, s60
    v_perm_b32 v79, v29, v28, s60
    ds_write_b128 v9, v[76:79] offset:14720
    v_perm_b32 v64, v31, v30, s60
    v_perm_b32 v65, v33, v32, s60
    v_perm_b32 v66, v35, v34, s60
    v_perm_b32 v67, v37, v36, s60
    ds_write_b128 v9, v[64:67] offset:3072
    v_perm_b32 v68, v32, v31, s60
    v_perm_b32 v69, v34, v33, s60
    v_perm_b32 v70, v36, v35, s60
    v_perm_b32 v71, v38, v37, s60
    ds_write_b128 v9, v[68:71] offset:11520
    v_perm_b32 v72, v33, v32, s60
    v_perm_b32 v73, v35, v34, s60
    v_perm_b32 v74, v37, v36, s60
    v_perm_b32 v75, v39, v38, s60
    ds_write_b128 v9, v[72:75] offset:7296
    v_perm_b32 v76, v34, v33, s60
    v_perm_b32 v77, v36, v35, s60
    v_perm_b32 v78, v38, v37, s60
    v_perm_b32 v79, v40, v39, s60
    ds_write_b128 v9, v[76:79] offset:15744
    ds_write_b16 v21, v41
    v_and_b32_e64 v4, 1, v2
    v_mul_u32_u24 v4, 4220, v4
    v_lshlrev_b32 v5, 4, v3
    v_lshlrev_b32 v6, 2, v2
    v_sub_u32 v5, v5, v6
    v_sub_u32 v5, v5, v4
    s_lshr_b32 s4, s64, 1
    s_and_b32 s5, s64, 1
    s_mov_b32 s6, 13688
    s_cmp_eq_u32 s5, 1
    s_cselect_b32 s60, 5240, s6
    s_mul_i32 s61, s4, 16896
    s_add_u32 s60, s60, s61
    s_sub_u32 s60, s60, 960
    v_add_u32 v12, s60, v5
    s_cmp_eq_u32 s68, 1
    s_cselect_b32 s60, 5240, s6
    s_lshl_b32 s61, s64, 8
    s_sub_u32 s60, s60, s61
    s_add_u32 s60, s60, 33600
    v_add_u32 v13, s60, v5
    v_lshlrev_b32 v4, 8, v3
    v_lshl_add_u32 v4, v2, 4, v4
    s_mul_i32 s61, s4, 5120
    s_add_u32 s61, s61, 51472
    v_add_u32_e64 v14, s61, v4
    v_subrev_u32 v15, 768, v14
    v_mov_b32 v16, v14
    s_lshl_b32 s60, s64, 6
    s_sub_u32 s61, 61904, s60
    v_add_u32_e64 v4, s61, v4
    v_subrev_u32 v5, 768, v4
    s_lshl_b32 s60, s64, 2
    v_cmp_gt_u32 vcc, s60, v2
    s_nop 1
    v_cndmask_b32 v18, v4, v5, vcc
    s_add_u32 s60, s60, 1
    v_cmp_gt_u32 vcc, s60, v2
    s_nop 1
    v_cndmask_b32 v19, v4, v5, vcc
    s_add_u32 s60, s60, 1
    v_cmp_gt_u32 vcc, s60, v2
    s_nop 1
    v_cndmask_b32 v20, v4, v5, vcc
    s_add_u32 s60, s60, 1
    v_cmp_gt_u32 vcc, s60, v2
    s_nop 1
    v_cndmask_b32 v21, v4, v5, vcc
    v_lshlrev_b32 v4, 4, v1
    s_lshl_b32 s60, s64, 12
    s_add_u32 s60, s60, 70400
    v_add_u32 v22, s60, v4
    s_lshl_b32 s60, s64, 2
    s_add_u32 s60, s60, 70400
    v_add_u32 v23, s60, v4
    s_branch L_conv
L_help:
    s_mov_b32 s91, s67
    s_mov_b32 s90, s68
    s_lshr_b32 s64, s59, 2
    s_lshl_b32 s60, s58, 3
    s_add_u32 s64, s64, s60
    v_lshlrev_b32 v24, 4, v1
    v_xor_b32_e64 v25, 64, v24
    v_xor_b32 v26, 128, v24
    v_xor_b32 v27, 192, v24
    v_lshlrev_b32 v4, 2, v3
    v_xor_b32 v4, v4, v2
    v_mul_u32_u24 v5, 81920, v3
    v_lshl_add_u32 v4, v4, 4, v5
    v_add_u32 v28, 1024, v4
    s_waitcnt lgkmcnt(0)
    s_mov_b32 s36, s4
    s_mov_b32 s37, s5
    s_mov_b32 s38, 2621440
    s_mov_b32 s39, 0x00020000
    s_add_u32 s60, s64, 1024
    s_mul_i32 s67, s60, 1280
    s_mov_b32 s68, 103168
    s_mov_b32 s69, 123648
    s_mov_b32 s60, s67
    s_add_u32 m0, s68, 0
    s_nop 0
    buffer_load_dwordx4 v24, s[36:39], s60 offen  lds
    s_add_u32 s60, s60, 81920
    s_add_u32 m0, s68, 1024
    s_nop 0
    buffer_load_dwordx4 v25, s[36:39], s60 offen  lds
    s_add_u32 s60, s60, 81920
    s_add_u32 m0, s68, 2048
    s_nop 0
    buffer_load_dwordx4 v26, s[36:39], s60 offen  lds
    s_add_u32 s60, s60, 81920
    s_add_u32 m0, s68, 3072
    s_nop 0
    buffer_load_dwordx4 v27, s[36:39], s60 offen  lds
    s_add_u32 s60, s60, 81920
    s_add_u32 m0, s68, 4096
    s_nop 0
    buffer_load_dwordx4 v24, s[36:39], s60 offen  lds
    s_add_u32 s60, s60, 81920
    s_add_u32 m0, s68, 5120
    s_nop 0
    buffer_load_dwordx4 v25, s[36:39], s60 offen  lds
    s_add_u32 s60, s60, 81920
    s_add_u32 m0, s68, 6144
    s_nop 0
    buffer_load_dwordx4 v26, s[36:39], s60 offen  lds
    s_add_u32 s60, s60, 81920
    s_add_u32 m0, s68, 7168
    s_nop 0
    buffer_load_dwordx4 v27, s[36:39], s60 offen  lds
    s_add_u32 m0, s69, 0
    s_nop 0
    buffer_load_dwordx4 v28, s[36:39], s67 offen  lds
    s_add_u32 s67, s67, 327680
    s_add_u32 m0, s69, 1024
    s_nop 0
    buffer_load_dwordx4 v28, s[36:39], s67 offen  lds
    s_add_u32 s60, s64, 1536
    s_mul_i32 s67, s60, 1280
    s_mov_b32 s68, 111360
    s_mov_b32 s69, 125696
    s_mov_b32 s60, s67
    s_add_u32 m0, s68, 0
    s_nop 0
    buffer_load_dwordx4 v24, s[36:39], s60 offen  lds
    s_add_u32 s60, s60, 81920
    s_add_u32 m0, s68, 1024
    s_nop 0
    buffer_load_dwordx4 v25, s[36:39], s60 offen  lds
    s_add_u32 s60, s60, 81920
    s_add_u32 m0, s68, 2048
    s_nop 0
    buffer_load_dwordx4 v26, s[36:39], s60 offen  lds
    s_add_u32 s60, s60, 81920
    s_add_u32 m0, s68, 3072
    s_nop 0
    buffer_load_dwordx4 v27, s[36:39], s60 offen  lds
    s_add_u32 s60, s60, 81920
    s_add_u32 m0, s68, 4096
    s_nop 0
    buffer_load_dwordx4 v24, s[36:39], s60 offen  lds
    s_add_u32 s60, s60, 81920
    s_add_u32 m0, s68, 5120
    s_nop 0
    buffer_load_dwordx4 v25, s[36:39], s60 offen  lds
    s_add_u32 s60, s60, 81920
    s_add_u32 m0, s68, 6144
    s_nop 0
    buffer_load_dwordx4 v26, s[36:39], s60 offen  lds
    s_add_u32 s60, s60, 81920
    s_add_u32 m0, s68, 7168
    s_nop 0
    buffer_load_dwordx4 v27, s[36:39], s60 offen  lds
    s_add_u32 m0, s69, 0
    s_nop 0
    buffer_load_dwordx4 v28, s[36:39], s67 offen  lds
    s_add_u32 s67, s67, 327680
    s_add_u32 m0, s69, 1024
    s_nop 0
    buffer_load_dwordx4 v28, s[36:39], s67 offen  lds
    s_load_dword s56, s[28:29], 0
    s_mov_b32 s64, 0
    s_mov_b32 s67, s91
    s_mov_b32 s68, s90
    s_mov_b32 s32, s28
    s_mov_b32 s33, s29
    s_mov_b32 s34, 268435456
    s_mov_b32 s35, 0x00020000
    s_setprio 1
    s_lshr_b32 s60, s65, 1
    s_mul_i32 s60, s60, 1088
    s_add_u32 s60, s60, 20971520
    v_lshlrev_b32 v72, 4, v1
    v_add_u32 v72, s60, v72
    v_lshrrev_b32_e64 v9, 2, v1
    v_mul_u32_u24 v9, 41088, v9
    v_and_b32_e64 v10, 3, v1
    v_lshl_add_u32 v73, v10, 4, v9
    v_lshrrev_b32_e64 v4, 2, v2
    v_lshl_add_u32 v4, v3, 3, v4
    v_lshlrev_b32_e64 v4, 6, v4
    v_lshl_add_u32 v4, v10, 3, v4
    v_add_u32 v74, 51712, v4
    v_lshrrev_b32 v5, 3, v2
    v_lshlrev_b32 v5, 10, v5
    v_and_b32_e64 v6, 7, v2
    v_lshl_add_u32 v5, v6, 5, v5
    v_lshl_add_u32 v5, v3, 8, v5
    v_add_u32 v75, 51712, v5
    v_mov_b32 v4, 0
    v_mov_b32 v5, 0
    v_mov_b32 v6, 0
    v_mov_b32 v7, 0
    v_lshlrev_b32_e64 v8, 4, v1
    ds_write_b128 v8, v[4:7] offset:50688
    ds_write_b128 v8, v[4:7] offset:55808
    ds_write_b128 v8, v[4:7] offset:60928
    s_waitcnt lgkmcnt(0)
    s_add_u32 s56, s56, 2654435769
    s_waitcnt vmcnt(0)
    s_mov_b64 exec, 1
    v_mov_b32 v4, 156480
    v_mov_b32 v5, 1
    ds_add_u32 v4, v5
    s_mov_b64 exec, -1
    v_and_b32 v4, 1, v2
    v_mul_u32_u24 v4, 4220, v4
    v_lshlrev_b32 v5, 4, v3
    v_lshlrev_b32 v6, 2, v2
    v_sub_u32 v5, v5, v6
    v_sub_u32 v5, v5, v4
    s_lshr_b32 s4, s64, 1
    s_and_b32 s5, s64, 1
    s_mov_b32 s6, 13688
    s_cmp_eq_u32 s5, 1
    s_cselect_b32 s60, 5240, s6
    s_mul_i32 s61, s4, 16896
    s_add_u32 s60, s60, s61
    s_sub_u32 s60, s60, 960
    v_add_u32 v12, s60, v5
    s_cmp_eq_u32 s68, 1
    s_cselect_b32 s60, 5240, s6
    s_lshl_b32 s61, s64, 8
    s_sub_u32 s60, s60, s61
    s_add_u32 s60, s60, 33600
    v_add_u32 v13, s60, v5
    v_lshlrev_b32 v4, 8, v3
    v_lshl_add_u32 v4, v2, 4, v4
    s_mul_i32 s61, s4, 5120
    s_add_u32 s61, s61, 51472
    v_add_u32_e64 v14, s61, v4
    v_subrev_u32 v15, 768, v14
    v_mov_b32 v16, v14
    s_lshl_b32 s60, s64, 6
    s_sub_u32 s61, 61904, s60
    v_add_u32_e64 v4, s61, v4
    v_subrev_u32 v5, 768, v4
    s_lshl_b32 s60, s64, 2
    v_cmp_gt_u32 vcc, s60, v2
    s_nop 1
    v_cndmask_b32 v18, v4, v5, vcc
    s_add_u32 s60, s60, 1
    v_cmp_gt_u32 vcc, s60, v2
    s_nop 1
    v_cndmask_b32 v19, v4, v5, vcc
    s_add_u32 s60, s60, 1
    v_cmp_gt_u32 vcc, s60, v2
    s_nop 1
    v_cndmask_b32 v20, v4, v5, vcc
    s_add_u32 s60, s60, 1
    v_cmp_gt_u32 vcc, s60, v2
    s_nop 1
    v_cndmask_b32 v21, v4, v5, vcc
    v_lshlrev_b32 v4, 4, v1
    s_lshl_b32 s60, s64, 12
    s_add_u32 s60, s60, 70400
    v_add_u32 v22, s60, v4
    s_lshl_b32 s60, s64, 2
    s_add_u32 s60, s60, 70400
    v_add_u32_e64 v23, s60, v4
    s_and_b32 s62, s59, 3
    s_cmp_eq_u32 s62, 3
    s_cselect_b32 s62, 2, 3
    s_mov_b64 exec, 1
    v_mov_b32 v4, 156528
    s_mov_b32 s61, 0
L_sy33:
    s_sleep 1
    ds_read_b32 v5, v4
    s_add_u32 s61, s61, 1
    s_waitcnt lgkmcnt(0)
    v_readfirstlane_b32 s60, v5
    s_cmp_ge_u32 s61, 1048576
    s_cbranch_scc1 L_syd34
    s_cmp_lt_u32 s60, s62
    s_cbranch_scc1 L_sy33
L_syd34:
    s_mov_b64 exec, -1
    s_sleep 4
    s_mov_b32 s61, 0
L_po35:
    v_mov_b32 v4, 0
    buffer_atomic_or v4, v72, s[32:35], 0 offen sc0 sc1
    s_add_u32 s61, s61, 1
    s_waitcnt vmcnt(0)
    v_xor_b32_e64 v4, s56, v4
    v_cmp_ne_u32 vcc, 0, v4
    s_cmp_ge_u32 s61, 65536
    s_cbranch_scc1 L_pod36
    s_cbranch_vccz L_pod36
    s_mov_b64 exec, vcc
    s_sleep 4
    s_branch L_po35
L_pod36:
    s_mov_b64 exec, -1
    s_lshl_b32 s3, s67, 6
    s_add_u32 s3, s3, 9437184
    s_mov_b32 m0, 51712
    s_nop 0
    buffer_load_dwordx4 v73, s[32:35], s3 offen sc1 lds
    s_add_u32 s3, s3, 657408
    s_mov_b32 m0, 52736
    s_nop 0
    buffer_load_dwordx4 v73, s[32:35], s3 offen sc1 lds
    s_add_u32 s3, s3, 657408
    s_mov_b32 m0, 53760
    s_nop 0
    buffer_load_dwordx4 v73, s[32:35], s3 offen sc1 lds
    s_add_u32 s3, s3, 657408
    s_mov_b32 m0, 54784
    s_nop 0
    buffer_load_dwordx4 v73, s[32:35], s3 offen sc1 lds
    s_lshl_b32 s3, s67, 6
    s_add_u32 s3, s3, 9437248
    s_mov_b32 m0, 56832
    s_nop 0
    buffer_load_dwordx4 v73, s[32:35], s3 offen sc1 lds
    s_add_u32 s3, s3, 657408
    s_mov_b32 m0, 57856
    s_nop 0
    buffer_load_dwordx4 v73, s[32:35], s3 offen sc1 lds
    s_add_u32 s3, s3, 657408
    s_mov_b32 m0, 58880
    s_nop 0
    buffer_load_dwordx4 v73, s[32:35], s3 offen sc1 lds
    s_add_u32 s3, s3, 657408
    s_mov_b32 m0, 59904
    s_nop 0
    buffer_load_dwordx4 v73, s[32:35], s3 offen sc1 lds
    s_lshl_b32 s3, s92, 6
    s_add_u32 s3, s3, 9437184
    s_mov_b32 m0, 61952
    s_nop 0
    buffer_load_dwordx4 v73, s[32:35], s3 offen sc1 lds
    s_add_u32 s3, s3, 657408
    s_mov_b32 m0, 62976
    s_nop 0
    buffer_load_dwordx4 v73, s[32:35], s3 offen sc1 lds
    s_add_u32 s3, s3, 657408
    s_mov_b32 m0, 64000
    s_nop 0
    buffer_load_dwordx4 v73, s[32:35], s3 offen sc1 lds
    s_add_u32 s3, s3, 657408
    s_mov_b32 m0, 65024
    s_nop 0
    buffer_load_dwordx4 v73, s[32:35], s3 offen sc1 lds
    s_setprio 3
    s_waitcnt vmcnt(8)
    ds_read_b64_tr_b16 v[24:25], v74 offset:0
    ds_read_b64_tr_b16 v[26:27], v74 offset:256
    ds_read_b64_tr_b16 v[28:29], v74 offset:32
    ds_read_b64_tr_b16 v[30:31], v74 offset:288
    ds_read_b64_tr_b16 v[32:33], v74 offset:2048
    ds_read_b64_tr_b16 v[34:35], v74 offset:2304
    ds_read_b64_tr_b16 v[36:37], v74 offset:2080
    ds_read_b64_tr_b16 v[38:39], v74 offset:2336
    s_waitcnt vmcnt(4)
    s_nop 0
    ds_read_b64_tr_b16 v[40:41], v74 offset:5120
    ds_read_b64_tr_b16 v[42:43], v74 offset:5376
    ds_read_b64_tr_b16 v[44:45], v74 offset:5152
    ds_read_b64_tr_b16 v[46:47], v74 offset:5408
    ds_read_b64_tr_b16 v[48:49], v74 offset:7168
    ds_read_b64_tr_b16 v[50:51], v74 offset:7424
    ds_read_b64_tr_b16 v[52:53], v74 offset:7200
    ds_read_b64_tr_b16 v[54:55], v74 offset:7456
    s_waitcnt lgkmcnt(8)
    ds_write_b128 v75, v[24:27] offset:0
    ds_write_b128 v75, v[28:31] offset:2048
    ds_write_b128 v75, v[32:35] offset:16
    ds_write_b128 v75, v[36:39] offset:2064
    s_waitcnt vmcnt(0)
    ds_read_b64_tr_b16 v[56:57], v74 offset:10240
    ds_read_b64_tr_b16 v[58:59], v74 offset:10496
    ds_read_b64_tr_b16 v[60:61], v74 offset:10272
    ds_read_b64_tr_b16 v[62:63], v74 offset:10528
    ds_read_b64_tr_b16 v[64:65], v74 offset:12288
    ds_read_b64_tr_b16 v[66:67], v74 offset:12544
    ds_read_b64_tr_b16 v[68:69], v74 offset:12320
    ds_read_b64_tr_b16 v[70:71], v74 offset:12576
    s_waitcnt lgkmcnt(12)
    ds_write_b128 v75, v[40:43] offset:5120
    ds_write_b128 v75, v[44:47] offset:7168
    ds_write_b128 v75, v[48:51] offset:5136
    ds_write_b128 v75, v[52:55] offset:7184
    s_waitcnt lgkmcnt(4)
    ds_write_b128 v75, v[56:59] offset:10240
    ds_write_b128 v75, v[60:63] offset:12288
    ds_write_b128 v75, v[64:67] offset:10256
    ds_write_b128 v75, v[68:71] offset:12304
    s_setprio 1
L_conv:
    s_waitcnt lgkmcnt(0)
    s_mov_b64 exec, 1
    v_mov_b32 v4, 156520
    s_mov_b32 s61, 0
    v_mov_b32 v5, 1
    ds_add_rtn_u32 v5, v4, v5
    s_waitcnt lgkmcnt(0)
    v_readfirstlane_b32 s60, v5
    s_nop 0
    s_cmp_eq_u32 s60, 3
    s_cbranch_scc1 L_syd39
L_sy38:
    s_sleep 1
    ds_read_b32 v5, v4
    s_add_u32 s61, s61, 1
    s_waitcnt lgkmcnt(0)
    v_readfirstlane_b32 s60, v5
    s_cmp_ge_u32 s61, 1048576
    s_cbranch_scc1 L_syd39
    s_cmp_lt_u32 s60, 4
    s_cbranch_scc1 L_sy38
L_syd39:
    s_mov_b64 exec, -1
    ds_read_b128 v[72:75], v18 offset:48
    ds_read_b64 v[56:57], v13 offset:3264
    ds_read_b64 v[58:59], v13 offset:3272
    ds_read_b128 v[76:79], v18 offset:1072
    ds_read_b128 v[80:83], v18 offset:2096
    ds_read_b128 v[84:87], v18 offset:3120
    ds_read_b64 v[60:61], v13 offset:2240
    ds_read_b64 v[62:63], v13 offset:2248
    ds_read_b64 v[64:65], v13 offset:1216
    ds_read_b64 v[66:67], v13 offset:1224
    ds_read_b64 v[68:69], v13 offset:192
    ds_read_b64 v[70:71], v13 offset:200
    ds_read_b128 v[104:107], v19 offset:32
    ds_read_b64 v[88:89], v13 offset:3200
    s_waitcnt lgkmcnt(8)
    v_mfma_f32_16x16x32_bf16 v[40:43], v[56:59], v[72:75], 0
    ds_read_b64 v[90:91], v13 offset:3208
    ds_read_b128 v[108:111], v19 offset:1056
    v_mfma_f32_16x16x32_bf16 v[44:47], v[56:59], v[76:79], 0
    ds_read_b128 v[112:115], v19 offset:2080
    v_mfma_f32_16x16x32_bf16 v[48:51], v[56:59], v[80:83], 0
    ds_read_b128 v[116:119], v19 offset:3104
    v_mfma_f32_16x16x32_bf16 v[52:55], v[56:59], v[84:87], 0
    ds_read_b64 v[92:93], v13 offset:2176
    s_waitcnt lgkmcnt(9)
    v_mfma_f32_16x16x32_bf16 v[44:47], v[60:63], v[72:75], v[44:47]
    ds_read_b64 v[94:95], v13 offset:2184
    v_mfma_f32_16x16x32_bf16 v[48:51], v[60:63], v[76:79], v[48:51]
    ds_read_b64 v[96:97], v13 offset:1152
    v_mfma_f32_16x16x32_bf16 v[52:55], v[60:63], v[80:83], v[52:55]
    ds_read_b64 v[98:99], v13 offset:1160
    v_mfma_f32_16x16x32_bf16 v[48:51], v[64:67], v[72:75], v[48:51]
    ds_read_b64 v[100:101], v13 offset:128
    v_mfma_f32_16x16x32_bf16 v[52:55], v[64:67], v[76:79], v[52:55]
    ds_read_b64 v[102:103], v13 offset:136
    s_waitcnt lgkmcnt(12)
    v_mfma_f32_16x16x32_bf16 v[52:55], v[68:71], v[72:75], v[52:55]
    ds_read_b128 v[72:75], v20 offset:16
    ds_read_b64 v[56:57], v13 offset:3136
    s_waitcnt lgkmcnt(8)
    v_mfma_f32_16x16x32_bf16 v[40:43], v[88:91], v[104:107], v[40:43]
    ds_read_b64 v[58:59], v13 offset:3144
    ds_read_b128 v[76:79], v20 offset:1040
    v_mfma_f32_16x16x32_bf16 v[44:47], v[88:91], v[108:111], v[44:47]
    ds_read_b128 v[80:83], v20 offset:2064
    v_mfma_f32_16x16x32_bf16 v[48:51], v[88:91], v[112:115], v[48:51]
    ds_read_b128 v[84:87], v20 offset:3088
    v_mfma_f32_16x16x32_bf16 v[52:55], v[88:91], v[116:119], v[52:55]
    ds_read_b64 v[60:61], v13 offset:2112
    s_waitcnt lgkmcnt(9)
    s_nop 0
    v_mfma_f32_16x16x32_bf16 v[44:47], v[92:95], v[104:107], v[44:47]
    ds_read_b64 v[62:63], v13 offset:2120
    v_mfma_f32_16x16x32_bf16 v[48:51], v[92:95], v[108:111], v[48:51]
    ds_read_b64 v[64:65], v13 offset:1088
    v_mfma_f32_16x16x32_bf16 v[52:55], v[92:95], v[112:115], v[52:55]
    ds_read_b64 v[66:67], v13 offset:1096
    v_mfma_f32_16x16x32_bf16 v[48:51], v[96:99], v[104:107], v[48:51]
    ds_read_b64 v[68:69], v13 offset:64
    v_mfma_f32_16x16x32_bf16 v[52:55], v[96:99], v[108:111], v[52:55]
    ds_read_b64 v[70:71], v13 offset:72
    s_waitcnt lgkmcnt(12)
    v_mfma_f32_16x16x32_bf16 v[52:55], v[100:103], v[104:107], v[52:55]
    ds_read_b128 v[104:107], v21 offset:0
    ds_read_b64 v[88:89], v13 offset:3072
    s_waitcnt lgkmcnt(8)
    v_mfma_f32_16x16x32_bf16 v[40:43], v[56:59], v[72:75], v[40:43]
    ds_read_b64 v[90:91], v13 offset:3080
    ds_read_b128 v[108:111], v21 offset:1024
    v_mfma_f32_16x16x32_bf16 v[44:47], v[56:59], v[76:79], v[44:47]
    ds_read_b128 v[112:115], v21 offset:2048
    v_mfma_f32_16x16x32_bf16 v[48:51], v[56:59], v[80:83], v[48:51]
    ds_read_b128 v[116:119], v21 offset:3072
    v_mfma_f32_16x16x32_bf16 v[52:55], v[56:59], v[84:87], v[52:55]
    ds_read_b64 v[92:93], v13 offset:2048
    s_waitcnt lgkmcnt(9)
    s_nop 0
    v_mfma_f32_16x16x32_bf16 v[44:47], v[60:63], v[72:75], v[44:47]
    ds_read_b64 v[94:95], v13 offset:2056
    v_mfma_f32_16x16x32_bf16 v[48:51], v[60:63], v[76:79], v[48:51]
    ds_read_b64 v[96:97], v13 offset:1024
    v_mfma_f32_16x16x32_bf16 v[52:55], v[60:63], v[80:83], v[52:55]
    ds_read_b64 v[98:99], v13 offset:1032
    v_mfma_f32_16x16x32_bf16 v[48:51], v[64:67], v[72:75], v[48:51]
    ds_read_b64 v[100:101], v13 offset:0
    v_mfma_f32_16x16x32_bf16 v[52:55], v[64:67], v[76:79], v[52:55]
    ds_read_b64 v[102:103], v13 offset:8
    s_waitcnt lgkmcnt(12)
    v_mfma_f32_16x16x32_bf16 v[52:55], v[68:71], v[72:75], v[52:55]
    ds_read_b128 v[72:75], v16 offset:240
    ds_read_b64 v[56:57], v12 offset:4032
    s_waitcnt lgkmcnt(8)
    v_mfma_f32_16x16x32_bf16 v[40:43], v[88:91], v[104:107], v[40:43]
    ds_read_b64 v[58:59], v12 offset:4040
    ds_read_b128 v[76:79], v16 offset:1264
    v_mfma_f32_16x16x32_bf16 v[44:47], v[88:91], v[108:111], v[44:47]
    ds_read_b128 v[80:83], v16 offset:2288
    v_mfma_f32_16x16x32_bf16 v[48:51], v[88:91], v[112:115], v[48:51]
    ds_read_b128 v[84:87], v16 offset:3312
    v_mfma_f32_16x16x32_bf16 v[52:55], v[88:91], v[116:119], v[52:55]
    ds_read_b64 v[60:61], v12 offset:3008
    s_waitcnt lgkmcnt(9)
    s_nop 0
    v_mfma_f32_16x16x32_bf16 v[44:47], v[92:95], v[104:107], v[44:47]
    ds_read_b64 v[62:63], v12 offset:3016
    v_mfma_f32_16x16x32_bf16 v[48:51], v[92:95], v[108:111], v[48:51]
    ds_read_b64 v[64:65], v12 offset:1984
    v_mfma_f32_16x16x32_bf16 v[52:55], v[92:95], v[112:115], v[52:55]
    ds_read_b64 v[66:67], v12 offset:1992
    v_mfma_f32_16x16x32_bf16 v[48:51], v[96:99], v[104:107], v[48:51]
    ds_read_b64 v[68:69], v12 offset:960
    v_mfma_f32_16x16x32_bf16 v[52:55], v[96:99], v[108:111], v[52:55]
    ds_read_b64 v[70:71], v12 offset:968
    s_waitcnt lgkmcnt(12)
    v_mfma_f32_16x16x32_bf16 v[52:55], v[100:103], v[104:107], v[52:55]
    s_mov_b32 s62, 65537
    s_mov_b32 s63, 65537
    v_cndmask_b32 v17, v14, v15, s[62:63]
    ds_read_b128 v[104:107], v17 offset:224
    ds_read_b64 v[88:89], v12 offset:3968
    s_waitcnt lgkmcnt(8)
    v_mfma_f32_16x16x32_bf16 v[24:27], v[56:59], v[72:75], 0
    ds_read_b64 v[90:91], v12 offset:3976
    ds_read_b128 v[108:111], v17 offset:1248
    v_mfma_f32_16x16x32_bf16 v[28:31], v[56:59], v[76:79], 0
    ds_read_b128 v[112:115], v17 offset:2272
    v_mfma_f32_16x16x32_bf16 v[32:35], v[56:59], v[80:83], 0
    ds_read_b128 v[116:119], v17 offset:3296
    v_mfma_f32_16x16x32_bf16 v[36:39], v[56:59], v[84:87], 0
    ds_read_b64 v[92:93], v12 offset:2944
    s_waitcnt lgkmcnt(9)
    s_nop 0
    v_mfma_f32_16x16x32_bf16 v[28:31], v[60:63], v[72:75], v[28:31]
    ds_read_b64 v[94:95], v12 offset:2952
    v_mfma_f32_16x16x32_bf16 v[32:35], v[60:63], v[76:79], v[32:35]
    ds_read_b64 v[96:97], v12 offset:1920
    v_mfma_f32_16x16x32_bf16 v[36:39], v[60:63], v[80:83], v[36:39]
    ds_read_b64 v[98:99], v12 offset:1928
    v_mfma_f32_16x16x32_bf16 v[32:35], v[64:67], v[72:75], v[32:35]
    ds_read_b64 v[100:101], v12 offset:896
    v_mfma_f32_16x16x32_bf16 v[36:39], v[64:67], v[76:79], v[36:39]
    ds_read_b64 v[102:103], v12 offset:904
    s_waitcnt lgkmcnt(12)
    v_mfma_f32_16x16x32_bf16 v[36:39], v[68:71], v[72:75], v[36:39]
    s_mov_b32 s62, 196611
    s_mov_b32 s63, 196611
    v_cndmask_b32 v16, v14, v15, s[62:63]
    ds_read_b128 v[72:75], v16 offset:208
    ds_read_b64 v[56:57], v12 offset:3904
    s_waitcnt lgkmcnt(8)
    v_mfma_f32_16x16x32_bf16 v[24:27], v[88:91], v[104:107], v[24:27]
    ds_read_b64 v[58:59], v12 offset:3912
    ds_read_b128 v[76:79], v16 offset:1232
    v_mfma_f32_16x16x32_bf16 v[28:31], v[88:91], v[108:111], v[28:31]
    ds_read_b128 v[80:83], v16 offset:2256
    v_mfma_f32_16x16x32_bf16 v[32:35], v[88:91], v[112:115], v[32:35]
    ds_read_b128 v[84:87], v16 offset:3280
    ds_write_b128 v22, v[40:43] offset:0
    ds_write_b128 v22, v[44:47] offset:1024
    ds_write_b128 v22, v[48:51] offset:2048
    ds_write_b128 v22, v[52:55] offset:3072
    v_mfma_f32_16x16x32_bf16 v[36:39], v[88:91], v[116:119], v[36:39]
    ds_read_b64 v[60:61], v12 offset:2880
    s_waitcnt lgkmcnt(13)
    s_nop 0
    v_mfma_f32_16x16x32_bf16 v[28:31], v[92:95], v[104:107], v[28:31]
    ds_read_b64 v[62:63], v12 offset:2888
    v_mfma_f32_16x16x32_bf16 v[32:35], v[92:95], v[108:111], v[32:35]
    ds_read_b64 v[64:65], v12 offset:1856
    v_mfma_f32_16x16x32_bf16 v[36:39], v[92:95], v[112:115], v[36:39]
    ds_read_b64 v[66:67], v12 offset:1864
    v_mfma_f32_16x16x32_bf16 v[32:35], v[96:99], v[104:107], v[32:35]
    ds_read_b64 v[68:69], v12 offset:832
    v_mfma_f32_16x16x32_bf16 v[36:39], v[96:99], v[108:111], v[36:39]
    ds_read_b64 v[70:71], v12 offset:840
    s_waitcnt lgkmcnt(15)
    v_mfma_f32_16x16x32_bf16 v[36:39], v[100:103], v[104:107], v[36:39]
    s_mov_b32 s62, 458759
    s_mov_b32 s63, 458759
    v_cndmask_b32 v17, v14, v15, s[62:63]
    ds_read_b128 v[104:107], v17 offset:192
    ds_read_b64 v[88:89], v12 offset:3840
    s_waitcnt lgkmcnt(8)
    v_mfma_f32_16x16x32_bf16 v[24:27], v[56:59], v[72:75], v[24:27]
    ds_read_b64 v[90:91], v12 offset:3848
    ds_read_b128 v[108:111], v17 offset:1216
    v_mfma_f32_16x16x32_bf16 v[28:31], v[56:59], v[76:79], v[28:31]
    ds_read_b128 v[112:115], v17 offset:2240
    v_mfma_f32_16x16x32_bf16 v[32:35], v[56:59], v[80:83], v[32:35]
    ds_read_b128 v[116:119], v17 offset:3264
    v_mfma_f32_16x16x32_bf16 v[36:39], v[56:59], v[84:87], v[36:39]
    ds_read_b64 v[92:93], v12 offset:2816
    s_waitcnt lgkmcnt(9)
    s_nop 0
    v_mfma_f32_16x16x32_bf16 v[28:31], v[60:63], v[72:75], v[28:31]
    ds_read_b64 v[94:95], v12 offset:2824
    v_mfma_f32_16x16x32_bf16 v[32:35], v[60:63], v[76:79], v[32:35]
    ds_read_b64 v[96:97], v12 offset:1792
    v_mfma_f32_16x16x32_bf16 v[36:39], v[60:63], v[80:83], v[36:39]
    ds_read_b64 v[98:99], v12 offset:1800
    v_mfma_f32_16x16x32_bf16 v[32:35], v[64:67], v[72:75], v[32:35]
    ds_read_b64 v[100:101], v12 offset:768
    v_mfma_f32_16x16x32_bf16 v[36:39], v[64:67], v[76:79], v[36:39]
    ds_read_b64 v[102:103], v12 offset:776
    s_waitcnt lgkmcnt(12)
    v_mfma_f32_16x16x32_bf16 v[36:39], v[68:71], v[72:75], v[36:39]
    s_mov_b64 exec, 1
    v_mov_b32 v4, 156524
    v_mov_b32 v5, 1
    ds_add_u32 v4, v5
    s_mov_b64 exec, -1
    s_mov_b32 s62, 983055
    s_mov_b32 s63, 983055
    v_cndmask_b32 v16, v14, v15, s[62:63]
    ds_read_b128 v[72:75], v16 offset:176
    ds_read_b64 v[56:57], v12 offset:3776
    s_waitcnt lgkmcnt(8)
    v_mfma_f32_16x16x32_bf16 v[24:27], v[88:91], v[104:107], v[24:27]
    ds_read_b64 v[58:59], v12 offset:3784
    ds_read_b128 v[76:79], v16 offset:1200
    v_mfma_f32_16x16x32_bf16 v[28:31], v[88:91], v[108:111], v[28:31]
    ds_read_b128 v[80:83], v16 offset:2224
    v_mfma_f32_16x16x32_bf16 v[32:35], v[88:91], v[112:115], v[32:35]
    ds_read_b128 v[84:87], v16 offset:3248
    v_mfma_f32_16x16x32_bf16 v[36:39], v[88:91], v[116:119], v[36:39]
    ds_read_b64 v[60:61], v12 offset:2752
    s_waitcnt lgkmcnt(9)
    v_mfma_f32_16x16x32_bf16 v[28:31], v[92:95], v[104:107], v[28:31]
    ds_read_b64 v[62:63], v12 offset:2760
    v_mfma_f32_16x16x32_bf16 v[32:35], v[92:95], v[108:111], v[32:35]
    ds_read_b64 v[64:65], v12 offset:1728
    v_mfma_f32_16x16x32_bf16 v[36:39], v[92:95], v[112:115], v[36:39]
    ds_read_b64 v[66:67], v12 offset:1736
    v_mfma_f32_16x16x32_bf16 v[32:35], v[96:99], v[104:107], v[32:35]
    ds_read_b64 v[68:69], v12 offset:704
    v_mfma_f32_16x16x32_bf16 v[36:39], v[96:99], v[108:111], v[36:39]
    ds_read_b64 v[70:71], v12 offset:712
    s_waitcnt lgkmcnt(12)
    v_mfma_f32_16x16x32_bf16 v[36:39], v[100:103], v[104:107], v[36:39]
    s_mov_b32 s62, 2031647
    s_mov_b32 s63, 2031647
    v_cndmask_b32 v17, v14, v15, s[62:63]
    ds_read_b128 v[104:107], v17 offset:160
    ds_read_b64 v[88:89], v12 offset:3712
    s_waitcnt lgkmcnt(8)
    v_mfma_f32_16x16x32_bf16 v[24:27], v[56:59], v[72:75], v[24:27]
    ds_read_b64 v[90:91], v12 offset:3720
    ds_read_b128 v[108:111], v17 offset:1184
    v_mfma_f32_16x16x32_bf16 v[28:31], v[56:59], v[76:79], v[28:31]
    ds_read_b128 v[112:115], v17 offset:2208
    v_mfma_f32_16x16x32_bf16 v[32:35], v[56:59], v[80:83], v[32:35]
    ds_read_b128 v[116:119], v17 offset:3232
    v_mfma_f32_16x16x32_bf16 v[36:39], v[56:59], v[84:87], v[36:39]
    ds_read_b64 v[92:93], v12 offset:2688
    s_waitcnt lgkmcnt(9)
    s_nop 0
    v_mfma_f32_16x16x32_bf16 v[28:31], v[60:63], v[72:75], v[28:31]
    ds_read_b64 v[94:95], v12 offset:2696
    v_mfma_f32_16x16x32_bf16 v[32:35], v[60:63], v[76:79], v[32:35]
    ds_read_b64 v[96:97], v12 offset:1664
    v_mfma_f32_16x16x32_bf16 v[36:39], v[60:63], v[80:83], v[36:39]
    ds_read_b64 v[98:99], v12 offset:1672
    v_mfma_f32_16x16x32_bf16 v[32:35], v[64:67], v[72:75], v[32:35]
    ds_read_b64 v[100:101], v12 offset:640
    v_mfma_f32_16x16x32_bf16 v[36:39], v[64:67], v[76:79], v[36:39]
    ds_read_b64 v[102:103], v12 offset:648
    s_waitcnt lgkmcnt(12)
    v_mfma_f32_16x16x32_bf16 v[36:39], v[68:71], v[72:75], v[36:39]
    s_mov_b32 s62, 4128831
    s_mov_b32 s63, 4128831
    v_cndmask_b32 v16, v14, v15, s[62:63]
    ds_read_b128 v[72:75], v16 offset:144
    ds_read_b64 v[56:57], v12 offset:3648
    s_waitcnt lgkmcnt(8)
    v_mfma_f32_16x16x32_bf16 v[24:27], v[88:91], v[104:107], v[24:27]
    ds_read_b64 v[58:59], v12 offset:3656
    ds_read_b128 v[76:79], v16 offset:1168
    v_mfma_f32_16x16x32_bf16 v[28:31], v[88:91], v[108:111], v[28:31]
    ds_read_b128 v[80:83], v16 offset:2192
    v_mfma_f32_16x16x32_bf16 v[32:35], v[88:91], v[112:115], v[32:35]
    ds_read_b128 v[84:87], v16 offset:3216
    v_mfma_f32_16x16x32_bf16 v[36:39], v[88:91], v[116:119], v[36:39]
    ds_read_b64 v[60:61], v12 offset:2624
    s_waitcnt lgkmcnt(9)
    s_nop 0
    v_mfma_f32_16x16x32_bf16 v[28:31], v[92:95], v[104:107], v[28:31]
    ds_read_b64 v[62:63], v12 offset:2632
    v_mfma_f32_16x16x32_bf16 v[32:35], v[92:95], v[108:111], v[32:35]
    ds_read_b64 v[64:65], v12 offset:1600
    v_mfma_f32_16x16x32_bf16 v[36:39], v[92:95], v[112:115], v[36:39]
    ds_read_b64 v[66:67], v12 offset:1608
    v_mfma_f32_16x16x32_bf16 v[32:35], v[96:99], v[104:107], v[32:35]
    ds_read_b64 v[68:69], v12 offset:576
    v_mfma_f32_16x16x32_bf16 v[36:39], v[96:99], v[108:111], v[36:39]
    ds_read_b64 v[70:71], v12 offset:584
    s_waitcnt lgkmcnt(12)
    v_mfma_f32_16x16x32_bf16 v[36:39], v[100:103], v[104:107], v[36:39]
    s_mov_b32 s62, 8323199
    s_mov_b32 s63, 8323199
    v_cndmask_b32 v17, v14, v15, s[62:63]
    ds_read_b128 v[104:107], v17 offset:128
    ds_read_b64 v[88:89], v12 offset:3584
    s_waitcnt lgkmcnt(8)
    v_mfma_f32_16x16x32_bf16 v[24:27], v[56:59], v[72:75], v[24:27]
    ds_read_b64 v[90:91], v12 offset:3592
    ds_read_b128 v[108:111], v17 offset:1152
    v_mfma_f32_16x16x32_bf16 v[28:31], v[56:59], v[76:79], v[28:31]
    ds_read_b128 v[112:115], v17 offset:2176
    v_mfma_f32_16x16x32_bf16 v[32:35], v[56:59], v[80:83], v[32:35]
    ds_read_b128 v[116:119], v17 offset:3200
    v_mfma_f32_16x16x32_bf16 v[36:39], v[56:59], v[84:87], v[36:39]
    ds_read_b64 v[92:93], v12 offset:2560
    s_waitcnt lgkmcnt(9)
    s_nop 0
    v_mfma_f32_16x16x32_bf16 v[28:31], v[60:63], v[72:75], v[28:31]
    ds_read_b64 v[94:95], v12 offset:2568
    v_mfma_f32_16x16x32_bf16 v[32:35], v[60:63], v[76:79], v[32:35]
    ds_read_b64 v[96:97], v12 offset:1536
    v_mfma_f32_16x16x32_bf16 v[36:39], v[60:63], v[80:83], v[36:39]
    ds_read_b64 v[98:99], v12 offset:1544
    v_mfma_f32_16x16x32_bf16 v[32:35], v[64:67], v[72:75], v[32:35]
    ds_read_b64 v[100:101], v12 offset:512
    v_mfma_f32_16x16x32_bf16 v[36:39], v[64:67], v[76:79], v[36:39]
    ds_read_b64 v[102:103], v12 offset:520
    s_waitcnt lgkmcnt(12)
    v_mfma_f32_16x16x32_bf16 v[36:39], v[68:71], v[72:75], v[36:39]
    s_mov_b32 s62, 16711935
    s_mov_b32 s63, 16711935
    v_cndmask_b32 v16, v14, v15, s[62:63]
    ds_read_b128 v[72:75], v16 offset:112
    ds_read_b64 v[56:57], v12 offset:3520
    s_waitcnt lgkmcnt(8)
    v_mfma_f32_16x16x32_bf16 v[24:27], v[88:91], v[104:107], v[24:27]
    ds_read_b64 v[58:59], v12 offset:3528
    ds_read_b128 v[76:79], v16 offset:1136
    v_mfma_f32_16x16x32_bf16 v[28:31], v[88:91], v[108:111], v[28:31]
    ds_read_b128 v[80:83], v16 offset:2160
    v_mfma_f32_16x16x32_bf16 v[32:35], v[88:91], v[112:115], v[32:35]
    ds_read_b128 v[84:87], v16 offset:3184
    v_mfma_f32_16x16x32_bf16 v[36:39], v[88:91], v[116:119], v[36:39]
    ds_read_b64 v[60:61], v12 offset:2496
    s_waitcnt lgkmcnt(9)
    s_nop 0
    v_mfma_f32_16x16x32_bf16 v[28:31], v[92:95], v[104:107], v[28:31]
    ds_read_b64 v[62:63], v12 offset:2504
    v_mfma_f32_16x16x32_bf16 v[32:35], v[92:95], v[108:111], v[32:35]
    ds_read_b64 v[64:65], v12 offset:1472
    v_mfma_f32_16x16x32_bf16 v[36:39], v[92:95], v[112:115], v[36:39]
    ds_read_b64 v[66:67], v12 offset:1480
    v_mfma_f32_16x16x32_bf16 v[32:35], v[96:99], v[104:107], v[32:35]
    ds_read_b64 v[68:69], v12 offset:448
    v_mfma_f32_16x16x32_bf16 v[36:39], v[96:99], v[108:111], v[36:39]
    ds_read_b64 v[70:71], v12 offset:456
    s_waitcnt lgkmcnt(12)
    v_mfma_f32_16x16x32_bf16 v[36:39], v[100:103], v[104:107], v[36:39]
    s_mov_b32 s62, 33489407
    s_mov_b32 s63, 33489407
    v_cndmask_b32 v17, v14, v15, s[62:63]
    ds_read_b128 v[104:107], v17 offset:96
    ds_read_b64 v[88:89], v12 offset:3456
    s_waitcnt lgkmcnt(8)
    v_mfma_f32_16x16x32_bf16 v[24:27], v[56:59], v[72:75], v[24:27]
    ds_read_b64 v[90:91], v12 offset:3464
    ds_read_b128 v[108:111], v17 offset:1120
    v_mfma_f32_16x16x32_bf16 v[28:31], v[56:59], v[76:79], v[28:31]
    ds_read_b128 v[112:115], v17 offset:2144
    v_mfma_f32_16x16x32_bf16 v[32:35], v[56:59], v[80:83], v[32:35]
    ds_read_b128 v[116:119], v17 offset:3168
    v_mfma_f32_16x16x32_bf16 v[36:39], v[56:59], v[84:87], v[36:39]
    ds_read_b64 v[92:93], v12 offset:2432
    s_waitcnt lgkmcnt(9)
    s_nop 0
    v_mfma_f32_16x16x32_bf16 v[28:31], v[60:63], v[72:75], v[28:31]
    ds_read_b64 v[94:95], v12 offset:2440
    v_mfma_f32_16x16x32_bf16 v[32:35], v[60:63], v[76:79], v[32:35]
    ds_read_b64 v[96:97], v12 offset:1408
    v_mfma_f32_16x16x32_bf16 v[36:39], v[60:63], v[80:83], v[36:39]
    ds_read_b64 v[98:99], v12 offset:1416
    v_mfma_f32_16x16x32_bf16 v[32:35], v[64:67], v[72:75], v[32:35]
    ds_read_b64 v[100:101], v12 offset:384
    v_mfma_f32_16x16x32_bf16 v[36:39], v[64:67], v[76:79], v[36:39]
    ds_read_b64 v[102:103], v12 offset:392
    s_waitcnt lgkmcnt(12)
    v_mfma_f32_16x16x32_bf16 v[36:39], v[68:71], v[72:75], v[36:39]
    s_mov_b32 s62, 67044351
    s_mov_b32 s63, 67044351
    v_cndmask_b32 v16, v14, v15, s[62:63]
    ds_read_b128 v[72:75], v16 offset:80
    ds_read_b64 v[56:57], v12 offset:3392
    s_waitcnt lgkmcnt(8)
    v_mfma_f32_16x16x32_bf16 v[24:27], v[88:91], v[104:107], v[24:27]
    ds_read_b64 v[58:59], v12 offset:3400
    ds_read_b128 v[76:79], v16 offset:1104
    v_mfma_f32_16x16x32_bf16 v[28:31], v[88:91], v[108:111], v[28:31]
    ds_read_b128 v[80:83], v16 offset:2128
    v_mfma_f32_16x16x32_bf16 v[32:35], v[88:91], v[112:115], v[32:35]
    ds_read_b128 v[84:87], v16 offset:3152
    v_mfma_f32_16x16x32_bf16 v[36:39], v[88:91], v[116:119], v[36:39]
    ds_read_b64 v[60:61], v12 offset:2368
    s_waitcnt lgkmcnt(9)
    s_nop 0
    v_mfma_f32_16x16x32_bf16 v[28:31], v[92:95], v[104:107], v[28:31]
    ds_read_b64 v[62:63], v12 offset:2376
    v_mfma_f32_16x16x32_bf16 v[32:35], v[92:95], v[108:111], v[32:35]
    ds_read_b64 v[64:65], v12 offset:1344
    v_mfma_f32_16x16x32_bf16 v[36:39], v[92:95], v[112:115], v[36:39]
    ds_read_b64 v[66:67], v12 offset:1352
    v_mfma_f32_16x16x32_bf16 v[32:35], v[96:99], v[104:107], v[32:35]
    ds_read_b64 v[68:69], v12 offset:320
    v_mfma_f32_16x16x32_bf16 v[36:39], v[96:99], v[108:111], v[36:39]
    ds_read_b64 v[70:71], v12 offset:328
    s_waitcnt lgkmcnt(12)
    v_mfma_f32_16x16x32_bf16 v[36:39], v[100:103], v[104:107], v[36:39]
    s_mov_b32 s62, 134154239
    s_mov_b32 s63, 134154239
    v_cndmask_b32 v17, v14, v15, s[62:63]
    ds_read_b128 v[104:107], v17 offset:64
    ds_read_b64 v[88:89], v12 offset:3328
    s_waitcnt lgkmcnt(8)
    v_mfma_f32_16x16x32_bf16 v[24:27], v[56:59], v[72:75], v[24:27]
    ds_read_b64 v[90:91], v12 offset:3336
    ds_read_b128 v[108:111], v17 offset:1088
    v_mfma_f32_16x16x32_bf16 v[28:31], v[56:59], v[76:79], v[28:31]
    ds_read_b128 v[112:115], v17 offset:2112
    v_mfma_f32_16x16x32_bf16 v[32:35], v[56:59], v[80:83], v[32:35]
    ds_read_b128 v[116:119], v17 offset:3136
    v_mfma_f32_16x16x32_bf16 v[36:39], v[56:59], v[84:87], v[36:39]
    ds_read_b64 v[92:93], v12 offset:2304
    s_waitcnt lgkmcnt(9)
    s_nop 0
    v_mfma_f32_16x16x32_bf16 v[28:31], v[60:63], v[72:75], v[28:31]
    ds_read_b64 v[94:95], v12 offset:2312
    v_mfma_f32_16x16x32_bf16 v[32:35], v[60:63], v[76:79], v[32:35]
    ds_read_b64 v[96:97], v12 offset:1280
    v_mfma_f32_16x16x32_bf16 v[36:39], v[60:63], v[80:83], v[36:39]
    ds_read_b64 v[98:99], v12 offset:1288
    v_mfma_f32_16x16x32_bf16 v[32:35], v[64:67], v[72:75], v[32:35]
    ds_read_b64 v[100:101], v12 offset:256
    v_mfma_f32_16x16x32_bf16 v[36:39], v[64:67], v[76:79], v[36:39]
    ds_read_b64 v[102:103], v12 offset:264
    s_waitcnt lgkmcnt(12)
    v_mfma_f32_16x16x32_bf16 v[36:39], v[68:71], v[72:75], v[36:39]
    s_mov_b32 s62, 268374015
    s_mov_b32 s63, 268374015
    v_cndmask_b32 v16, v14, v15, s[62:63]
    ds_read_b128 v[72:75], v16 offset:48
    ds_read_b64 v[56:57], v12 offset:3264
    s_waitcnt lgkmcnt(8)
    v_mfma_f32_16x16x32_bf16 v[24:27], v[88:91], v[104:107], v[24:27]
    ds_read_b64 v[58:59], v12 offset:3272
    ds_read_b128 v[76:79], v16 offset:1072
    v_mfma_f32_16x16x32_bf16 v[28:31], v[88:91], v[108:111], v[28:31]
    ds_read_b128 v[80:83], v16 offset:2096
    v_mfma_f32_16x16x32_bf16 v[32:35], v[88:91], v[112:115], v[32:35]
    ds_read_b128 v[84:87], v16 offset:3120
    v_mfma_f32_16x16x32_bf16 v[36:39], v[88:91], v[116:119], v[36:39]
    ds_read_b64 v[60:61], v12 offset:2240
    s_waitcnt lgkmcnt(9)
    s_nop 0
    v_mfma_f32_16x16x32_bf16 v[28:31], v[92:95], v[104:107], v[28:31]
    ds_read_b64 v[62:63], v12 offset:2248
    v_mfma_f32_16x16x32_bf16 v[32:35], v[92:95], v[108:111], v[32:35]
    ds_read_b64 v[64:65], v12 offset:1216
    v_mfma_f32_16x16x32_bf16 v[36:39], v[92:95], v[112:115], v[36:39]
    ds_read_b64 v[66:67], v12 offset:1224
    v_mfma_f32_16x16x32_bf16 v[32:35], v[96:99], v[104:107], v[32:35]
    ds_read_b64 v[68:69], v12 offset:192
    v_mfma_f32_16x16x32_bf16 v[36:39], v[96:99], v[108:111], v[36:39]
    ds_read_b64 v[70:71], v12 offset:200
    s_waitcnt lgkmcnt(12)
    v_mfma_f32_16x16x32_bf16 v[36:39], v[100:103], v[104:107], v[36:39]
    s_mov_b32 s62, 536813567
    s_mov_b32 s63, 536813567
    v_cndmask_b32 v17, v14, v15, s[62:63]
    ds_read_b128 v[104:107], v17 offset:32
    ds_read_b64 v[88:89], v12 offset:3200
    s_waitcnt lgkmcnt(8)
    v_mfma_f32_16x16x32_bf16 v[24:27], v[56:59], v[72:75], v[24:27]
    ds_read_b64 v[90:91], v12 offset:3208
    ds_read_b128 v[108:111], v17 offset:1056
    v_mfma_f32_16x16x32_bf16 v[28:31], v[56:59], v[76:79], v[28:31]
    ds_read_b128 v[112:115], v17 offset:2080
    v_mfma_f32_16x16x32_bf16 v[32:35], v[56:59], v[80:83], v[32:35]
    ds_read_b128 v[116:119], v17 offset:3104
    v_mfma_f32_16x16x32_bf16 v[36:39], v[56:59], v[84:87], v[36:39]
    ds_read_b64 v[92:93], v12 offset:2176
    s_waitcnt lgkmcnt(9)
    s_nop 0
    v_mfma_f32_16x16x32_bf16 v[28:31], v[60:63], v[72:75], v[28:31]
    ds_read_b64 v[94:95], v12 offset:2184
    v_mfma_f32_16x16x32_bf16 v[32:35], v[60:63], v[76:79], v[32:35]
    ds_read_b64 v[96:97], v12 offset:1152
    v_mfma_f32_16x16x32_bf16 v[36:39], v[60:63], v[80:83], v[36:39]
    ds_read_b64 v[98:99], v12 offset:1160
    v_mfma_f32_16x16x32_bf16 v[32:35], v[64:67], v[72:75], v[32:35]
    ds_read_b64 v[100:101], v12 offset:128
    v_mfma_f32_16x16x32_bf16 v[36:39], v[64:67], v[76:79], v[36:39]
    ds_read_b64 v[102:103], v12 offset:136
    s_waitcnt lgkmcnt(12)
    v_mfma_f32_16x16x32_bf16 v[36:39], v[68:71], v[72:75], v[36:39]
    s_mov_b32 s62, 1073692671
    s_mov_b32 s63, 1073692671
    v_cndmask_b32 v16, v14, v15, s[62:63]
    ds_read_b128 v[72:75], v16 offset:16
    ds_read_b64 v[56:57], v12 offset:3136
    s_waitcnt lgkmcnt(8)
    v_mfma_f32_16x16x32_bf16 v[24:27], v[88:91], v[104:107], v[24:27]
    ds_read_b64 v[58:59], v12 offset:3144
    ds_read_b128 v[76:79], v16 offset:1040
    v_mfma_f32_16x16x32_bf16 v[28:31], v[88:91], v[108:111], v[28:31]
    ds_read_b128 v[80:83], v16 offset:2064
    v_mfma_f32_16x16x32_bf16 v[32:35], v[88:91], v[112:115], v[32:35]
    ds_read_b128 v[84:87], v16 offset:3088
    v_mfma_f32_16x16x32_bf16 v[36:39], v[88:91], v[116:119], v[36:39]
    ds_read_b64 v[60:61], v12 offset:2112
    s_waitcnt lgkmcnt(9)
    s_nop 0
    v_mfma_f32_16x16x32_bf16 v[28:31], v[92:95], v[104:107], v[28:31]
    ds_read_b64 v[62:63], v12 offset:2120
    v_mfma_f32_16x16x32_bf16 v[32:35], v[92:95], v[108:111], v[32:35]
    ds_read_b64 v[64:65], v12 offset:1088
    v_mfma_f32_16x16x32_bf16 v[36:39], v[92:95], v[112:115], v[36:39]
    ds_read_b64 v[66:67], v12 offset:1096
    v_mfma_f32_16x16x32_bf16 v[32:35], v[96:99], v[104:107], v[32:35]
    ds_read_b64 v[68:69], v12 offset:64
    v_mfma_f32_16x16x32_bf16 v[36:39], v[96:99], v[108:111], v[36:39]
    ds_read_b64 v[70:71], v12 offset:72
    s_waitcnt lgkmcnt(12)
    v_mfma_f32_16x16x32_bf16 v[36:39], v[100:103], v[104:107], v[36:39]
    s_mov_b32 s62, 2147450879
    s_mov_b32 s63, 2147450879
    v_cndmask_b32 v17, v14, v15, s[62:63]
    ds_read_b128 v[104:107], v17 offset:0
    ds_read_b64 v[88:89], v12 offset:3072
    s_waitcnt lgkmcnt(8)
    v_mfma_f32_16x16x32_bf16 v[24:27], v[56:59], v[72:75], v[24:27]
    ds_read_b64 v[90:91], v12 offset:3080
    ds_read_b128 v[108:111], v17 offset:1024
    v_mfma_f32_16x16x32_bf16 v[28:31], v[56:59], v[76:79], v[28:31]
    ds_read_b128 v[112:115], v17 offset:2048
    v_mfma_f32_16x16x32_bf16 v[32:35], v[56:59], v[80:83], v[32:35]
    ds_read_b128 v[116:119], v17 offset:3072
    v_mfma_f32_16x16x32_bf16 v[36:39], v[56:59], v[84:87], v[36:39]
    ds_read_b64 v[92:93], v12 offset:2048
    s_waitcnt lgkmcnt(9)
    s_nop 0
    v_mfma_f32_16x16x32_bf16 v[28:31], v[60:63], v[72:75], v[28:31]
    ds_read_b64 v[94:95], v12 offset:2056
    v_mfma_f32_16x16x32_bf16 v[32:35], v[60:63], v[76:79], v[32:35]
    ds_read_b64 v[96:97], v12 offset:1024
    v_mfma_f32_16x16x32_bf16 v[36:39], v[60:63], v[80:83], v[36:39]
    ds_read_b64 v[98:99], v12 offset:1032
    v_mfma_f32_16x16x32_bf16 v[32:35], v[64:67], v[72:75], v[32:35]
    ds_read_b64 v[100:101], v12 offset:0
    v_mfma_f32_16x16x32_bf16 v[36:39], v[64:67], v[76:79], v[36:39]
    ds_read_b64 v[102:103], v12 offset:8
    s_waitcnt lgkmcnt(12)
    v_mfma_f32_16x16x32_bf16 v[36:39], v[68:71], v[72:75], v[36:39]
    s_waitcnt lgkmcnt(6)
    v_mfma_f32_16x16x32_bf16 v[24:27], v[88:91], v[104:107], v[24:27]
    v_mfma_f32_16x16x32_bf16 v[28:31], v[88:91], v[108:111], v[28:31]
    v_mfma_f32_16x16x32_bf16 v[32:35], v[88:91], v[112:115], v[32:35]
    v_mfma_f32_16x16x32_bf16 v[36:39], v[88:91], v[116:119], v[36:39]
    s_waitcnt lgkmcnt(2)
    v_mfma_f32_16x16x32_bf16 v[28:31], v[92:95], v[104:107], v[28:31]
    v_mfma_f32_16x16x32_bf16 v[32:35], v[92:95], v[108:111], v[32:35]
    v_mfma_f32_16x16x32_bf16 v[36:39], v[92:95], v[112:115], v[36:39]
    v_mfma_f32_16x16x32_bf16 v[32:35], v[96:99], v[104:107], v[32:35]
    v_mfma_f32_16x16x32_bf16 v[36:39], v[96:99], v[108:111], v[36:39]
    s_waitcnt lgkmcnt(0)
    v_mfma_f32_16x16x32_bf16 v[36:39], v[100:103], v[104:107], v[36:39]
    v_and_b32 v4, 1, v2
    v_lshlrev_b32 v4, 5, v4
    v_lshl_add_u32 v4, v3, 3, v4
    v_mul_u32_u24 v4, 40960, v4
    v_lshrrev_b32 v5, 1, v2
    v_lshl_add_u32 v8, v5, 3, v4
    s_add_u32 s60, s67, s4
    s_lshl_b32 s60, s60, 6
    s_mul_i32 s61, s5, 40960
    s_add_u32 s60, s60, s61
    s_add_u32 s3, s60, 12582912
    v_cvt_pk_bf16_f32 v56, v24, v28
    v_cvt_pk_bf16_f32 v57, v32, v36
    buffer_store_dwordx2 v[56:57], v8, s[32:35], s3 offen sc1
    s_add_u32 s3, s3, 81920
    v_cvt_pk_bf16_f32 v58, v25, v29
    v_cvt_pk_bf16_f32 v59, v33, v37
    buffer_store_dwordx2 v[58:59], v8, s[32:35], s3 offen sc1
    s_add_u32 s3, s3, 81920
    v_cvt_pk_bf16_f32 v60, v26, v30
    v_cvt_pk_bf16_f32 v61, v34, v38
    buffer_store_dwordx2 v[60:61], v8, s[32:35], s3 offen sc1
    s_add_u32 s3, s3, 81920
    v_cvt_pk_bf16_f32 v62, v27, v31
    v_cvt_pk_bf16_f32 v63, v35, v39
    buffer_store_dwordx2 v[62:63], v8, s[32:35], s3 offen sc1
    s_mov_b64 exec, 1
    s_nop 0
    v_mov_b32 v4, 156524
    s_mov_b32 s61, 0
L_sy40:
    ds_read_b32 v5, v4
    s_add_u32 s61, s61, 1
    s_waitcnt lgkmcnt(0)
    v_readfirstlane_b32 s60, v5
    s_cmp_ge_u32 s61, 1048576
    s_cbranch_scc1 L_syd41
    s_cmp_lt_u32 s60, 4
    s_cbranch_scc1 L_sy40
L_syd41:
    s_mov_b64 exec, -1
    ds_read_b32 v72, v23 offset:0
    ds_read_b32 v73, v23 offset:1024
    ds_read_b32 v74, v23 offset:2048
    ds_read_b32 v75, v23 offset:3072
    ds_read_b32 v76, v23 offset:4096
    ds_read_b32 v77, v23 offset:5120
    ds_read_b32 v78, v23 offset:6144
    ds_read_b32 v79, v23 offset:7168
    ds_read_b32 v80, v23 offset:8192
    ds_read_b32 v81, v23 offset:9216
    ds_read_b32 v82, v23 offset:10240
    ds_read_b32 v83, v23 offset:11264
    ds_read_b32 v84, v23 offset:12288
    ds_read_b32 v85, v23 offset:13312
    ds_read_b32 v86, v23 offset:14336
    ds_read_b32 v87, v23 offset:15360
    s_lshl_b32 s60, s64, 1
    s_add_u32 s60, s60, s68
    s_mul_i32 s60, s60, 40960
    s_lshl_b32 s61, s92, 6
    s_add_u32 s60, s60, s61
    s_add_u32 s3, s60, 12582912
    s_lshr_b32 s62, s65, 6
    s_mul_i32 s62, s62, 576
    s_and_b32 s63, s65, 3
    s_mul_i32 s63, s63, 128
    s_add_u32 s62, s62, s63
    s_add_u32 s62, s62, 19922944
    s_waitcnt lgkmcnt(0)
    v_pk_add_f32 v[72:73], v[72:73], v[76:77]
    v_pk_add_f32 v[80:81], v[80:81], v[84:85]
    v_pk_add_f32 v[74:75], v[74:75], v[78:79]
    v_pk_add_f32 v[82:83], v[82:83], v[86:87]
    v_pk_add_f32 v[72:73], v[72:73], v[80:81]
    v_pk_add_f32 v[74:75], v[74:75], v[82:83]
    v_cvt_pk_bf16_f32 v64, v72, v73
    v_cvt_pk_bf16_f32 v65, v74, v75
    buffer_store_dwordx2 v[64:65], v8, s[32:35], s3 offen sc1
    s_waitcnt vmcnt(0)
    s_mov_b64 exec, 1
    v_mov_b32 v4, 156512
    v_mov_b32 v5, 1
    ds_add_rtn_u32 v5, v4, v5
    s_waitcnt lgkmcnt(0)
    v_readfirstlane_b32 s60, v5
    s_mov_b64 exec, -1
    s_cmp_lg_u32 s60, 3
    s_cbranch_scc1 L_anf
    v_mul_u32_u24 v4, 2304, v1
    v_mov_b32_e64 v5, 1
    buffer_atomic_add v5, v4, s[32:35], s62 offen sc1
L_anf:
    s_lshr_b32 s60, s59, 2
    s_lshl_b32 s61, s58, 3
    s_add_u32 s60, s60, s61
    s_lshr_b32 s61, s60, 0
    s_lshl_b32 s61, s61, 2
    s_add_u32 s61, s61, s64
    s_mul_i32 s61, s61, 576
    s_add_u32 s25, s61, 19922944
    s_mul_i32 s60, s60, 40960
    s_mul_i32 s61, s64, 10240
    s_add_u32 s60, s60, s61
    s_and_b32 s61, s59, 3
    s_lshl_b32 s61, s61, 4
    s_add_u32 s60, s60, s61
    s_add_u32 s7, s60, 12582912
    s_mul_i32 s60, s64, 2560
    s_add_u32 s9, s60, 144128
    v_lshlrev_b32_e64 v11, 6, v1
    s_load_dwordx2 s[52:53], s[0:1], 88
    s_mov_b32 s54, 2621440
    s_mov_b32 s55, 0x00020000
    s_and_b32 s66, s59, 3
    s_lshr_b32 s69, s59, 2
    s_lshl_b32 s61, s58, 3
    s_add_u32 s69, s69, s61
    v_lshrrev_b32 v6, 1, v3
    v_and_b32 v7, 1, v3
    v_and_b32 v8, 3, v1
    v_lshrrev_b32 v9, 2, v2
    v_lshlrev_b32_e64 v10, 5, v6
    v_lshl_add_u32 v10, v8, 3, v10
    v_add_u32 v10, v10, v9
    v_lshlrev_b32 v10, 4, v10
    v_lshl_add_u32 v10, v7, 3, v10
    s_lshl_b32 s60, s57, 10
    s_add_u32 s60, s60, 86784
    v_add_u32 v120, s60, v10
    v_lshl_add_u32 v10, v7, 2, v8
    v_lshlrev_b32_e64 v10, 2, v10
    v_add_u32 v122, 156416, v10
    v_lshl_add_u32 v8, v8, 3, v7
    v_mul_u32_u24 v8, 81920, v8
    v_lshlrev_b32_e64 v6, 6, v6
    v_lshl_add_u32 v6, v9, 4, v6
    v_add_u32 v121, v8, v6
    s_mov_b64 exec, 1
    v_mov_b32 v4, 156484
    s_mov_b32 s61, 0
L_sy42:
    s_sleep 2
    ds_read_b32 v5, v4
    s_add_u32 s61, s61, 1
    s_waitcnt lgkmcnt(0)
    v_readfirstlane_b32 s60, v5
    s_cmp_ge_u32 s61, 1048576
    s_cbranch_scc1 L_syd43
    s_cmp_lt_u32 s60, 4
    s_cbranch_scc1 L_sy42
L_syd43:
    s_mov_b64 exec, -1
    s_mov_b32 s61, 0
    s_add_u32 s26, s56, 16
    s_mov_b32 s27, s26
L_sp44:
    s_load_dword s40, s[28:29], s25 offset:0 glc
    s_load_dword s41, s[28:29], s25 offset:128 glc
    s_load_dword s42, s[28:29], s25 offset:256 glc
    s_load_dword s43, s[28:29], s25 offset:384 glc
    s_add_u32 s61, s61, 1
    s_cmp_ge_u32 s61, 65536
    s_waitcnt lgkmcnt(0)
    s_cbranch_scc1 L_spd45
    s_cmp_lg_u64 s[40:41], s[26:27]
    s_cbranch_scc1 L_spa46
    s_cmp_lg_u64 s[42:43], s[26:27]
    s_cbranch_scc1 L_spa46
    s_branch L_spd45
L_spa46:
    s_sleep 2
    s_branch L_sp44
L_spd45:
    s_add_u32 m0, s9, 0
    s_nop 0
    buffer_load_dwordx4 v11, s[32:35], s7 offen sc1 lds
    s_add_u32 s7, s7, 4096
    s_add_u32 m0, s9, 1024
    s_nop 0
    s_nop 0
    buffer_load_dwordx4 v11, s[32:35], s7 offen sc1 lds
    s_add_u32 s7, s7, 4096
    s_add_u32 m0, s9, 2048
    s_mov_b32 exec_hi, 0
    buffer_load_dwordx4 v11, s[32:35], s7 offen sc1 lds
    s_mov_b64 exec, -1
    s_waitcnt vmcnt(0)
    s_lshl_b32 s60, s66, 7
    s_add_u32 s60, s60, s69
    s_mul_i32 s60, s60, 1280
    s_lshl_b32 s61, s57, 7
    s_add_u32 s4, s60, s61
    s_barrier
    ds_read_b32 v88, v122
    ds_read_b64_tr_b16 v[56:57], v120 offset:57344
    ds_read_b64_tr_b16 v[60:61], v120 offset:0
    ds_read_b64_tr_b16 v[58:59], v120 offset:57408
    ds_read_b64_tr_b16 v[62:63], v120 offset:64
    ds_read_b64_tr_b16 v[64:65], v120 offset:61440
    ds_read_b64_tr_b16 v[68:69], v120 offset:4096
    ds_read_b64_tr_b16 v[66:67], v120 offset:61504
    ds_read_b64_tr_b16 v[70:71], v120 offset:4160
    s_waitcnt lgkmcnt(4)
    v_lshlrev_b32 v72, 16, v56
    v_and_b32 v73, 0xffff0000, v56
    v_lshlrev_b32_e64 v74, 16, v60
    v_and_b32 v75, 0xffff0000, v60
    v_lshlrev_b32_e64 v76, 16, v57
    v_and_b32 v77, 0xffff0000, v57
    v_lshlrev_b32_e64 v78, 16, v61
    v_and_b32 v79, 0xffff0000, v61
    v_lshlrev_b32_e64 v80, 16, v58
    v_and_b32 v81, 0xffff0000, v58
    v_lshlrev_b32_e64 v82, 16, v62
    v_and_b32 v83, 0xffff0000, v62
    v_lshlrev_b32_e64 v84, 16, v59
    v_and_b32 v85, 0xffff0000, v59
    v_lshlrev_b32_e64 v86, 16, v63
    v_and_b32 v87, 0xffff0000, v63
    v_pk_fma_f32 v[72:73], v[88:89], v[72:73], v[74:75] op_sel:[0,0,0] op_sel_hi:[0,1,1]
    v_pk_fma_f32 v[76:77], v[88:89], v[76:77], v[78:79] op_sel:[0,0,0] op_sel_hi:[0,1,1]
    v_pk_fma_f32 v[80:81], v[88:89], v[80:81], v[82:83] op_sel:[0,0,0] op_sel_hi:[0,1,1]
    v_pk_fma_f32 v[84:85], v[88:89], v[84:85], v[86:87] op_sel:[0,0,0] op_sel_hi:[0,1,1]
    v_cvt_pk_bf16_f32 v56, v72, v73
    v_cvt_pk_bf16_f32 v57, v76, v77
    v_cvt_pk_bf16_f32 v58, v80, v81
    v_cvt_pk_bf16_f32 v59, v84, v85
    buffer_store_dwordx4 v[56:59], v121, s[52:55], s4 offen offset:0 sc1
    s_cmp_gt_u32 s57, 5
    s_cbranch_scc1 L_ff48
    s_waitcnt lgkmcnt(0)
    v_lshlrev_b32 v72, 16, v64
    v_and_b32 v73, 0xffff0000, v64
    v_lshlrev_b32_e64 v74, 16, v68
    v_and_b32 v75, 0xffff0000, v68
    v_lshlrev_b32_e64 v76, 16, v65
    v_and_b32 v77, 0xffff0000, v65
    v_lshlrev_b32_e64 v78, 16, v69
    v_and_b32 v79, 0xffff0000, v69
    v_lshlrev_b32_e64 v80, 16, v66
    v_and_b32 v81, 0xffff0000, v66
    v_lshlrev_b32_e64 v82, 16, v70
    v_and_b32 v83, 0xffff0000, v70
    v_lshlrev_b32_e64 v84, 16, v67
    v_and_b32 v85, 0xffff0000, v67
    v_lshlrev_b32_e64 v86, 16, v71
    v_and_b32 v87, 0xffff0000, v71
    v_pk_fma_f32 v[72:73], v[88:89], v[72:73], v[74:75] op_sel:[0,0,0] op_sel_hi:[0,1,1]
    v_pk_fma_f32 v[76:77], v[88:89], v[76:77], v[78:79] op_sel:[0,0,0] op_sel_hi:[0,1,1]
    v_pk_fma_f32 v[80:81], v[88:89], v[80:81], v[82:83] op_sel:[0,0,0] op_sel_hi:[0,1,1]
    v_pk_fma_f32 v[84:85], v[88:89], v[84:85], v[86:87] op_sel:[0,0,0] op_sel_hi:[0,1,1]
    v_cvt_pk_bf16_f32 v64, v72, v73
    v_cvt_pk_bf16_f32 v65, v76, v77
    v_cvt_pk_bf16_f32 v66, v80, v81
    v_cvt_pk_bf16_f32 v67, v84, v85
    buffer_store_dwordx4 v[64:67], v121, s[52:55], s4 offen offset:512 sc1
L_ff48:
L_end:
    s_endpgm
.section .rodata,"a"
.p2align 6
.amdhsa_kernel gated_mix__ssm_conv_s4d__spectral_gfnet__prompt_kernel
  .amdhsa_next_free_vgpr 256
  .amdhsa_next_free_sgpr 100
  .amdhsa_accum_offset 256
  .amdhsa_group_segment_fixed_size 0
  .amdhsa_kernarg_size 112
  .amdhsa_user_sgpr_count 2
  .amdhsa_user_sgpr_kernarg_segment_ptr 1
  .amdhsa_system_sgpr_workgroup_id_x 1
  .amdhsa_float_denorm_mode_32 3
.end_amdhsa_kernel
.p2align 8
L_tab:
.quad 0x3f8000003f80,0x3f8000003f80,0x3f8080003f808000,0x3f8080003f808000,0x3ec43f6d00003f80,0xbec4bf6d250dbf80,0x3f6dbec43f808000,0xbf6d3ec4bf80a50d,0x3f353f3500003f80,0x3f353f3500003f80,0x3f35bf353f808000,0x3f35bf353f808000,0x3f6d3ec400003f80,0xbf6dbec4250dbf80,0x3ec4bf6d3f808000,0xbec43f6dbf80a50d
.quad 0x3f80248d00003f80,0x3f80248d00003f80,0x248dbf803f808000,0x248dbf803f808000,0x3f6dbec400003f80,0xbf6d3ec4250dbf80,0xbec4bf6d3f808000,0x3ec43f6dbf80a50d,0x3f35bf3500003f80,0x3f35bf3500003f80,0xbf35bf353f808000,0xbf35bf353f808000,0x3ec4bf6d00003f80,0xbec43f6d250dbf80,0xbf6dbec43f808000,0x3f6d3ec4bf80a50d
.quad 0x3f8000003f80,0x3f8000003f80,0x3f8080003f808000,0x3f8080003f808000,0x3f6d3ec43f353f35,0xbf6dbec4bf35bf35,0x3ec4bf6d3f35bf35,0xbec43f6dbf353f35,0x3f35bf353f80248d,0x3f35bf353f80248d,0xbf35bf35248dbf80,0xbf35bf35248dbf80,0xbec4bf6d3f35bf35,0x3ec43f6dbf353f35,0xbf6d3ec4bf35bf35,0x3f6dbec43f353f35
.quad 0xbf80a554250dbf80,0xbf80a554250dbf80,0xa5543f80bf80a50d,0xa5543f80bf80a50d,0xbec43f6dbf35bf35,0x3ec4bf6d3f353f35,0x3f6d3ec4bf353f35,0xbf6dbec43f35bf35,0x3f353f35bf80a554,0x3f353f35bf80a554,0x3f35bf35a5543f80,0x3f35bf35a5543f80,0x3f6dbec4bf353f35,0xbf6d3ec43f35bf35,0xbec4bf6d3f353f35,0x3ec43f6dbf35bf35
.quad 0x3f8000003f80,0x3f8000003f80,0x3f8080003f808000,0x3f8080003f808000,0x3f6dbec43f80248d,0xbf6d3ec4bf80a554,0xbec4bf6d248dbf80,0x3ec43f6da5543f80,0xbf35bf35250dbf80,0xbf35bf35250dbf80,0xbf353f35bf80a50d,0xbf353f35bf80a50d,0xbec43f6dbf80a554,0x3ec4bf6d3f80248d,0x3f6d3ec4a5543f80,0xbf6dbec4248dbf80
.quad 0x3f80248d00003f80,0x3f80248d00003f80,0x248dbf803f808000,0x248dbf803f808000,0xbec4bf6d3f80248d,0x3ec43f6dbf80a554,0xbf6d3ec4248dbf80,0x3f6dbec4a5543f80,0xbf353f35250dbf80,0xbf353f35250dbf80,0x3f353f35bf80a50d,0x3f353f35bf80a50d,0x3f6d3ec4bf80a554,0xbf6dbec43f80248d,0x3ec4bf6da5543f80,0xbec43f6d248dbf80
.quad 0x3f8000003f80,0x3f8000003f80,0x3f8080003f808000,0x3f8080003f808000,0x3ec4bf6d3f35bf35,0xbec43f6dbf353f35,0xbf6dbec4bf35bf35,0x3f6d3ec43f353f35,0xbf353f35bf80a554,0xbf353f35bf80a554,0x3f353f35a5543f80,0x3f353f35a5543f80,0x3f6dbec43f353f35,0xbf6d3ec4bf35bf35,0xbec4bf6d3f35bf35,0x3ec43f6dbf353f35
.quad 0xbf80a554250dbf80,0xbf80a554250dbf80,0xa5543f80bf80a50d,0xa5543f80bf80a50d,0x3f6d3ec4bf353f35,0xbf6dbec43f35bf35,0x3ec4bf6d3f353f35,0xbec43f6dbf35bf35,0xbf35bf353f80248d,0xbf35bf353f80248d,0xbf353f35248dbf80,0xbf353f35248dbf80,0x3ec43f6dbf35bf35,0xbec4bf6d3f353f35,0x3f6dbec4bf353f35,0xbf6d3ec43f35bf35
.quad 0x250dbf8000003f80,0x250dbf8000003f80,0xbf80a50d3f808000,0xbf80a50d3f808000,0xbec4bf6d00003f80,0x3ec43f6d250dbf80,0xbf6d3ec43f808000,0x3f6dbec4bf80a50d,0xbf35bf3500003f80,0xbf35bf3500003f80,0xbf353f353f808000,0xbf353f353f808000,0xbf6dbec400003f80,0x3f6d3ec4250dbf80,0xbec43f6d3f808000,0x3ec4bf6dbf80a50d
.quad 0xbf80a55400003f80,0xbf80a55400003f80,0xa5543f803f808000,0xa5543f803f808000,0xbf6d3ec400003f80,0x3f6dbec4250dbf80,0x3ec43f6d3f808000,0xbec4bf6dbf80a50d,0xbf353f3500003f80,0xbf353f3500003f80,0x3f353f353f808000,0x3f353f353f808000,0xbec43f6d00003f80,0x3ec4bf6d250dbf80,0x3f6d3ec43f808000,0xbf6dbec4bf80a50d
.quad 0x250dbf8000003f80,0x250dbf8000003f80,0xbf80a50d3f808000,0xbf80a50d3f808000,0xbf6dbec43f353f35,0x3f6d3ec4bf35bf35,0xbec43f6d3f35bf35,0x3ec4bf6dbf353f35,0xbf353f353f80248d,0xbf353f353f80248d,0x3f353f35248dbf80,0x3f353f35248dbf80,0x3ec43f6d3f35bf35,0xbec4bf6dbf353f35,0x3f6dbec4bf35bf35,0xbf6d3ec43f353f35
.quad 0x3f80248d250dbf80,0x3f80248d250dbf80,0x248dbf80bf80a50d,0x248dbf80bf80a50d,0x3ec4bf6dbf35bf35,0xbec43f6d3f353f35,0xbf6dbec4bf353f35,0x3f6d3ec43f35bf35,0xbf35bf35bf80a554,0xbf35bf35bf80a554,0xbf353f35a5543f80,0xbf353f35a5543f80,0xbf6d3ec4bf353f35,0x3f6dbec43f35bf35,0x3ec43f6d3f353f35,0xbec4bf6dbf35bf35
.quad 0x250dbf8000003f80,0x250dbf8000003f80,0xbf80a50d3f808000,0xbf80a50d3f808000,0xbf6d3ec43f80248d,0x3f6dbec4bf80a554,0x3ec43f6d248dbf80,0xbec4bf6da5543f80,0x3f353f35250dbf80,0x3f353f35250dbf80,0x3f35bf35bf80a50d,0x3f35bf35bf80a50d,0x3ec4bf6dbf80a554,0xbec43f6d3f80248d,0xbf6dbec4a5543f80,0x3f6d3ec4248dbf80
.quad 0xbf80a55400003f80,0xbf80a55400003f80,0xa5543f803f808000,0xa5543f803f808000,0x3ec43f6d3f80248d,0xbec4bf6dbf80a554,0x3f6dbec4248dbf80,0xbf6d3ec4a5543f80,0x3f35bf35250dbf80,0x3f35bf35250dbf80,0xbf35bf35bf80a50d,0xbf35bf35bf80a50d,0xbf6dbec4bf80a554,0x3f6d3ec43f80248d,0xbec43f6da5543f80,0x3ec4bf6d248dbf80
.quad 0x250dbf8000003f80,0x250dbf8000003f80,0xbf80a50d3f808000,0xbf80a50d3f808000,0xbec43f6d3f35bf35,0x3ec4bf6dbf353f35,0x3f6d3ec4bf35bf35,0xbf6dbec43f353f35,0x3f35bf35bf80a554,0x3f35bf35bf80a554,0xbf35bf35a5543f80,0xbf35bf35a5543f80,0xbf6d3ec43f353f35,0x3f6dbec4bf35bf35,0x3ec43f6d3f35bf35,0xbec4bf6dbf353f35
.quad 0x3f80248d250dbf80,0x3f80248d250dbf80,0x248dbf80bf80a50d,0x248dbf80bf80a50d,0xbf6dbec4bf353f35,0x3f6d3ec43f35bf35,0xbec43f6d3f353f35,0x3ec4bf6dbf35bf35,0x3f353f353f80248d,0x3f353f353f80248d,0x3f35bf35248dbf80,0x3f35bf35248dbf80,0xbec4bf6dbf35bf35,0x3ec43f6d3f353f35,0xbf6d3ec4bf353f35,0x3f6dbec43f35bf35
.quad 0x3f8000003f80,0x3f8000003f80,0x3f8080003f808000,0x3f8080003f808000,0x3ef13f623dc93f7f,0xbef1bf62bdc9bf7f,0x3f62bef13f7fbdc9,0xbf623ef1bf7f3dc9,0x3f553f0e3e483f7b,0x3f553f0e3e483f7b,0x3f0ebf553f7bbe48,0x3f0ebf553f7bbe48,0x3f7f3dc93e953f75,0xbf7fbdc9be95bf75,0x3dc9bf7f3f75be95,0xbdc93f7fbf753e95
.quad 0x3f6dbec43ec43f6d,0x3f6dbec43ec43f6d,0xbec4bf6d3f6dbec4,0xbec4bf6d3f6dbec4,0x3f22bf463ef13f62,0xbf223f46bef1bf62,0xbf46bf223f62bef1,0x3f463f22bf623ef1,0x3e48bf7b3f0e3f55,0x3e48bf7b3f0e3f55,0xbf7bbe483f55bf0e,0xbf7bbe483f55bf0e,0xbe95bf753f223f46,0x3e953f75bf22bf46,0xbf753e953f46bf22,0x3f75be95bf463f22
.quad 0x3f8000003f80,0x3f8000003f80,0x3f8080003f808000,0x3f8080003f808000,0x3f753e953f463f22,0xbf75be95bf46bf22,0x3e95bf753f22bf46,0xbe953f75bf223f46,0x3f0ebf553f7bbe48,0x3f0ebf553f7bbe48,0xbf55bf0ebe48bf7b,0xbf55bf0ebe48bf7b,0xbf22bf463ef1bf62,0x3f223f46bef13f62,0xbf463f22bf62bef1,0x3f46bf223f623ef1
.quad 0xbf6d3ec4bec4bf6d,0xbf6d3ec4bec4bf6d,0x3ec43f6dbf6d3ec4,0x3ec43f6dbf6d3ec4,0x3dc93f7fbf75be95,0xbdc9bf7f3f753e95,0x3f7fbdc9be953f75,0xbf7f3dc93e95bf75,0x3f7b3e48bf553f0e,0x3f7b3e48bf553f0e,0x3e48bf7b3f0e3f55,0x3e48bf7b3f0e3f55,0x3ef1bf62bdc93f7f,0xbef13f623dc9bf7f,0xbf62bef13f7f3dc9,0x3f623ef1bf7fbdc9
.quad 0x3f8000003f80,0x3f8000003f80,0x3f8080003f808000,0x3f8080003f808000,0x3f62bef13f7fbdc9,0xbf623ef1bf7f3dc9,0xbef1bf62bdc9bf7f,0x3ef13f623dc93f7f,0xbf55bf0ebe48bf7b,0xbf55bf0ebe48bf7b,0xbf0e3f55bf7b3e48,0xbf0e3f55bf7b3e48,0xbdc93f7fbf753e95,0x3dc9bf7f3f75be95,0x3f7f3dc93e953f75,0xbf7fbdc9be95bf75
.quad 0x3f6dbec43ec43f6d,0x3f6dbec43ec43f6d,0xbec4bf6d3f6dbec4,0xbec4bf6d3f6dbec4,0xbf46bf223f62bef1,0x3f463f22bf623ef1,0xbf223f46bef1bf62,0x3f22bf463ef13f62,0xbe483f7bbf0ebf55,0xbe483f7bbf0ebf55,0x3f7b3e48bf553f0e,0x3f7b3e48bf553f0e,0x3f75be95bf463f22,0xbf753e953f46bf22,0xbe95bf753f223f46,0x3e953f75bf22bf46
.quad 0x3f8000003f80,0x3f8000003f80,0x3f8080003f808000,0x3f8080003f808000,0x3e95bf753f22bf46,0xbe953f75bf223f46,0xbf75be95bf46bf22,0x3f753e953f463f22,0xbf0e3f55bf7b3e48,0xbf0e3f55bf7b3e48,0x3f553f0e3e483f7b,0x3f553f0e3e483f7b,0x3f46bf223f623ef1,0xbf463f22bf62bef1,0xbf22bf463ef1bf62,0x3f223f46bef13f62
.quad 0xbf6d3ec4bec4bf6d,0xbf6d3ec4bec4bf6d,0x3ec43f6dbf6d3ec4,0x3ec43f6dbf6d3ec4,0x3f7fbdc9be953f75,0xbf7f3dc93e95bf75,0xbdc9bf7f3f753e95,0x3dc93f7fbf75be95,0xbf7bbe483f55bf0e,0xbf7bbe483f55bf0e,0xbe483f7bbf0ebf55,0xbe483f7bbf0ebf55,0x3f623ef1bf7fbdc9,0xbf62bef13f7f3dc9,0x3ef1bf62bdc93f7f,0xbef13f623dc9bf7f
.quad 0xbf35bf353f353f35,0xbf35bf353f353f35,0xbf353f353f35bf35,0xbf353f353f35bf35,0xbf75be953f463f22,0x3f753e95bf46bf22,0xbe953f753f22bf46,0x3e95bf75bf223f46,0xbf7b3e483f553f0e,0xbf7b3e483f553f0e,0x3e483f7b3f0ebf55,0x3e483f7b3f0ebf55,0xbf463f223f623ef1,0x3f46bf22bf62bef1,0x3f223f463ef1bf62,0xbf22bf46bef13f62
.quad 0xbec43f6d3f6d3ec4,0xbec43f6d3f6d3ec4,0x3f6d3ec43ec4bf6d,0x3f6d3ec43ec4bf6d,0x3dc93f7f3f753e95,0xbdc9bf7fbf75be95,0x3f7fbdc93e95bf75,0xbf7f3dc9be953f75,0x3f0e3f553f7b3e48,0x3f0e3f553f7b3e48,0x3f55bf0e3e48bf7b,0x3f55bf0e3e48bf7b,0x3f623ef13f7f3dc9,0xbf62bef1bf7fbdc9,0x3ef1bf623dc9bf7f,0xbef13f62bdc93f7f
.quad 0xbf35bf353f353f35,0xbf35bf353f353f35,0xbf353f353f35bf35,0xbf353f353f35bf35,0xbf623ef13f7fbdc9,0x3f62bef1bf7f3dc9,0x3ef13f62bdc9bf7f,0xbef1bf623dc93f7f,0x3e483f7b3f0ebf55,0x3e483f7b3f0ebf55,0x3f7bbe48bf55bf0e,0x3f7bbe48bf55bf0e,0x3f7f3dc9be95bf75,0xbf7fbdc93e953f75,0x3dc9bf7fbf753e95,0xbdc93f7f3f75be95
.quad 0x3ec4bf6dbf6dbec4,0x3ec4bf6dbf6dbec4,0xbf6dbec4bec43f6d,0xbf6dbec4bec43f6d,0xbf46bf22bf623ef1,0x3f463f223f62bef1,0xbf223f463ef13f62,0x3f22bf46bef1bf62,0xbf553f0ebe483f7b,0xbf553f0ebe483f7b,0x3f0e3f553f7b3e48,0x3f0e3f553f7b3e48,0x3e953f753f223f46,0xbe95bf75bf22bf46,0x3f75be953f46bf22,0xbf753e95bf463f22
.quad 0xbf35bf353f353f35,0xbf35bf353f353f35,0xbf353f353f35bf35,0xbf353f353f35bf35,0xbe953f753f22bf46,0x3e95bf75bf223f46,0x3f753e95bf46bf22,0xbf75be953f463f22,0x3f7bbe48bf55bf0e,0x3f7bbe48bf55bf0e,0xbe48bf7bbf0e3f55,0xbe48bf7bbf0e3f55,0xbf22bf46bef13f62,0x3f223f463ef1bf62,0xbf463f223f623ef1,0x3f46bf22bf62bef1
.quad 0xbec43f6d3f6d3ec4,0xbec43f6d3f6d3ec4,0x3f6d3ec43ec4bf6d,0x3f6d3ec43ec4bf6d,0x3f7fbdc93e95bf75,0xbf7f3dc9be953f75,0xbdc9bf7fbf75be95,0x3dc93f7f3f753e95,0xbf0ebf55bf7bbe48,0xbf0ebf55bf7bbe48,0xbf553f0ebe483f7b,0xbf553f0ebe483f7b,0xbef13f62bdc93f7f,0x3ef1bf623dc9bf7f,0x3f623ef13f7f3dc9,0xbf62bef1bf7fbdc9
.quad 0xbf35bf353f353f35,0xbf35bf353f353f35,0xbf353f353f35bf35,0xbf353f353f35bf35,0x3ef13f62bdc9bf7f,0xbef1bf623dc93f7f,0x3f62bef1bf7f3dc9,0xbf623ef13f7fbdc9,0xbe48bf7bbf0e3f55,0xbe48bf7bbf0e3f55,0xbf7b3e483f553f0e,0xbf7b3e483f553f0e,0xbdc93f7f3f75be95,0x3dc9bf7fbf753e95,0x3f7f3dc9be95bf75,0xbf7fbdc93e953f75
.quad 0x3ec4bf6dbf6dbec4,0x3ec4bf6dbf6dbec4,0xbf6dbec4bec43f6d,0xbf6dbec4bec43f6d,0xbf223f463ef13f62,0x3f22bf46bef1bf62,0x3f463f223f62bef1,0xbf46bf22bf623ef1,0x3f55bf0e3e48bf7b,0x3f55bf0e3e48bf7b,0xbf0ebf55bf7bbe48,0xbf0ebf55bf7bbe48,0xbf753e95bf463f22,0x3f75be953f46bf22,0x3e953f753f223f46,0xbe95bf75bf22bf46
.quad 0x3f8000003f80,0x3f8000003f80,0x3f8080003f808000,0x3f8080003f808000,0x3f0e3f553e483f7b,0xbf0ebf55be48bf7b,0x3f55bf0e3f7bbe48,0xbf553f0ebf7b3e48,0x3f6d3ec43ec43f6d,0x3f6d3ec43ec43f6d,0x3ec4bf6d3f6dbec4,0x3ec4bf6d3f6dbec4,0x3f7bbe483f0e3f55,0xbf7b3e48bf0ebf55,0xbe48bf7b3f55bf0e,0x3e483f7bbf553f0e
.quad 0x3f35bf353f353f35,0x3f35bf353f353f35,0xbf35bf353f35bf35,0xbf35bf353f35bf35,0x3e48bf7b3f553f0e,0xbe483f7bbf55bf0e,0xbf7bbe483f0ebf55,0x3f7b3e48bf0e3f55,0xbec4bf6d3f6d3ec4,0xbec4bf6d3f6d3ec4,0xbf6d3ec43ec4bf6d,0xbf6d3ec43ec4bf6d,0xbf55bf0e3f7b3e48,0x3f553f0ebf7bbe48,0xbf0e3f553e48bf7b,0x3f0ebf55be483f7b
.quad 0x3f8000003f80,0x3f8000003f80,0x3f8080003f808000,0x3f8080003f808000,0x3f7b3e483f553f0e,0xbf7bbe48bf55bf0e,0x3e48bf7b3f0ebf55,0xbe483f7bbf0e3f55,0x3ec4bf6d3f6dbec4,0x3ec4bf6d3f6dbec4,0xbf6dbec4bec4bf6d,0xbf6dbec4bec4bf6d,0xbf55bf0e3e48bf7b,0x3f553f0ebe483f7b,0xbf0e3f55bf7bbe48,0x3f0ebf553f7b3e48
.quad 0xbf353f35bf35bf35,0xbf353f35bf35bf35,0x3f353f35bf353f35,0x3f353f35bf353f35,0x3f0e3f55bf7b3e48,0xbf0ebf553f7bbe48,0x3f55bf0e3e483f7b,0xbf553f0ebe48bf7b,0x3f6dbec4bec43f6d,0x3f6dbec4bec43f6d,0xbec4bf6d3f6d3ec4,0xbec4bf6d3f6d3ec4,0xbe48bf7b3f0e3f55,0x3e483f7bbf0ebf55,0xbf7b3e483f55bf0e,0x3f7bbe48bf553f0e
.quad 0x3f8000003f80,0x3f8000003f80,0x3f8080003f808000,0x3f8080003f808000,0x3f55bf0e3f7bbe48,0xbf553f0ebf7b3e48,0xbf0ebf55be48bf7b,0x3f0e3f553e483f7b,0xbf6dbec4bec4bf6d,0xbf6dbec4bec4bf6d,0xbec43f6dbf6d3ec4,0xbec43f6dbf6d3ec4,0x3e483f7bbf553f0e,0xbe48bf7b3f55bf0e,0x3f7bbe483f0e3f55,0xbf7b3e48bf0ebf55
.quad 0x3f35bf353f353f35,0x3f35bf353f353f35,0xbf35bf353f35bf35,0xbf35bf353f35bf35,0xbf7bbe483f0ebf55,0x3f7b3e48bf0e3f55,0xbe483f7bbf55bf0e,0x3e48bf7b3f553f0e,0x3ec43f6dbf6dbec4,0x3ec43f6dbf6dbec4,0x3f6dbec4bec43f6d,0x3f6dbec4bec43f6d,0x3f0ebf55be483f7b,0xbf0e3f553e48bf7b,0xbf55bf0e3f7b3e48,0x3f553f0ebf7bbe48
.quad 0x3f8000003f80,0x3f8000003f80,0x3f8080003f808000,0x3f8080003f808000,0x3e48bf7b3f0ebf55,0xbe483f7bbf0e3f55,0xbf7bbe48bf55bf0e,0x3f7b3e483f553f0e,0xbec43f6dbf6d3ec4,0xbec43f6dbf6d3ec4,0x3f6d3ec43ec43f6d,0x3f6d3ec43ec43f6d,0x3f0ebf553f7b3e48,0xbf0e3f55bf7bbe48,0xbf55bf0e3e48bf7b,0x3f553f0ebe483f7b
.quad 0xbf353f35bf35bf35,0xbf353f35bf35bf35,0x3f353f35bf353f35,0x3f353f35bf353f35,0x3f55bf0e3e483f7b,0xbf553f0ebe48bf7b,0xbf0ebf553f7bbe48,0x3f0e3f55bf7b3e48,0xbf6d3ec43ec4bf6d,0xbf6d3ec43ec4bf6d,0x3ec43f6dbf6dbec4,0x3ec43f6dbf6dbec4,0x3f7bbe48bf553f0e,0xbf7b3e483f55bf0e,0xbe48bf7b3f0e3f55,0x3e483f7bbf0ebf55
.quad 0xbf80a5543f80248d,0xbf80a5543f80248d,0xa5543f80248dbf80,0xa5543f80248dbf80,0xbf553f0e3f7bbe48,0x3f55bf0ebf7b3e48,0x3f0e3f55be48bf7b,0xbf0ebf553e483f7b,0xbec43f6d3f6dbec4,0xbec43f6d3f6dbec4,0x3f6d3ec4bec4bf6d,0x3f6d3ec4bec4bf6d,0x3e483f7b3f55bf0e,0xbe48bf7bbf553f0e,0x3f7bbe48bf0ebf55,0xbf7b3e483f0e3f55
.quad 0x3f353f353f35bf35,0x3f353f353f35bf35,0x3f35bf35bf35bf35,0x3f35bf35bf35bf35,0x3f7b3e483f0ebf55,0xbf7bbe48bf0e3f55,0x3e48bf7bbf55bf0e,0xbe483f7b3f553f0e,0x3f6dbec43ec4bf6d,0x3f6dbec43ec4bf6d,0xbec4bf6dbf6dbec4,0xbec4bf6dbf6dbec4,0x3f0ebf553e48bf7b,0xbf0e3f55be483f7b,0xbf55bf0ebf7bbe48,0x3f553f0e3f7b3e48
.quad 0xbf80a5543f80248d,0xbf80a5543f80248d,0xa5543f80248dbf80,0xa5543f80248dbf80,0xbe483f7b3f0ebf55,0x3e48bf7bbf0e3f55,0x3f7b3e48bf55bf0e,0xbf7bbe483f553f0e,0x3f6d3ec4bec4bf6d,0x3f6d3ec4bec4bf6d,0x3ec4bf6dbf6d3ec4,0x3ec4bf6dbf6d3ec4,0x3f0ebf55bf7bbe48,0xbf0e3f553f7b3e48,0xbf55bf0ebe483f7b,0x3f553f0e3e48bf7b
.quad 0xbf35bf35bf353f35,0xbf35bf35bf353f35,0xbf353f353f353f35,0xbf353f353f353f35,0xbf553f0e3e483f7b,0x3f55bf0ebe48bf7b,0x3f0e3f553f7bbe48,0xbf0ebf55bf7b3e48,0x3ec43f6d3f6d3ec4,0x3ec43f6d3f6d3ec4,0x3f6dbec43ec4bf6d,0x3f6dbec43ec4bf6d,0x3f7bbe483f55bf0e,0xbf7b3e48bf553f0e,0xbe48bf7bbf0ebf55,0x3e483f7b3f0e3f55
.quad 0xbf80a5543f80248d,0xbf80a5543f80248d,0xa5543f80248dbf80,0xa5543f80248dbf80,0x3f0e3f55be48bf7b,0xbf0ebf553e483f7b,0x3f55bf0ebf7b3e48,0xbf553f0e3f7bbe48,0x3ec4bf6dbf6d3ec4,0x3ec4bf6dbf6d3ec4,0xbf6dbec43ec43f6d,0xbf6dbec43ec43f6d,0xbf7b3e483f0e3f55,0x3f7bbe48bf0ebf55,0x3e483f7b3f55bf0e,0xbe48bf7bbf553f0e
.quad 0x3f353f353f35bf35,0x3f353f353f35bf35,0x3f35bf35bf35bf35,0x3f35bf35bf35bf35,0x3e48bf7bbf55bf0e,0xbe483f7b3f553f0e,0xbf7bbe48bf0e3f55,0x3f7b3e483f0ebf55,0xbf6d3ec4bec43f6d,0xbf6d3ec4bec43f6d,0x3ec43f6d3f6d3ec4,0x3ec43f6d3f6d3ec4,0x3f553f0e3f7b3e48,0xbf55bf0ebf7bbe48,0x3f0ebf553e48bf7b,0xbf0e3f55be483f7b
.quad 0xbf80a5543f80248d,0xbf80a5543f80248d,0xa5543f80248dbf80,0xa5543f80248dbf80,0x3f7b3e48bf55bf0e,0xbf7bbe483f553f0e,0x3e48bf7bbf0e3f55,0xbe483f7b3f0ebf55,0xbf6dbec43ec43f6d,0xbf6dbec43ec43f6d,0xbec43f6d3f6dbec4,0xbec43f6d3f6dbec4,0x3f553f0e3e48bf7b,0xbf55bf0ebe483f7b,0x3f0ebf55bf7bbe48,0xbf0e3f553f7b3e48
.quad 0xbf35bf35bf353f35,0xbf35bf35bf353f35,0xbf353f353f353f35,0xbf353f353f353f35,0x3f0e3f553f7bbe48,0xbf0ebf55bf7b3e48,0x3f55bf0ebe48bf7b,0xbf553f0e3e483f7b,0xbec4bf6dbf6dbec4,0xbec4bf6dbf6dbec4,0xbf6d3ec4bec43f6d,0xbf6d3ec4bec43f6d,0x3e483f7b3f0e3f55,0xbe48bf7bbf0ebf55,0x3f7bbe483f55bf0e,0xbf7b3e48bf553f0e
.quad 0x3f8000003f80,0x3f8000003f80,0x3f8080003f808000,0x3f8080003f808000,0x3f223f463e953f75,0xbf22bf46be95bf75,0x3f46bf223f75be95,0xbf463f22bf753e95,0x3f7b3e483f0e3f55,0x3f7b3e483f0e3f55,0x3e48bf7b3f55bf0e,0x3e48bf7b3f55bf0e,0x3f62bef13f463f22,0xbf623ef1bf46bf22,0xbef1bf623f22bf46,0x3ef13f62bf223f46
.quad 0x3ec4bf6d3f6d3ec4,0x3ec4bf6d3f6d3ec4,0xbf6dbec43ec4bf6d,0xbf6dbec43ec4bf6d,0xbe95bf753f7f3dc9,0x3e953f75bf7fbdc9,0xbf753e953dc9bf7f,0x3f75be95bdc93f7f,0xbf55bf0e3f7bbe48,0xbf55bf0e3f7bbe48,0xbf0e3f55be48bf7b,0xbf0e3f55be48bf7b,0xbf7f3dc93f62bef1,0x3f7fbdc9bf623ef1,0x3dc93f7fbef1bf62,0xbdc9bf7f3ef13f62
.quad 0x3f8000003f80,0x3f8000003f80,0x3f8080003f808000,0x3f8080003f808000,0x3f7f3dc93f623ef1,0xbf7fbdc9bf62bef1,0x3dc9bf7f3ef1bf62,0xbdc93f7fbef13f62,0x3e48bf7b3f55bf0e,0x3e48bf7b3f55bf0e,0xbf7bbe48bf0ebf55,0xbf7bbe48bf0ebf55,0xbf75be95bdc9bf7f,0x3f753e953dc93f7f,0xbe953f75bf7f3dc9,0x3e95bf753f7fbdc9
.quad 0xbec43f6dbf6dbec4,0xbec43f6dbf6dbec4,0x3f6d3ec4bec43f6d,0x3f6d3ec4bec43f6d,0x3f623ef1bf463f22,0xbf62bef13f46bf22,0x3ef1bf623f223f46,0xbef13f62bf22bf46,0x3f0ebf553e483f7b,0x3f0ebf553e483f7b,0xbf55bf0e3f7bbe48,0xbf55bf0e3f7bbe48,0xbf46bf223f753e95,0x3f463f22bf75be95,0xbf223f463e95bf75,0x3f22bf46be953f75
.quad 0x3f8000003f80,0x3f8000003f80,0x3f8080003f808000,0x3f8080003f808000,0x3f46bf223f75be95,0xbf463f22bf753e95,0xbf22bf46be95bf75,0x3f223f463e953f75,0xbf7bbe48bf0ebf55,0xbf7bbe48bf0ebf55,0xbe483f7bbf553f0e,0xbe483f7bbf553f0e,0x3ef13f62bf223f46,0xbef1bf623f22bf46,0x3f62bef13f463f22,0xbf623ef1bf46bf22
.quad 0x3ec4bf6d3f6d3ec4,0x3ec4bf6d3f6d3ec4,0xbf6dbec43ec4bf6d,0xbf6dbec43ec4bf6d,0xbf753e953dc9bf7f,0x3f75be95bdc93f7f,0x3e953f75bf7fbdc9,0xbe95bf753f7f3dc9,0x3f553f0ebf7b3e48,0x3f553f0ebf7b3e48,0x3f0ebf553e483f7b,0x3f0ebf553e483f7b,0xbdc9bf7f3ef13f62,0x3dc93f7fbef1bf62,0xbf7f3dc93f62bef1,0x3f7fbdc9bf623ef1
.quad 0x3f8000003f80,0x3f8000003f80,0x3f8080003f808000,0x3f8080003f808000,0x3dc9bf7f3ef1bf62,0xbdc93f7fbef13f62,0xbf7fbdc9bf62bef1,0x3f7f3dc93f623ef1,0xbe483f7bbf553f0e,0xbe483f7bbf553f0e,0x3f7b3e483f0e3f55,0x3f7b3e483f0e3f55,0x3e95bf753f7fbdc9,0xbe953f75bf7f3dc9,0xbf75be95bdc9bf7f,0x3f753e953dc93f7f
.quad 0xbec43f6dbf6dbec4,0xbec43f6dbf6dbec4,0x3f6d3ec4bec43f6d,0x3f6d3ec4bec43f6d,0x3ef1bf623f223f46,0xbef13f62bf22bf46,0xbf62bef13f46bf22,0x3f623ef1bf463f22,0xbf0e3f55be48bf7b,0xbf0e3f55be48bf7b,0x3f553f0ebf7b3e48,0x3f553f0ebf7b3e48,0x3f22bf46be953f75,0xbf223f463e95bf75,0xbf46bf223f753e95,0x3f463f22bf75be95
.quad 0xbf353f353f35bf35,0xbf353f353f35bf35,0x3f353f35bf35bf35,0x3f353f35bf35bf35,0xbdc93f7f3ef1bf62,0x3dc9bf7fbef13f62,0x3f7f3dc9bf62bef1,0xbf7fbdc93f623ef1,0x3f0e3f553e48bf7b,0x3f0e3f553e48bf7b,0x3f55bf0ebf7bbe48,0x3f55bf0ebf7bbe48,0x3f753e95bdc9bf7f,0xbf75be953dc93f7f,0x3e95bf75bf7f3dc9,0xbe953f753f7fbdc9
.quad 0x3f6dbec4bec4bf6d,0x3f6dbec4bec4bf6d,0xbec4bf6dbf6d3ec4,0xbec4bf6dbf6d3ec4,0x3ef1bf62bf22bf46,0xbef13f623f223f46,0xbf62bef1bf463f22,0x3f623ef13f46bf22,0xbe48bf7bbf55bf0e,0xbe48bf7bbf55bf0e,0xbf7b3e48bf0e3f55,0xbf7b3e48bf0e3f55,0xbf46bf22bf75be95,0x3f463f223f753e95,0xbf223f46be953f75,0x3f22bf463e95bf75
.quad 0xbf353f353f35bf35,0xbf353f353f35bf35,0x3f353f35bf35bf35,0x3f353f35bf35bf35,0x3f223f46be95bf75,0xbf22bf463e953f75,0x3f46bf22bf753e95,0xbf463f223f75be95,0x3f55bf0ebf7bbe48,0x3f55bf0ebf7bbe48,0xbf0ebf55be483f7b,0xbf0ebf55be483f7b,0xbef1bf62bf223f46,0x3ef13f623f22bf46,0xbf623ef13f463f22,0x3f62bef1bf46bf22
.quad 0xbf6d3ec43ec43f6d,0xbf6d3ec43ec43f6d,0x3ec43f6d3f6dbec4,0x3ec43f6d3f6dbec4,0x3e953f753f7f3dc9,0xbe95bf75bf7fbdc9,0x3f75be953dc9bf7f,0xbf753e95bdc93f7f,0x3f7bbe483f0ebf55,0x3f7bbe483f0ebf55,0xbe48bf7bbf55bf0e,0xbe48bf7bbf55bf0e,0xbdc9bf7fbef1bf62,0x3dc93f7f3ef13f62,0xbf7f3dc9bf623ef1,0x3f7fbdc93f62bef1
.quad 0xbf353f353f35bf35,0xbf353f353f35bf35,0x3f353f35bf35bf35,0x3f353f35bf35bf35,0x3f7f3dc9bf62bef1,0xbf7fbdc93f623ef1,0x3dc9bf7fbef13f62,0xbdc93f7f3ef1bf62,0xbf0ebf55be483f7b,0xbf0ebf55be483f7b,0xbf553f0e3f7b3e48,0xbf553f0e3f7b3e48,0xbe953f753f7fbdc9,0x3e95bf75bf7f3dc9,0x3f753e95bdc9bf7f,0xbf75be953dc93f7f
.quad 0x3f6dbec4bec4bf6d,0x3f6dbec4bec4bf6d,0xbec4bf6dbf6d3ec4,0xbec4bf6dbf6d3ec4,0xbf62bef1bf463f22,0x3f623ef13f46bf22,0xbef13f623f223f46,0x3ef1bf62bf22bf46,0x3e483f7b3f553f0e,0x3e483f7b3f553f0e,0x3f7bbe483f0ebf55,0x3f7bbe483f0ebf55,0x3f22bf463e95bf75,0xbf223f46be953f75,0xbf46bf22bf75be95,0x3f463f223f753e95
.quad 0xbf353f353f35bf35,0xbf353f353f35bf35,0x3f353f35bf35bf35,0x3f353f35bf35bf35,0x3f46bf22bf753e95,0xbf463f223f75be95,0xbf22bf463e953f75,0x3f223f46be95bf75,0xbf553f0e3f7b3e48,0xbf553f0e3f7b3e48,0x3f0e3f553e48bf7b,0x3f0e3f553e48bf7b,0x3f62bef1bf46bf22,0xbf623ef13f463f22,0xbef1bf62bf223f46,0x3ef13f623f22bf46
.quad 0xbf6d3ec43ec43f6d,0xbf6d3ec43ec43f6d,0x3ec43f6d3f6dbec4,0x3ec43f6d3f6dbec4,0x3f75be953dc9bf7f,0xbf753e95bdc93f7f,0xbe95bf75bf7fbdc9,0x3e953f753f7f3dc9,0xbf7b3e48bf0e3f55,0xbf7b3e48bf0e3f55,0x3e483f7b3f553f0e,0x3e483f7b3f553f0e,0x3f7fbdc93f62bef1,0xbf7f3dc9bf623ef1,0xbdc9bf7fbef1bf62,0x3dc93f7f3ef13f62
.quad 0x80003f8080003f80,0x80003f8080003f80,0xbec43f6d80003f80,0x3ec4bf6da50dbf80,0xbf353f3580003f80,0xbf353f3580003f80,0xbf6d3ec480003f80,0x3f6dbec4a50dbf80,0xbf80248d80003f80,0xbf80248d80003f80,0xbf6dbec480003f80,0x3f6d3ec4a50dbf80,0xbf35bf3580003f80,0xbf35bf3580003f80,0xbec4bf6d80003f80,0x3ec43f6da50dbf80
.quad 0xa50dbf8080003f80,0xa50dbf8080003f80,0x3ec4bf6d80003f80,0xbec43f6da50dbf80,0x3f35bf3580003f80,0x3f35bf3580003f80,0x3f6dbec480003f80,0xbf6d3ec4a50dbf80,0x3f80a55480003f80,0x3f80a55480003f80,0x3f6d3ec480003f80,0xbf6dbec4a50dbf80,0x3f353f3580003f80,0x3f353f3580003f80,0x3ec43f6d80003f80,0xbec4bf6da50dbf80
.quad 0x80003f8080003f80,0x80003f8080003f80,0xbf6d3ec4bf353f35,0x3f6dbec43f35bf35,0xbf35bf35bf80248d,0xbf35bf35bf80248d,0x3ec4bf6dbf35bf35,0xbec43f6d3f353f35,0x3f80a554a50dbf80,0x3f80a554a50dbf80,0x3ec43f6d3f35bf35,0xbec4bf6dbf353f35,0xbf353f353f80a554,0xbf353f353f80a554,0xbf6dbec43f353f35,0x3f6d3ec4bf35bf35
.quad 0xa50dbf8080003f80,0xa50dbf8080003f80,0x3f6dbec4bf353f35,0xbf6d3ec43f35bf35,0x3f353f35bf80248d,0x3f353f35bf80248d,0xbec43f6dbf35bf35,0x3ec4bf6d3f353f35,0xbf80248da50dbf80,0xbf80248da50dbf80,0xbec4bf6d3f35bf35,0x3ec43f6dbf353f35,0x3f35bf353f80a554,0x3f35bf353f80a554,0x3f6d3ec43f353f35,0xbf6dbec4bf35bf35
.quad 0x80003f8080003f80,0x80003f8080003f80,0xbf6dbec4bf80248d,0x3f6d3ec43f80a554,0x3f35bf35a50dbf80,0x3f35bf35a50dbf80,0x3ec43f6d3f80a554,0xbec4bf6dbf80248d,0xbf80248d80003f80,0xbf80248d80003f80,0x3ec4bf6dbf80248d,0xbec43f6d3f80a554,0x3f353f35a50dbf80,0x3f353f35a50dbf80,0xbf6d3ec43f80a554,0x3f6dbec4bf80248d
.quad 0xa50dbf8080003f80,0xa50dbf8080003f80,0x3f6d3ec4bf80248d,0xbf6dbec43f80a554,0xbf353f35a50dbf80,0xbf353f35a50dbf80,0xbec4bf6d3f80a554,0x3ec43f6dbf80248d,0x3f80a55480003f80,0x3f80a55480003f80,0xbec43f6dbf80248d,0x3ec4bf6d3f80a554,0xbf35bf35a50dbf80,0xbf35bf35a50dbf80,0x3f6dbec43f80a554,0xbf6d3ec4bf80248d
.quad 0x80003f8080003f80,0x80003f8080003f80,0xbec4bf6dbf35bf35,0x3ec43f6d3f353f35,0x3f353f353f80a554,0x3f353f353f80a554,0xbf6dbec4bf353f35,0x3f6d3ec43f35bf35,0x3f80a554a50dbf80,0x3f80a554a50dbf80,0xbf6d3ec43f353f35,0x3f6dbec4bf35bf35,0x3f35bf35bf80248d,0x3f35bf35bf80248d,0xbec43f6d3f35bf35,0x3ec4bf6dbf353f35
.quad 0xa50dbf8080003f80,0xa50dbf8080003f80,0x3ec43f6dbf35bf35,0xbec4bf6d3f353f35,0xbf35bf353f80a554,0xbf35bf353f80a554,0x3f6d3ec4bf353f35,0xbf6dbec43f35bf35,0xbf80248da50dbf80,0xbf80248da50dbf80,0x3f6dbec43f353f35,0xbf6d3ec4bf35bf35,0xbf353f35bf80248d,0xbf353f35bf80248d,0x3ec4bf6d3f35bf35,0xbec43f6dbf353f35
.quad 0xbdc93f7f80003f80,0xbf463f22bf353f35,0xbef13f6280003f80,0x3f75be953f35bf35,0xbf463f2280003f80,0xbf7fbdc9bf353f35,0xbf753e9580003f80,0x3f623ef13f35bf35,0xbf7fbdc980003f80,0xbf22bf46bf353f35,0xbf62bef180003f80,0x3e953f753f35bf35,0xbf22bf4680003f80,0x3dc9bf7fbf353f35,0xbe95bf7580003f80,0xbef13f623f35bf35
.quad 0x3dc9bf7f80003f80,0x3f46bf22bf353f35,0x3ef1bf6280003f80,0xbf753e953f35bf35,0x3f46bf2280003f80,0x3f7f3dc9bf353f35,0x3f75be9580003f80,0xbf62bef13f35bf35,0x3f7f3dc980003f80,0x3f223f46bf353f35,0x3f623ef180003f80,0xbe95bf753f35bf35,0x3f223f4680003f80,0xbdc93f7fbf353f35,0x3e953f7580003f80,0x3ef1bf623f35bf35
.quad 0xbe953f75be483f7b,0xbf623ef1bf553f0e,0xbf7f3dc9bf553f0e,0x3f463f223f7b3e48,0xbef1bf62bf7bbe48,0x3e95bf75bf0ebf55,0x3f22bf46bf0ebf55,0xbf7f3dc9be483f7b,0x3f753e953e48bf7b,0x3ef13f623f55bf0e,0x3dc93f7f3f55bf0e,0x3f22bf46bf7bbe48,0xbf623ef13f7b3e48,0xbf75be953f0e3f55,0xbf46bf223f0e3f55,0x3dc93f7f3e48bf7b
.quad 0x3e95bf75be483f7b,0x3f62bef1bf553f0e,0x3f7fbdc9bf553f0e,0xbf46bf223f7b3e48,0x3ef13f62bf7bbe48,0xbe953f75bf0ebf55,0xbf223f46bf0ebf55,0x3f7fbdc9be483f7b,0xbf75be953e48bf7b,0xbef1bf623f55bf0e,0xbdc9bf7f3f55bf0e,0xbf223f46bf7bbe48,0x3f62bef13f7b3e48,0x3f753e953f0e3f55,0x3f463f223f0e3f55,0xbdc9bf7f3e48bf7b
.quad 0xbef13f62bec43f6d,0xbf753e95bf6d3ec4,0xbf22bf46bf6dbec4,0xbdc93f7f3ec43f6d,0x3f75be953ec4bf6d,0x3f623ef13f6dbec4,0xbdc93f7f3f6d3ec4,0x3f46bf22bec4bf6d,0xbf62bef1bec43f6d,0xbe95bf75bf6d3ec4,0x3f46bf22bf6dbec4,0xbf7fbdc93ec43f6d,0x3e953f753ec4bf6d,0xbef13f623f6dbec4,0xbf7fbdc93f6d3ec4,0x3f223f46bec4bf6d
.quad 0x3ef1bf62bec43f6d,0x3f75be95bf6d3ec4,0x3f223f46bf6dbec4,0x3dc9bf7f3ec43f6d,0xbf753e953ec4bf6d,0xbf62bef13f6dbec4,0x3dc9bf7f3f6d3ec4,0xbf463f22bec4bf6d,0x3f623ef1bec43f6d,0x3e953f75bf6d3ec4,0xbf463f22bf6dbec4,0x3f7f3dc93ec43f6d,0xbe95bf753ec4bf6d,0x3ef1bf623f6dbec4,0x3f7f3dc93f6d3ec4,0xbf22bf46bec4bf6d
.quad 0xbf223f46bf0e3f55,0xbf7f3dc9bf7b3e48,0x3e95bf75be48bf7b,0xbf623ef1bf0e3f55,0x3dc93f7f3f553f0e,0xbf223f463e483f7b,0xbef1bf62bf7b3e48,0xbe953f753f553f0e,0x3f463f223f0ebf55,0x3dc93f7f3f7bbe48,0xbf75be953e483f7b,0x3ef13f623f0ebf55,0x3f7fbdc9bf55bf0e,0x3f463f22be48bf7b,0xbf623ef13f7bbe48,0x3f753e95bf55bf0e
.quad 0x3f22bf46bf0e3f55,0x3f7fbdc9bf7b3e48,0xbe953f75be48bf7b,0x3f62bef1bf0e3f55,0xbdc9bf7f3f553f0e,0x3f22bf463e483f7b,0x3ef13f62bf7b3e48,0x3e95bf753f553f0e,0xbf46bf223f0ebf55,0xbdc9bf7f3f7bbe48,0x3f753e953e483f7b,0xbef1bf623f0ebf55,0xbf7f3dc9bf55bf0e,0xbf46bf22be48bf7b,0x3f62bef13f7bbe48,0xbf75be95bf55bf0e
.quad 0xbe483f7b80003f80,0xbf7bbe48bf80248d,0xbf0e3f5580003f80,0x3f553f0e3f80a554,0xbf553f0e80003f80,0xbf0ebf55bf80248d,0xbf7b3e4880003f80,0x3e483f7b3f80a554,0xbf7bbe4880003f80,0x3e48bf7bbf80248d,0xbf55bf0e80003f80,0xbf0e3f553f80a554,0xbf0ebf5580003f80,0x3f55bf0ebf80248d,0xbe48bf7b80003f80,0xbf7b3e483f80a554
.quad 0x3e48bf7b80003f80,0x3f7b3e48bf80248d,0x3f0ebf5580003f80,0xbf55bf0e3f80a554,0x3f55bf0e80003f80,0x3f0e3f55bf80248d,0x3f7bbe4880003f80,0xbe48bf7b3f80a554,0x3f7b3e4880003f80,0xbe483f7bbf80248d,0x3f553f0e80003f80,0x3f0ebf553f80a554,0x3f0e3f5580003f80,0xbf553f0ebf80248d,0x3e483f7b80003f80,0x3f7bbe483f80a554
.quad 0xbf0e3f55bec43f6d,0xbf55bf0ebf6dbec4,0xbf7bbe48bf6d3ec4,0xbe483f7b3ec43f6d,0xbe48bf7bbf6dbec4,0x3f7bbe483ec4bf6d,0x3f55bf0ebec4bf6d,0xbf0ebf55bf6d3ec4,0x3f553f0e3ec4bf6d,0xbf0e3f553f6d3ec4,0xbe483f7b3f6dbec4,0x3f7b3e48bec4bf6d,0xbf7b3e483f6d3ec4,0xbe48bf7bbec43f6d,0xbf0ebf553ec43f6d,0xbf553f0e3f6dbec4
.quad 0x3f0ebf55bec43f6d,0x3f553f0ebf6dbec4,0x3f7b3e48bf6d3ec4,0x3e48bf7b3ec43f6d,0x3e483f7bbf6dbec4,0xbf7b3e483ec4bf6d,0xbf553f0ebec4bf6d,0x3f0e3f55bf6d3ec4,0xbf55bf0e3ec4bf6d,0x3f0ebf553f6d3ec4,0x3e48bf7b3f6dbec4,0xbf7bbe48bec4bf6d,0x3f7bbe483f6d3ec4,0x3e483f7bbec43f6d,0x3f0e3f553ec43f6d,0x3f55bf0e3f6dbec4
.quad 0xbf553f0ebf353f35,0xbf0ebf55bf35bf35,0xbe48bf7bbf35bf35,0xbf7b3e48bf353f35,0x3f7b3e483f35bf35,0xbe483f7b3f353f35,0xbf0e3f553f353f35,0x3f553f0e3f35bf35,0xbf0ebf55bf353f35,0x3f55bf0ebf35bf35,0x3f7bbe48bf35bf35,0xbe48bf7bbf353f35,0xbe483f7b3f35bf35,0xbf7bbe483f353f35,0xbf55bf0e3f353f35,0xbf0e3f553f35bf35
.quad 0x3f55bf0ebf353f35,0x3f0e3f55bf35bf35,0x3e483f7bbf35bf35,0x3f7bbe48bf353f35,0xbf7bbe483f35bf35,0x3e48bf7b3f353f35,0x3f0ebf553f353f35,0xbf55bf0e3f35bf35,0x3f0e3f55bf353f35,0xbf553f0ebf35bf35,0xbf7b3e48bf35bf35,0x3e483f7bbf353f35,0x3e48bf7b3f35bf35,0x3f7b3e483f353f35,0x3f553f0e3f353f35,0x3f0ebf553f35bf35
.quad 0xbf7b3e48bf6d3ec4,0xbe48bf7bbec4bf6d,0x3f55bf0e3ec4bf6d,0xbf0ebf55bf6dbec4,0xbf0e3f553ec43f6d,0xbf55bf0ebf6d3ec4,0x3e48bf7bbf6dbec4,0xbf7bbe48bec43f6d,0x3e483f7b3f6dbec4,0xbf7b3e483ec43f6d,0xbf0ebf55bec43f6d,0xbf553f0e3f6d3ec4,0x3f553f0ebec4bf6d,0xbf0e3f553f6dbec4,0xbf7bbe483f6d3ec4,0xbe483f7b3ec4bf6d
.quad 0x3f7bbe48bf6d3ec4,0x3e483f7bbec4bf6d,0xbf553f0e3ec4bf6d,0x3f0e3f55bf6dbec4,0x3f0ebf553ec43f6d,0x3f553f0ebf6d3ec4,0xbe483f7bbf6dbec4,0x3f7b3e48bec43f6d,0xbe48bf7b3f6dbec4,0x3f7bbe483ec43f6d,0x3f0e3f55bec43f6d,0x3f55bf0e3f6d3ec4,0xbf55bf0ebec4bf6d,0x3f0ebf553f6dbec4,0x3f7b3e483f6d3ec4,0x3e48bf7b3ec4bf6d
.quad 0xbe953f7580003f80,0xbef1bf62bf35bf35,0xbf223f4680003f80,0x3dc93f7f3f353f35,0xbf623ef180003f80,0x3e95bf75bf35bf35,0xbf7f3dc980003f80,0xbf223f463f353f35,0xbf75be9580003f80,0x3f62bef1bf35bf35,0xbf46bf2280003f80,0xbf7f3dc93f353f35,0xbef1bf6280003f80,0x3f753e95bf35bf35,0xbdc9bf7f80003f80,0xbf46bf223f353f35
.quad 0x3e95bf7580003f80,0x3ef13f62bf35bf35,0x3f22bf4680003f80,0xbdc9bf7f3f353f35,0x3f62bef180003f80,0xbe953f75bf35bf35,0x3f7fbdc980003f80,0x3f22bf463f353f35,0x3f753e9580003f80,0xbf623ef1bf35bf35,0x3f463f2280003f80,0x3f7fbdc93f353f35,0x3ef13f6280003f80,0xbf75be95bf35bf35,0x3dc93f7f80003f80,0x3f463f223f353f35
.quad 0xbf463f22bf0e3f55,0x3dc9bf7fbe48bf7b,0xbf62bef1bf7b3e48,0xbf753e95bf0e3f55,0x3dc9bf7fbf55bf0e,0x3f223f463f7bbe48,0x3f75be95be48bf7b,0x3ef1bf62bf55bf0e,0x3f223f463f0ebf55,0xbf7fbdc93e483f7b,0xbef13f623f7bbe48,0x3e953f753f0ebf55,0xbf7fbdc93f553f0e,0x3f46bf22bf7b3e48,0xbe95bf753e483f7b,0xbf62bef13f553f0e
.quad 0x3f46bf22bf0e3f55,0xbdc93f7fbe48bf7b,0x3f623ef1bf7b3e48,0x3f75be95bf0e3f55,0xbdc93f7fbf55bf0e,0xbf22bf463f7bbe48,0xbf753e95be48bf7b,0xbef13f62bf55bf0e,0xbf22bf463f0ebf55,0x3f7f3dc93e483f7b,0x3ef1bf623f7bbe48,0xbe95bf753f0ebf55,0x3f7f3dc93f553f0e,0xbf463f22bf7b3e48,0x3e953f753e483f7b,0x3f623ef13f553f0e
.quad 0xbf7f3dc9bf6d3ec4,0x3f22bf463ec4bf6d,0x3e95bf75bec4bf6d,0xbef1bf62bf6dbec4,0x3f463f223f6dbec4,0xbf7f3dc9bec43f6d,0xbf623ef13ec43f6d,0xbe953f753f6d3ec4,0xbdc9bf7fbf6d3ec4,0x3f463f223ec4bf6d,0x3f753e95bec4bf6d,0x3f62bef1bf6dbec4,0xbf223f463f6dbec4,0xbdc9bf7fbec43f6d,0xbef1bf623ec43f6d,0xbf75be953f6d3ec4
.quad 0x3f7fbdc9bf6d3ec4,0xbf223f463ec4bf6d,0xbe953f75bec4bf6d,0x3ef13f62bf6dbec4,0xbf46bf223f6dbec4,0x3f7fbdc9bec43f6d,0x3f62bef13ec43f6d,0x3e95bf753f6d3ec4,0x3dc93f7fbf6d3ec4,0xbf46bf223ec4bf6d,0xbf75be95bec4bf6d,0xbf623ef1bf6dbec4,0x3f22bf463f6dbec4,0x3dc93f7fbec43f6d,0x3ef13f623ec43f6d,0x3f753e953f6d3ec4
.quad 0xbf62bef1bf7bbe48,0x3f75be953f55bf0e,0x3f7f3dc93f55bf0e,0x3f46bf223e48bf7b,0xbf753e95be483f7b,0x3ef1bf62bf0ebf55,0x3f46bf22bf0ebf55,0x3dc9bf7fbf7bbe48,0xbef13f623f7b3e48,0xbe95bf75bf553f0e,0x3dc9bf7fbf553f0e,0xbf22bf46be483f7b,0x3e953f753e48bf7b,0xbf62bef13f0e3f55,0xbf22bf463f0e3f55,0xbf7fbdc93f7b3e48
.quad 0x3f623ef1bf7bbe48,0xbf753e953f55bf0e,0xbf7fbdc93f55bf0e,0xbf463f223e48bf7b,0x3f75be95be483f7b,0xbef13f62bf0ebf55,0xbf463f22bf0ebf55,0xbdc93f7fbf7bbe48,0x3ef1bf623f7b3e48,0x3e953f75bf553f0e,0xbdc93f7fbf553f0e,0x3f223f46be483f7b,0xbe95bf753e48bf7b,0x3f623ef13f0e3f55,0x3f223f463f0e3f55,0x3f7f3dc93f7b3e48
.quad 0x3f803f803f803f80,0x3f803f803f803f80,0x0,0x0,0xbd21248d3f803f80,0xbe48be203f7b3f7d,0x3f803f803d210000,0x3f7b3f7d3e483e20,0xbf7fbf803f7f3f80,0xbf6dbf733f6d3f73,0xbda1250d3da10000,0xbec4be9e3ec43e9e,0x3df1a5543f7e3f80,0x3f0e3ee83f553f64,0xbf7ebf803df10000,0xbf55bf643f0e3ee8
.quad 0x3f7d3f803f7d3f80,0x3f353f4f3f353f4f,0x3e2000003e200000,0x3f353f163f353f16,0xbe48248d3f7b3f80,0xbf55bf353f0e3f35,0x3f7b3f803e480000,0x3f0e3f353f553f35,0xbf79bf803f793f80,0xbec4bf163ec43f16,0xbe6f250d3e6f0000,0xbf6dbf4f3f6d3f4f,0x3e8ba5543f763f80,0x3f7b3f643e483ee8,0xbf76bf803e8b0000,0xbe48bee83f7b3f64
.quad 0x3f803f803f803f80,0x3f803f803f803f80,0x0,0x0,0x3d21a554bf80bf80,0x3e483e20bf7bbf7d,0xbf80bf80bd21250d,0xbf7bbf7dbe48be20,0xbf7fbf803f7f3f80,0xbf6dbf733f6d3f73,0xbda1250d3da10000,0xbec4be9e3ec43e9e,0xbdf1248dbf7ebf80,0xbf0ebee8bf55bf64,0x3f7e3f80bdf1250d,0x3f553f64bf0ebee8
.quad 0x3f7d3f803f7d3f80,0x3f353f4f3f353f4f,0x3e2000003e200000,0x3f353f163f353f16,0x3e48a554bf7bbf80,0x3f553f35bf0ebf35,0xbf7bbf80be48250d,0xbf0ebf35bf55bf35,0xbf79bf803f793f80,0xbec4bf163ec43f16,0xbe6f250d3e6f0000,0xbf6dbf4f3f6d3f4f,0xbe8b248dbf76bf80,0xbf7bbf64be48bee8,0x3f763f80be8b250d,0x3e483ee8bf7bbf64
.quad 0x3f803f803f803f80,0x3f803f803f803f80,0x0,0x0,0xbdf1bda13f7e3f7f,0xbe8bbe6f3f763f79,0x3f7e3f7f3df13da1,0x3f763f793e8b3e6f,0xbf79bf7d3f793f7d,0xbf5abf643f5a3f64,0xbe6fbe203e6f3e20,0xbf06bee83f063ee8,0x3eb13e6f3f703f79,0x3f3c3f263f2e3f43,0xbf70bf793eb13e6f,0xbf2ebf433f3c3f26
.quad 0x3f643f733f643f73,0x3ee83f163ee83f16,0x3ee83e9e3ee83e9e,0x3f643f4f3f643f4f,0xbf0ebec43f553f6d,0xbf7bbf6d3e483ec4,0x3f553f6d3f0e3ec4,0x3e483ec43f7b3f6d,0xbf43bf643f433f64,0x3da1be20bda13e20,0xbf26bee83f263ee8,0xbf7fbf7d3f7f3f7d,0x3f3c3f063f2e3f5a,0x3f703f7fbeb1bda1,0xbf2ebf5a3f3c3f06,0x3eb13da13f703f7f
.quad 0x3f803f803f803f80,0x3f803f803f803f80,0x0,0x0,0x3df13da1bf7ebf7f,0x3e8b3e6fbf76bf79,0xbf7ebf7fbdf1bda1,0xbf76bf79be8bbe6f,0xbf79bf7d3f793f7d,0xbf5abf643f5a3f64,0xbe6fbe203e6f3e20,0xbf06bee83f063ee8,0xbeb1be6fbf70bf79,0xbf3cbf26bf2ebf43,0x3f703f79beb1be6f,0x3f2e3f43bf3cbf26
.quad 0x3f643f733f643f73,0x3ee83f163ee83f16,0x3ee83e9e3ee83e9e,0x3f643f4f3f643f4f,0x3f0e3ec4bf55bf6d,0x3f7b3f6dbe48bec4,0xbf55bf6dbf0ebec4,0xbe48bec4bf7bbf6d,0xbf43bf643f433f64,0x3da1be20bda13e20,0xbf26bee83f263ee8,0xbf7fbf7d3f7f3f7d,0xbf3cbf06bf2ebf5a,0xbf70bf7f3eb13da1,0x3f2e3f5abf3cbf06,0xbeb1bda1bf70bf7f
.quad 0x3f803f803f803f80,0x3f803f803f803f80,0x0,0x0,0xbeb1be9e3f703f73,0xbefabee83f5f3f64,0x3f703f733eb13e9e,0x3f5f3f643efa3ee8,0xbf43bf4f3f433f4f,0xbf06bf163f063f16,0xbf26bf163f263f16,0xbf5abf4f3f5a3f4f,0x3f5f3f4f3efa3f16,0x3f803f7d3d213e20,0xbefabf163f5f3f4f,0xbd21be203f803f7d
.quad 0x3e203e9e3e203e9e,0xbee8be9ebee8be9e,0x3f7d3f733f7d3f73,0x3f643f733f643f73,0xbf7bbf80be48248d,0xbf0ebf35bf55bf35,0xbe48250d3f7b3f80,0xbf55bf353f0e3f35,0x3f063e9ebf06be9e,0x3f7f3f73bf7fbf73,0xbf5abf733f5a3f73,0xbda1be9e3da13e9e,0x3f1e3f4fbf49bf16,0xbed6be20bf68bf7d,0x3f493f163f1e3f4f,0x3f683f7dbed6be20
.quad 0x3f803f803f803f80,0x3f803f803f803f80,0x0,0x0,0x3eb13e9ebf70bf73,0x3efa3ee8bf5fbf64,0xbf70bf73beb1be9e,0xbf5fbf64befabee8,0xbf43bf4f3f433f4f,0xbf06bf163f063f16,0xbf26bf163f263f16,0xbf5abf4f3f5a3f4f,0xbf5fbf4fbefabf16,0xbf80bf7dbd21be20,0x3efa3f16bf5fbf4f,0x3d213e20bf80bf7d
.quad 0x3e203e9e3e203e9e,0xbee8be9ebee8be9e,0x3f7d3f733f7d3f73,0x3f643f733f643f73,0x3f7b3f803e48a554,0x3f0e3f353f553f35,0x3e480000bf7bbf80,0x3f553f35bf0ebf35,0x3f063e9ebf06be9e,0x3f7f3f73bf7fbf73,0xbf5abf733f5a3f73,0xbda1be9e3da13e9e,0xbf1ebf4f3f493f16,0x3ed63e203f683f7d,0xbf49bf16bf1ebf4f,0xbf68bf7d3ed63e20
.quad 0x3f803f803f803f80,0x3f803f803f803f80,0x0,0x0,0xbed6bec43f683f6d,0xbf0ebf063f553f5a,0x3f683f6d3ed63ec4,0x3f553f5a3f0e3f06,0xbf26bf353f263f35,0xbec4bee83ec43ee8,0xbf43bf353f433f35,0xbf6dbf643f6d3f64,0x3f763f6d3e8b3ec4,0x3f7b3f7fbe48bda1,0xbe8bbec43f763f6d,0x3e483da13f7b3f7f
.quad 0xbe20248dbe20248d,0xbf35bf16bf35bf16,0x3f7d3f803f7d3f80,0x3f353f4f3f353f4f,0xbf55bf6dbf0ebec4,0xbe48bec4bf7bbf6d,0xbf0ebec43f553f6d,0xbf7bbf6d3e483ec4,0x3f5a3f35bf5abf35,0x3f6d3f7dbf6dbf7d,0xbf06bf353f063f35,0x3ec43e20bec4be20,0x3df13ec4bf7ebf6d,0xbf55bf26bf0ebf43,0x3f7e3f6d3df13ec4,0x3f0e3f43bf55bf26
.quad 0x3f803f803f803f80,0x3f803f803f803f80,0x0,0x0,0x3ed63ec4bf68bf6d,0x3f0e3f06bf55bf5a,0xbf68bf6dbed6bec4,0xbf55bf5abf0ebf06,0xbf26bf353f263f35,0xbec4bee83ec43ee8,0xbf43bf353f433f35,0xbf6dbf643f6d3f64,0xbf76bf6dbe8bbec4,0xbf7bbf7f3e483da1,0x3e8b3ec4bf76bf6d,0xbe48bda1bf7bbf7f
.quad 0xbe20248dbe20248d,0xbf35bf16bf35bf16,0x3f7d3f803f7d3f80,0x3f353f4f3f353f4f,0x3f553f6d3f0e3ec4,0x3e483ec43f7b3f6d,0x3f0e3ec4bf55bf6d,0x3f7b3f6dbe48bec4,0x3f5a3f35bf5abf35,0x3f6d3f7dbf6dbf7d,0xbf06bf353f063f35,0x3ec43e20bec4be20,0xbdf1bec43f7e3f6d,0x3f553f263f0e3f43,0xbf7ebf6dbdf1bec4,0xbf0ebf433f553f26
.quad 0x3f803f803f803f80,0x3f8000003f80,0x0,0x0,0xbf1ebf163f493f4f,0xbf3500003f35,0x3f493f4f3f1e3f16,0x3f3500003f35,0xbe6fbe9e3e6f3e9e,0xa5540000248d,0xbf79bf733f793f73,0xbf8000003f80,0x3f683f73bed6be9e,0x3f350000bf35,0x3ed63e9e3f683f73,0x3f3500003f35
.quad 0xbf64bf4fbf64bf4f,0xbf800000bf80,0x3ee83f163ee83f16,0x250d0000250d,0x3e48a554bf7bbf80,0x3f350000bf35,0xbf7bbf80be48250d,0xbf350000bf35,0x3f263f4fbf26bf4f,0x248d0000a554,0x3f433f16bf43bf16,0x3f800000bf80,0xbf80bf73bd21be9e,0xbf3500003f35,0x3d213e9ebf80bf73,0xbf350000bf35
.quad 0x3f803f803f803f80,0x0,0x0,0x0,0x3f1e3f16bf49bf4f,0x800000000000,0xbf49bf4fbf1ebf16,0x0,0xbe6fbe9e3e6f3e9e,0x800000000000,0xbf79bf733f793f73,0x800000000000,0xbf68bf733ed63e9e,0x8000,0xbed6be9ebf68bf73,0x0
.quad 0xbf64bf4fbf64bf4f,0x800000008000,0x3ee83f163ee83f16,0x0,0xbe48248d3f7b3f80,0x8000,0x3f7b3f803e480000,0x800000008000,0x3f263f4fbf26bf4f,0x8000,0x3f433f16bf43bf16,0x8000,0x3f803f733d213e9e,0x800000000000,0xbd21be9e3f803f73,0x800000008000
.quad 0x3f803f803f803f80,0x0,0x0,0x0,0xbf2ebf263f3c3f43,0x800000000000,0x3f3c3f433f2e3f26,0x0,0xbda1be203da13e20,0x800000000000,0xbf7fbf7d3f7f3f7d,0x800000000000,0x3f493f5abf1ebf06,0x8000,0x3f1e3f063f493f5a,0x0
.quad 0xbf7dbf73bf7dbf73,0x800000008000,0x3e203e9e3e203e9e,0x0,0x3f0e3ec4bf55bf6d,0x8000,0xbf55bf6dbf0ebec4,0x800000008000,0x3e6f3ee8be6fbee8,0x8000,0x3f793f64bf79bf64,0x8000,0xbf5fbf793efa3e6f,0x800000000000,0xbefabe6fbf5fbf79,0x800000008000
.quad 0x3f803f803f803f80,0x0,0x0,0x0,0x3f2e3f26bf3cbf43,0x800000000000,0xbf3cbf43bf2ebf26,0x0,0xbda1be203da13e20,0x800000000000,0xbf7fbf7d3f7f3f7d,0x800000000000,0xbf49bf5a3f1e3f06,0x8000,0xbf1ebf06bf49bf5a,0x0
.quad 0xbf7dbf73bf7dbf73,0x800000008000,0x3e203e9e3e203e9e,0x0,0xbf0ebec43f553f6d,0x8000,0x3f553f6d3f0e3ec4,0x800000008000,0x3e6f3ee8be6fbee8,0x8000,0x3f793f64bf79bf64,0x8000,0x3f5f3f79befabe6f,0x800000000000,0x3efa3e6f3f5f3f79,0x800000008000
.quad 0x3f733f803f733f80,0x248d3e9e248d3e9e,0x3e9e00003e9e0000,0x3f803f733f803f73,0xbeb1248d3f703f80,0xbf7bbf7dbe483e20,0x3f703f803eb10000,0xbe483e203f7b3f7d,0xbf6dbf803f6d3f80,0x3ec4a554bec4248d,0xbec4250d3ec40000,0xbf6dbf803f6d3f80,0x3ed6a5543f683f80,0x3f553f7dbf0ebe20,0xbf68bf803ed60000,0x3f0e3e203f553f7d
.quad 0x3f643f803f643f80,0xbf35be9ebf35be9e,0x3ee800003ee80000,0x3f353f733f353f73,0xbefa248d3f5f3f80,0xbf0ebf64bf55bee8,0x3f5f3f803efa0000,0xbf55bee83f0e3f64,0xbf5abf803f5a3f80,0x3f6d3f16bf6dbf16,0xbf06250d3f060000,0xbec4bf4f3ec43f4f,0x3f0ea5543f553f80,0x3e483f35bf7bbf35,0xbf55bf803f0e0000,0x3f7b3f353e483f35
.quad 0x3f733f803f733f80,0x248d3e9e248d3e9e,0x3e9e00003e9e0000,0x3f803f733f803f73,0x3eb1a554bf70bf80,0x3f7b3f7d3e48be20,0xbf70bf80beb1250d,0x3e48be20bf7bbf7d,0xbf6dbf803f6d3f80,0x3ec4a554bec4248d,0xbec4250d3ec40000,0xbf6dbf803f6d3f80,0xbed6248dbf68bf80,0xbf55bf7d3f0e3e20,0x3f683f80bed6250d,0xbf0ebe20bf55bf7d
.quad 0x3f643f803f643f80,0xbf35be9ebf35be9e,0x3ee800003ee80000,0x3f353f733f353f73,0x3efaa554bf5fbf80,0x3f0e3f643f553ee8,0xbf5fbf80befa250d,0x3f553ee8bf0ebf64,0xbf5abf803f5a3f80,0x3f6d3f16bf6dbf16,0xbf06250d3f060000,0xbec4bf4f3ec43f4f,0xbf0e248dbf55bf80,0xbe48bf353f7b3f35,0x3f553f80bf0e250d,0xbf7bbf35be48bf35
.quad 0x3f163f4f3f163f4f,0xbf16be9ebf16be9e,0x3f4f3f163f4f3f16,0x3f4f3f733f4f3f73,0xbf5fbf263efa3f43,0xbf1ebf5abf49bf06,0x3efa3f433f5f3f26,0xbf49bf063f1e3f5a,0xbec4bf353ec43f35,0x3f6d3f35bf6dbf35,0xbf6dbf353f6d3f35,0xbec4bf353ec43f35,0x3f763f433e8b3f26,0x3df13f06bf7ebf5a,0xbe8bbf263f763f43,0x3f7e3f5a3df13f06
.quad 0x3e203f163e203f16,0xbf7dbf73bf7dbf73,0x3f7d3f4f3f7d3f4f,0xbe203e9ebe203e9e,0xbf80bf5a3d213f06,0x3ed6bda1bf68bf7f,0x3d213f063f803f5a,0xbf68bf7fbed63da1,0x3da1bee8bda13ee8,0x3f433f7dbf43bf7d,0xbf7fbf643f7f3f64,0x3f263e20bf26be20,0x3f7b3f6dbe483ec4,0xbf55bec4bf0ebf6d,0x3e48bec43f7b3f6d,0x3f0e3f6dbf55bec4
.quad 0x3f163f4f3f163f4f,0xbf16be9ebf16be9e,0x3f4f3f163f4f3f16,0x3f4f3f733f4f3f73,0x3f5f3f26befabf43,0x3f1e3f5a3f493f06,0xbefabf43bf5fbf26,0x3f493f06bf1ebf5a,0xbec4bf353ec43f35,0x3f6d3f35bf6dbf35,0xbf6dbf353f6d3f35,0xbec4bf353ec43f35,0xbf76bf43be8bbf26,0xbdf1bf063f7e3f5a,0x3e8b3f26bf76bf43,0xbf7ebf5abdf1bf06
.quad 0x3e203f163e203f16,0xbf7dbf73bf7dbf73,0x3f7d3f4f3f7d3f4f,0xbe203e9ebe203e9e,0x3f803f5abd21bf06,0xbed63da13f683f7f,0xbd21bf06bf80bf5a,0x3f683f7f3ed6bda1,0x3da1bee8bda13ee8,0x3f433f7dbf43bf7d,0xbf7fbf643f7f3f64,0x3f263e20bf26be20,0xbf7bbf6d3e48bec4,0x3f553ec43f0e3f6d,0xbe483ec4bf7bbf6d,0xbf0ebf6d3f553ec4
.quad 0xbf73bf4fbf73bf4f,0xbf16bf4fbf16bf4f,0x3e9e3f163e9e3f16,0xbf4fbf16bf4fbf16,0x3d21be9ebf80bf73,0x3f7e3f64bdf1bee8,0xbf80bf73bd213e9e,0xbdf1bee8bf7ebf64,0x3f6d3f80bf6dbf80,0xbec4248d3ec4a554,0x3ec40000bec4250d,0x3f6d3f80bf6dbf80,0xbf2ebe9ebf3cbf73,0xbf1ebf643f493ee8,0x3f3c3f73bf2ebe9e,0xbf49bee8bf1ebf64
.quad 0xbee8bf4fbee8bf4f,0x3f7d3f4f3f7d3f4f,0xbf64bf16bf64bf16,0xbe20bf16be20bf16,0x3f7e3f4fbdf1bf16,0xbeb13e203f703f7d,0xbdf1bf16bf7ebf4f,0x3f703f7d3eb1be20,0xbe6f3e9e3e6fbe9e,0xbf26bf733f263f73,0x3f793f73bf79bf73,0xbf43be9e3f433e9e,0xbf55bf803f0ea554,0x3f7b3f353e483f35,0xbf0e250dbf55bf80,0xbe48bf353f7b3f35
.quad 0xbf73bf4fbf73bf4f,0xbf16bf4fbf16bf4f,0x3e9e3f163e9e3f16,0xbf4fbf16bf4fbf16,0xbd213e9e3f803f73,0xbf7ebf643df13ee8,0x3f803f733d21be9e,0x3df13ee83f7e3f64,0x3f6d3f80bf6dbf80,0xbec4248d3ec4a554,0x3ec40000bec4250d,0x3f6d3f80bf6dbf80,0x3f2e3e9e3f3c3f73,0x3f1e3f64bf49bee8,0xbf3cbf733f2e3e9e,0x3f493ee83f1e3f64
.quad 0xbee8bf4fbee8bf4f,0x3f7d3f4f3f7d3f4f,0xbf64bf16bf64bf16,0xbe20bf16be20bf16,0xbf7ebf4f3df13f16,0x3eb1be20bf70bf7d,0x3df13f163f7e3f4f,0xbf70bf7dbeb13e20,0xbe6f3e9e3e6fbe9e,0xbf26bf733f263f73,0x3f793f73bf79bf73,0xbf43be9e3f433e9e,0x3f553f80bf0e248d,0xbf7bbf35be48bf35,0x3f0e00003f553f80,0x3e483f35bf7bbf35
.quad 0xbf73bf80bf73bf80,0xa554be9ea554be9e,0xbe9e250dbe9e250d,0xbf80bf73bf80bf73,0x3f2e3ec4bf3cbf6d,0x3f553f793f0e3e6f,0xbf3cbf6dbf2ebec4,0x3f0e3e6fbf55bf79,0x3ec43f35bec4bf35,0xbf6dbf353f6d3f35,0x3f6d3f35bf6dbf35,0x3ec43f35bec4bf35,0xbf80bf6d3d21bec4,0x3e48be6f3f7b3f79,0xbd213ec4bf80bf6d,0xbf7bbf793e48be6f
.quad 0x3ee8a5543ee8a554,0x3f353f733f353f73,0xbf64bf80bf64bf80,0x3f353e9e3f353e9e,0x3f1e3f6d3f493ec4,0xbf7bbf433e483f26,0x3f493ec4bf1ebf6d,0x3e483f263f7b3f43,0xbf79bf353f793f35,0x3ec4be20bec43e20,0x3e6f3f35be6fbf35,0xbf6dbf7d3f6d3f7d,0x3e48bec43f7b3f6d,0x3f0e3f6dbf55bec4,0xbf7bbf6d3e48bec4,0x3f553ec43f0e3f6d
.quad 0xbf73bf80bf73bf80,0xa554be9ea554be9e,0xbe9e250dbe9e250d,0xbf80bf73bf80bf73,0xbf2ebec43f3c3f6d,0xbf55bf79bf0ebe6f,0x3f3c3f6d3f2e3ec4,0xbf0ebe6f3f553f79,0x3ec43f35bec4bf35,0xbf6dbf353f6d3f35,0x3f6d3f35bf6dbf35,0x3ec43f35bec4bf35,0x3f803f6dbd213ec4,0xbe483e6fbf7bbf79,0x3d21bec43f803f6d,0x3f7b3f79be483e6f
.quad 0x3ee8a5543ee8a554,0x3f353f733f353f73,0xbf64bf80bf64bf80,0x3f353e9e3f353e9e,0xbf1ebf6dbf49bec4,0x3f7b3f43be48bf26,0xbf49bec43f1e3f6d,0xbe48bf26bf7bbf43,0xbf79bf353f793f35,0x3ec4be20bec43e20,0x3e6f3f35be6fbf35,0xbf6dbf7d3f6d3f7d,0xbe483ec4bf7bbf6d,0xbf0ebf6d3f553ec4,0x3f7b3f6dbe483ec4,0xbf55bec4bf0ebf6d
.quad 0x3f163e9e3f163e9e,0x3f8000003f80,0xbf4fbf73bf4fbf73,0x0,0x3e8b3f163f763f4f,0xbf3500003f35,0x3f763f4fbe8bbf16,0x3f3500003f35,0xbf6dbf803f6d3f80,0xa5540000248d,0xbec4250d3ec40000,0xbf8000003f80,0x3f5f3f163efa3f4f,0x3f350000bf35,0xbefabf4f3f5f3f16,0x3f3500003f35
.quad 0xbe203e9ebe203e9e,0xbf800000bf80,0x3f7d3f733f7d3f73,0x250d0000250d,0xbf2ebf73bf3cbe9e,0x3f350000bf35,0xbf3cbe9e3f2e3f73,0xbf350000bf35,0x3f7f3f4fbf7fbf4f,0x248d0000a554,0xbda1bf163da13f16,0x3f800000bf80,0xbf0e248dbf55bf80,0xbf3500003f35,0x3f553f80bf0e250d,0xbf350000bf35
.quad 0x3f163e9e3f163e9e,0x0,0xbf4fbf73bf4fbf73,0x0,0xbe8bbf16bf76bf4f,0x800000000000,0xbf76bf4f3e8b3f16,0x0,0xbf6dbf803f6d3f80,0x800000000000,0xbec4250d3ec40000,0x800000000000,0xbf5fbf16befabf4f,0x8000,0x3efa3f4fbf5fbf16,0x0
.quad 0xbe203e9ebe203e9e,0x800000008000,0x3f7d3f733f7d3f73,0x0,0x3f2e3f733f3c3e9e,0x8000,0x3f3c3e9ebf2ebf73,0x800000008000,0x3f7f3f4fbf7fbf4f,0x8000,0xbda1bf163da13f16,0x8000,0x3f0ea5543f553f80,0x800000000000,0xbf55bf803f0e0000,0x800000008000
.quad 0x3f733f4f3f733f4f,0x0,0xbe9ebf16be9ebf16,0x0,0xbed6bda13f683f7f,0x800000000000,0x3f683f7f3ed63da1,0x0,0xbec4bf353ec43f35,0x800000000000,0xbf6dbf353f6d3f35,0x800000000000,0x3f703f7fbeb13da1,0x8000,0x3eb1bda13f703f7f,0x0
.quad 0xbf64bf16bf64bf16,0x800000008000,0x3ee83f4f3ee83f4f,0x0,0x3e8bbe6fbf76bf79,0x8000,0xbf76bf79be8b3e6f,0x800000008000,0x3f063f64bf06bf64,0x8000,0x3f5a3ee8bf5abee8,0x8000,0xbf7bbf6d3e48bec4,0x800000000000,0xbe483ec4bf7bbf6d,0x800000008000
.quad 0x3f733f4f3f733f4f,0x0,0xbe9ebf16be9ebf16,0x0,0x3ed63da1bf68bf7f,0x800000000000,0xbf68bf7fbed6bda1,0x0,0xbec4bf353ec43f35,0x800000000000,0xbf6dbf353f6d3f35,0x800000000000,0xbf70bf7f3eb1bda1,0x8000,0xbeb13da1bf70bf7f,0x0
.quad 0xbf64bf16bf64bf16,0x800000008000,0x3ee83f4f3ee83f4f,0x0,0xbe8b3e6f3f763f79,0x8000,0x3f763f793e8bbe6f,0x800000008000,0x3f063f64bf06bf64,0x8000,0x3f5a3ee8bf5abee8,0x8000,0x3f7b3f6dbe483ec4,0x800000000000,0x3e48bec43f7b3f6d,0x800000008000
.quad 0x3f4f3f803f4f3f80,0xbf80bf4fbf80bf4f,0x3f1600003f160000,0x250d3f16250d3f16,0xbf1e248d3f493f80,0x3e48bee8bf7bbf64,0x3f493f803f1e0000,0xbf7bbf64be483ee8,0xbf43bf803f433f80,0x3f6d3f73bf6dbf73,0xbf26250d3f260000,0x3ec4be9ebec43e9e,0x3f2ea5543f3c3f80,0xbf0e3e20bf55bf7d,0xbf3cbf803f2e0000,0x3f553f7dbf0e3e20
.quad 0x3f353f803f353f80,0xbf35bf80bf35bf80,0x3f3500003f350000,0xbf35250dbf35250d,0xbf3c248d3f2e3f80,0x3f553e20bf0ebf7d,0x3f2e3f803f3c0000,0xbf0ebf7dbf55be20,0xbf26bf803f263f80,0x3ec43f73bec4bf73,0xbf43250d3f430000,0x3f6d3e9ebf6dbe9e,0x3f49a5543f1e3f80,0xbf7bbee8be48bf64,0xbf1ebf803f490000,0x3e483f64bf7bbee8
.quad 0x3f4f3f803f4f3f80,0xbf80bf4fbf80bf4f,0x3f1600003f160000,0x250d3f16250d3f16,0x3f1ea554bf49bf80,0xbe483ee83f7b3f64,0xbf49bf80bf1e250d,0x3f7b3f643e48bee8,0xbf43bf803f433f80,0x3f6d3f73bf6dbf73,0xbf26250d3f260000,0x3ec4be9ebec43e9e,0xbf2e248dbf3cbf80,0x3f0ebe203f553f7d,0x3f3c3f80bf2e250d,0xbf55bf7d3f0ebe20
.quad 0x3f353f803f353f80,0xbf35bf80bf35bf80,0x3f3500003f350000,0xbf35250dbf35250d,0x3f3ca554bf2ebf80,0xbf55be203f0e3f7d,0xbf2ebf80bf3c250d,0x3f0e3f7d3f553e20,0xbf26bf803f263f80,0x3ec43f73bec4bf73,0xbf43250d3f430000,0x3f6d3e9ebf6dbe9e,0xbf49248dbf1ebf80,0x3f7b3ee83e483f64,0x3f1e3f80bf49250d,0xbe48bf643f7b3ee8
.quad 0xbe9e3e9ebe9e3e9e,0xbe9ebf4fbe9ebf4f,0x3f733f733f733f73,0xbf73bf16bf73bf16,0xbf68bf79bed63e6f,0x3f803f43bd21bf26,0xbed63e6f3f683f79,0xbd21bf26bf80bf43,0x3f06be20bf063e20,0xbe6f3ee83e6fbee8,0xbf5abf7d3f5a3f7d,0x3f793f64bf79bf64,0x3f493f7fbf1e3da1,0xbf5fbf793efabe6f,0x3f1ebda13f493f7f,0xbefa3e6fbf5fbf79
.quad 0xbf35248dbf35248d,0x3f35a5543f35a554,0x3f353f803f353f80,0xbf35bf80bf35bf80,0xbf1ebf7fbf49bda1,0x3efa3f793f5f3e6f,0xbf49bda13f1e3f7f,0x3f5f3e6fbefabf79,0x3f5a3e20bf5abe20,0xbf79bee83f793ee8,0xbf06bf7d3f063f7d,0x3e6f3f64be6fbf64,0x3ed63f79bf68be6f,0x3d21bf433f803f26,0x3f683e6f3ed63f79,0xbf80bf263d21bf43
.quad 0xbe9e3e9ebe9e3e9e,0xbe9ebf4fbe9ebf4f,0x3f733f733f733f73,0xbf73bf16bf73bf16,0x3f683f793ed6be6f,0xbf80bf433d213f26,0x3ed6be6fbf68bf79,0x3d213f263f803f43,0x3f06be20bf063e20,0xbe6f3ee83e6fbee8,0xbf5abf7d3f5a3f7d,0x3f793f64bf79bf64,0xbf49bf7f3f1ebda1,0x3f5f3f79befa3e6f,0xbf1e3da1bf49bf7f,0x3efabe6f3f5f3f79
.quad 0xbf35248dbf35248d,0x3f35a5543f35a554,0x3f353f803f353f80,0xbf35bf80bf35bf80,0x3f1e3f7f3f493da1,0xbefabf79bf5fbe6f,0x3f493da1bf1ebf7f,0xbf5fbe6f3efa3f79,0x3f5a3e20bf5abe20,0xbf79bee83f793ee8,0xbf06bf7d3f063f7d,0x3e6f3f64be6fbf64,0xbed6bf793f683e6f,0xbd213f43bf80bf26,0xbf68be6fbed6bf79,0x3f803f26bd213f43
.quad 0x3f4f3e9e3f4f3e9e,0xbe9e3e9ebe9e3e9e,0xbf16bf73bf16bf73,0x3f733f733f733f73,0x3e8b3f4f3f763f16,0xbf2ebf7dbf3cbe20,0x3f763f16be8bbf4f,0xbf3cbe203f2e3f7d,0xbf7fbf4f3f7f3f4f,0x3f793f16bf79bf16,0xbda13f163da1bf16,0xbe6fbf4f3e6f3f4f,0x3ed6be9e3f683f73,0xbe8b3ee8bf76bf64,0xbf68bf733ed6be9e,0x3f763f64be8b3ee8
.quad 0x3f353f803f353f80,0xbf35bf80bf35bf80,0x3f3500003f350000,0xbf35250dbf35250d,0xbf68be9e3ed63f73,0x3f763ee8be8bbf64,0x3ed63f733f683e9e,0xbe8bbf64bf76bee8,0xbda1bf4f3da13f4f,0xbe6f3f163e6fbf16,0xbf7fbf163f7f3f16,0x3f793f4fbf79bf4f,0x3f763f4fbe8b3f16,0xbf3cbf7d3f2ebe20,0x3e8bbf163f763f4f,0xbf2e3e20bf3cbf7d
.quad 0x3f4f3e9e3f4f3e9e,0xbe9e3e9ebe9e3e9e,0xbf16bf73bf16bf73,0x3f733f733f733f73,0xbe8bbf4fbf76bf16,0x3f2e3f7d3f3c3e20,0xbf76bf163e8b3f4f,0x3f3c3e20bf2ebf7d,0xbf7fbf4f3f7f3f4f,0x3f793f16bf79bf16,0xbda13f163da1bf16,0xbe6fbf4f3e6f3f4f,0xbed63e9ebf68bf73,0x3e8bbee83f763f64,0x3f683f73bed63e9e,0xbf76bf643e8bbee8
.quad 0x3f353f803f353f80,0xbf35bf80bf35bf80,0x3f3500003f350000,0xbf35250dbf35250d,0x3f683e9ebed6bf73,0xbf76bee83e8b3f64,0xbed6bf73bf68be9e,0x3e8b3f643f763ee8,0xbda1bf4f3da13f4f,0xbe6f3f163e6fbf16,0xbf7fbf163f7f3f16,0x3f793f4fbf79bf4f,0xbf76bf4f3e8bbf16,0x3f3c3f7dbf2e3e20,0xbe8b3f16bf76bf4f,0x3f2ebe203f3c3f7d
.quad 0x3f4f3f803f4f3f80,0xbf80bf4fbf80bf4f,0x3f1600003f160000,0x250d3f16250d3f16,0xbf5fbec43efa3f6d,0x3f0ebda1bf55bf7f,0x3efa3f6d3f5f3ec4,0xbf55bf7fbf0e3da1,0xbda1bf353da13f35,0x3ec43f64bec4bf64,0xbf7fbf353f7f3f35,0x3f6d3ee8bf6dbee8,0x3f703f6dbeb13ec4,0xbf7bbf5a3e48bf06,0x3eb1bec43f703f6d,0xbe483f06bf7bbf5a
.quad 0xbf35248dbf35248d,0x3f35a5543f35a554,0x3f353f803f353f80,0xbf35bf80bf35bf80,0xbeb1bf6dbf70bec4,0x3e483f5a3f7b3f06,0xbf70bec43eb13f6d,0x3f7b3f06be48bf5a,0x3f7f3f35bf7fbf35,0xbf6dbf643f6d3f64,0x3da1bf35bda13f35,0xbec43ee83ec4bee8,0xbefa3ec4bf5fbf6d,0x3f553da13f0e3f7f,0x3f5f3f6dbefa3ec4,0xbf0ebf7f3f553da1
.quad 0x3f4f3f803f4f3f80,0xbf80bf4fbf80bf4f,0x3f1600003f160000,0x250d3f16250d3f16,0x3f5f3ec4befabf6d,0xbf0e3da13f553f7f,0xbefabf6dbf5fbec4,0x3f553f7f3f0ebda1,0xbda1bf353da13f35,0x3ec43f64bec4bf64,0xbf7fbf353f7f3f35,0x3f6d3ee8bf6dbee8,0xbf70bf6d3eb1bec4,0x3f7b3f5abe483f06,0xbeb13ec4bf70bf6d,0x3e48bf063f7b3f5a
.quad 0xbf35248dbf35248d,0x3f35a5543f35a554,0x3f353f803f353f80,0xbf35bf80bf35bf80,0x3eb13f6d3f703ec4,0xbe48bf5abf7bbf06,0x3f703ec4beb1bf6d,0xbf7bbf063e483f5a,0x3f7f3f35bf7fbf35,0xbf6dbf643f6d3f64,0x3da1bf35bda13f35,0xbec43ee83ec4bee8,0x3efabec43f5f3f6d,0xbf55bda1bf0ebf7f,0xbf5fbf6d3efabec4,0x3f0e3f7fbf55bda1
.quad 0xbe9ebf4fbe9ebf4f,0x3f8000003f80,0xbf73bf16bf73bf16,0x0,0x3f703f733eb1be9e,0xbf3500003f35,0x3eb1be9ebf70bf73,0x3f3500003f35,0xbf5abe9e3f5a3e9e,0xa5540000248d,0x3f063f73bf06bf73,0xbf8000003f80,0x3df1bf163f7e3f4f,0x3f350000bf35,0xbf7ebf4f3df1bf16,0x3f3500003f35
.quad 0x3f353f803f353f80,0xbf800000bf80,0x3f3500003f350000,0x250d0000250d,0xbf7ebf163df13f4f,0x3f350000bf35,0x3df13f4f3f7e3f16,0xbf350000bf35,0x3f06be9ebf063e9e,0x248d0000a554,0xbf5abf733f5a3f73,0x3f800000bf80,0x3eb13f73bf70be9e,0xbf3500003f35,0x3f703e9e3eb13f73,0xbf350000bf35
.quad 0xbe9ebf4fbe9ebf4f,0x0,0xbf73bf16bf73bf16,0x0,0xbf70bf73beb13e9e,0x800000000000,0xbeb13e9e3f703f73,0x0,0xbf5abe9e3f5a3e9e,0x800000000000,0x3f063f73bf06bf73,0x800000000000,0xbdf13f16bf7ebf4f,0x8000,0x3f7e3f4fbdf13f16,0x0
.quad 0x3f353f803f353f80,0x800000008000,0x3f3500003f350000,0x0,0x3f7e3f16bdf1bf4f,0x8000,0xbdf1bf4fbf7ebf16,0x800000008000,0x3f06be9ebf063e9e,0x8000,0xbf5abf733f5a3f73,0x8000,0xbeb1bf733f703e9e,0x800000000000,0xbf70be9ebeb1bf73,0x800000008000
.quad 0x3f4f3e9e3f4f3e9e,0x0,0xbf16bf73bf16bf73,0x0,0xbdf13f063f7e3f5a,0x800000000000,0x3f7e3f5a3df1bf06,0x0,0xbf26bf7d3f263f7d,0x800000000000,0xbf43be203f433e20,0x800000000000,0x3f803f43bd213f26,0x8000,0x3d21bf263f803f43,0x0
.quad 0xbf35248dbf35248d,0x800000008000,0x3f353f803f353f80,0x0,0xbd21bf43bf80bf26,0x8000,0xbf80bf263d213f43,0x800000008000,0x3f433f7dbf43bf7d,0x8000,0x3f26be20bf263e20,0x8000,0xbf7ebf06bdf1bf5a,0x800000000000,0x3df13f5abf7ebf06,0x800000008000
.quad 0x3f4f3e9e3f4f3e9e,0x0,0xbf16bf73bf16bf73,0x0,0x3df1bf06bf7ebf5a,0x800000000000,0xbf7ebf5abdf13f06,0x0,0xbf26bf7d3f263f7d,0x800000000000,0xbf43be203f433e20,0x800000000000,0xbf80bf433d21bf26,0x8000,0xbd213f26bf80bf43,0x0
.quad 0xbf35248dbf35248d,0x800000008000,0x3f353f803f353f80,0x0,0x3d213f433f803f26,0x8000,0x3f803f26bd21bf43,0x800000008000,0x3f433f7dbf43bf7d,0x8000,0x3f26be20bf263e20,0x8000,0x3f7e3f063df13f5a,0x800000000000,0xbdf1bf5a3f7e3f06,0x800000008000
.quad 0x3f163f803f163f80,0xa554bf4fa554bf4f,0x3f4f00003f4f0000,0xbf80bf16bf80bf16,0xbf55248d3f0e3f80,0x3f7b3f353e48bf35,0x3f0e3f803f550000,0x3e48bf35bf7bbf35,0xbf06bf803f063f80,0xbec43f163ec4bf16,0xbf5a250d3f5a0000,0x3f6d3f4fbf6dbf4f,0x3f5fa5543efa3f80,0xbf55bf643f0ebee8,0xbefabf803f5f0000,0xbf0e3ee8bf55bf64
.quad 0x3ee83f803ee83f80,0x3f35be9e3f35be9e,0x3f6400003f640000,0xbf35bf73bf35bf73,0xbf68248d3ed63f80,0x3f0e3f7d3f55be20,0x3ed63f803f680000,0x3f55be20bf0ebf7d,0xbec4bf803ec43f80,0xbf6d248d3f6da554,0xbf6d250d3f6d0000,0x3ec43f80bec4bf80,0x3f70a5543eb13f80,0xbe48bf7d3f7b3e20,0xbeb1bf803f700000,0xbf7bbe20be48bf7d
.quad 0x3f163f803f163f80,0xa554bf4fa554bf4f,0x3f4f00003f4f0000,0xbf80bf16bf80bf16,0x3f55a554bf0ebf80,0xbf7bbf35be483f35,0xbf0ebf80bf55250d,0xbe483f353f7b3f35,0xbf06bf803f063f80,0xbec43f163ec4bf16,0xbf5a250d3f5a0000,0x3f6d3f4fbf6dbf4f,0xbf5f248dbefabf80,0x3f553f64bf0e3ee8,0x3efa3f80bf5f250d,0x3f0ebee83f553f64
.quad 0x3ee83f803ee83f80,0x3f35be9e3f35be9e,0x3f6400003f640000,0xbf35bf73bf35bf73,0x3f68a554bed6bf80,0xbf0ebf7dbf553e20,0xbed6bf80bf68250d,0xbf553e203f0e3f7d,0xbec4bf803ec43f80,0xbf6d248d3f6da554,0xbf6d250d3f6d0000,0x3ec43f80bec4bf80,0xbf70248dbeb1bf80,0x3e483f7dbf7bbe20,0x3eb13f80bf70250d,0x3f7b3e203e483f7d
.quad 0xbf73be9ebf73be9e,0x3f733f4f3f733f4f,0x3e9e3f733e9e3f73,0x3e9ebf163e9ebf16,0xbe48bf6dbf7bbec4,0xbf0e3ec43f553f6d,0xbf7bbec43e483f6d,0x3f553f6d3f0ebec4,0x3f7f3ee8bf7fbee8,0xbf26bf7d3f263f7d,0xbda1bf643da13f64,0xbf433e203f43be20,0xbd213f5abf80bf06,0x3f683da13ed63f7f,0x3f803f06bd213f5a,0xbed6bf7f3f683da1
.quad 0xbf7dbf16bf7dbf16,0x3e203f733e203f73,0xbe203f4fbe203f4f,0x3f7d3e9e3f7d3e9e,0x3e8bbf43bf76bf26,0xbf7ebf06bdf13f5a,0xbf76bf26be8b3f43,0xbdf13f5a3f7e3f06,0x3f6d3f35bf6dbf35,0x3ec4bf35bec43f35,0x3ec4bf35bec43f35,0xbf6dbf353f6d3f35,0xbefa3f26bf5fbf43,0x3f493f5abf1e3f06,0x3f5f3f43befa3f26,0x3f1ebf063f493f5a
.quad 0xbf73be9ebf73be9e,0x3f733f4f3f733f4f,0x3e9e3f733e9e3f73,0x3e9ebf163e9ebf16,0x3e483f6d3f7b3ec4,0x3f0ebec4bf55bf6d,0x3f7b3ec4be48bf6d,0xbf55bf6dbf0e3ec4,0x3f7f3ee8bf7fbee8,0xbf26bf7d3f263f7d,0xbda1bf643da13f64,0xbf433e203f43be20,0x3d21bf5a3f803f06,0xbf68bda1bed6bf7f,0xbf80bf063d21bf5a,0x3ed63f7fbf68bda1
.quad 0xbf7dbf16bf7dbf16,0x3e203f733e203f73,0xbe203f4fbe203f4f,0x3f7d3e9e3f7d3e9e,0xbe8b3f433f763f26,0x3f7e3f063df1bf5a,0x3f763f263e8bbf43,0x3df1bf5abf7ebf06,0x3f6d3f35bf6dbf35,0x3ec4bf35bec43f35,0x3ec4bf35bec43f35,0xbf6dbf353f6d3f35,0x3efabf263f5f3f43,0xbf49bf5a3f1ebf06,0xbf5fbf433efabf26,0xbf1e3f06bf49bf5a
.quad 0xbf163e9ebf163e9e,0x3f733e9e3f733e9e,0x3f4f3f733f4f3f73,0xbe9ebf73be9ebf73,0xbf0ebf80bf55248d,0xbe483f353f7b3f35,0xbf55250d3f0e3f80,0x3f7b3f353e48bf35,0x3f793e9ebf79be9e,0xbf43bf733f433f73,0xbe6fbf733e6f3f73,0xbf263e9e3f26be9e,0xbdf13f4fbf7ebf16,0x3f703e203eb13f7d,0x3f7e3f16bdf13f4f,0xbeb1bf7d3f703e20
.quad 0xbf64bf4fbf64bf4f,0xbe203f4fbe203f4f,0xbee83f16bee83f16,0x3f7d3f163f7d3f16,0x3f3cbe9ebf2ebf73,0xbf49bf64bf1e3ee8,0xbf2ebf73bf3c3e9e,0xbf1e3ee83f493f64,0x3ec43f80bec4bf80,0x3f6da554bf6d248d,0x3f6d0000bf6d250d,0xbec4bf803ec43f80,0xbf80be9ebd21bf73,0xbdf13f64bf7ebee8,0x3d213f73bf80be9e,0x3f7e3ee8bdf13f64
.quad 0xbf163e9ebf163e9e,0x3f733e9e3f733e9e,0x3f4f3f733f4f3f73,0xbe9ebf73be9ebf73,0x3f0e3f803f55a554,0x3e48bf35bf7bbf35,0x3f550000bf0ebf80,0xbf7bbf35be483f35,0x3f793e9ebf79be9e,0xbf43bf733f433f73,0xbe6fbf733e6f3f73,0xbf263e9e3f26be9e,0x3df1bf4f3f7e3f16,0xbf70be20beb1bf7d,0xbf7ebf163df1bf4f,0x3eb13f7dbf70be20
.quad 0xbf64bf4fbf64bf4f,0xbe203f4fbe203f4f,0xbee83f16bee83f16,0x3f7d3f163f7d3f16,0xbf3c3e9e3f2e3f73,0x3f493f643f1ebee8,0x3f2e3f733f3cbe9e,0x3f1ebee8bf49bf64,0x3ec43f80bec4bf80,0x3f6da554bf6d248d,0x3f6d0000bf6d250d,0xbec4bf803ec43f80,0x3f803e9e3d213f73,0x3df1bf643f7e3ee8,0xbd21bf733f803e9e,0xbf7ebee83df1bf64
.quad 0xbf16bf80bf16bf80,0x248d3f4f248d3f4f,0xbf4f250dbf4f250d,0x3f803f163f803f16,0x3f7b3ec4be48bf6d,0xbf55bf6dbf0e3ec4,0xbe48bf6dbf7bbec4,0xbf0e3ec43f553f6d,0xbe6f3f353e6fbf35,0x3f6d3e20bf6dbe20,0x3f793f35bf79bf35,0xbec4bf7d3ec43f7d,0xbf49bf6d3f1ebec4,0xbe483f43bf7bbf26,0xbf1e3ec4bf49bf6d,0x3f7b3f26be483f43
.quad 0x3f64a5543f64a554,0xbf35bf73bf35bf73,0xbee8bf80bee8bf80,0xbf353e9ebf353e9e,0x3d213f6d3f803ec4,0x3f7b3e6fbe48bf79,0x3f803ec4bd21bf6d,0xbe48bf79bf7bbe6f,0xbf6dbf353f6d3f35,0xbec43f353ec4bf35,0xbec43f353ec4bf35,0x3f6d3f35bf6dbf35,0x3f3cbec43f2e3f6d,0xbf0ebf793f55be6f,0xbf2ebf6d3f3cbec4,0xbf553e6fbf0ebf79
.quad 0xbf16bf80bf16bf80,0x248d3f4f248d3f4f,0xbf4f250dbf4f250d,0x3f803f163f803f16,0xbf7bbec43e483f6d,0x3f553f6d3f0ebec4,0x3e483f6d3f7b3ec4,0x3f0ebec4bf55bf6d,0xbe6f3f353e6fbf35,0x3f6d3e20bf6dbe20,0x3f793f35bf79bf35,0xbec4bf7d3ec43f7d,0x3f493f6dbf1e3ec4,0x3e48bf433f7b3f26,0x3f1ebec43f493f6d,0xbf7bbf263e48bf43
.quad 0x3f64a5543f64a554,0xbf35bf73bf35bf73,0xbee8bf80bee8bf80,0xbf353e9ebf353e9e,0xbd21bf6dbf80bec4,0xbf7bbe6f3e483f79,0xbf80bec43d213f6d,0x3e483f793f7b3e6f,0xbf6dbf353f6d3f35,0xbec43f353ec4bf35,0xbec43f353ec4bf35,0x3f6d3f35bf6dbf35,0xbf3c3ec4bf2ebf6d,0x3f0e3f79bf553e6f,0x3f2e3f6dbf3c3ec4,0x3f55be6f3f0e3f79
.quad 0xbf73bf4fbf73bf4f,0x3f8000003f80,0xbe9e3f16be9e3f16,0x0,0x3f55a554bf0ebf80,0xbf3500003f35,0xbf0ebf80bf55250d,0x3f3500003f35,0xbda13f4f3da1bf4f,0xa5540000248d,0x3f7f3f16bf7fbf16,0xbf8000003f80,0xbf3cbf733f2ebe9e,0x3f350000bf35,0xbf2e3e9ebf3cbf73,0x3f3500003f35
.quad 0x3f7d3e9e3f7d3e9e,0xbf800000bf80,0xbe20bf73be20bf73,0x250d0000250d,0xbefa3f163f5f3f4f,0x3f350000bf35,0x3f5f3f4f3efabf16,0xbf350000bf35,0xbec4bf803ec43f80,0x248d0000a554,0xbf6d250d3f6d0000,0x3f800000bf80,0x3f763f16be8b3f4f,0xbf3500003f35,0x3e8bbf4f3f763f16,0xbf350000bf35
.quad 0xbf73bf4fbf73bf4f,0x0,0xbe9e3f16be9e3f16,0x0,0xbf55248d3f0e3f80,0x800000000000,0x3f0e3f803f550000,0x0,0xbda13f4f3da1bf4f,0x800000000000,0x3f7f3f16bf7fbf16,0x800000000000,0x3f3c3f73bf2e3e9e,0x8000,0x3f2ebe9e3f3c3f73,0x0
.quad 0x3f7d3e9e3f7d3e9e,0x800000008000,0xbe20bf73be20bf73,0x0,0x3efabf16bf5fbf4f,0x8000,0xbf5fbf4fbefa3f16,0x800000008000,0xbec4bf803ec43f80,0x8000,0xbf6d250d3f6d0000,0x8000,0xbf76bf163e8bbf4f,0x800000000000,0xbe8b3f4fbf76bf16,0x800000008000
.quad 0x3f16be9e3f16be9e,0x0,0xbf4fbf73bf4fbf73,0x0,0x3e483f6d3f7b3ec4,0x800000000000,0x3f7b3ec4be48bf6d,0x0,0xbf5abf643f5a3f64,0x800000000000,0xbf063ee83f06bee8,0x800000000000,0x3f763e6f3e8b3f79,0x8000,0xbe8bbf793f763e6f,0x0
.quad 0xbee83f16bee83f16,0x800000008000,0x3f643f4f3f643f4f,0x0,0xbeb1bf7fbf70bda1,0x8000,0xbf70bda13eb13f7f,0x800000008000,0x3f6d3f35bf6dbf35,0x8000,0x3ec4bf35bec43f35,0x8000,0xbf683da1bed6bf7f,0x800000000000,0x3ed63f7fbf683da1,0x800000008000
.quad 0x3f16be9e3f16be9e,0x0,0xbf4fbf73bf4fbf73,0x0,0xbe48bf6dbf7bbec4,0x800000000000,0xbf7bbec43e483f6d,0x0,0xbf5abf643f5a3f64,0x800000000000,0xbf063ee83f06bee8,0x800000000000,0xbf76be6fbe8bbf79,0x8000,0x3e8b3f79bf76be6f,0x0
.quad 0xbee83f16bee83f16,0x800000008000,0x3f643f4f3f643f4f,0x0,0x3eb13f7f3f703da1,0x8000,0x3f703da1beb1bf7f,0x800000008000,0x3f6d3f35bf6dbf35,0x8000,0x3ec4bf35bec43f35,0x8000,0x3f68bda13ed63f7f,0x800000000000,0xbed6bf7f3f68bda1,0x800000008000
.quad 0x3e9e3f803e9e3f80,0x3f803e9e3f803e9e,0x3f7300003f730000,0xbf730000bf73,0xbf76248d3e8b3f80,0xbe483f643f7b3ee8,0x3e8b3f803f760000,0x3f7b3ee83e48bf64,0xbe6fbf803e6f3f80,0xbf6dbf163f6d3f16,0xbf79250d3f790000,0xbec43f4f3ec4bf4f,0x3f7ba5543e483f80,0x3f0ebf353f553f35,0xbe48bf803f7b0000,0xbf55bf353f0ebf35
.quad 0x3e203f803e203f80,0x3f353f4f3f353f4f,0x3f7d00003f7d0000,0x3f35bf163f35bf16,0xbf7e248d3df13f80,0xbf553ee83f0e3f64,0x3df13f803f7e0000,0x3f0e3f643f55bee8,0xbda1bf803da13f80,0xbec4bf733ec43f73,0xbf7f250d3f7f0000,0xbf6d3e9e3f6dbe9e,0x3f80a5543d213f80,0x3f7bbe203e483f7d,0xbd21bf803f800000,0xbe48bf7d3f7bbe20
.quad 0x3e9e3f803e9e3f80,0x3f803e9e3f803e9e,0x3f7300003f730000,0xbf730000bf73,0x3f76a554be8bbf80,0x3e48bf64bf7bbee8,0xbe8bbf80bf76250d,0xbf7bbee8be483f64,0xbe6fbf803e6f3f80,0xbf6dbf163f6d3f16,0xbf79250d3f790000,0xbec43f4f3ec4bf4f,0xbf7b248dbe48bf80,0xbf0e3f35bf55bf35,0x3e483f80bf7b250d,0x3f553f35bf0e3f35
.quad 0x3e203f803e203f80,0x3f353f4f3f353f4f,0x3f7d00003f7d0000,0x3f35bf163f35bf16,0x3f7ea554bdf1bf80,0x3f55bee8bf0ebf64,0xbdf1bf80bf7e250d,0xbf0ebf64bf553ee8,0xbda1bf803da13f80,0xbec4bf733ec43f73,0xbf7f250d3f7f0000,0xbf6d3e9e3f6dbe9e,0xbf80248dbd21bf80,0xbf7b3e20be48bf7d,0x3d213f80bf80250d,0x3e483f7dbf7b3e20
.quad 0xbf4fbf4fbf4fbf4f,0xbf4f3e9ebf4f3e9e,0xbf163f16bf163f16,0x3f163f733f163f73,0x3f2ebf06bf3cbf5a,0xbeb1bf7fbf703da1,0xbf3cbf5abf2e3f06,0xbf703da13eb13f7f,0x3f263f64bf26bf64,0x3f7f3e20bf7fbe20,0x3f43bee8bf433ee8,0xbda1bf7d3da13f7d,0xbf553ec4bf0ebf6d,0xbe483f6dbf7bbec4,0x3f0e3f6dbf553ec4,0x3f7b3ec4be483f6d
.quad 0xbee8bf73bee8bf73,0xbf64bf16bf64bf16,0xbf643e9ebf643e9e,0xbee83f4fbee83f4f,0x3f70be6fbeb1bf79,0x3f2ebf26bf3cbf43,0xbeb1bf79bf703e6f,0xbf3cbf43bf2e3f26,0x3e6f3f7dbe6fbf7d,0x3f063f64bf06bf64,0x3f79be20bf793e20,0x3f5abee8bf5a3ee8,0xbf7e3da1bdf1bf7f,0xbf763e6fbe8bbf79,0x3df13f7fbf7e3da1,0x3e8b3f79bf763e6f
.quad 0xbf4fbf4fbf4fbf4f,0xbf4f3e9ebf4f3e9e,0xbf163f16bf163f16,0x3f163f733f163f73,0xbf2e3f063f3c3f5a,0x3eb13f7f3f70bda1,0x3f3c3f5a3f2ebf06,0x3f70bda1beb1bf7f,0x3f263f64bf26bf64,0x3f7f3e20bf7fbe20,0x3f43bee8bf433ee8,0xbda1bf7d3da13f7d,0x3f55bec43f0e3f6d,0x3e48bf6d3f7b3ec4,0xbf0ebf6d3f55bec4,0xbf7bbec43e48bf6d
.quad 0xbee8bf73bee8bf73,0xbf64bf16bf64bf16,0xbf643e9ebf643e9e,0xbee83f4fbee83f4f,0xbf703e6f3eb13f79,0xbf2e3f263f3c3f43,0x3eb13f793f70be6f,0x3f3c3f433f2ebf26,0x3e6f3f7dbe6fbf7d,0x3f063f64bf06bf64,0x3f79be20bf793e20,0x3f5abee8bf5a3ee8,0x3f7ebda13df13f7f,0x3f76be6f3e8b3f79,0xbdf1bf7f3f7ebda1,0xbe8bbf793f76be6f
.quad 0x3e9ebf4f3e9ebf4f,0xbf4fbf4fbf4fbf4f,0xbf73bf16bf73bf16,0xbf163f16bf163f16,0x3f493f4f3f1ebf16,0x3f68be20bed6bf7d,0x3f1ebf16bf49bf4f,0xbed6bf7dbf683e20,0xbf5a3e9e3f5abe9e,0xbda13f733da1bf73,0x3f063f73bf06bf73,0x3f7f3e9ebf7fbe9e,0xbe48bf803f7ba554,0xbf55bf353f0ebf35,0xbf7b250dbe48bf80,0xbf0e3f35bf55bf35
.quad 0x3f7d3e9e3f7d3e9e,0x3f64be9e3f64be9e,0x3e20bf733e20bf73,0xbee8bf73bee8bf73,0xbefa3f4f3f5f3f16,0xbd213f7d3f803e20,0x3f5f3f163efabf4f,0x3f803e203d21bf7d,0xbf26bf4f3f263f4f,0xbf5abf163f5a3f16,0xbf433f163f43bf16,0xbf063f4f3f06bf4f,0x3f70be9e3eb13f73,0x3f5fbee83efa3f64,0xbeb1bf733f70be9e,0xbefabf643f5fbee8
.quad 0x3e9ebf4f3e9ebf4f,0xbf4fbf4fbf4fbf4f,0xbf73bf16bf73bf16,0xbf163f16bf163f16,0xbf49bf4fbf1e3f16,0xbf683e203ed63f7d,0xbf1e3f163f493f4f,0x3ed63f7d3f68be20,0xbf5a3e9e3f5abe9e,0xbda13f733da1bf73,0x3f063f73bf06bf73,0x3f7f3e9ebf7fbe9e,0x3e483f80bf7b248d,0x3f553f35bf0e3f35,0x3f7b00003e483f80,0x3f0ebf353f553f35
.quad 0x3f7d3e9e3f7d3e9e,0x3f64be9e3f64be9e,0x3e20bf733e20bf73,0xbee8bf73bee8bf73,0x3efabf4fbf5fbf16,0x3d21bf7dbf80be20,0xbf5fbf16befa3f4f,0xbf80be20bd213f7d,0xbf26bf4f3f263f4f,0xbf5abf163f5a3f16,0xbf433f163f43bf16,0xbf063f4f3f06bf4f,0xbf703e9ebeb1bf73,0xbf5f3ee8befabf64,0x3eb13f73bf703e9e,0x3efa3f64bf5f3ee8
.quad 0x3e9e3f803e9e3f80,0x3f803e9e3f803e9e,0x3f7300003f730000,0xbf730000bf73,0xbf7ebec4bdf13f6d,0xbf0e3f263f553f43,0xbdf13f6d3f7e3ec4,0x3f553f433f0ebf26,0x3f06bf35bf063f35,0xbec4bf7d3ec43f7d,0xbf5abf353f5a3f35,0xbf6d3e203f6dbe20,0x3f0e3f6dbf553ec4,0x3f7b3ec4be483f6d,0x3f55bec43f0e3f6d,0x3e48bf6d3f7b3ec4
.quad 0xbf7d248dbf7d248d,0xbf353f16bf353f16,0x3e203f803e203f80,0x3f353f4f3f353f4f,0x3e8bbf6dbf76bec4,0xbe48bf7fbf7b3da1,0xbf76bec4be8b3f6d,0xbf7b3da13e483f7f,0x3f433f35bf43bf35,0x3f6d3ee8bf6dbee8,0x3f26bf35bf263f35,0x3ec4bf64bec43f64,0xbf683ec4bed6bf6d,0xbf553f06bf0ebf5a,0x3ed63f6dbf683ec4,0x3f0e3f5abf553f06
.quad 0x3e9e3f803e9e3f80,0x3f803e9e3f803e9e,0x3f7300003f730000,0xbf730000bf73,0x3f7e3ec43df1bf6d,0x3f0ebf26bf55bf43,0x3df1bf6dbf7ebec4,0xbf55bf43bf0e3f26,0x3f06bf35bf063f35,0xbec4bf7d3ec43f7d,0xbf5abf353f5a3f35,0xbf6d3e203f6dbe20,0xbf0ebf6d3f55bec4,0xbf7bbec43e48bf6d,0xbf553ec4bf0ebf6d,0xbe483f6dbf7bbec4
.quad 0xbf7d248dbf7d248d,0xbf353f16bf353f16,0x3e203f803e203f80,0x3f353f4f3f353f4f,0xbe8b3f6d3f763ec4,0x3e483f7f3f7bbda1,0x3f763ec43e8bbf6d,0x3f7bbda1be48bf7f,0x3f433f35bf43bf35,0x3f6d3ee8bf6dbee8,0x3f26bf35bf263f35,0x3ec4bf64bec43f64,0x3f68bec43ed63f6d,0x3f55bf063f0e3f5a,0xbed6bf6d3f68bec4,0xbf0ebf5a3f55bf06
.quad 0xbf4f3e9ebf4f3e9e,0x3f8000003f80,0x3f163f733f163f73,0x0,0x3d21bf73bf80be9e,0xbf3500003f35,0xbf80be9ebd213f73,0x3f3500003f35,0x3f433f4fbf43bf4f,0xa5540000248d,0x3f26bf16bf263f16,0xbf8000003f80,0xbf7b248dbe48bf80,0x3f350000bf35,0x3e483f80bf7b250d,0x3f3500003f35
.quad 0x3ee8bf4f3ee8bf4f,0xbf800000bf80,0xbf64bf16bf64bf16,0x250d0000250d,0x3ed63f733f68be9e,0x3f350000bf35,0x3f68be9ebed6bf73,0xbf350000bf35,0xbf79be9e3f793e9e,0x248d0000a554,0xbe6f3f733e6fbf73,0x3f800000bf80,0x3f49bf163f1e3f4f,0xbf3500003f35,0xbf1ebf4f3f49bf16,0xbf350000bf35
.quad 0xbf4f3e9ebf4f3e9e,0x0,0x3f163f733f163f73,0x0,0xbd213f733f803e9e,0x800000000000,0x3f803e9e3d21bf73,0x0,0x3f433f4fbf43bf4f,0x800000000000,0x3f26bf16bf263f16,0x800000000000,0x3f7ba5543e483f80,0x8000,0xbe48bf803f7b0000,0x0
.quad 0x3ee8bf4f3ee8bf4f,0x800000008000,0xbf64bf16bf64bf16,0x0,0xbed6bf73bf683e9e,0x8000,0xbf683e9e3ed63f73,0x800000008000,0xbf79be9e3f793e9e,0x8000,0xbe6f3f733e6fbf73,0x8000,0xbf493f16bf1ebf4f,0x800000000000,0x3f1e3f4fbf493f16,0x800000008000
.quad 0x3e9ebf4f3e9ebf4f,0x0,0xbf73bf16bf73bf16,0x0,0x3efa3f793f5fbe6f,0x800000000000,0x3f5fbe6fbefabf79,0x0,0xbf79bee83f793ee8,0x800000000000,0xbe6f3f643e6fbf64,0x800000000000,0x3f55bec43f0e3f6d,0x8000,0xbf0ebf6d3f55bec4,0x0
.quad 0xbe203f73be203f73,0x800000008000,0x3f7d3e9e3f7d3e9e,0x0,0xbf1ebf5abf493f06,0x8000,0xbf493f063f1e3f5a,0x800000008000,0x3f7f3e20bf7fbe20,0x8000,0x3da1bf7dbda13f7d,0x8000,0xbf3c3f26bf2ebf43,0x800000000000,0x3f2e3f43bf3c3f26,0x800000008000
.quad 0x3e9ebf4f3e9ebf4f,0x0,0xbf73bf16bf73bf16,0x0,0xbefabf79bf5f3e6f,0x800000000000,0xbf5f3e6f3efa3f79,0x0,0xbf79bee83f793ee8,0x800000000000,0xbe6f3f643e6fbf64,0x800000000000,0xbf553ec4bf0ebf6d,0x8000,0x3f0e3f6dbf553ec4,0x0
.quad 0xbe203f73be203f73,0x800000008000,0x3f7d3e9e3f7d3e9e,0x0,0x3f1e3f5a3f49bf06,0x8000,0x3f49bf06bf1ebf5a,0x800000008000,0x3f7f3e20bf7fbe20,0x8000,0x3da1bf7dbda13f7d,0x8000,0x3f3cbf263f2e3f43,0x800000000000,0xbf2ebf433f3cbf26,0x800000008000
.quad 0x248d3f80248d3f80,0x248d3f80248d3f80,0x3f8000003f800000,0x3f8000003f800000,0xbf80248dbd213f80,0xbf7bbe20be483f7d,0xbd213f803f800000,0xbe483f7d3f7b3e20,0x3da1bf80bda13f80,0x3ec4bf73bec43f73,0xbf7f250d3f7f0000,0xbf6dbe9e3f6d3e9e,0x3f7ea554bdf13f80,0x3f553ee8bf0e3f64,0x3df1bf803f7e0000,0x3f0ebf643f553ee8
.quad 0xbe203f80be203f80,0xbf353f4fbf353f4f,0x3f7d00003f7d0000,0x3f353f163f353f16,0xbf7b248dbe483f80,0xbf0ebf35bf553f35,0xbe483f803f7b0000,0xbf553f353f0e3f35,0x3e6fbf80be6f3f80,0x3f6dbf16bf6d3f16,0xbf79250d3f790000,0xbec4bf4f3ec43f4f,0x3f76a554be8b3f80,0x3e483f64bf7b3ee8,0x3e8bbf803f760000,0x3f7bbee83e483f64
.quad 0x248d3f80248d3f80,0x248d3f80248d3f80,0x3f8000003f800000,0x3f8000003f800000,0x3f80a5543d21bf80,0x3f7b3e203e48bf7d,0x3d21bf80bf80250d,0x3e48bf7dbf7bbe20,0x3da1bf80bda13f80,0x3ec4bf73bec43f73,0xbf7f250d3f7f0000,0xbf6dbe9e3f6d3e9e,0xbf7e248d3df1bf80,0xbf55bee83f0ebf64,0xbdf13f80bf7e250d,0xbf0e3f64bf55bee8
.quad 0xbe203f80be203f80,0xbf353f4fbf353f4f,0x3f7d00003f7d0000,0x3f353f163f353f16,0x3f7ba5543e48bf80,0x3f0e3f353f55bf35,0x3e48bf80bf7b250d,0x3f55bf35bf0ebf35,0x3e6fbf80be6f3f80,0x3f6dbf16bf6d3f16,0xbf79250d3f790000,0xbec4bf4f3ec43f4f,0xbf76248d3e8bbf80,0xbe48bf643f7bbee8,0xbe8b3f80bf76250d,0xbf7b3ee8be48bf64
.quad 0xa554bf80a554bf80,0xa554bf80a554bf80,0xbf80250dbf80250d,0xbf80250dbf80250d,0x3f7e3da13df1bf7f,0x3f763e6f3e8bbf79,0x3df1bf7fbf7ebda1,0x3e8bbf79bf76be6f,0xbe6f3f7d3e6fbf7d,0xbf063f643f06bf64,0x3f793e20bf79be20,0x3f5a3ee8bf5abee8,0xbf70be6f3eb1bf79,0xbf2ebf263f3cbf43,0xbeb13f79bf70be6f,0xbf3c3f43bf2ebf26
.quad 0x3ee8bf733ee8bf73,0x3f64bf163f64bf16,0xbf64be9ebf64be9e,0xbee8bf4fbee8bf4f,0x3f553ec43f0ebf6d,0x3e483f6d3f7bbec4,0x3f0ebf6dbf55bec4,0x3f7bbec4be48bf6d,0xbf263f643f26bf64,0xbf7f3e203f7fbe20,0x3f433ee8bf43bee8,0xbda13f7d3da1bf7d,0xbf2ebf063f3cbf5a,0x3eb1bf7f3f703da1,0xbf3c3f5abf2ebf06,0xbf70bda13eb1bf7f
.quad 0xa554bf80a554bf80,0xa554bf80a554bf80,0xbf80250dbf80250d,0xbf80250dbf80250d,0xbf7ebda1bdf13f7f,0xbf76be6fbe8b3f79,0xbdf13f7f3f7e3da1,0xbe8b3f793f763e6f,0xbe6f3f7d3e6fbf7d,0xbf063f643f06bf64,0x3f793e20bf79be20,0x3f5a3ee8bf5abee8,0x3f703e6fbeb13f79,0x3f2e3f26bf3c3f43,0x3eb1bf793f703e6f,0x3f3cbf433f2e3f26
.quad 0x3ee8bf733ee8bf73,0x3f64bf163f64bf16,0xbf64be9ebf64be9e,0xbee8bf4fbee8bf4f,0xbf55bec4bf0e3f6d,0xbe48bf6dbf7b3ec4,0xbf0e3f6d3f553ec4,0xbf7b3ec43e483f6d,0xbf263f643f26bf64,0xbf7f3e203f7fbe20,0x3f433ee8bf43bee8,0xbda13f7d3da1bf7d,0x3f2e3f06bf3c3f5a,0xbeb13f7fbf70bda1,0x3f3cbf5a3f2e3f06,0x3f703da1beb13f7f
.quad 0x248d3f80248d3f80,0x248d3f80248d3f80,0x3f8000003f800000,0x3f8000003f800000,0xbf70be9ebeb13f73,0xbf5fbee8befa3f64,0xbeb13f733f703e9e,0xbefa3f643f5f3ee8,0x3f26bf4fbf263f4f,0x3f5abf16bf5a3f16,0xbf43bf163f433f16,0xbf06bf4f3f063f4f,0x3efa3f4fbf5f3f16,0x3d213f7dbf803e20,0x3f5fbf163efa3f4f,0x3f80be203d213f7d
.quad 0xbf7d3e9ebf7d3e9e,0xbf64be9ebf64be9e,0x3e203f733e203f73,0xbee83f73bee83f73,0x3e48bf80bf7b248d,0x3f55bf35bf0ebf35,0xbf7b250dbe483f80,0xbf0ebf35bf553f35,0x3f5a3e9ebf5abe9e,0x3da13f73bda1bf73,0x3f06bf73bf063f73,0x3f7fbe9ebf7f3e9e,0xbf493f4fbf1ebf16,0xbf68be203ed6bf7d,0x3f1e3f16bf493f4f,0xbed63f7dbf68be20
.quad 0x248d3f80248d3f80,0x248d3f80248d3f80,0x3f8000003f800000,0x3f8000003f800000,0x3f703e9e3eb1bf73,0x3f5f3ee83efabf64,0x3eb1bf73bf70be9e,0x3efabf64bf5fbee8,0x3f26bf4fbf263f4f,0x3f5abf16bf5a3f16,0xbf43bf163f433f16,0xbf06bf4f3f063f4f,0xbefabf4f3f5fbf16,0xbd21bf7d3f80be20,0xbf5f3f16befabf4f,0xbf803e20bd21bf7d
.quad 0xbf7d3e9ebf7d3e9e,0xbf64be9ebf64be9e,0x3e203f733e203f73,0xbee83f73bee83f73,0xbe483f803f7ba554,0xbf553f353f0e3f35,0x3f7b00003e48bf80,0x3f0e3f353f55bf35,0x3f5a3e9ebf5abe9e,0x3da13f73bda1bf73,0x3f06bf73bf063f73,0x3f7fbe9ebf7f3e9e,0x3f49bf4f3f1e3f16,0x3f683e20bed63f7d,0xbf1ebf163f49bf4f,0x3ed6bf7d3f683e20
.quad 0xa554bf80a554bf80,0xa554bf80a554bf80,0xbf80250dbf80250d,0xbf80250dbf80250d,0x3f683ec43ed6bf6d,0x3f553f063f0ebf5a,0x3ed6bf6dbf68bec4,0x3f0ebf5abf55bf06,0xbf433f353f43bf35,0xbf6d3ee83f6dbee8,0x3f263f35bf26bf35,0x3ec43f64bec4bf64,0xbe8bbf6d3f76bec4,0x3e48bf7f3f7b3da1,0xbf763ec4be8bbf6d,0xbf7bbda13e48bf7f
.quad 0x3f7da5543f7da554,0x3f353f163f353f16,0x3e20bf803e20bf80,0x3f35bf4f3f35bf4f,0xbf0e3f6d3f553ec4,0xbf7b3ec43e483f6d,0x3f553ec43f0ebf6d,0x3e483f6d3f7bbec4,0xbf06bf353f063f35,0x3ec4bf7dbec43f7d,0xbf5a3f353f5abf35,0xbf6dbe203f6d3e20,0x3f7ebec43df13f6d,0x3f0e3f26bf553f43,0xbdf1bf6d3f7ebec4,0x3f55bf433f0e3f26
.quad 0xa554bf80a554bf80,0xa554bf80a554bf80,0xbf80250dbf80250d,0xbf80250dbf80250d,0xbf68bec4bed63f6d,0xbf55bf06bf0e3f5a,0xbed63f6d3f683ec4,0xbf0e3f5a3f553f06,0xbf433f353f43bf35,0xbf6d3ee83f6dbee8,0x3f263f35bf26bf35,0x3ec43f64bec4bf64,0x3e8b3f6dbf763ec4,0xbe483f7fbf7bbda1,0x3f76bec43e8b3f6d,0x3f7b3da1be483f7f
.quad 0x3f7da5543f7da554,0x3f353f163f353f16,0x3e20bf803e20bf80,0x3f35bf4f3f35bf4f,0x3f0ebf6dbf55bec4,0x3f7bbec4be48bf6d,0xbf55bec4bf0e3f6d,0xbe48bf6dbf7b3ec4,0xbf06bf353f063f35,0x3ec4bf7dbec43f7d,0xbf5a3f353f5abf35,0xbf6dbe203f6d3e20,0xbf7e3ec4bdf1bf6d,0xbf0ebf263f55bf43,0x3df13f6dbf7e3ec4,0xbf553f43bf0ebf26
.quad 0x248d3f80248d3f80,0x3f8000003f80,0x3f8000003f800000,0x0,0xbf49bf16bf1e3f4f,0xbf3500003f35,0xbf1e3f4f3f493f16,0x3f3500003f35,0x3f79be9ebf793e9e,0xa5540000248d,0xbe6fbf733e6f3f73,0xbf8000003f80,0xbed63f73bf68be9e,0x3f350000bf35,0x3f683e9ebed63f73,0x3f3500003f35
.quad 0xbee8bf4fbee8bf4f,0xbf800000bf80,0xbf643f16bf643f16,0x250d0000250d,0x3f7ba5543e48bf80,0x3f350000bf35,0x3e48bf80bf7b250d,0xbf350000bf35,0xbf433f4f3f43bf4f,0x248d0000a554,0x3f263f16bf26bf16,0x3f800000bf80,0xbd21bf733f80be9e,0xbf3500003f35,0xbf803e9ebd21bf73,0xbf350000bf35
.quad 0x248d3f80248d3f80,0x0,0x3f8000003f800000,0x0,0x3f493f163f1ebf4f,0x800000000000,0x3f1ebf4fbf49bf16,0x0,0x3f79be9ebf793e9e,0x800000000000,0xbe6fbf733e6f3f73,0x800000000000,0x3ed6bf733f683e9e,0x8000,0xbf68be9e3ed6bf73,0x0
.quad 0xbee8bf4fbee8bf4f,0x800000008000,0xbf643f16bf643f16,0x0,0xbf7b248dbe483f80,0x8000,0xbe483f803f7b0000,0x800000008000,0xbf433f4f3f43bf4f,0x8000,0x3f263f16bf26bf16,0x8000,0x3d213f73bf803e9e,0x800000000000,0x3f80be9e3d213f73,0x800000008000
.quad 0xa554bf80a554bf80,0x0,0xbf80250dbf80250d,0x0,0x3f3c3f263f2ebf43,0x800000000000,0x3f2ebf43bf3cbf26,0x0,0xbf7f3e203f7fbe20,0x800000000000,0x3da13f7dbda1bf7d,0x800000000000,0x3f1ebf5a3f493f06,0x8000,0xbf49bf063f1ebf5a,0x0
.quad 0x3e203f733e203f73,0x800000008000,0x3f7dbe9e3f7dbe9e,0x0,0xbf55bec4bf0e3f6d,0x8000,0xbf0e3f6d3f553ec4,0x800000008000,0x3f79bee8bf793ee8,0x8000,0xbe6fbf643e6f3f64,0x8000,0xbefa3f79bf5fbe6f,0x800000000000,0x3f5f3e6fbefa3f79,0x800000008000
.quad 0xa554bf80a554bf80,0x0,0xbf80250dbf80250d,0x0,0xbf3cbf26bf2e3f43,0x800000000000,0xbf2e3f433f3c3f26,0x0,0xbf7f3e203f7fbe20,0x800000000000,0x3da13f7dbda1bf7d,0x800000000000,0xbf1e3f5abf49bf06,0x8000,0x3f493f06bf1e3f5a,0x0
.quad 0x3e203f733e203f73,0x800000008000,0x3f7dbe9e3f7dbe9e,0x0,0x3f553ec43f0ebf6d,0x8000,0x3f0ebf6dbf55bec4,0x800000008000,0x3f79bee8bf793ee8,0x8000,0xbe6fbf643e6f3f64,0x8000,0x3efabf793f5f3e6f,0x800000000000,0xbf5fbe6f3efabf79,0x800000008000
.quad 0xbe9e3f80be9e3f80,0xbf803e9ebf803e9e,0x3f7300003f730000,0x250d3f73250d3f73,0xbf70248dbeb13f80,0x3e48bf7dbf7b3e20,0xbeb13f803f700000,0xbf7b3e20be483f7d,0x3ec4bf80bec43f80,0x3f6da554bf6d248d,0xbf6d250d3f6d0000,0x3ec4bf80bec43f80,0x3f68a554bed63f80,0xbf0e3f7dbf55be20,0x3ed6bf803f680000,0x3f553e20bf0e3f7d
.quad 0xbee83f80bee83f80,0xbf35be9ebf35be9e,0x3f6400003f640000,0xbf353f73bf353f73,0xbf5f248dbefa3f80,0x3f55bf64bf0ebee8,0xbefa3f803f5f0000,0xbf0ebee8bf553f64,0x3f06bf80bf063f80,0x3ec43f16bec4bf16,0xbf5a250d3f5a0000,0x3f6dbf4fbf6d3f4f,0x3f55a554bf0e3f80,0xbf7b3f35be48bf35,0x3f0ebf803f550000,0x3e483f35bf7b3f35
.quad 0xbe9e3f80be9e3f80,0xbf803e9ebf803e9e,0x3f7300003f730000,0x250d3f73250d3f73,0x3f70a5543eb1bf80,0xbe483f7d3f7bbe20,0x3eb1bf80bf70250d,0x3f7bbe203e48bf7d,0x3ec4bf80bec43f80,0x3f6da554bf6d248d,0xbf6d250d3f6d0000,0x3ec4bf80bec43f80,0xbf68248d3ed6bf80,0x3f0ebf7d3f553e20,0xbed63f80bf68250d,0xbf55be203f0ebf7d
.quad 0xbee83f80bee83f80,0xbf35be9ebf35be9e,0x3f6400003f640000,0xbf353f73bf353f73,0x3f5fa5543efabf80,0xbf553f643f0e3ee8,0x3efabf80bf5f250d,0x3f0e3ee83f55bf64,0x3f06bf80bf063f80,0x3ec43f16bec4bf16,0xbf5a250d3f5a0000,0x3f6dbf4fbf6d3f4f,0xbf55248d3f0ebf80,0x3f7bbf353e483f35,0xbf0e3f80bf55250d,0xbe48bf353f7bbf35
.quad 0x3f4fbf4f3f4fbf4f,0x3f4f3e9e3f4f3e9e,0xbf16bf16bf16bf16,0x3f16bf733f16bf73,0x3efa3f263f5fbf43,0xbf493f5a3f1e3f06,0x3f5fbf43befabf26,0x3f1e3f063f49bf5a,0xbf6d3f353f6dbf35,0xbec4bf353ec43f35,0x3ec43f35bec4bf35,0xbf6d3f353f6dbf35,0xbe8bbf433f76bf26,0x3f7ebf063df13f5a,0xbf763f26be8bbf43,0xbdf1bf5a3f7ebf06
.quad 0x3f7dbf163f7dbf16,0xbe203f73be203f73,0xbe20bf4fbe20bf4f,0x3f7dbe9e3f7dbe9e,0x3d213f5a3f80bf06,0xbf683da1bed63f7f,0x3f80bf06bd21bf5a,0xbed63f7f3f68bda1,0xbf7f3ee83f7fbee8,0x3f26bf7dbf263f7d,0xbda13f643da1bf64,0xbf43be203f433e20,0x3e48bf6d3f7bbec4,0x3f0e3ec4bf553f6d,0xbf7b3ec43e48bf6d,0x3f55bf6d3f0e3ec4
.quad 0x3f4fbf4f3f4fbf4f,0x3f4f3e9e3f4f3e9e,0xbf16bf16bf16bf16,0x3f16bf733f16bf73,0xbefabf26bf5f3f43,0x3f49bf5abf1ebf06,0xbf5f3f433efa3f26,0xbf1ebf06bf493f5a,0xbf6d3f353f6dbf35,0xbec4bf353ec43f35,0x3ec43f35bec4bf35,0xbf6d3f353f6dbf35,0x3e8b3f43bf763f26,0xbf7e3f06bdf1bf5a,0x3f76bf263e8b3f43,0x3df13f5abf7e3f06
.quad 0x3f7dbf163f7dbf16,0xbe203f73be203f73,0xbe20bf4fbe20bf4f,0x3f7dbe9e3f7dbe9e,0xbd21bf5abf803f06,0x3f68bda13ed6bf7f,0xbf803f063d213f5a,0x3ed6bf7fbf683da1,0xbf7f3ee83f7fbee8,0x3f26bf7dbf263f7d,0xbda13f643da1bf64,0xbf43be203f433e20,0xbe483f6dbf7b3ec4,0xbf0ebec43f55bf6d,0x3f7bbec4be483f6d,0xbf553f6dbf0ebec4
.quad 0xbe9ebf4fbe9ebf4f,0x3f4fbf4f3f4fbf4f,0xbf733f16bf733f16,0xbf16bf16bf16bf16,0x3f80be9e3d21bf73,0x3df13f643f7ebee8,0x3d21bf73bf803e9e,0x3f7ebee8bdf1bf64,0xbec43f803ec4bf80,0xbf6d248d3f6da554,0x3f6d0000bf6d250d,0xbec43f803ec4bf80,0xbf3cbe9e3f2ebf73,0x3f49bf643f1e3ee8,0xbf2e3f73bf3cbe9e,0xbf1ebee83f49bf64
.quad 0x3f64bf4f3f64bf4f,0x3e203f4f3e203f4f,0xbee8bf16bee8bf16,0x3f7dbf163f7dbf16,0x3df13f4f3f7ebf16,0xbf703e20beb13f7d,0x3f7ebf16bdf1bf4f,0xbeb13f7d3f70be20,0xbf793e9e3f79be9e,0x3f43bf73bf433f73,0xbe6f3f733e6fbf73,0xbf26be9e3f263e9e,0x3f0ebf803f55a554,0x3e483f35bf7b3f35,0xbf55250d3f0ebf80,0x3f7bbf353e483f35
.quad 0xbe9ebf4fbe9ebf4f,0x3f4fbf4f3f4fbf4f,0xbf733f16bf733f16,0xbf16bf16bf16bf16,0xbf803e9ebd213f73,0xbdf1bf64bf7e3ee8,0xbd213f733f80be9e,0xbf7e3ee83df13f64,0xbec43f803ec4bf80,0xbf6d248d3f6da554,0x3f6d0000bf6d250d,0xbec43f803ec4bf80,0x3f3c3e9ebf2e3f73,0xbf493f64bf1ebee8,0x3f2ebf733f3c3e9e,0x3f1e3ee8bf493f64
.quad 0x3f64bf4f3f64bf4f,0x3e203f4f3e203f4f,0xbee8bf16bee8bf16,0x3f7dbf163f7dbf16,0xbdf1bf4fbf7e3f16,0x3f70be203eb1bf7d,0xbf7e3f163df13f4f,0x3eb1bf7dbf703e20,0xbf793e9e3f79be9e,0x3f43bf73bf433f73,0xbe6f3f733e6fbf73,0xbf26be9e3f263e9e,0xbf0e3f80bf55248d,0xbe48bf353f7bbf35,0x3f550000bf0e3f80,0xbf7b3f35be48bf35
.quad 0xbe9e3f80be9e3f80,0xbf803e9ebf803e9e,0x3f7300003f730000,0x250d3f73250d3f73,0xbf3cbec4bf2e3f6d,0x3f0ebf79bf55be6f,0xbf2e3f6d3f3c3ec4,0xbf55be6fbf0e3f79,0x3f6dbf35bf6d3f35,0x3ec43f35bec4bf35,0xbec4bf353ec43f35,0x3f6dbf35bf6d3f35,0xbd213f6dbf803ec4,0xbf7b3e6f3e48bf79,0x3f80bec4bd213f6d,0xbe483f79bf7b3e6f
.quad 0xbf64248dbf64248d,0x3f35bf733f35bf73,0xbee83f80bee83f80,0xbf35be9ebf35be9e,0x3f49bf6dbf1ebec4,0x3e483f433f7bbf26,0xbf1ebec4bf493f6d,0x3f7bbf26be48bf43,0x3e6f3f35be6fbf35,0xbf6d3e203f6dbe20,0x3f79bf35bf793f35,0xbec43f7d3ec4bf7d,0xbf7b3ec43e48bf6d,0x3f55bf6d3f0e3ec4,0xbe483f6dbf7b3ec4,0xbf0ebec43f55bf6d
.quad 0xbe9e3f80be9e3f80,0xbf803e9ebf803e9e,0x3f7300003f730000,0x250d3f73250d3f73,0x3f3c3ec43f2ebf6d,0xbf0e3f793f553e6f,0x3f2ebf6dbf3cbec4,0x3f553e6f3f0ebf79,0x3f6dbf35bf6d3f35,0x3ec43f35bec4bf35,0xbec4bf353ec43f35,0x3f6dbf35bf6d3f35,0x3d21bf6d3f80bec4,0x3f7bbe6fbe483f79,0xbf803ec43d21bf6d,0x3e48bf793f7bbe6f
.quad 0xbf64248dbf64248d,0x3f35bf733f35bf73,0xbee83f80bee83f80,0xbf35be9ebf35be9e,0xbf493f6d3f1e3ec4,0xbe48bf43bf7b3f26,0x3f1e3ec43f49bf6d,0xbf7b3f263e483f43,0x3e6f3f35be6fbf35,0xbf6d3e203f6dbe20,0x3f79bf35bf793f35,0xbec43f7d3ec4bf7d,0x3f7bbec4be483f6d,0xbf553f6dbf0ebec4,0x3e48bf6d3f7bbec4,0x3f0e3ec4bf553f6d
.quad 0x3f4f3e9e3f4f3e9e,0x3f8000003f80,0x3f16bf733f16bf73,0x0,0xbf763f163e8b3f4f,0xbf3500003f35,0x3e8b3f4f3f76bf16,0x3f3500003f35,0x3ec4bf80bec43f80,0xa5540000248d,0xbf6d250d3f6d0000,0xbf8000003f80,0x3efa3f16bf5f3f4f,0x3f350000bf35,0x3f5fbf4f3efa3f16,0x3f3500003f35
.quad 0xbf7d3e9ebf7d3e9e,0xbf800000bf80,0xbe203f73be203f73,0x250d0000250d,0x3f3cbf73bf2ebe9e,0x3f350000bf35,0xbf2ebe9ebf3c3f73,0xbf350000bf35,0x3da13f4fbda1bf4f,0x248d0000a554,0x3f7fbf16bf7f3f16,0x3f800000bf80,0xbf55248d3f0ebf80,0xbf3500003f35,0xbf0e3f80bf55250d,0xbf350000bf35
.quad 0x3f4f3e9e3f4f3e9e,0x0,0x3f16bf733f16bf73,0x0,0x3f76bf16be8bbf4f,0x800000000000,0xbe8bbf4fbf763f16,0x0,0x3ec4bf80bec43f80,0x800000000000,0xbf6d250d3f6d0000,0x800000000000,0xbefabf163f5fbf4f,0x8000,0xbf5f3f4fbefabf16,0x0
.quad 0xbf7d3e9ebf7d3e9e,0x800000008000,0xbe203f73be203f73,0x0,0xbf3c3f733f2e3e9e,0x8000,0x3f2e3e9e3f3cbf73,0x800000008000,0x3da13f4fbda1bf4f,0x8000,0x3f7fbf16bf7f3f16,0x8000,0x3f55a554bf0e3f80,0x800000000000,0x3f0ebf803f550000,0x800000008000
.quad 0xbe9ebf4fbe9ebf4f,0x0,0xbf733f16bf733f16,0x0,0x3f683da13ed6bf7f,0x800000000000,0x3ed6bf7fbf68bda1,0x0,0xbf6d3f353f6dbf35,0x800000000000,0x3ec43f35bec4bf35,0x800000000000,0x3eb1bf7f3f70bda1,0x8000,0xbf703da13eb1bf7f,0x0
.quad 0x3ee83f163ee83f16,0x800000008000,0x3f64bf4f3f64bf4f,0x0,0xbf763e6fbe8b3f79,0x8000,0xbe8b3f793f76be6f,0x800000008000,0x3f5abf64bf5a3f64,0x8000,0xbf06bee83f063ee8,0x8000,0xbe483f6dbf7b3ec4,0x800000000000,0x3f7bbec4be483f6d,0x800000008000
.quad 0xbe9ebf4fbe9ebf4f,0x0,0xbf733f16bf733f16,0x0,0xbf68bda1bed63f7f,0x800000000000,0xbed63f7f3f683da1,0x0,0xbf6d3f353f6dbf35,0x800000000000,0x3ec43f35bec4bf35,0x800000000000,0xbeb13f7fbf703da1,0x8000,0x3f70bda1beb13f7f,0x0
.quad 0x3ee83f163ee83f16,0x800000008000,0x3f64bf4f3f64bf4f,0x0,0x3f76be6f3e8bbf79,0x8000,0x3e8bbf79bf763e6f,0x800000008000,0x3f5abf64bf5a3f64,0x8000,0xbf06bee83f063ee8,0x8000,0x3e48bf6d3f7bbec4,0x800000000000,0xbf7b3ec43e48bf6d,0x800000008000
.quad 0xbf163f80bf163f80,0xa554bf4fa554bf4f,0x3f4f00003f4f0000,0xbf803f16bf803f16,0xbf49248dbf1e3f80,0x3f7bbee83e48bf64,0xbf1e3f803f490000,0x3e48bf64bf7b3ee8,0x3f26bf80bf263f80,0xbec43f733ec4bf73,0xbf43250d3f430000,0x3f6dbe9ebf6d3e9e,0x3f3ca554bf2e3f80,0xbf553e203f0ebf7d,0x3f2ebf803f3c0000,0xbf0e3f7dbf553e20
.quad 0xbf353f80bf353f80,0x3f35bf803f35bf80,0x3f3500003f350000,0xbf35250dbf35250d,0xbf2e248dbf3c3f80,0x3f0e3e203f55bf7d,0xbf3c3f803f2e0000,0x3f55bf7dbf0ebe20,0x3f43bf80bf433f80,0xbf6d3f733f6dbf73,0xbf26250d3f260000,0x3ec43e9ebec4be9e,0x3f1ea554bf493f80,0xbe48bee83f7bbf64,0x3f49bf803f1e0000,0xbf7b3f64be48bee8
.quad 0xbf163f80bf163f80,0xa554bf4fa554bf4f,0x3f4f00003f4f0000,0xbf803f16bf803f16,0x3f49a5543f1ebf80,0xbf7b3ee8be483f64,0x3f1ebf80bf49250d,0xbe483f643f7bbee8,0x3f26bf80bf263f80,0xbec43f733ec4bf73,0xbf43250d3f430000,0x3f6dbe9ebf6d3e9e,0xbf3c248d3f2ebf80,0x3f55be20bf0e3f7d,0xbf2e3f80bf3c250d,0x3f0ebf7d3f55be20
.quad 0xbf353f80bf353f80,0x3f35bf803f35bf80,0x3f3500003f350000,0xbf35250dbf35250d,0x3f2ea5543f3cbf80,0xbf0ebe20bf553f7d,0x3f3cbf80bf2e250d,0xbf553f7d3f0e3e20,0x3f43bf80bf433f80,0xbf6d3f733f6dbf73,0xbf26250d3f260000,0x3ec43e9ebec4be9e,0xbf1e248d3f49bf80,0x3e483ee8bf7b3f64,0xbf493f80bf1e250d,0x3f7bbf643e483ee8
.quad 0x3f73be9e3f73be9e,0xbf733f4fbf733f4f,0x3e9ebf733e9ebf73,0x3e9e3f163e9e3f16,0xbed63f793f68be6f,0xbd21bf43bf803f26,0x3f68be6f3ed6bf79,0xbf803f263d213f43,0xbf5a3e203f5abe20,0x3f79bee8bf793ee8,0xbf063f7d3f06bf7d,0x3e6fbf64be6f3f64,0x3f1ebf7f3f49bda1,0xbefa3f79bf5f3e6f,0xbf493da13f1ebf7f,0x3f5fbe6fbefa3f79
.quad 0x3f35a5543f35a554,0xbf35248dbf35248d,0x3f35bf803f35bf80,0xbf353f80bf353f80,0xbf493f7f3f1e3da1,0x3f5fbf79befabe6f,0x3f1e3da13f49bf7f,0xbefabe6fbf5f3f79,0xbf06be203f063e20,0x3e6f3ee8be6fbee8,0xbf5a3f7d3f5abf7d,0x3f79bf64bf793f64,0x3f68bf793ed63e6f,0xbf803f433d21bf26,0xbed6be6f3f68bf79,0xbd213f26bf803f43
.quad 0x3f73be9e3f73be9e,0xbf733f4fbf733f4f,0x3e9ebf733e9ebf73,0x3e9e3f163e9e3f16,0x3ed6bf79bf683e6f,0x3d213f433f80bf26,0xbf683e6fbed63f79,0x3f80bf26bd21bf43,0xbf5a3e203f5abe20,0x3f79bee8bf793ee8,0xbf063f7d3f06bf7d,0x3e6fbf64be6f3f64,0xbf1e3f7fbf493da1,0x3efabf793f5fbe6f,0x3f49bda1bf1e3f7f,0xbf5f3e6f3efabf79
.quad 0x3f35a5543f35a554,0xbf35248dbf35248d,0x3f35bf803f35bf80,0xbf353f80bf353f80,0x3f49bf7fbf1ebda1,0xbf5f3f793efa3e6f,0xbf1ebda1bf493f7f,0x3efa3e6f3f5fbf79,0xbf06be203f063e20,0x3e6f3ee8be6fbee8,0xbf5a3f7d3f5abf7d,0x3f79bf64bf793f64,0xbf683f79bed6be6f,0x3f80bf43bd213f26,0x3ed63e6fbf683f79,0x3d21bf263f80bf43
.quad 0x3f163e9e3f163e9e,0xbf733e9ebf733e9e,0x3f4fbf733f4fbf73,0xbe9e3f73be9e3f73,0xbf763f4f3e8b3f16,0x3f3cbf7dbf2ebe20,0x3e8b3f163f76bf4f,0xbf2ebe20bf3c3f7d,0x3da1bf4fbda13f4f,0x3e6f3f16be6fbf16,0xbf7f3f163f7fbf16,0x3f79bf4fbf793f4f,0x3f68be9ebed63f73,0xbf763ee83e8bbf64,0x3ed6bf733f68be9e,0xbe8b3f64bf763ee8
.quad 0xbf353f80bf353f80,0x3f35bf803f35bf80,0x3f3500003f350000,0xbf35250dbf35250d,0xbed6be9ebf683f73,0x3e8b3ee83f76bf64,0xbf683f733ed63e9e,0x3f76bf64be8bbee8,0x3f7fbf4fbf7f3f4f,0xbf793f163f79bf16,0xbda1bf163da13f16,0xbe6f3f4f3e6fbf4f,0xbe8b3f4fbf763f16,0x3f2ebf7d3f3cbe20,0x3f76bf16be8b3f4f,0xbf3c3e203f2ebf7d
.quad 0x3f163e9e3f163e9e,0xbf733e9ebf733e9e,0x3f4fbf733f4fbf73,0xbe9e3f73be9e3f73,0x3f76bf4fbe8bbf16,0xbf3c3f7d3f2e3e20,0xbe8bbf16bf763f4f,0x3f2e3e203f3cbf7d,0x3da1bf4fbda13f4f,0x3e6f3f16be6fbf16,0xbf7f3f163f7fbf16,0x3f79bf4fbf793f4f,0xbf683e9e3ed6bf73,0x3f76bee8be8b3f64,0xbed63f73bf683e9e,0x3e8bbf643f76bee8
.quad 0xbf353f80bf353f80,0x3f35bf803f35bf80,0x3f3500003f350000,0xbf35250dbf35250d,0x3ed63e9e3f68bf73,0xbe8bbee8bf763f64,0x3f68bf73bed6be9e,0xbf763f643e8b3ee8,0x3f7fbf4fbf7f3f4f,0xbf793f163f79bf16,0xbda1bf163da13f16,0xbe6f3f4f3e6fbf4f,0x3e8bbf4f3f76bf16,0xbf2e3f7dbf3c3e20,0xbf763f163e8bbf4f,0x3f3cbe20bf2e3f7d
.quad 0x3f16bf803f16bf80,0x248d3f4f248d3f4f,0xbf4f250dbf4f250d,0x3f80bf163f80bf16,0x3efa3ec43f5fbf6d,0xbf553da1bf0e3f7f,0x3f5fbf6dbefabec4,0xbf0e3f7f3f55bda1,0xbf7f3f353f7fbf35,0x3f6dbf64bf6d3f64,0x3da13f35bda1bf35,0xbec4bee83ec43ee8,0x3eb1bf6d3f70bec4,0xbe483f5abf7b3f06,0xbf703ec43eb1bf6d,0x3f7bbf06be483f5a
.quad 0x3f35a5543f35a554,0xbf35248dbf35248d,0x3f35bf803f35bf80,0xbf353f80bf353f80,0xbf703f6d3eb13ec4,0x3f7bbf5abe48bf06,0x3eb13ec43f70bf6d,0xbe48bf06bf7b3f5a,0x3da1bf35bda13f35,0xbec43f643ec4bf64,0xbf7f3f353f7fbf35,0x3f6dbee8bf6d3ee8,0x3f5fbec4befa3f6d,0xbf0ebda13f55bf7f,0x3efabf6d3f5fbec4,0xbf553f7fbf0ebda1
.quad 0x3f16bf803f16bf80,0x248d3f4f248d3f4f,0xbf4f250dbf4f250d,0x3f80bf163f80bf16,0xbefabec4bf5f3f6d,0x3f55bda13f0ebf7f,0xbf5f3f6d3efa3ec4,0x3f0ebf7fbf553da1,0xbf7f3f353f7fbf35,0x3f6dbf64bf6d3f64,0x3da13f35bda1bf35,0xbec4bee83ec43ee8,0xbeb13f6dbf703ec4,0x3e48bf5a3f7bbf06,0x3f70bec4beb13f6d,0xbf7b3f063e48bf5a
.quad 0x3f35a5543f35a554,0xbf35248dbf35248d,0x3f35bf803f35bf80,0xbf353f80bf353f80,0x3f70bf6dbeb1bec4,0xbf7b3f5a3e483f06,0xbeb1bec4bf703f6d,0x3e483f063f7bbf5a,0x3da1bf35bda13f35,0xbec43f643ec4bf64,0xbf7f3f353f7fbf35,0x3f6dbee8bf6d3ee8,0xbf5f3ec43efabf6d,0x3f0e3da1bf553f7f,0xbefa3f6dbf5f3ec4,0x3f55bf7f3f0e3da1
.quad 0x3f73bf4f3f73bf4f,0x3f8000003f80,0xbe9ebf16be9ebf16,0x0,0xbeb13f733f70be9e,0xbf3500003f35,0x3f70be9e3eb1bf73,0x3f3500003f35,0xbf06be9e3f063e9e,0xa5540000248d,0xbf5a3f733f5abf73,0xbf8000003f80,0x3f7ebf16bdf13f4f,0x3f350000bf35,0x3df1bf4f3f7ebf16,0x3f3500003f35
.quad 0xbf353f80bf353f80,0xbf800000bf80,0x3f3500003f350000,0x250d0000250d,0xbdf1bf16bf7e3f4f,0x3f350000bf35,0xbf7e3f4f3df13f16,0xbf350000bf35,0x3f5abe9ebf5a3e9e,0x248d0000a554,0x3f06bf73bf063f73,0x3f800000bf80,0xbf703f73beb1be9e,0xbf3500003f35,0x3eb13e9ebf703f73,0xbf350000bf35
.quad 0x3f73bf4f3f73bf4f,0x0,0xbe9ebf16be9ebf16,0x0,0x3eb1bf73bf703e9e,0x800000000000,0xbf703e9ebeb13f73,0x0,0xbf06be9e3f063e9e,0x800000000000,0xbf5a3f733f5abf73,0x800000000000,0xbf7e3f163df1bf4f,0x8000,0xbdf13f4fbf7e3f16,0x0
.quad 0xbf353f80bf353f80,0x800000008000,0x3f3500003f350000,0x0,0x3df13f163f7ebf4f,0x8000,0x3f7ebf4fbdf1bf16,0x800000008000,0x3f5abe9ebf5a3e9e,0x8000,0x3f06bf73bf063f73,0x8000,0x3f70bf733eb13e9e,0x800000000000,0xbeb1be9e3f70bf73,0x800000008000
.quad 0xbf16be9ebf16be9e,0x0,0xbf4f3f73bf4f3f73,0x0,0x3f7ebf063df1bf5a,0x800000000000,0x3df1bf5abf7e3f06,0x0,0xbf433f7d3f43bf7d,0x800000000000,0x3f263e20bf26be20,0x800000000000,0x3d21bf433f80bf26,0x8000,0xbf803f263d21bf43,0x0
.quad 0x3f35a5543f35a554,0x800000008000,0x3f35bf803f35bf80,0x0,0xbf803f433d213f26,0x8000,0x3d213f263f80bf43,0x800000008000,0x3f26bf7dbf263f7d,0x8000,0xbf433e203f43be20,0x8000,0x3df13f06bf7e3f5a,0x800000000000,0x3f7ebf5a3df13f06,0x800000008000
.quad 0xbf16be9ebf16be9e,0x0,0xbf4f3f73bf4f3f73,0x0,0xbf7e3f06bdf13f5a,0x800000000000,0xbdf13f5a3f7ebf06,0x0,0xbf433f7d3f43bf7d,0x800000000000,0x3f263e20bf26be20,0x800000000000,0xbd213f43bf803f26,0x8000,0x3f80bf26bd213f43,0x0
.quad 0x3f35a5543f35a554,0x800000008000,0x3f35bf803f35bf80,0x0,0x3f80bf43bd21bf26,0x8000,0xbd21bf26bf803f43,0x800000008000,0x3f26bf7dbf263f7d,0x8000,0xbf433e203f43be20,0x8000,0xbdf1bf063f7ebf5a,0x800000000000,0xbf7e3f5abdf1bf06,0x800000008000
.quad 0xbf4f3f80bf4f3f80,0x3f80bf4f3f80bf4f,0x3f1600003f160000,0xbf160000bf16,0xbf0e248dbf553f80,0xbe483f353f7bbf35,0xbf553f803f0e0000,0x3f7bbf353e48bf35,0x3f5abf80bf5a3f80,0xbf6d3f163f6dbf16,0xbf06250d3f060000,0xbec43f4f3ec4bf4f,0x3efaa554bf5f3f80,0x3f0ebf643f55bee8,0x3f5fbf803efa0000,0xbf553ee83f0ebf64
.quad 0xbf643f80bf643f80,0x3f35be9e3f35be9e,0x3ee800003ee80000,0x3f35bf733f35bf73,0xbed6248dbf683f80,0xbf553f7d3f0ebe20,0xbf683f803ed60000,0x3f0ebe203f55bf7d,0x3f6dbf80bf6d3f80,0xbec4248d3ec4a554,0xbec4250d3ec40000,0xbf6d3f803f6dbf80,0x3eb1a554bf703f80,0x3f7bbf7d3e483e20,0x3f70bf803eb10000,0xbe48be203f7bbf7d
.quad 0xbf4f3f80bf4f3f80,0x3f80bf4f3f80bf4f,0x3f1600003f160000,0xbf160000bf16,0x3f0ea5543f55bf80,0x3e48bf35bf7b3f35,0x3f55bf80bf0e250d,0xbf7b3f35be483f35,0x3f5abf80bf5a3f80,0xbf6d3f163f6dbf16,0xbf06250d3f060000,0xbec43f4f3ec4bf4f,0xbefa248d3f5fbf80,0xbf0e3f64bf553ee8,0xbf5f3f80befa250d,0x3f55bee8bf0e3f64
.quad 0xbf643f80bf643f80,0x3f35be9e3f35be9e,0x3ee800003ee80000,0x3f35bf733f35bf73,0x3ed6a5543f68bf80,0x3f55bf7dbf0e3e20,0x3f68bf80bed6250d,0xbf0e3e20bf553f7d,0x3f6dbf80bf6d3f80,0xbec4248d3ec4a554,0xbec4250d3ec40000,0xbf6d3f803f6dbf80,0xbeb1248d3f70bf80,0xbf7b3f7dbe48be20,0xbf703f80beb1250d,0x3e483e20bf7b3f7d
.quad 0x3e9e3e9e3e9e3e9e,0x3e9ebf4f3e9ebf4f,0x3f73bf733f73bf73,0xbf733f16bf733f16,0xbf7b3f6d3e483ec4,0x3f55bec43f0ebf6d,0x3e483ec43f7bbf6d,0x3f0ebf6dbf553ec4,0xbda1bee83da13ee8,0xbf433f7d3f43bf7d,0xbf7f3f643f7fbf64,0x3f26be20bf263e20,0x3f80bf5abd213f06,0xbed6bda13f68bf7f,0x3d21bf063f80bf5a,0xbf683f7fbed6bda1
.quad 0xbe203f16be203f16,0x3f7dbf733f7dbf73,0x3f7dbf4f3f7dbf4f,0xbe20be9ebe20be9e,0xbf763f43be8b3f26,0xbdf13f063f7ebf5a,0xbe8b3f263f76bf43,0x3f7ebf5a3df1bf06,0x3ec4bf35bec43f35,0xbf6d3f353f6dbf35,0xbf6d3f353f6dbf35,0xbec43f353ec4bf35,0x3f5fbf26befa3f43,0x3f1ebf5a3f49bf06,0x3efabf433f5fbf26,0xbf493f063f1ebf5a
.quad 0x3e9e3e9e3e9e3e9e,0x3e9ebf4f3e9ebf4f,0x3f73bf733f73bf73,0xbf733f16bf733f16,0x3f7bbf6dbe48bec4,0xbf553ec4bf0e3f6d,0xbe48bec4bf7b3f6d,0xbf0e3f6d3f55bec4,0xbda1bee83da13ee8,0xbf433f7d3f43bf7d,0xbf7f3f643f7fbf64,0x3f26be20bf263e20,0xbf803f5a3d21bf06,0x3ed63da1bf683f7f,0xbd213f06bf803f5a,0x3f68bf7f3ed63da1
.quad 0xbe203f16be203f16,0x3f7dbf733f7dbf73,0x3f7dbf4f3f7dbf4f,0xbe20be9ebe20be9e,0x3f76bf433e8bbf26,0x3df1bf06bf7e3f5a,0x3e8bbf26bf763f43,0xbf7e3f5abdf13f06,0x3ec4bf35bec43f35,0xbf6d3f353f6dbf35,0xbf6d3f353f6dbf35,0xbec43f353ec4bf35,0xbf5f3f263efabf43,0xbf1e3f5abf493f06,0xbefa3f43bf5f3f26,0x3f49bf06bf1e3f5a
.quad 0xbf4f3e9ebf4f3e9e,0x3e9e3e9e3e9e3e9e,0xbf163f73bf163f73,0x3f73bf733f73bf73,0x3f55bf80bf0e248d,0xbf7b3f35be483f35,0xbf0e250dbf553f80,0xbe483f353f7bbf35,0x3e6f3e9ebe6fbe9e,0x3f26bf73bf263f73,0x3f79bf73bf793f73,0xbf433e9e3f43be9e,0xbf7e3f4f3df1bf16,0x3eb13e20bf703f7d,0xbdf13f16bf7e3f4f,0x3f70bf7d3eb13e20
.quad 0x3ee8bf4f3ee8bf4f,0xbf7d3f4fbf7d3f4f,0xbf643f16bf643f16,0xbe203f16be203f16,0x3f2ebe9e3f3cbf73,0x3f1ebf64bf493ee8,0x3f3cbf73bf2e3e9e,0xbf493ee8bf1e3f64,0xbf6d3f803f6dbf80,0x3ec4a554bec4248d,0x3ec40000bec4250d,0x3f6dbf80bf6d3f80,0xbd21be9e3f80bf73,0xbf7e3f643df1bee8,0xbf803f73bd21be9e,0xbdf13ee8bf7e3f64
.quad 0xbf4f3e9ebf4f3e9e,0x3e9e3e9e3e9e3e9e,0xbf163f73bf163f73,0x3f73bf733f73bf73,0xbf553f803f0ea554,0x3f7bbf353e48bf35,0x3f0e00003f55bf80,0x3e48bf35bf7b3f35,0x3e6f3e9ebe6fbe9e,0x3f26bf73bf263f73,0x3f79bf73bf793f73,0xbf433e9e3f43be9e,0x3f7ebf4fbdf13f16,0xbeb1be203f70bf7d,0x3df1bf163f7ebf4f,0xbf703f7dbeb1be20
.quad 0x3ee8bf4f3ee8bf4f,0xbf7d3f4fbf7d3f4f,0xbf643f16bf643f16,0xbe203f16be203f16,0xbf2e3e9ebf3c3f73,0xbf1e3f643f49bee8,0xbf3c3f733f2ebe9e,0x3f49bee83f1ebf64,0xbf6d3f803f6dbf80,0x3ec4a554bec4248d,0x3ec40000bec4250d,0x3f6dbf80bf6d3f80,0x3d213e9ebf803f73,0x3f7ebf64bdf13ee8,0x3f80bf733d213e9e,0x3df1bee83f7ebf64
.quad 0xbf4f3f80bf4f3f80,0x3f80bf4f3f80bf4f,0x3f1600003f160000,0xbf160000bf16,0xbe48bec4bf7b3f6d,0xbf0e3f6d3f55bec4,0xbf7b3f6d3e483ec4,0x3f55bec43f0ebf6d,0x3f79bf35bf793f35,0xbec4be203ec43e20,0x3e6fbf35be6f3f35,0xbf6d3f7d3f6dbf7d,0xbf1e3f6dbf493ec4,0x3f7bbf43be483f26,0x3f49bec4bf1e3f6d,0x3e48bf263f7bbf43
.quad 0xbee8248dbee8248d,0xbf353f73bf353f73,0xbf643f80bf643f80,0x3f35be9e3f35be9e,0x3f80bf6dbd21bec4,0xbe48be6fbf7b3f79,0xbd21bec4bf803f6d,0xbf7b3f793e483e6f,0xbec43f353ec4bf35,0x3f6dbf35bf6d3f35,0x3f6dbf35bf6d3f35,0x3ec4bf35bec43f35,0xbf2e3ec43f3cbf6d,0xbf553f79bf0e3e6f,0xbf3c3f6dbf2e3ec4,0x3f0ebe6fbf553f79
.quad 0xbf4f3f80bf4f3f80,0x3f80bf4f3f80bf4f,0x3f1600003f160000,0xbf160000bf16,0x3e483ec43f7bbf6d,0x3f0ebf6dbf553ec4,0x3f7bbf6dbe48bec4,0xbf553ec4bf0e3f6d,0x3f79bf35bf793f35,0xbec4be203ec43e20,0x3e6fbf35be6f3f35,0xbf6d3f7d3f6dbf7d,0x3f1ebf6d3f49bec4,0xbf7b3f433e48bf26,0xbf493ec43f1ebf6d,0xbe483f26bf7b3f43
.quad 0xbee8248dbee8248d,0xbf353f73bf353f73,0xbf643f80bf643f80,0x3f35be9e3f35be9e,0xbf803f6d3d213ec4,0x3e483e6f3f7bbf79,0x3d213ec43f80bf6d,0x3f7bbf79be48be6f,0xbec43f353ec4bf35,0x3f6dbf35bf6d3f35,0x3f6dbf35bf6d3f35,0x3ec4bf35bec43f35,0x3f2ebec4bf3c3f6d,0x3f55bf793f0ebe6f,0x3f3cbf6d3f2ebec4,0xbf0e3e6f3f55bf79
.quad 0x3e9ebf4f3e9ebf4f,0x3f8000003f80,0xbf733f16bf733f16,0x0,0x3f0ea5543f55bf80,0xbf3500003f35,0x3f55bf80bf0e250d,0x3f3500003f35,0xbf7f3f4f3f7fbf4f,0xa5540000248d,0xbda13f163da1bf16,0xbf8000003f80,0x3f2ebf733f3cbe9e,0x3f350000bf35,0xbf3c3e9e3f2ebf73,0x3f3500003f35
.quad 0x3e203e9e3e203e9e,0xbf800000bf80,0x3f7dbf733f7dbf73,0x250d0000250d,0xbf5f3f16befa3f4f,0x3f350000bf35,0xbefa3f4f3f5fbf16,0xbf350000bf35,0x3f6dbf80bf6d3f80,0x248d0000a554,0xbec4250d3ec40000,0x3f800000bf80,0xbe8b3f16bf763f4f,0xbf3500003f35,0x3f76bf4fbe8b3f16,0xbf350000bf35
.quad 0x3e9ebf4f3e9ebf4f,0x0,0xbf733f16bf733f16,0x0,0xbf0e248dbf553f80,0x800000000000,0xbf553f803f0e0000,0x0,0xbf7f3f4f3f7fbf4f,0x800000000000,0xbda13f163da1bf16,0x800000000000,0xbf2e3f73bf3c3e9e,0x8000,0x3f3cbe9ebf2e3f73,0x0
.quad 0x3e203e9e3e203e9e,0x800000008000,0x3f7dbf733f7dbf73,0x0,0x3f5fbf163efabf4f,0x8000,0x3efabf4fbf5f3f16,0x800000008000,0x3f6dbf80bf6d3f80,0x8000,0xbec4250d3ec40000,0x8000,0x3e8bbf163f76bf4f,0x800000000000,0xbf763f4f3e8bbf16,0x800000008000
.quad 0xbf4f3e9ebf4f3e9e,0x0,0xbf163f73bf163f73,0x0,0x3f7bbf6dbe48bec4,0x800000000000,0xbe48bec4bf7b3f6d,0x0,0xbf063f643f06bf64,0x800000000000,0x3f5abee8bf5a3ee8,0x800000000000,0xbe8bbe6f3f76bf79,0x8000,0xbf763f79be8bbe6f,0x0
.quad 0x3f64bf163f64bf16,0x800000008000,0x3ee8bf4f3ee8bf4f,0x0,0xbf703f7f3eb13da1,0x8000,0x3eb13da13f70bf7f,0x800000008000,0x3ec4bf35bec43f35,0x8000,0xbf6d3f353f6dbf35,0x8000,0x3ed6bda1bf683f7f,0x800000000000,0x3f68bf7f3ed6bda1,0x800000008000
.quad 0xbf4f3e9ebf4f3e9e,0x0,0xbf163f73bf163f73,0x0,0xbf7b3f6d3e483ec4,0x800000000000,0x3e483ec43f7bbf6d,0x0,0xbf063f643f06bf64,0x800000000000,0x3f5abee8bf5a3ee8,0x800000000000,0x3e8b3e6fbf763f79,0x8000,0x3f76bf793e8b3e6f,0x0
.quad 0x3f64bf163f64bf16,0x800000008000,0x3ee8bf4f3ee8bf4f,0x0,0x3f70bf7fbeb1bda1,0x8000,0xbeb1bda1bf703f7f,0x800000008000,0x3ec4bf35bec43f35,0x8000,0xbf6d3f353f6dbf35,0x8000,0xbed63da13f68bf7f,0x800000000000,0xbf683f7fbed63da1,0x800000008000
.quad 0xbf733f80bf733f80,0x248d3e9e248d3e9e,0x3e9e00003e9e0000,0x3f80bf733f80bf73,0xbe8b248dbf763f80,0xbf7b3f64be483ee8,0xbf763f803e8b0000,0xbe483ee83f7bbf64,0x3f79bf80bf793f80,0x3ec4bf16bec43f16,0xbe6f250d3e6f0000,0xbf6d3f4f3f6dbf4f,0x3e48a554bf7b3f80,0x3f55bf35bf0e3f35,0x3f7bbf803e480000,0x3f0ebf353f55bf35
.quad 0xbf7d3f80bf7d3f80,0xbf353f4fbf353f4f,0x3e2000003e200000,0x3f35bf163f35bf16,0xbdf1248dbf7e3f80,0xbf0e3ee8bf553f64,0xbf7e3f803df10000,0xbf553f643f0ebee8,0x3f7fbf80bf7f3f80,0x3f6dbf73bf6d3f73,0xbda1250d3da10000,0xbec43e9e3ec4be9e,0x3d21a554bf803f80,0x3e48be20bf7b3f7d,0x3f80bf803d210000,0x3f7bbf7d3e48be20
.quad 0xbf733f80bf733f80,0x248d3e9e248d3e9e,0x3e9e00003e9e0000,0x3f80bf733f80bf73,0x3e8ba5543f76bf80,0x3f7bbf643e48bee8,0x3f76bf80be8b250d,0x3e48bee8bf7b3f64,0x3f79bf80bf793f80,0x3ec4bf16bec43f16,0xbe6f250d3e6f0000,0xbf6d3f4f3f6dbf4f,0xbe48248d3f7bbf80,0xbf553f353f0ebf35,0xbf7b3f80be48250d,0xbf0e3f35bf553f35
.quad 0xbf7d3f80bf7d3f80,0xbf353f4fbf353f4f,0x3e2000003e200000,0x3f35bf163f35bf16,0x3df1a5543f7ebf80,0x3f0ebee83f55bf64,0x3f7ebf80bdf1250d,0x3f55bf64bf0e3ee8,0x3f7fbf80bf7f3f80,0x3f6dbf73bf6d3f73,0xbda1250d3da10000,0xbec43e9e3ec4be9e,0xbd21248d3f80bf80,0xbe483e203f7bbf7d,0xbf803f80bd21250d,0xbf7b3f7dbe483e20
.quad 0xbf163f4fbf163f4f,0x3f16be9e3f16be9e,0x3f4fbf163f4fbf16,0x3f4fbf733f4fbf73,0xbf3c3f06bf2e3f5a,0xbf703f7f3eb1bda1,0xbf2e3f5a3f3cbf06,0x3eb1bda13f70bf7f,0x3f43bf64bf433f64,0xbda1be203da13e20,0xbf263ee83f26bee8,0xbf7f3f7d3f7fbf7d,0x3f0ebec4bf553f6d,0x3f7bbf6dbe483ec4,0x3f55bf6d3f0ebec4,0x3e48bec43f7bbf6d
.quad 0xbf643f73bf643f73,0xbee83f16bee83f16,0x3ee8be9e3ee8be9e,0x3f64bf4f3f64bf4f,0xbeb13e6fbf703f79,0xbf3c3f26bf2e3f43,0xbf703f793eb1be6f,0xbf2e3f433f3cbf26,0x3f79bf7dbf793f7d,0x3f5abf64bf5a3f64,0xbe6f3e203e6fbe20,0xbf063ee83f06bee8,0x3df1bda1bf7e3f7f,0x3e8bbe6fbf763f79,0x3f7ebf7f3df1bda1,0x3f76bf793e8bbe6f
.quad 0xbf163f4fbf163f4f,0x3f16be9e3f16be9e,0x3f4fbf163f4fbf16,0x3f4fbf733f4fbf73,0x3f3cbf063f2ebf5a,0x3f70bf7fbeb13da1,0x3f2ebf5abf3c3f06,0xbeb13da1bf703f7f,0x3f43bf64bf433f64,0xbda1be203da13e20,0xbf263ee83f26bee8,0xbf7f3f7d3f7fbf7d,0xbf0e3ec43f55bf6d,0xbf7b3f6d3e48bec4,0xbf553f6dbf0e3ec4,0xbe483ec4bf7b3f6d
.quad 0xbf643f73bf643f73,0xbee83f16bee83f16,0x3ee8be9e3ee8be9e,0x3f64bf4f3f64bf4f,0x3eb1be6f3f70bf79,0x3f3cbf263f2ebf43,0x3f70bf79beb13e6f,0x3f2ebf43bf3c3f26,0x3f79bf7dbf793f7d,0x3f5abf64bf5a3f64,0xbe6f3e203e6fbe20,0xbf063ee83f06bee8,0xbdf13da13f7ebf7f,0xbe8b3e6f3f76bf79,0xbf7e3f7fbdf13da1,0xbf763f79be8b3e6f
.quad 0x3f73bf4f3f73bf4f,0x3f16bf4f3f16bf4f,0x3e9ebf163e9ebf16,0xbf4f3f16bf4f3f16,0xbf1e3f4f3f49bf16,0x3ed6be203f68bf7d,0x3f49bf163f1ebf4f,0x3f68bf7dbed63e20,0xbf063e9e3f06be9e,0xbf7f3f733f7fbf73,0xbf5a3f733f5abf73,0xbda13e9e3da1be9e,0x3f7bbf803e48a554,0x3f0ebf353f55bf35,0xbe48250d3f7bbf80,0xbf553f353f0ebf35
.quad 0xbe203e9ebe203e9e,0x3ee8be9e3ee8be9e,0x3f7dbf733f7dbf73,0x3f64bf733f64bf73,0xbf5f3f4fbefa3f16,0xbf803f7dbd213e20,0xbefa3f163f5fbf4f,0xbd213e203f80bf7d,0x3f43bf4fbf433f4f,0x3f06bf16bf063f16,0xbf263f163f26bf16,0xbf5a3f4f3f5abf4f,0x3eb1be9ebf703f73,0x3efabee8bf5f3f64,0x3f70bf733eb1be9e,0x3f5fbf643efabee8
.quad 0x3f73bf4f3f73bf4f,0x3f16bf4f3f16bf4f,0x3e9ebf163e9ebf16,0xbf4f3f16bf4f3f16,0x3f1ebf4fbf493f16,0xbed63e20bf683f7d,0xbf493f16bf1e3f4f,0xbf683f7d3ed6be20,0xbf063e9e3f06be9e,0xbf7f3f733f7fbf73,0xbf5a3f733f5abf73,0xbda13e9e3da1be9e,0xbf7b3f80be48248d,0xbf0e3f35bf553f35,0x3e480000bf7b3f80,0x3f55bf35bf0e3f35
.quad 0xbe203e9ebe203e9e,0x3ee8be9e3ee8be9e,0x3f7dbf733f7dbf73,0x3f64bf733f64bf73,0x3f5fbf4f3efabf16,0x3f80bf7d3d21be20,0x3efabf16bf5f3f4f,0x3d21be20bf803f7d,0x3f43bf4fbf433f4f,0x3f06bf16bf063f16,0xbf263f163f26bf16,0xbf5a3f4f3f5abf4f,0xbeb13e9e3f70bf73,0xbefa3ee83f5fbf64,0xbf703f73beb13e9e,0xbf5f3f64befa3ee8
.quad 0x3f73bf803f73bf80,0xa554be9ea554be9e,0xbe9e250dbe9e250d,0xbf803f73bf803f73,0xbdf13ec43f7ebf6d,0x3f55bf263f0ebf43,0x3f7ebf6d3df1bec4,0x3f0ebf43bf553f26,0xbf5a3f353f5abf35,0xbf6d3f7d3f6dbf7d,0xbf063f353f06bf35,0x3ec4be20bec43e20,0x3f55bf6d3f0ebec4,0x3e48bec43f7bbf6d,0xbf0e3ec43f55bf6d,0xbf7b3f6d3e48bec4
.quad 0x3e20a5543e20a554,0x3f35bf163f35bf16,0x3f7dbf803f7dbf80,0x3f35bf4f3f35bf4f,0xbf763f6dbe8b3ec4,0xbf7b3f7f3e48bda1,0xbe8b3ec43f76bf6d,0x3e48bda13f7bbf7f,0x3f26bf35bf263f35,0x3ec4bee8bec43ee8,0xbf433f353f43bf35,0xbf6d3f643f6dbf64,0x3ed6bec4bf683f6d,0x3f0ebf06bf553f5a,0x3f68bf6d3ed6bec4,0x3f55bf5a3f0ebf06
.quad 0x3f73bf803f73bf80,0xa554be9ea554be9e,0xbe9e250dbe9e250d,0xbf803f73bf803f73,0x3df1bec4bf7e3f6d,0xbf553f26bf0e3f43,0xbf7e3f6dbdf13ec4,0xbf0e3f433f55bf26,0xbf5a3f353f5abf35,0xbf6d3f7d3f6dbf7d,0xbf063f353f06bf35,0x3ec4be20bec43e20,0xbf553f6dbf0e3ec4,0xbe483ec4bf7b3f6d,0x3f0ebec4bf553f6d,0x3f7bbf6dbe483ec4
.quad 0x3e20a5543e20a554,0x3f35bf163f35bf16,0x3f7dbf803f7dbf80,0x3f35bf4f3f35bf4f,0x3f76bf6d3e8bbec4,0x3f7bbf7fbe483da1,0x3e8bbec4bf763f6d,0xbe483da1bf7b3f7f,0x3f26bf35bf263f35,0x3ec4bee8bec43ee8,0xbf433f353f43bf35,0xbf6d3f643f6dbf64,0xbed63ec43f68bf6d,0xbf0e3f063f55bf5a,0xbf683f6dbed63ec4,0xbf553f5abf0e3f06
.quad 0xbf163e9ebf163e9e,0x3f8000003f80,0xbf4f3f73bf4f3f73,0x0,0x3f80bf733d21be9e,0xbf3500003f35,0x3d21be9ebf803f73,0x3f3500003f35,0xbf263f4f3f26bf4f,0xa5540000248d,0x3f43bf16bf433f16,0xbf8000003f80,0xbe48248d3f7bbf80,0x3f350000bf35,0xbf7b3f80be48250d,0x3f3500003f35
.quad 0x3f64bf4f3f64bf4f,0xbf800000bf80,0x3ee8bf163ee8bf16,0x250d0000250d,0xbf683f733ed6be9e,0x3f350000bf35,0x3ed6be9e3f68bf73,0xbf350000bf35,0x3e6fbe9ebe6f3e9e,0x248d0000a554,0xbf793f733f79bf73,0x3f800000bf80,0x3f1ebf16bf493f4f,0xbf3500003f35,0x3f49bf4f3f1ebf16,0xbf350000bf35
.quad 0xbf163e9ebf163e9e,0x0,0xbf4f3f73bf4f3f73,0x0,0xbf803f73bd213e9e,0x800000000000,0xbd213e9e3f80bf73,0x0,0xbf263f4f3f26bf4f,0x800000000000,0x3f43bf16bf433f16,0x800000000000,0x3e48a554bf7b3f80,0x8000,0x3f7bbf803e480000,0x0
.quad 0x3f64bf4f3f64bf4f,0x800000008000,0x3ee8bf163ee8bf16,0x0,0x3f68bf73bed63e9e,0x8000,0xbed63e9ebf683f73,0x800000008000,0x3e6fbe9ebe6f3e9e,0x8000,0xbf793f733f79bf73,0x8000,0xbf1e3f163f49bf4f,0x800000000000,0xbf493f4fbf1e3f16,0x800000008000
.quad 0xbf733f4fbf733f4f,0x0,0xbe9e3f16be9e3f16,0x0,0x3f5fbf79befa3e6f,0x800000000000,0xbefa3e6fbf5f3f79,0x0,0xbe6f3ee83e6fbee8,0x800000000000,0x3f79bf64bf793f64,0x800000000000,0xbf0e3ec43f55bf6d,0x8000,0xbf553f6dbf0e3ec4,0x0
.quad 0x3f7dbf733f7dbf73,0x800000008000,0x3e20be9e3e20be9e,0x0,0xbf493f5a3f1ebf06,0x8000,0x3f1ebf063f49bf5a,0x800000008000,0x3da1be20bda13e20,0x8000,0xbf7f3f7d3f7fbf7d,0x8000,0x3f2ebf26bf3c3f43,0x800000000000,0x3f3cbf433f2ebf26,0x800000008000
.quad 0xbf733f4fbf733f4f,0x0,0xbe9e3f16be9e3f16,0x0,0xbf5f3f793efabe6f,0x800000000000,0x3efabe6f3f5fbf79,0x0,0xbe6f3ee83e6fbee8,0x800000000000,0x3f79bf64bf793f64,0x800000000000,0x3f0ebec4bf553f6d,0x8000,0x3f55bf6d3f0ebec4,0x0
.quad 0x3f7dbf733f7dbf73,0x800000008000,0x3e20be9e3e20be9e,0x0,0x3f49bf5abf1e3f06,0x8000,0xbf1e3f06bf493f5a,0x800000008000,0x3da1be20bda13e20,0x8000,0xbf7f3f7d3f7fbf7d,0x8000,0xbf2e3f263f3cbf43,0x800000000000,0xbf3c3f43bf2e3f26,0x800000008000
.quad 0xbf803f80bf803f80,0xbf803f80bf803f80,0x250d0000250d0000,0x250d0000250d0000,0xbf803f80bf803f80,0xbf803f80bf803f80,0x250d0000250d0000,0x250d0000250d0000,0xbf803f80bf803f80,0xbf803f80bf803f80,0x250d0000250d0000,0x250d0000250d0000,0xbf803f80bf803f80,0xbf803f80bf803f80,0x250d0000250d0000,0x250d0000250d0000
.quad 0xbf803f80bf803f80,0xbf803f80bf803f80,0x250d0000250d0000,0x250d0000250d0000,0xbf803f80bf803f80,0xbf803f80bf803f80,0x250d0000250d0000,0x250d0000250d0000,0xbf803f80bf803f80,0xbf803f80bf803f80,0x250d0000250d0000,0x250d0000250d0000,0xbf803f80bf803f80,0xbf803f80bf803f80,0x250d0000250d0000,0x250d0000250d0000
.quad 0xbf803f80bf803f80,0xbf803f80bf803f80,0x250d0000250d0000,0x250d0000250d0000,0xbf803f80bf803f80,0xbf803f80bf803f80,0x250d0000250d0000,0x250d0000250d0000,0xbf803f80bf803f80,0xbf803f80bf803f80,0x250d0000250d0000,0x250d0000250d0000,0xbf803f80bf803f80,0xbf803f80bf803f80,0x250d0000250d0000,0x250d0000250d0000
.quad 0xbf803f80bf803f80,0xbf803f80bf803f80,0x250d0000250d0000,0x250d0000250d0000,0xbf803f80bf803f80,0xbf803f80bf803f80,0x250d0000250d0000,0x250d0000250d0000,0xbf803f80bf803f80,0xbf803f80bf803f80,0x250d0000250d0000,0x250d0000250d0000,0xbf803f80bf803f80,0xbf803f80bf803f80,0x250d0000250d0000,0x250d0000250d0000
.quad 0xbf803f80bf803f80,0xbf803f80bf803f80,0x250d0000250d0000,0x250d0000250d0000,0xbf803f80bf803f80,0xbf803f80bf803f80,0x250d0000250d0000,0x250d0000250d0000,0xbf803f80bf803f80,0xbf803f80bf803f80,0x250d0000250d0000,0x250d0000250d0000,0xbf803f80bf803f80,0xbf803f80bf803f80,0x250d0000250d0000,0x250d0000250d0000
.quad 0xbf803f80bf803f80,0xbf803f80bf803f80,0x250d0000250d0000,0x250d0000250d0000,0xbf803f80bf803f80,0xbf803f80bf803f80,0x250d0000250d0000,0x250d0000250d0000,0xbf803f80bf803f80,0xbf803f80bf803f80,0x250d0000250d0000,0x250d0000250d0000,0xbf803f80bf803f80,0xbf803f80bf803f80,0x250d0000250d0000,0x250d0000250d0000
.quad 0xbf803f80bf803f80,0xbf803f80bf803f80,0x250d0000250d0000,0x250d0000250d0000,0xbf803f80bf803f80,0xbf803f80bf803f80,0x250d0000250d0000,0x250d0000250d0000,0xbf803f80bf803f80,0xbf803f80bf803f80,0x250d0000250d0000,0x250d0000250d0000,0xbf803f80bf803f80,0xbf803f80bf803f80,0x250d0000250d0000,0x250d0000250d0000
.quad 0xbf803f80bf803f80,0xbf803f80bf803f80,0x250d0000250d0000,0x250d0000250d0000,0xbf803f80bf803f80,0xbf803f80bf803f80,0x250d0000250d0000,0x250d0000250d0000,0xbf803f80bf803f80,0xbf803f80bf803f80,0x250d0000250d0000,0x250d0000250d0000,0xbf803f80bf803f80,0xbf803f80bf803f80,0x250d0000250d0000,0x250d0000250d0000
.quad 0xbf803f80bf803f80,0xbf803f80bf803f80,0x250d0000250d0000,0x250d0000250d0000,0xbf803f80bf803f80,0xbf803f80bf803f80,0x250d0000250d0000,0x250d0000250d0000,0xbf803f80bf803f80,0xbf803f80bf803f80,0x250d0000250d0000,0x250d0000250d0000,0xbf803f80bf803f80,0xbf803f80bf803f80,0x250d0000250d0000,0x250d0000250d0000
.quad 0xbf803f80bf803f80,0xbf803f80bf803f80,0x250d0000250d0000,0x250d0000250d0000,0xbf803f80bf803f80,0xbf803f80bf803f80,0x250d0000250d0000,0x250d0000250d0000,0xbf803f80bf803f80,0xbf803f80bf803f80,0x250d0000250d0000,0x250d0000250d0000,0xbf803f80bf803f80,0xbf803f80bf803f80,0x250d0000250d0000,0x250d0000250d0000
.quad 0xbf803f80bf803f80,0xbf803f80bf803f80,0x250d0000250d0000,0x250d0000250d0000,0xbf803f80bf803f80,0xbf803f80bf803f80,0x250d0000250d0000,0x250d0000250d0000,0xbf803f80bf803f80,0xbf803f80bf803f80,0x250d0000250d0000,0x250d0000250d0000,0xbf803f80bf803f80,0xbf803f80bf803f80,0x250d0000250d0000,0x250d0000250d0000
.quad 0xbf803f80bf803f80,0xbf803f80bf803f80,0x250d0000250d0000,0x250d0000250d0000,0xbf803f80bf803f80,0xbf803f80bf803f80,0x250d0000250d0000,0x250d0000250d0000,0xbf803f80bf803f80,0xbf803f80bf803f80,0x250d0000250d0000,0x250d0000250d0000,0xbf803f80bf803f80,0xbf803f80bf803f80,0x250d0000250d0000,0x250d0000250d0000
.quad 0xbf803f80bf803f80,0xbf803f80bf803f80,0x250d0000250d0000,0x250d0000250d0000,0xbf803f80bf803f80,0xbf803f80bf803f80,0x250d0000250d0000,0x250d0000250d0000,0xbf803f80bf803f80,0xbf803f80bf803f80,0x250d0000250d0000,0x250d0000250d0000,0xbf803f80bf803f80,0xbf803f80bf803f80,0x250d0000250d0000,0x250d0000250d0000
.quad 0xbf803f80bf803f80,0xbf803f80bf803f80,0x250d0000250d0000,0x250d0000250d0000,0xbf803f80bf803f80,0xbf803f80bf803f80,0x250d0000250d0000,0x250d0000250d0000,0xbf803f80bf803f80,0xbf803f80bf803f80,0x250d0000250d0000,0x250d0000250d0000,0xbf803f80bf803f80,0xbf803f80bf803f80,0x250d0000250d0000,0x250d0000250d0000
.quad 0xbf803f80bf803f80,0xbf803f80bf803f80,0x250d0000250d0000,0x250d0000250d0000,0xbf803f80bf803f80,0xbf803f80bf803f80,0x250d0000250d0000,0x250d0000250d0000,0xbf803f80bf803f80,0xbf803f80bf803f80,0x250d0000250d0000,0x250d0000250d0000,0xbf803f80bf803f80,0xbf803f80bf803f80,0x250d0000250d0000,0x250d0000250d0000
.quad 0xbf803f80bf803f80,0xbf803f80bf803f80,0x250d0000250d0000,0x250d0000250d0000,0xbf803f80bf803f80,0xbf803f80bf803f80,0x250d0000250d0000,0x250d0000250d0000,0xbf803f80bf803f80,0xbf803f80bf803f80,0x250d0000250d0000,0x250d0000250d0000,0xbf803f80bf803f80,0xbf803f80bf803f80,0x250d0000250d0000,0x250d0000250d0000
.quad 0xbf803f80bf803f80,0x3f8000003f80,0x250d0000250d0000,0x0,0xbf803f80bf803f80,0x3f8000003f80,0x250d0000250d0000,0x0,0xbf803f80bf803f80,0x3f8000003f80,0x250d0000250d0000,0x0,0xbf803f80bf803f80,0x3f8000003f80,0x250d0000250d0000,0x0
.quad 0xbf803f80bf803f80,0x3f8000003f80,0x250d0000250d0000,0x0,0xbf803f80bf803f80,0x3f8000003f80,0x250d0000250d0000,0x0,0xbf803f80bf803f80,0x3f8000003f80,0x250d0000250d0000,0x0,0xbf803f80bf803f80,0x3f8000003f80,0x250d0000250d0000,0x0
.quad 0xbf803f80bf803f80,0x0,0x250d0000250d0000,0x0,0xbf803f80bf803f80,0x0,0x250d0000250d0000,0x0,0xbf803f80bf803f80,0x0,0x250d0000250d0000,0x0,0xbf803f80bf803f80,0x0,0x250d0000250d0000,0x0
.quad 0xbf803f80bf803f80,0x0,0x250d0000250d0000,0x0,0xbf803f80bf803f80,0x0,0x250d0000250d0000,0x0,0xbf803f80bf803f80,0x0,0x250d0000250d0000,0x0,0xbf803f80bf803f80,0x0,0x250d0000250d0000,0x0
.quad 0xbf803f80bf803f80,0x0,0x250d0000250d0000,0x0,0xbf803f80bf803f80,0x0,0x250d0000250d0000,0x0,0xbf803f80bf803f80,0x0,0x250d0000250d0000,0x0,0xbf803f80bf803f80,0x0,0x250d0000250d0000,0x0
.quad 0xbf803f80bf803f80,0x0,0x250d0000250d0000,0x0,0xbf803f80bf803f80,0x0,0x250d0000250d0000,0x0,0xbf803f80bf803f80,0x0,0x250d0000250d0000,0x0,0xbf803f80bf803f80,0x0,0x250d0000250d0000,0x0
.quad 0xbf803f80bf803f80,0x0,0x250d0000250d0000,0x0,0xbf803f80bf803f80,0x0,0x250d0000250d0000,0x0,0xbf803f80bf803f80,0x0,0x250d0000250d0000,0x0,0xbf803f80bf803f80,0x0,0x250d0000250d0000,0x0
.quad 0xbf803f80bf803f80,0x0,0x250d0000250d0000,0x0,0xbf803f80bf803f80,0x0,0x250d0000250d0000,0x0,0xbf803f80bf803f80,0x0,0x250d0000250d0000,0x0,0xbf803f80bf803f80,0x0,0x250d0000250d0000,0x0
.quad 0x397e000003fe,0x1c7e000002fe,0x3d7c000002fe,0x3d7e000002fc,0x2efe000001fe,0x1e7c000001fe,0x3f7a000001fe,0x1e7e000001fc,0x3f7c000001fc,0x3f7e000001fa,0x3f7e000001fa,0x3f7e000001fa,0x3f7e000001fa,0x3f7e000001fa,0x3f7e000001fa,0x3f7e000001fa
.quad 0x3f7e000001fa,0x3f7e000001fa,0x3f7e000001fa,0x3f7e000001fa,0x3f7e000001fa,0x3f7e000001fa,0x3f7e000001fa,0x3f7e000001fa,0x3f7e000001fa,0x3f7e000001fa,0x3f7e000001fa,0x3f7e000001fa,0x3f7e000001fa,0x3f7e000001fa,0x3f7e000001fa,0x3f7e000001fa
.quad 0x3f7e000001fa,0x3f7e000001fa,0x3f7e000001fa,0x3f7e000001fa,0x3f7e000001fa,0x3f7e000001fa,0x3f7e000001fa,0x3f7e000001fa,0x3f7e000001fa,0x3f7e000001fa,0x3f7e000001fa,0x3f7e000001fa,0x3f7e000001fa,0x3f7e000001fa,0x3f7e000001fa,0x3f7e000001fa
.quad 0x3f7e000001fa,0x3f7e000001fa,0x3f7e000001fa,0x3f7e000001fa,0x3f7e000001fa,0x3f7e000001fa,0x3f7e000001fa,0x3f7e000001fa,0x3f7e000001fa,0x3f7e000001fa,0x3f7e000001fa,0x3f7e000001fa,0x3f7e000001fa,0x3f7e000001fa,0x3f7e000001fa,0x3f7e000001fa
.quad 0x3f803f803f803f80,0x3f803f803f803f80,0x8000800080008000,0x8000800080008000,0x3f643f733f7d3f80,0xbf7dbf73bf64bf4f,0xbee8be9ebe208000,0xbe20be9ebee8bf16,0x3f7e3f7f3f803f80,0x3f3c3f433f493f4f,0xbdf1bda1bd218000,0xbf2ebf26bf1ebf16,0x3f553f6d3f7b3f80,0xbf55bf6dbf7bbf80,0xbf0ebec4be488000,0x3f0e3ec43e48a50d
.quad 0x3f793f7d3f7f3f80,0x3da13e203e6f3e9e,0xbe6fbe20bda18000,0xbf7fbf7dbf79bf73,0x3f433f643f793f80,0xbe6fbee8bf26bf4f,0xbf26bee8be6f8000,0x3f793f643f433f16,0x3f703f793f7e3f80,0xbf1ebf06bed6be9e,0xbeb1be6fbdf18000,0xbf49bf5abf68bf73,0x3f2e3f5a3f763f80,0x3efa3e6fbd21be9e,0xbf3cbf06be8b8000,0x3f5f3f793f803f73
.quad 0x3f803f803f803f80,0x3f803f803f803f80,0x8000800080008000,0x8000800080008000,0x3ee83f163f353f4f,0xbf64bf73bf7dbf80,0xbf64bf4fbf35bf16,0x3ee83e9e3e20a50d,0x3f763f793f7b3f7d,0x3f1e3f263f2e3f35,0xbe8bbe6fbe48be20,0xbf49bf43bf3cbf35,0x3e483ec43f0e3f35,0xbe48bec4bf0ebf35,0xbf7bbf6dbf55bf35,0x3f7b3f6d3f553f35
.quad 0x3f5a3f643f6d3f73,0xbe6fbe20bda1248d,0xbf06bee8bec4be9e,0xbf79bf7dbf7fbf80,0xbda13e203ec43f16,0x3f263ee83e6fa554,0xbf7fbf7dbf6dbf4f,0x3f433f643f793f80,0x3f2e3f433f553f64,0xbf68bf5abf49bf35,0xbf3cbf26bf0ebee8,0xbed6bf06bf1ebf35,0xbeb1bda13e483ee8,0x3f803f793f5f3f35,0xbf70bf7fbf7bbf64,0xbd213e6f3efa3f35
.quad 0x3f803f803f803f80,0x3f803f803f803f80,0x8000800080008000,0x8000800080008000,0xbe20248d3e203e9e,0xbee8bf16bf35bf4f,0xbf7dbf80bf7dbf73,0x3f643f4f3f353f16,0x3f683f6d3f703f73,0x3efa3f063f0e3f16,0xbed6bec4beb1be9e,0xbf5fbf5abf55bf4f,0xbf0ebec4be48248d,0x3f0e3ec43e48a554,0xbf55bf6dbf7bbf80,0x3f553f6d3f7b3f80
.quad 0x3f263f353f433f4f,0xbf06bee8bec4be9e,0xbf43bf35bf26bf16,0xbf5abf64bf6dbf73,0xbf5abf35bf06be9e,0x3f7f3f7d3f6d3f4f,0xbf06bf35bf5abf73,0xbda13e203ec43f16,0x3e8b3ec43efa3f16,0xbf80bf7fbf7bbf73,0xbf76bf6dbf5fbf4f,0x3d21bda1be48be9e,0xbf7ebf6dbf49bf16,0x3ed63f263f553f73,0xbdf1bec4bf1ebf4f,0xbf68bf43bf0ebe9e
.quad 0x3f803f803f803f80,0x3f803f803f803f80,0x8000800080008000,0x8000800080008000,0xbf35bf16bee8be9e,0x3e20a554be20be9e,0xbf35bf4fbf64bf73,0x3f7d3f803f7d3f73,0x3f553f5a3f5f3f64,0x3eb13ec43ed63ee8,0xbf0ebf06befabee8,0xbf70bf6dbf68bf64,0xbf7bbf6dbf55bf35,0x3f7b3f6d3f553f35,0xbe48bec4bf0ebf35,0x3e483ec43f0e3f35
.quad 0x3ec43ee83f063f16,0xbf43bf35bf26bf16,0xbf6dbf64bf5abf4f,0xbf26bf35bf43bf4f,0xbf6dbf7dbf7fbf73,0x3f063f353f5a3f73,0x3ec43e20bda1be9e,0xbf5abf35bf06be9e,0xbe48bda13d213e20,0xbf5fbf6dbf76bf7d,0xbf7bbf7fbf80bf7d,0x3efa3ec43e8b3e20,0xbf0ebf43bf68bf7d,0xbf1ebec4bdf13e20,0x3f553f263ed63e20,0xbf49bf6dbf7ebf7d
.quad 0x3f803f803f803f80,0x3f803f803f803f80,0x8000800080008000,0x8000800080008000,0x3f353f163ee83e9e,0xbe20248d3e203e9e,0x3f353f4f3f643f73,0xbf7dbf80bf7dbf73,0x3e483e6f3e8b3e9e,0xbed6bec4beb1be9e,0xbf7bbf79bf76bf73,0xbf68bf6dbf70bf73,0x3f553f6d3f7b3f80,0xbf55bf6dbf7bbf80,0xbf0ebec4be488000,0x3f0e3ec43e48a50d
.quad 0xbf6dbf64bf5abf4f,0xbf26bf35bf43bf4f,0xbec4bee8bf06bf16,0x3f433f353f263f16,0xbec4be203da13e9e,0x3f5a3f353f063e9e,0xbf6dbf7dbf7fbf73,0x3f063f353f5a3f73,0xbf0ebf26bf3cbf4f,0x3f763f6d3f5f3f4f,0x3f553f433f2e3f16,0x3e8b3ec43efa3f16,0xbf7bbf7fbf70bf4f,0x3df13ec43f1e3f4f,0x3e48bda1beb1bf16,0xbf7ebf6dbf49bf16
.quad 0x3f803f803f803f80,0x3f803f803f803f80,0x8000800080008000,0x8000800080008000,0x3f7d3f733f643f4f,0xbf35bf16bee8be9e,0x3e203e9e3ee83f16,0xbf35bf4fbf64bf73,0x3d213da13df13e20,0xbf0ebf06befabee8,0xbf80bf7fbf7ebf7d,0xbf55bf5abf5fbf64,0x3e483ec43f0e3f35,0xbe48bec4bf0ebf35,0xbf7bbf6dbf55bf35,0x3f7b3f6d3f553f35
.quad 0xbf7fbf7dbf79bf73,0xbec4bee8bf06bf16,0xbda1be20be6fbe9e,0x3f6d3f643f5a3f4f,0xbf79bf64bf43bf16,0x3f6d3f7d3f7f3f73,0xbe6fbee8bf26bf4f,0xbec4be203da13e9e,0xbdf1be6fbeb1bee8,0x3f7b3f7f3f803f7d,0x3f7e3f793f703f64,0xbe48bda13d213e20,0xbe8bbf06bf3cbf64,0xbf55bf26bed6be20,0x3f763f5a3f2e3ee8,0xbf0ebf43bf68bf7d
.quad 0x3f803f803f803f80,0x3f803f803f803f80,0x8000800080008000,0x8000800080008000,0x3f643f733f7d3f80,0xbf7dbf73bf64bf4f,0xbee8be9ebe208000,0xbe20be9ebee8bf16,0xbdf1bda1bd21248d,0xbf2ebf26bf1ebf16,0xbf7ebf7fbf80bf80,0xbf3cbf43bf49bf4f,0xbf0ebec4be48248d,0x3f0e3ec43e48a554,0xbf55bf6dbf7bbf80,0x3f553f6d3f7b3f80
.quad 0xbf79bf7dbf7fbf80,0xbda1be20be6fbe9e,0x3e6f3e203da1a50d,0x3f7f3f7d3f793f73,0xbf43bf64bf79bf80,0x3e6f3ee83f263f4f,0x3f263ee83e6fa50d,0xbf79bf64bf43bf16,0x3eb13e6f3df1a554,0x3f493f5a3f683f73,0x3f703f793f7e3f80,0xbf1ebf06bed6be9e,0x3f3c3f063e8ba554,0xbf5fbf79bf80bf73,0x3f2e3f5a3f763f80,0x3efa3e6fbd21be9e
.quad 0x3f803f803f803f80,0x3f803f803f803f80,0x8000800080008000,0x8000800080008000,0x3ee83f163f353f4f,0xbf64bf73bf7dbf80,0xbf64bf4fbf35bf16,0x3ee83e9e3e20a50d,0xbe8bbe6fbe48be20,0xbf49bf43bf3cbf35,0xbf76bf79bf7bbf7d,0xbf1ebf26bf2ebf35,0xbf7bbf6dbf55bf35,0x3f7b3f6d3f553f35,0xbe48bec4bf0ebf35,0x3e483ec43f0e3f35
.quad 0xbf5abf64bf6dbf73,0x3e6f3e203da1a554,0x3f063ee83ec43e9e,0x3f793f7d3f7f3f80,0x3da1be20bec4bf16,0xbf26bee8be6f248d,0x3f7f3f7d3f6d3f4f,0xbf43bf64bf79bf80,0x3f3c3f263f0e3ee8,0x3ed63f063f1e3f35,0x3f2e3f433f553f64,0xbf68bf5abf49bf35,0x3f703f7f3f7b3f64,0x3d21be6fbefabf35,0xbeb1bda13e483ee8,0x3f803f793f5f3f35
.quad 0x3f803f803f803f80,0x3f803f803f803f80,0x8000800080008000,0x8000800080008000,0xbee8bf16bf35bf4f,0x3f643f733f7d3f80,0x3f643f4f3f353f16,0xbee8be9ebe208000,0xbf5fbf5abf55bf4f,0xbf7ebf7fbf80bf80,0xbefabf06bf0ebf16,0x3df13da13d21a50d,0x3f553f6d3f7b3f80,0xbf55bf6dbf7bbf80,0xbf0ebec4be488000,0x3f0e3ec43e48a50d
.quad 0x3f063ee83ec43e9e,0x3f793f7d3f7f3f80,0x3f5a3f643f6d3f73,0xbe6fbe20bda18000,0xbf7fbf7dbf6dbf4f,0x3f433f643f793f80,0x3da1be20bec4bf16,0xbf26bee8be6f8000,0xbd213da13e483e9e,0xbf70bf79bf7ebf80,0xbf80bf7fbf7bbf73,0x3eb13e6f3df1a50d,0x3f683f433f0e3e9e,0xbf2ebf5abf76bf80,0x3ed63f263f553f73,0x3f3c3f063e8ba50d
.quad 0x3f803f803f803f80,0x3f803f803f803f80,0x8000800080008000,0x8000800080008000,0x3e20a554be20be9e,0x3ee83f163f353f4f,0x3f7d3f803f7d3f73,0xbf64bf4fbf35bf16,0xbf70bf6dbf68bf64,0xbf76bf79bf7bbf7d,0xbeb1bec4bed6bee8,0x3e8b3e6f3e483e20,0x3e483ec43f0e3f35,0xbe48bec4bf0ebf35,0xbf7bbf6dbf55bf35,0x3f7b3f6d3f553f35
.quad 0x3f433f353f263f16,0x3f5a3f643f6d3f73,0x3f263f353f433f4f,0xbf06bee8bec4be9e,0xbf06bf35bf5abf73,0xbda13e203ec43f16,0x3f5a3f353f063e9e,0xbf7fbf7dbf6dbf4f,0xbefabec4be8bbe20,0xbf2ebf43bf55bf64,0xbf5fbf6dbf76bf7d,0x3f3c3f263f0e3ee8,0x3f493f6d3f7e3f7d,0x3eb13da1be48bee8,0xbf1ebec4bdf13e20,0x3f703f7f3f7b3f64
.quad 0x3f803f803f803f80,0x3f803f803f803f80,0x8000800080008000,0x8000800080008000,0x3f353f163ee83e9e,0xbe20248d3e203e9e,0x3f353f4f3f643f73,0xbf7dbf80bf7dbf73,0xbf7bbf79bf76bf73,0xbf68bf6dbf70bf73,0xbe48be6fbe8bbe9e,0x3ed63ec43eb13e9e,0xbf0ebec4be48248d,0x3f0e3ec43e48a554,0xbf55bf6dbf7bbf80,0x3f553f6d3f7b3f80
.quad 0x3f6d3f643f5a3f4f,0x3f263f353f433f4f,0x3ec43ee83f063f16,0xbf43bf35bf26bf16,0x3ec43e20bda1be9e,0xbf5abf35bf06be9e,0x3f6d3f7d3f7f3f73,0xbf06bf35bf5abf73,0xbf55bf43bf2ebf16,0xbe8bbec4befabf16,0xbf0ebf26bf3cbf4f,0x3f763f6d3f5f3f4f,0xbe483da13eb13f16,0x3f7e3f6d3f493f16,0xbf7bbf7fbf70bf4f,0x3df13ec43f1e3f4f
.quad 0x3f803f803f803f80,0x3f803f803f803f80,0x8000800080008000,0x8000800080008000,0x3f7d3f733f643f4f,0xbf35bf16bee8be9e,0x3e203e9e3ee83f16,0xbf35bf4fbf64bf73,0xbf80bf7fbf7ebf7d,0xbf55bf5abf5fbf64,0xbd21bda1bdf1be20,0x3f0e3f063efa3ee8,0xbf7bbf6dbf55bf35,0x3f7b3f6d3f553f35,0xbe48bec4bf0ebf35,0x3e483ec43f0e3f35
.quad 0x3f7f3f7d3f793f73,0x3ec43ee83f063f16,0x3da13e203e6f3e9e,0xbf6dbf64bf5abf4f,0x3f793f643f433f16,0xbf6dbf7dbf7fbf73,0x3e6f3ee83f263f4f,0x3ec43e20bda1be9e,0xbf7ebf79bf70bf64,0x3e483da1bd21be20,0xbdf1be6fbeb1bee8,0x3f7b3f7f3f803f7d,0xbf76bf5abf2ebee8,0x3f0e3f433f683f7d,0xbe8bbf06bf3cbf64,0xbf55bf26bed6be20
.quad 0x3f803f803f803f80,0x3f803f803f803f80,0x8000800080008000,0x8000800080008000,0xbf7dbf73bf64bf4f,0x3f353f163ee83e9e,0xbe20be9ebee8bf16,0x3f353f4f3f643f73,0xbf3cbf43bf49bf4f,0xbe48be6fbe8bbe9e,0x3f2e3f263f1e3f16,0x3f7b3f793f763f73,0x3f553f6d3f7b3f80,0xbf55bf6dbf7bbf80,0xbf0ebec4be488000,0x3f0e3ec43e48a50d
.quad 0x3da13e203e6f3e9e,0xbf6dbf64bf5abf4f,0xbf7fbf7dbf79bf73,0xbec4bee8bf06bf16,0xbe6fbee8bf26bf4f,0xbec4be203da13e9e,0x3f793f643f433f16,0xbf6dbf7dbf7fbf73,0x3f1e3f063ed63e9e,0x3f0e3f263f3c3f4f,0x3f493f5a3f683f73,0xbf55bf43bf2ebf16,0xbefabe6f3d213e9e,0x3f7b3f7f3f703f4f,0xbf5fbf79bf80bf73,0xbe483da13eb13f16
.quad 0x3f803f803f803f80,0x3f803f803f803f80,0x8000800080008000,0x8000800080008000,0xbf64bf73bf7dbf80,0x3f7d3f733f643f4f,0x3ee83e9e3e20a50d,0x3e203e9e3ee83f16,0xbf1ebf26bf2ebf35,0xbd21bda1bdf1be20,0x3f493f433f3c3f35,0x3f803f7f3f7e3f7d,0x3e483ec43f0e3f35,0xbe48bec4bf0ebf35,0xbf7bbf6dbf55bf35,0x3f7b3f6d3f553f35
.quad 0xbe6fbe20bda1248d,0xbf7fbf7dbf79bf73,0xbf79bf7dbf7fbf80,0xbda1be20be6fbe9e,0x3f263ee83e6fa554,0xbf79bf64bf43bf16,0x3f433f643f793f80,0xbe6fbee8bf26bf4f,0x3f683f5a3f493f35,0x3df13e6f3eb13ee8,0x3ed63f063f1e3f35,0xbf7ebf79bf70bf64,0xbf80bf79bf5fbf35,0x3e8b3f063f3c3f64,0x3d21be6fbefabf35,0xbf76bf5abf2ebee8
.quad 0x3f803f803f803f80,0x3f803f803f803f80,0x8000800080008000,0x8000800080008000,0xbee8bf16bf35bf4f,0x3f643f733f7d3f80,0x3f643f4f3f353f16,0xbee8be9ebe208000,0xbefabf06bf0ebf16,0x3df13da13d21a554,0x3f5f3f5a3f553f4f,0x3f7e3f7f3f803f80,0xbf0ebec4be48248d,0x3f0e3ec43e48a554,0xbf55bf6dbf7bbf80,0x3f553f6d3f7b3f80
.quad 0xbf06bee8bec4be9e,0xbf79bf7dbf7fbf80,0xbf5abf64bf6dbf73,0x3e6f3e203da1a50d,0x3f7f3f7d3f6d3f4f,0xbf43bf64bf79bf80,0xbda13e203ec43f16,0x3f263ee83e6fa50d,0x3f803f7f3f7b3f73,0xbeb1be6fbdf1248d,0xbd213da13e483e9e,0xbf70bf79bf7ebf80,0xbed6bf26bf55bf73,0xbf3cbf06be8b248d,0x3f683f433f0e3e9e,0xbf2ebf5abf76bf80
.quad 0x3f803f803f803f80,0x3f803f803f803f80,0x8000800080008000,0x8000800080008000,0x3e20a554be20be9e,0x3ee83f163f353f4f,0x3f7d3f803f7d3f73,0xbf64bf4fbf35bf16,0xbeb1bec4bed6bee8,0x3e8b3e6f3e483e20,0x3f703f6d3f683f64,0x3f763f793f7b3f7d,0xbf7bbf6dbf55bf35,0x3f7b3f6d3f553f35,0xbe48bec4bf0ebf35,0x3e483ec43f0e3f35
.quad 0xbf43bf35bf26bf16,0xbf5abf64bf6dbf73,0xbf26bf35bf43bf4f,0x3f063ee83ec43e9e,0x3f063f353f5a3f73,0x3da1be20bec4bf16,0xbf5abf35bf06be9e,0x3f7f3f7d3f6d3f4f,0x3f5f3f6d3f763f7d,0xbf3cbf26bf0ebee8,0xbefabec4be8bbe20,0xbf2ebf43bf55bf64,0x3f1e3ec43df1be20,0xbf70bf7fbf7bbf64,0x3f493f6d3f7e3f7d,0x3eb13da1be48bee8
.quad 0x3f803f803f803f80,0x3f803f803f803f80,0x8000800080008000,0x8000800080008000,0xbe20248d3e203e9e,0xbee8bf16bf35bf4f,0xbf7dbf80bf7dbf73,0x3f643f4f3f353f16,0x3ed63ec43eb13e9e,0x3f5f3f5a3f553f4f,0x3f683f6d3f703f73,0x3efa3f063f0e3f16,0x3f553f6d3f7b3f80,0xbf55bf6dbf7bbf80,0xbf0ebec4be488000,0x3f0e3ec43e48a50d
.quad 0xbf26bf35bf43bf4f,0x3f063ee83ec43e9e,0x3f433f353f263f16,0x3f5a3f643f6d3f73,0x3f5a3f353f063e9e,0xbf7fbf7dbf6dbf4f,0x3f063f353f5a3f73,0x3da1be20bec4bf16,0xbf76bf6dbf5fbf4f,0x3d21bda1be48be9e,0xbe8bbec4befabf16,0x3f803f7f3f7b3f73,0xbdf1bec4bf1ebf4f,0xbf68bf43bf0ebe9e,0x3f7e3f6d3f493f16,0xbed6bf26bf55bf73
.quad 0x3f803f803f803f80,0x3f803f803f803f80,0x8000800080008000,0x8000800080008000,0xbf35bf16bee8be9e,0x3e20a554be20be9e,0xbf35bf4fbf64bf73,0x3f7d3f803f7d3f73,0x3f0e3f063efa3ee8,0x3f703f6d3f683f64,0x3f553f5a3f5f3f64,0x3eb13ec43ed63ee8,0x3e483ec43f0e3f35,0xbe48bec4bf0ebf35,0xbf7bbf6dbf55bf35,0x3f7b3f6d3f553f35
.quad 0xbec4bee8bf06bf16,0x3f433f353f263f16,0x3f6d3f643f5a3f4f,0x3f263f353f433f4f,0x3f6d3f7d3f7f3f73,0xbf06bf35bf5abf73,0xbec4be203da13e9e,0x3f5a3f353f063e9e,0xbf7bbf7fbf80bf7d,0x3efa3ec43e8b3e20,0x3e483da1bd21be20,0x3f5f3f6d3f763f7d,0x3f553f263ed63e20,0xbf49bf6dbf7ebf7d,0x3f0e3f433f683f7d,0x3f1e3ec43df1be20
.quad 0x3f803f803f803f80,0x3f803f803f803f80,0x8000800080008000,0x8000800080008000,0xbf7dbf73bf64bf4f,0x3f353f163ee83e9e,0xbe20be9ebee8bf16,0x3f353f4f3f643f73,0x3f2e3f263f1e3f16,0x3f7b3f793f763f73,0x3f3c3f433f493f4f,0x3e483e6f3e8b3e9e,0xbf0ebec4be48248d,0x3f0e3ec43e48a554,0xbf55bf6dbf7bbf80,0x3f553f6d3f7b3f80
.quad 0xbda1be20be6fbe9e,0x3f6d3f643f5a3f4f,0x3f7f3f7d3f793f73,0x3ec43ee83f063f16,0x3e6f3ee83f263f4f,0x3ec43e20bda1be9e,0xbf79bf64bf43bf16,0x3f6d3f7d3f7f3f73,0xbf49bf5abf68bf73,0x3f553f433f2e3f16,0x3f1e3f063ed63e9e,0x3f0e3f263f3c3f4f,0x3f5f3f793f803f73,0x3e48bda1beb1bf16,0xbefabe6f3d213e9e,0x3f7b3f7f3f703f4f
.quad 0x3f803f803f803f80,0x3f803f803f803f80,0x8000800080008000,0x8000800080008000,0xbf64bf73bf7dbf80,0x3f7d3f733f643f4f,0x3ee83e9e3e20a50d,0x3e203e9e3ee83f16,0x3f493f433f3c3f35,0x3f803f7f3f7e3f7d,0x3f1e3f263f2e3f35,0x3d213da13df13e20,0xbf7bbf6dbf55bf35,0x3f7b3f6d3f553f35,0xbe48bec4bf0ebf35,0x3e483ec43f0e3f35
.quad 0x3e6f3e203da1a554,0x3f7f3f7d3f793f73,0x3f793f7d3f7f3f80,0x3da13e203e6f3e9e,0xbf26bee8be6f248d,0x3f793f643f433f16,0xbf43bf64bf79bf80,0x3e6f3ee83f263f4f,0xbed6bf06bf1ebf35,0x3f7e3f793f703f64,0x3f683f5a3f493f35,0x3df13e6f3eb13ee8,0xbd213e6f3efa3f35,0x3f763f5a3f2e3ee8,0xbf80bf79bf5fbf35,0x3e8b3f063f3c3f64
.quad 0x3f163f4f3f733f80,0x3f733f4f3f163e9e,0xbf4fbf16be9e8000,0x3e9e3f163f4f3f73,0x3e203f163f643f80,0xbf64bf16be203e9e,0xbf7dbf4fbee88000,0xbee8bf4fbf7dbf73,0x3efa3f433f703f80,0x3f683f7f3f763f4f,0xbf5fbf26beb18000,0xbed6bda13e8b3f16,0x3d213f063f5f3f80,0xbf76bf79bf3cbe9e,0xbf80bf5abefa8000,0x3e8bbe6fbf2ebf73
.quad 0x3ec43f353f6d3f80,0x3ec43f353f6d3f80,0xbf6dbf35bec48000,0xbf6dbf35bec48000,0xbda13ee83f5a3f80,0xbf06bf64bf7fbf4f,0xbf7fbf64bf068000,0x3f5a3ee8bda1bf16,0x3e8b3f263f683f80,0xbeb13da13efa3f4f,0xbf76bf43bed68000,0xbf70bf7fbf5fbf16,0xbe483ec43f553f80,0x3e48bec4bf55bf80,0xbf7bbf6dbf0e8000,0x3f7b3f6d3f0ea50d
.quad 0xbf16be9e248d3e9e,0x3f163f4f3f733f80,0xbf4fbf73bf80bf73,0xbf4fbf16be9e8000,0xbf7dbf73bf35be9e,0xbe20bf16bf64bf80,0x3e20be9ebf35bf73,0x3f7d3f4f3ee8a50d,0xbf49bf06be483e20,0xbe8b3da13ed63f35,0xbf1ebf5abf7bbf7d,0xbf76bf7fbf68bf35,0xbf68bf7fbf55bee8,0x3f2e3e6fbe8bbf35,0x3ed6bda1bf0ebf64,0x3f3c3f793f763f35
.quad 0xbf6dbf35bec4248d,0xbf6dbf35bec4248d,0xbec4bf35bf6dbf80,0xbec4bf35bf6dbf80,0xbf43bf7dbf6dbf16,0x3f7f3f643f06a554,0x3f263e20bec4bf4f,0xbda13ee83f5a3f80,0xbf7ebf5abf0ebe20,0xbf5fbf7fbf70bf35,0xbdf1bf06bf55bf7d,0x3efa3da1beb1bf35,0xbf0ebf6dbf7bbf35,0x3f0e3f6d3f7b3f35,0x3f553ec4be48bf35,0xbf55bec43e483f35
.quad 0xbf73bf80bf73bf4f,0xbf16be9e248d3e9e,0x3e9ea50dbe9ebf16,0xbf4fbf73bf80bf73,0x3ee8a554bee8bf4f,0x3f7d3f733f353e9e,0x3f643f803f643f16,0xbe203e9e3f353f73,0xbf3cbf6dbf80bf73,0xbf7ebf79bf55bf16,0x3f2e3ec43d21be9e,0x3df1be6fbf0ebf4f,0x3f493ec4bdf1bf16,0x3eb13f433f7b3f73,0x3f1e3f6d3f7e3f4f,0xbf70bf26be483e9e
.quad 0xbec4bf35bf6dbf80,0xbec4bf35bf6dbf80,0x3f6d3f353ec4a50d,0x3f6d3f353ec4a50d,0x3f793f353e6fbe9e,0xbf26be203ec43f4f,0x3e6f3f353f793f73,0xbf43bf7dbf6dbf16,0x3d21bec4bf3cbf73,0x3f1e3e6fbe48bf16,0x3f803f6d3f2e3e9e,0x3f493f793f7b3f4f,0x3f7b3f6d3f0ea554,0xbf7bbf6dbf0e248d,0xbe483ec43f553f80,0x3e48bec4bf55bf80
.quad 0xa554be9ebf16bf4f,0xbf73bf80bf73bf4f,0x3f803f733f4f3f16,0x3e9ea50dbe9ebf16,0x3f353f733f7d3f4f,0xbee8248d3ee83f4f,0xbf35be9e3e203f16,0xbf64bf80bf64bf16,0x3f0e3e6fbdf1bee8,0xbd21bec4bf2ebf64,0x3f553f793f7e3f64,0x3f803f6d3f3c3ee8,0x3e483f263f703f7d,0xbf7ebf6dbf1ebe20,0xbf7bbf43beb13e20,0x3df1bec4bf49bf7d
.quad 0x3f6d3f353ec4a554,0x3f6d3f353ec4a554,0x3ec43f353f6d3f80,0x3ec43f353f6d3f80,0xbec43e203f263f73,0xbe6fbf35bf79bf73,0xbf6dbf7dbf43be9e,0x3f793f353e6fbe9e,0x3f7b3f793f493ee8,0x3f2e3f6d3f803f64,0xbe483e6f3f1e3f64,0xbf3cbec43d213ee8,0xbf55bec43e483f35,0x3f553ec4be48bf35,0xbf0ebf6dbf7bbf35,0x3f0e3f6d3f7b3f35
.quad 0xa554be9ebf16bf4f,0xbf73bf80bf73bf4f,0x3f803f733f4f3f16,0x3e9ea50dbe9ebf16,0xbf35bf73bf7dbf4f,0x3ee8a554bee8bf4f,0x3f353e9ebe20bf16,0x3f643f803f643f16,0x3f7b3f5a3f1e3e9e,0x3f2e3ec43d21be9e,0x3e483f063f493f73,0x3f3c3f6d3f803f73,0x3f0e3da1bed6bf4f,0x3f1e3f6d3f7e3f4f,0x3f553f7f3f683f16,0xbf49bec43df13f16
.quad 0x3ec43f353f6d3f80,0x3ec43f353f6d3f80,0xbf6dbf35bec48000,0xbf6dbf35bec48000,0x3f6d3f7d3f433e9e,0xbf79bf35be6f3e9e,0xbec43e203f263f73,0xbe6fbf35bf79bf73,0xbf55bf06bdf13e9e,0xbf80bf6dbf2ebe9e,0xbf0ebf5abf7ebf73,0x3d21bec4bf3cbf73,0xbe483ec43f553f80,0x3e48bec4bf55bf80,0xbf7bbf6dbf0e8000,0x3f7b3f6d3f0ea50d
.quad 0x3f733f4f3f163e9e,0xa554be9ebf16bf4f,0x3e9e3f163f4f3f73,0x3f803f733f4f3f16,0x3f643f163e20be9e,0x3f353f733f7d3f4f,0x3ee83f4f3f7d3f73,0xbf35be9e3e203f16,0x3eb13f263f5f3f7d,0x3f553f793f7e3f64,0xbf70bf43befabe20,0xbf0ebe6f3df13ee8,0x3efa3f5a3f803f64,0xbf7bbf43beb13e20,0xbf5fbf06bd213ee8,0xbe48bf26bf70bf7d
.quad 0xbf6dbf35bec4248d,0xbf6dbf35bec4248d,0xbec4bf35bf6dbf80,0xbec4bf35bf6dbf80,0xbf5abee83da13f16,0x3ec4be20bf26bf73,0xbf06bf64bf7fbf4f,0x3f6d3f7d3f433e9e,0xbed6bf43bf76bf7d,0x3e48be6fbf1ebf64,0x3f683f263e8bbe20,0x3f7b3f793f493ee8,0xbf0ebf6dbf7bbf35,0x3f0e3f6d3f7b3f35,0x3f553ec4be48bf35,0xbf55bec43e483f35
.quad 0x3f163f4f3f733f80,0x3f733f4f3f163e9e,0xbf4fbf16be9e8000,0x3e9e3f163f4f3f73,0x3e203f163f643f80,0xbf64bf16be203e9e,0xbf7dbf4fbee88000,0xbee8bf4fbf7dbf73,0xbf5fbf26beb1248d,0xbed6bda13e8b3f16,0xbefabf43bf70bf80,0xbf68bf7fbf76bf4f,0xbf80bf5abefa248d,0x3e8bbe6fbf2ebf73,0xbd21bf06bf5fbf80,0x3f763f793f3c3e9e
.quad 0xbec4bf35bf6dbf80,0xbec4bf35bf6dbf80,0x3f6d3f353ec4a50d,0x3f6d3f353ec4a50d,0x3da1bee8bf5abf80,0x3f063f643f7f3f4f,0x3f7f3f643f06a50d,0xbf5abee83da13f16,0x3f763f433ed6a554,0x3f703f7f3f5f3f16,0x3e8b3f263f683f80,0xbeb13da13efa3f4f,0x3f7b3f6d3f0ea554,0xbf7bbf6dbf0e248d,0xbe483ec43f553f80,0x3e48bec4bf55bf80
.quad 0xbf16be9e248d3e9e,0x3f163f4f3f733f80,0xbf4fbf73bf80bf73,0xbf4fbf16be9e8000,0xbf7dbf73bf35be9e,0xbe20bf16bf64bf80,0x3e20be9ebf35bf73,0x3f7d3f4f3ee8a50d,0xbf1ebf5abf7bbf7d,0xbf76bf7fbf68bf35,0x3f493f063e48be20,0x3e8bbda1bed6bf35,0x3ed6bda1bf0ebf64,0x3f3c3f793f763f35,0x3f683f7f3f553ee8,0xbf2ebe6f3e8b3f35
.quad 0x3f6d3f353ec4a554,0x3f6d3f353ec4a554,0x3ec43f353f6d3f80,0x3ec43f353f6d3f80,0x3f433f7d3f6d3f16,0xbf7fbf64bf06248d,0xbf26be203ec43f4f,0x3da1bee8bf5abf80,0x3df13f063f553f7d,0xbefabda13eb13f35,0xbf7ebf5abf0ebe20,0xbf5fbf7fbf70bf35,0xbf55bec43e483f35,0x3f553ec4be48bf35,0xbf0ebf6dbf7bbf35,0x3f0e3f6d3f7b3f35
.quad 0xbf16be9e248d3e9e,0x3f163f4f3f733f80,0xbf4fbf73bf80bf73,0xbf4fbf16be9e8000,0x3f7d3f733f353e9e,0x3e203f163f643f80,0xbe203e9e3f353f73,0xbf7dbf4fbee88000,0x3df1be6fbf0ebf4f,0xbefabf43bf70bf80,0x3f7e3f793f553f16,0x3f5f3f263eb1a50d,0xbf70bf26be483e9e,0xbd21bf06bf5fbf80,0xbeb1bf43bf7bbf73,0x3f803f5a3efaa50d
.quad 0x3ec43f353f6d3f80,0x3ec43f353f6d3f80,0xbf6dbf35bec48000,0xbf6dbf35bec48000,0x3f263e20bec4bf4f,0xbda13ee83f5a3f80,0x3f433f7d3f6d3f16,0xbf7fbf64bf068000,0xbf49bf79bf7bbf4f,0xbe8bbf26bf68bf80,0x3f1e3e6fbe48bf16,0x3f763f433ed6a50d,0xbe483ec43f553f80,0x3e48bec4bf55bf80,0xbf7bbf6dbf0e8000,0x3f7b3f6d3f0ea50d
.quad 0xbf73bf80bf73bf4f,0xbf16be9e248d3e9e,0x3e9ea50dbe9ebf16,0xbf4fbf73bf80bf73,0xbee8248d3ee83f4f,0xbf7dbf73bf35be9e,0xbf64bf80bf64bf16,0x3e20be9ebf35bf73,0x3f803f6d3f3c3ee8,0x3f493f063e48be20,0x3d213ec43f2e3f64,0x3f1e3f5a3f7b3f7d,0x3df1bec4bf49bf7d,0x3f683f7f3f553ee8,0x3f7e3f6d3f1e3e20,0xbed63da13f0e3f64
.quad 0xbf6dbf35bec4248d,0xbf6dbf35bec4248d,0xbec4bf35bf6dbf80,0xbec4bf35bf6dbf80,0x3e6f3f353f793f73,0xbf43bf7dbf6dbf16,0xbf79bf35be6f3e9e,0x3f263e20bec4bf4f,0x3f3c3ec4bd21bee8,0x3f7e3f5a3f0e3e20,0x3f2e3f6d3f803f64,0x3df13f063f553f7d,0xbf0ebf6dbf7bbf35,0x3f0e3f6d3f7b3f35,0x3f553ec4be48bf35,0xbf55bec43e483f35
.quad 0xa554be9ebf16bf4f,0xbf73bf80bf73bf4f,0x3f803f733f4f3f16,0x3e9ea50dbe9ebf16,0xbf35bf73bf7dbf4f,0x3ee8a554bee8bf4f,0x3f353e9ebe20bf16,0x3f643f803f643f16,0x3e483f063f493f73,0x3f3c3f6d3f803f73,0xbf7bbf5abf1ebe9e,0xbf2ebec4bd213e9e,0x3f553f7f3f683f16,0xbf49bec43df13f16,0xbf0ebda13ed63f4f,0xbf1ebf6dbf7ebf4f
.quad 0xbec4bf35bf6dbf80,0xbec4bf35bf6dbf80,0x3f6d3f353ec4a50d,0x3f6d3f353ec4a50d,0xbf6dbf7dbf43be9e,0x3f793f353e6fbe9e,0x3ec4be20bf26bf73,0x3e6f3f353f793f73,0x3f0e3f5a3f7e3f73,0xbd213ec43f3c3f73,0xbf55bf06bdf13e9e,0xbf80bf6dbf2ebe9e,0x3f7b3f6d3f0ea554,0xbf7bbf6dbf0e248d,0xbe483ec43f553f80,0x3e48bec4bf55bf80
.quad 0x3f733f4f3f163e9e,0xa554be9ebf16bf4f,0x3e9e3f163f4f3f73,0x3f803f733f4f3f16,0x3f643f163e20be9e,0x3f353f733f7d3f4f,0x3ee83f4f3f7d3f73,0xbf35be9e3e203f16,0xbf70bf43befabe20,0xbf0ebe6f3df13ee8,0xbeb1bf26bf5fbf7d,0xbf55bf79bf7ebf64,0xbf5fbf06bd213ee8,0xbe48bf26bf70bf7d,0xbefabf5abf80bf64,0x3f7b3f433eb1be20
.quad 0x3f6d3f353ec4a554,0x3f6d3f353ec4a554,0x3ec43f353f6d3f80,0x3ec43f353f6d3f80,0x3f5a3ee8bda1bf16,0xbec43e203f263f73,0x3f063f643f7f3f4f,0xbf6dbf7dbf43be9e,0xbf68bf26be8b3e20,0xbf7bbf79bf49bee8,0xbed6bf43bf76bf7d,0x3e48be6fbf1ebf64,0xbf55bec43e483f35,0x3f553ec4be48bf35,0xbf0ebf6dbf7bbf35,0x3f0e3f6d3f7b3f35
.quad 0x3f733f4f3f163e9e,0xa554be9ebf16bf4f,0x3e9e3f163f4f3f73,0x3f803f733f4f3f16,0xbf64bf16be203e9e,0xbf35bf73bf7dbf4f,0xbee8bf4fbf7dbf73,0x3f353e9ebe20bf16,0xbf68bf7fbf76bf4f,0xbf7bbf5abf1ebe9e,0x3ed63da1be8bbf16,0xbe48bf06bf49bf73,0x3f763f793f3c3e9e,0xbf0ebda13ed63f4f,0xbe8b3e6f3f2e3f73,0xbf55bf7fbf68bf16
.quad 0x3ec43f353f6d3f80,0x3ec43f353f6d3f80,0xbf6dbf35bec48000,0xbf6dbf35bec48000,0xbf06bf64bf7fbf4f,0x3f6d3f7d3f433e9e,0x3f5a3ee8bda1bf16,0xbec43e203f263f73,0x3eb1bda1befabf4f,0x3f553f063df1be9e,0x3f703f7f3f5f3f16,0x3f0e3f5a3f7e3f73,0xbe483ec43f553f80,0x3e48bec4bf55bf80,0xbf7bbf6dbf0e8000,0x3f7b3f6d3f0ea50d
.quad 0x3f163f4f3f733f80,0x3f733f4f3f163e9e,0xbf4fbf16be9e8000,0x3e9e3f163f4f3f73,0xbe20bf16bf64bf80,0x3f643f163e20be9e,0x3f7d3f4f3ee8a50d,0x3ee83f4f3f7d3f73,0x3e8bbda1bed6bf35,0xbeb1bf26bf5fbf7d,0x3f763f7f3f683f35,0x3f703f433efa3e20,0xbf2ebe6f3e8b3f35,0xbefabf5abf80bf64,0xbf3cbf79bf76bf35,0x3f5f3f063d21bee8
.quad 0xbf6dbf35bec4248d,0xbf6dbf35bec4248d,0xbec4bf35bf6dbf80,0xbec4bf35bf6dbf80,0x3f7f3f643f06a554,0xbf5abee83da13f16,0xbda13ee83f5a3f80,0xbf06bf64bf7fbf4f,0x3f5f3f7f3f703f35,0x3ed63f433f763f7d,0xbefabda13eb13f35,0xbf68bf26be8b3e20,0xbf0ebf6dbf7bbf35,0x3f0e3f6d3f7b3f35,0x3f553ec4be48bf35,0xbf55bec43e483f35
.quad 0xbf16be9e248d3e9e,0x3f163f4f3f733f80,0xbf4fbf73bf80bf73,0xbf4fbf16be9e8000,0x3f7d3f733f353e9e,0x3e203f163f643f80,0xbe203e9e3f353f73,0xbf7dbf4fbee88000,0x3f7e3f793f553f16,0x3f5f3f263eb1a554,0xbdf13e6f3f0e3f4f,0x3efa3f433f703f80,0xbeb1bf43bf7bbf73,0x3f803f5a3efaa554,0x3f703f263e48be9e,0x3d213f063f5f3f80
.quad 0xbec4bf35bf6dbf80,0xbec4bf35bf6dbf80,0x3f6d3f353ec4a50d,0x3f6d3f353ec4a50d,0xbf26be203ec43f4f,0x3da1bee8bf5abf80,0xbf43bf7dbf6dbf16,0x3f7f3f643f06a50d,0xbf1ebe6f3e483f16,0xbf76bf43bed6248d,0xbf49bf79bf7bbf4f,0xbe8bbf26bf68bf80,0x3f7b3f6d3f0ea554,0xbf7bbf6dbf0e248d,0xbe483ec43f553f80,0x3e48bec4bf55bf80
.quad 0xbf73bf80bf73bf4f,0xbf16be9e248d3e9e,0x3e9ea50dbe9ebf16,0xbf4fbf73bf80bf73,0xbee8248d3ee83f4f,0xbf7dbf73bf35be9e,0xbf64bf80bf64bf16,0x3e20be9ebf35bf73,0x3d213ec43f2e3f64,0x3f1e3f5a3f7b3f7d,0xbf80bf6dbf3cbee8,0xbf49bf06be483e20,0x3f7e3f6d3f1e3e20,0xbed63da13f0e3f64,0xbdf13ec43f493f7d,0xbf68bf7fbf55bee8
.quad 0x3f6d3f353ec4a554,0x3f6d3f353ec4a554,0x3ec43f353f6d3f80,0x3ec43f353f6d3f80,0xbe6fbf35bf79bf73,0x3f433f7d3f6d3f16,0x3f793f353e6fbe9e,0xbf26be203ec43f4f,0xbf2ebf6dbf80bf64,0xbdf1bf06bf55bf7d,0x3f3c3ec4bd21bee8,0x3f7e3f5a3f0e3e20,0xbf55bec43e483f35,0x3f553ec4be48bf35,0xbf0ebf6dbf7bbf35,0x3f0e3f6d3f7b3f35
.quad 0xbf73bf80bf73bf4f,0xbf16be9e248d3e9e,0x3e9ea50dbe9ebf16,0xbf4fbf73bf80bf73,0x3ee8a554bee8bf4f,0x3f7d3f733f353e9e,0x3f643f803f643f16,0xbe203e9e3f353f73,0xbf2ebec4bd213e9e,0xbdf13e6f3f0e3f4f,0xbf3cbf6dbf80bf73,0xbf7ebf79bf55bf16,0xbf1ebf6dbf7ebf4f,0x3f703f263e48be9e,0x3f493ec4bdf1bf16,0x3eb13f433f7b3f73
.quad 0x3ec43f353f6d3f80,0x3ec43f353f6d3f80,0xbf6dbf35bec48000,0xbf6dbf35bec48000,0xbf79bf35be6f3e9e,0x3f263e20bec4bf4f,0xbe6fbf35bf79bf73,0x3f433f7d3f6d3f16,0x3f803f6d3f2e3e9e,0x3f493f793f7b3f4f,0xbd213ec43f3c3f73,0xbf1ebe6f3e483f16,0xbe483ec43f553f80,0x3e48bec4bf55bf80,0xbf7bbf6dbf0e8000,0x3f7b3f6d3f0ea50d
.quad 0xa554be9ebf16bf4f,0xbf73bf80bf73bf4f,0x3f803f733f4f3f16,0x3e9ea50dbe9ebf16,0x3f353f733f7d3f4f,0xbee8248d3ee83f4f,0xbf35be9e3e203f16,0xbf64bf80bf64bf16,0xbf55bf79bf7ebf64,0xbf80bf6dbf3cbee8,0x3f0e3e6fbdf1bee8,0xbd21bec4bf2ebf64,0x3f7b3f433eb1be20,0xbdf13ec43f493f7d,0x3e483f263f703f7d,0xbf7ebf6dbf1ebe20
.quad 0xbf6dbf35bec4248d,0xbf6dbf35bec4248d,0xbec4bf35bf6dbf80,0xbec4bf35bf6dbf80,0x3ec4be20bf26bf73,0x3e6f3f353f793f73,0x3f6d3f7d3f433e9e,0xbf79bf35be6f3e9e,0xbe483e6f3f1e3f64,0xbf3cbec43d213ee8,0xbf7bbf79bf49bee8,0xbf2ebf6dbf80bf64,0xbf0ebf6dbf7bbf35,0x3f0e3f6d3f7b3f35,0x3f553ec4be48bf35,0xbf55bec43e483f35
.quad 0x3f733f4f3f163e9e,0xa554be9ebf16bf4f,0x3e9e3f163f4f3f73,0x3f803f733f4f3f16,0xbf64bf16be203e9e,0xbf35bf73bf7dbf4f,0xbee8bf4fbf7dbf73,0x3f353e9ebe20bf16,0x3ed63da1be8bbf16,0xbe48bf06bf49bf73,0x3f683f7f3f763f4f,0x3f7b3f5a3f1e3e9e,0xbe8b3e6f3f2e3f73,0xbf55bf7fbf68bf16,0xbf76bf79bf3cbe9e,0x3f0e3da1bed6bf4f
.quad 0xbec4bf35bf6dbf80,0xbec4bf35bf6dbf80,0x3f6d3f353ec4a50d,0x3f6d3f353ec4a50d,0x3f063f643f7f3f4f,0xbf6dbf7dbf43be9e,0xbf5abee83da13f16,0x3ec4be20bf26bf73,0xbf70bf7fbf5fbf16,0xbf0ebf5abf7ebf73,0x3eb1bda1befabf4f,0x3f553f063df1be9e,0x3f7b3f6d3f0ea554,0xbf7bbf6dbf0e248d,0xbe483ec43f553f80,0x3e48bec4bf55bf80
.quad 0x3f163f4f3f733f80,0x3f733f4f3f163e9e,0xbf4fbf16be9e8000,0x3e9e3f163f4f3f73,0xbe20bf16bf64bf80,0x3f643f163e20be9e,0x3f7d3f4f3ee8a50d,0x3ee83f4f3f7d3f73,0x3f763f7f3f683f35,0x3f703f433efa3e20,0xbe8b3da13ed63f35,0x3eb13f263f5f3f7d,0xbf3cbf79bf76bf35,0x3f5f3f063d21bee8,0x3f2e3e6fbe8bbf35,0x3efa3f5a3f803f64
.quad 0x3f6d3f353ec4a554,0x3f6d3f353ec4a554,0x3ec43f353f6d3f80,0x3ec43f353f6d3f80,0xbf7fbf64bf06248d,0x3f5a3ee8bda1bf16,0x3da1bee8bf5abf80,0x3f063f643f7f3f4f,0x3efa3da1beb1bf35,0x3f683f263e8bbe20,0x3f5f3f7f3f703f35,0x3ed63f433f763f7d,0xbf55bec43e483f35,0x3f553ec4be48bf35,0xbf0ebf6dbf7bbf35,0x3f0e3f6d3f7b3f35
.quad 0xbe9e3e9e3f4f3f80,0x3f4f3e9ebe9ebf4f,0xbf73bf73bf168000,0x3f163f733f733f16,0xbf35248d3f353f80,0xbf35248d3f353f80,0xbf35bf80bf358000,0xbf35bf80bf358000,0xbed63e6f3f493f80,0x3f7e3f5a3eb1be9e,0xbf68bf79bf1e8000,0xbdf13f063f703f73,0xbf49bda13f2e3f80,0xbf80bf263df13f4f,0xbf1ebf7fbf3c8000,0xbd21bf43bf7ebf16
.quad 0xbf063e203f433f80,0x3f263f7d3f5a3e9e,0xbf5abf7dbf268000,0xbf43be203f063f73,0xbf5abe203f263f80,0xbf43bf7dbf063e9e,0xbf06bf7dbf438000,0x3f26be20bf5abf73,0xbf1e3da13f3c3f80,0xbd213f263f7e3f4f,0xbf49bf7fbf2e8000,0xbf80bf43bdf13f16,0xbf68be6f3f1e3f80,0xbdf1bf5abf70be9e,0xbed6bf79bf498000,0x3f7e3f06beb1bf73
.quad 0xbe9ebf4fbf80bf4f,0xbe9e3e9e3f4f3f80,0x3f733f16a50dbf16,0xbf73bf73bf168000,0x3f35a554bf35bf80,0x3f35a554bf35bf80,0x3f353f803f35a50d,0x3f353f803f35a50d,0xbd21bf26bf7bbf64,0xbf70bf063df13f35,0x3f803f433e48bee8,0xbeb1bf5abf7ebf35,0x3f5f3e6fbf0ebf7d,0x3f7e3f433d21bf35,0x3efa3f793f553e20,0xbdf13f263f803f35
.quad 0x3e6fbee8bf6dbf73,0xbf5abf7dbf26248d,0x3f793f643ec4be9e,0x3f06be20bf43bf80,0x3f793ee8bec4bf73,0x3f063f7d3f43a554,0x3e6f3f643f6d3e9e,0xbf5abe203f263f80,0x3efabe6fbf55bf7d,0xbdf1bf43bf80bf35,0x3f5f3f793f0ebe20,0x3f7e3f26bd21bf35,0x3f803f26be48bf64,0xbeb13f063f7e3f35,0xbd213f433f7b3ee8,0xbf70bf5abdf13f35
.quad 0x3f4f3f803f4f3e9e,0xbe9ebf4fbf80bf4f,0xbf1680003f163f73,0x3f733f16a50dbf16,0xbf35248d3f353f80,0xbf35248d3f353f80,0xbf35bf80bf358000,0xbf35bf80bf358000,0x3efa3f6d3f763f16,0x3f2e3da1bf0ebf73,0xbf5fbec43e8b3f4f,0x3f3c3f7f3f553e9e,0xbf70bec43ed63f73,0xbf76bf5abe483f16,0xbeb1bf6dbf68be9e,0x3e8bbf06bf7bbf4f
.quad 0x3da13f353f7f3f4f,0x3f793f643ec4be9e,0xbf7fbf35bda13f16,0xbe6f3ee83f6d3f73,0xbf7fbf353da13f4f,0xbe6fbf64bf6dbe9e,0x3da1bf35bf7fbf16,0x3f793ee8bec4bf73,0xbeb13ec43f683f73,0x3e8b3f5a3f7b3f16,0xbf70bf6dbed63e9e,0xbf76bf063e483f4f,0xbf5fbf6dbe8b3f16,0x3f3cbda1bf55bf73,0x3efabec4bf76bf4f,0x3f2e3f7f3f0ebe9e
.quad 0xbf80bf4fbe9e3e9e,0x3f4f3f803f4f3e9e,0xa50dbf16bf73bf73,0xbf1680003f163f73,0x3f35a554bf35bf80,0x3f35a554bf35bf80,0x3f353f803f35a50d,0x3f353f803f35a50d,0xbf55bf7fbf3cbe20,0xbe8b3ec43f5f3f7d,0x3f0ebda1bf2ebf7d,0xbf76bf6dbefa3e20,0x3f7b3f06be8bbf64,0x3f683f6d3eb1bee8,0x3e483f5a3f763ee8,0xbed63ec43f703f64
.quad 0xbec4bf64bf79bf16,0xbf7fbf35bda13f16,0x3f6d3ee8be6fbf4f,0xbda1bf35bf7fbf4f,0x3f6d3f643e6fbf16,0xbda13f353f7f3f16,0xbec43ee83f793f4f,0xbf7fbf353da13f4f,0x3e48bf06bf76bf64,0xbed6bf6dbf70bee8,0x3f7b3f5a3e8bbee8,0x3f683ec4beb1bf64,0x3f0e3f7f3f2ebe20,0xbf76bec43efa3f7d,0xbf55bda13f3c3f7d,0xbe8bbf6dbf5fbe20
.quad 0xbf80bf4fbe9e3e9e,0x3f4f3f803f4f3e9e,0xa50dbf16bf73bf73,0xbf1680003f163f73,0xbf35248d3f353f80,0xbf35248d3f353f80,0xbf35bf80bf358000,0xbf35bf80bf358000,0xbe48bf43bf80bf4f,0xbf5fbec43e8b3f4f,0x3f7b3f263d21bf16,0xbefabf6dbf76bf16,0xbf55bf79befa3e9e,0xbeb1bf6dbf68be9e,0x3f0ebe6fbf5fbf73,0x3f703ec4bed6bf73
.quad 0x3f6d3ee8be6fbf4f,0xbda1bf35bf7fbf4f,0x3ec43f643f793f16,0x3f7f3f353da1bf16,0x3ec4bee8bf79bf4f,0x3f7f3f35bda1bf4f,0x3f6d3f643e6fbf16,0xbda13f353f7f3f16,0x3f0e3f793f5f3e9e,0x3f703f6d3ed6be9e,0xbf55be6f3efa3f73,0xbeb13ec43f683f73,0x3f7b3f43bd21bf4f,0xbefa3ec43f763f4f,0xbe483f263f803f16,0xbf5fbf6dbe8b3f16
.quad 0x3f4f3e9ebe9ebf4f,0xbf80bf4fbe9e3e9e,0x3f163f733f733f16,0xa50dbf16bf73bf73,0x3f35a554bf35bf80,0x3f35a554bf35bf80,0x3f353f803f35a50d,0x3f353f803f35a50d,0x3f1e3f793f683ee8,0x3f0ebda1bf2ebf7d,0xbf49be6f3ed63f64,0x3f553f7f3f3c3e20,0x3f3c3f7f3f1ebe20,0x3e483f5a3f763ee8,0xbf2e3da13f493f7d,0xbf7bbf063e8b3f64
.quad 0xbf43be203f063f73,0x3ec43f643f793f16,0xbf26bf7dbf5abe9e,0xbf6dbee83e6f3f4f,0xbf263e203f5a3f73,0xbf6dbf64be6f3f16,0xbf43bf7dbf063e9e,0x3ec4bee8bf79bf4f,0xbf2ebf7fbf49be20,0xbf7bbf5abe8b3ee8,0x3f3c3da1bf1ebf7d,0x3e48bf06bf76bf64,0xbf49bf79bed63ee8,0x3f553da1bf3cbf7d,0x3f1ebe6fbf68bf64,0x3f0e3f7f3f2ebe20
.quad 0xbe9e3e9e3f4f3f80,0x3f4f3e9ebe9ebf4f,0xbf73bf73bf168000,0x3f163f733f733f16,0xbf35248d3f353f80,0xbf35248d3f353f80,0xbf35bf80bf358000,0xbf35bf80bf358000,0xbf68bf79bf1e248d,0xbdf13f063f703f73,0x3ed6be6fbf49bf80,0xbf7ebf5abeb13e9e,0xbf1ebf7fbf3c248d,0xbd21bf43bf7ebf16,0x3f493da1bf2ebf80,0x3f803f26bdf1bf4f
.quad 0x3f06be20bf43bf80,0xbf26bf7dbf5abe9e,0x3f5a3f7d3f26a50d,0x3f433e20bf06bf73,0x3f5a3e20bf26bf80,0x3f433f7d3f06be9e,0x3f063f7d3f43a50d,0xbf263e203f5a3f73,0x3f493f7f3f2ea554,0x3f803f433df1bf16,0xbf1e3da13f3c3f80,0xbd213f263f7e3f4f,0x3ed63f793f49a554,0xbf7ebf063eb13f73,0xbf68be6f3f1e3f80,0xbdf1bf5abf70be9e
.quad 0xbe9ebf4fbf80bf4f,0xbe9e3e9e3f4f3f80,0x3f733f16a50dbf16,0xbf73bf73bf168000,0x3f35a554bf35bf80,0x3f35a554bf35bf80,0x3f353f803f35a50d,0x3f353f803f35a50d,0x3f803f433e48bee8,0xbeb1bf5abf7ebf35,0x3d213f263f7b3f64,0x3f703f06bdf1bf35,0x3efa3f793f553e20,0xbdf13f263f803f35,0xbf5fbe6f3f0e3f7d,0xbf7ebf43bd213f35
.quad 0xbe6f3ee83f6d3f73,0x3f5a3f7d3f26a554,0xbf79bf64bec43e9e,0xbf063e203f433f80,0xbf79bee83ec43f73,0xbf06bf7dbf43248d,0xbe6fbf64bf6dbe9e,0x3f5a3e20bf26bf80,0xbf5fbf79bf0e3e20,0xbf7ebf263d213f35,0x3efabe6fbf55bf7d,0xbdf1bf43bf80bf35,0x3d21bf43bf7bbee8,0x3f703f5a3df1bf35,0x3f803f26be48bf64,0xbeb13f063f7e3f35
.quad 0xbe9ebf4fbf80bf4f,0xbe9e3e9e3f4f3f80,0x3f733f16a50dbf16,0xbf73bf73bf168000,0xbf35248d3f353f80,0xbf35248d3f353f80,0xbf35bf80bf358000,0xbf35bf80bf358000,0x3f3c3f7f3f553e9e,0x3ed6be6fbf49bf80,0xbf2ebda13f0e3f73,0x3f683f793f1ea50d,0x3e8bbf06bf7bbf4f,0x3f493da1bf2ebf80,0x3f763f5a3e48bf16,0x3f1e3f7f3f3ca50d
.quad 0xbf79bf64bec43e9e,0xbf063e203f433f80,0x3e6fbee8bf6dbf73,0xbf5abf7dbf268000,0x3e6f3f643f6d3e9e,0xbf5abe203f263f80,0xbf79bee83ec43f73,0xbf06bf7dbf438000,0x3f763f06be48bf4f,0x3f1ebda1bf3cbf80,0x3e8b3f5a3f7b3f16,0x3f493f7f3f2ea50d,0xbf2ebf7fbf0e3e9e,0x3f683e6fbf1ebf80,0x3f3cbda1bf55bf73,0x3ed63f793f49a50d
.quad 0x3f4f3f803f4f3e9e,0xbe9ebf4fbf80bf4f,0xbf1680003f163f73,0x3f733f16a50dbf16,0x3f35a554bf35bf80,0x3f35a554bf35bf80,0x3f353f803f35a50d,0x3f353f803f35a50d,0xbf76bf6dbefa3e20,0x3d213f263f7b3f64,0x3e8bbec4bf5fbf7d,0xbf80bf43be483ee8,0xbed63ec43f703f64,0xbf5fbe6f3f0e3f7d,0xbf68bf6dbeb13ee8,0xbefabf79bf55be20
.quad 0x3f7f3f353da1bf16,0x3e6fbee8bf6dbf73,0x3da13f353f7f3f4f,0x3f793f643ec4be9e,0x3da1bf35bf7fbf16,0x3f793ee8bec4bf73,0x3f7f3f35bda1bf4f,0x3e6f3f643f6d3e9e,0xbf68bec43eb13f64,0xbefa3e6f3f553f7d,0xbed6bf6dbf70bee8,0xbf5fbf79bf0e3e20,0x3e8b3f6d3f5f3e20,0xbf80bf263e483f64,0xbf76bec43efa3f7d,0x3d21bf43bf7bbee8
.quad 0xbf80bf4fbe9e3e9e,0x3f4f3f803f4f3e9e,0xa50dbf16bf73bf73,0xbf1680003f163f73,0xbf35248d3f353f80,0xbf35248d3f353f80,0xbf35bf80bf358000,0xbf35bf80bf358000,0x3f7b3f263d21bf16,0xbefabf6dbf76bf16,0x3e483f433f803f4f,0x3f5f3ec4be8bbf4f,0x3f0ebe6fbf5fbf73,0x3f703ec4bed6bf73,0x3f553f793efabe9e,0x3eb13f6d3f683e9e
.quad 0xbf6dbee83e6f3f4f,0x3da13f353f7f3f4f,0xbec4bf64bf79bf16,0xbf7fbf35bda13f16,0xbec43ee83f793f4f,0xbf7fbf353da13f4f,0xbf6dbf64be6f3f16,0x3da1bf35bf7fbf16,0x3f553e6fbefabf73,0x3eb1bec4bf68bf73,0x3f0e3f793f5f3e9e,0x3f703f6d3ed6be9e,0x3e48bf26bf80bf16,0x3f5f3f6d3e8bbf16,0x3f7b3f43bd21bf4f,0xbefa3ec43f763f4f
.quad 0x3f4f3e9ebe9ebf4f,0xbf80bf4fbe9e3e9e,0x3f163f733f733f16,0xa50dbf16bf73bf73,0x3f35a554bf35bf80,0x3f35a554bf35bf80,0x3f353f803f35a50d,0x3f353f803f35a50d,0xbf49be6f3ed63f64,0x3f553f7f3f3c3e20,0xbf1ebf79bf68bee8,0xbf0e3da13f2e3f7d,0xbf2e3da13f493f7d,0xbf7bbf063e8b3f64,0xbf3cbf7fbf1e3e20,0xbe48bf5abf76bee8
.quad 0x3f433e20bf06bf73,0xbec4bf64bf79bf16,0x3f263f7d3f5a3e9e,0x3f6d3ee8be6fbf4f,0x3f26be20bf5abf73,0x3f6d3f643e6fbf16,0x3f433f7d3f06be9e,0xbec43ee83f793f4f,0xbf3cbda13f1e3f7d,0xbe483f063f763f64,0xbf2ebf7fbf49be20,0xbf7bbf5abe8b3ee8,0xbf1e3e6f3f683f64,0xbf0ebf7fbf2e3e20,0xbf49bf79bed63ee8,0x3f553da1bf3cbf7d
.quad 0x3f4f3e9ebe9ebf4f,0xbf80bf4fbe9e3e9e,0x3f163f733f733f16,0xa50dbf16bf73bf73,0xbf35248d3f353f80,0xbf35248d3f353f80,0xbf35bf80bf358000,0xbf35bf80bf358000,0xbf7ebf5abeb13e9e,0x3e483f433f803f4f,0x3df1bf06bf70bf73,0xbf7bbf26bd213f16,0x3f803f26bdf1bf4f,0x3f553f793efabe9e,0x3d213f433f7e3f16,0xbf0e3e6f3f5f3f73
.quad 0x3f263f7d3f5a3e9e,0x3f6d3ee8be6fbf4f,0xbf43be203f063f73,0x3ec43f643f793f16,0xbf43bf7dbf063e9e,0x3ec4bee8bf79bf4f,0x3f26be20bf5abf73,0x3f6d3f643e6fbf16,0x3d21bf26bf7ebf4f,0xbf0ebf79bf5fbe9e,0x3f803f433df1bf16,0x3f553e6fbefabf73,0x3df13f5a3f703e9e,0xbf7bbf433d213f4f,0xbf7ebf063eb13f73,0x3e48bf26bf80bf16
.quad 0xbe9e3e9e3f4f3f80,0x3f4f3e9ebe9ebf4f,0xbf73bf73bf168000,0x3f163f733f733f16,0x3f35a554bf35bf80,0x3f35a554bf35bf80,0x3f353f803f35a50d,0x3f353f803f35a50d,0x3f703f06bdf1bf35,0xbf1ebf79bf68bee8,0x3eb13f5a3f7e3f35,0x3f493e6fbed6bf64,0xbf7ebf43bd213f35,0xbf3cbf7fbf1e3e20,0x3df1bf26bf80bf35,0x3f2ebda1bf49bf7d
.quad 0xbf5abf7dbf26248d,0xbf43be203f063f73,0x3f06be20bf43bf80,0xbf26bf7dbf5abe9e,0x3f063f7d3f43a554,0xbf263e203f5a3f73,0xbf5abe203f263f80,0xbf43bf7dbf063e9e,0x3df13f433f803f35,0x3f2e3f7f3f493e20,0xbf7ebf263d213f35,0xbf3cbda13f1e3f7d,0x3eb1bf06bf7ebf35,0x3f493f793ed6bee8,0x3f703f5a3df1bf35,0xbf1e3e6f3f683f64
.quad 0xbe9ebf4fbf80bf4f,0xbe9e3e9e3f4f3f80,0x3f733f16a50dbf16,0xbf73bf73bf168000,0xbf35248d3f353f80,0xbf35248d3f353f80,0xbf35bf80bf358000,0xbf35bf80bf358000,0xbf2ebda13f0e3f73,0x3f683f793f1ea554,0xbf3cbf7fbf55be9e,0xbed63e6f3f493f80,0x3f763f5a3e48bf16,0x3f1e3f7f3f3ca554,0xbe8b3f063f7b3f4f,0xbf49bda13f2e3f80
.quad 0x3f793f643ec4be9e,0x3f06be20bf43bf80,0xbe6f3ee83f6d3f73,0x3f5a3f7d3f26a50d,0xbe6fbf64bf6dbe9e,0x3f5a3e20bf26bf80,0x3f793ee8bec4bf73,0x3f063f7d3f43a50d,0xbe8bbf5abf7bbf16,0xbf49bf7fbf2e248d,0x3f763f06be48bf4f,0x3f1ebda1bf3cbf80,0xbf3c3da13f553f73,0xbed6bf79bf49248d,0xbf2ebf7fbf0e3e9e,0x3f683e6fbf1ebf80
.quad 0x3f4f3f803f4f3e9e,0xbe9ebf4fbf80bf4f,0xbf1680003f163f73,0x3f733f16a50dbf16,0x3f35a554bf35bf80,0x3f35a554bf35bf80,0x3f353f803f35a50d,0x3f353f803f35a50d,0x3e8bbec4bf5fbf7d,0xbf80bf43be483ee8,0x3f763f6d3efabe20,0xbd21bf26bf7bbf64,0xbf68bf6dbeb13ee8,0xbefabf79bf55be20,0x3ed6bec4bf70bf64,0x3f5f3e6fbf0ebf7d
.quad 0xbf7fbf35bda13f16,0xbe6f3ee83f6d3f73,0xbda1bf35bf7fbf4f,0xbf79bf64bec43e9e,0xbda13f353f7f3f16,0xbf79bee83ec43f73,0xbf7fbf353da13f4f,0xbe6fbf64bf6dbe9e,0x3ed63f6d3f703ee8,0x3f5f3f793f0ebe20,0xbf68bec43eb13f64,0xbefa3e6f3f553f7d,0x3f763ec4befabf7d,0xbd213f433f7b3ee8,0x3e8b3f6d3f5f3e20,0xbf80bf263e483f64
.quad 0x3f4f3f803f4f3e9e,0xbe9ebf4fbf80bf4f,0xbf1680003f163f73,0x3f733f16a50dbf16,0xbf35248d3f353f80,0xbf35248d3f353f80,0xbf35bf80bf358000,0xbf35bf80bf358000,0x3f5f3ec4be8bbf4f,0xbf3cbf7fbf55be9e,0x3efa3f6d3f763f16,0x3f2e3da1bf0ebf73,0x3eb13f6d3f683e9e,0xbe8b3f063f7b3f4f,0xbf70bec43ed63f73,0xbf76bf5abe483f16
.quad 0xbda1bf35bf7fbf4f,0xbf79bf64bec43e9e,0x3f7f3f353da1bf16,0x3e6fbee8bf6dbf73,0x3f7f3f35bda1bf4f,0x3e6f3f643f6d3e9e,0xbda13f353f7f3f16,0xbf79bee83ec43f73,0xbf70bf6dbed63e9e,0xbf76bf063e483f4f,0x3eb1bec4bf68bf73,0xbe8bbf5abf7bbf16,0x3efabec4bf76bf4f,0x3f2e3f7f3f0ebe9e,0x3f5f3f6d3e8bbf16,0xbf3c3da13f553f73
.quad 0xbf80bf4fbe9e3e9e,0x3f4f3f803f4f3e9e,0xa50dbf16bf73bf73,0xbf1680003f163f73,0x3f35a554bf35bf80,0x3f35a554bf35bf80,0x3f353f803f35a50d,0x3f353f803f35a50d,0xbf0e3da13f2e3f7d,0x3f763f6d3efabe20,0xbf55bf7fbf3cbe20,0xbe8b3ec43f5f3f7d,0xbe48bf5abf76bee8,0x3ed6bec4bf70bf64,0x3f7b3f06be8bbf64,0x3f683f6d3eb1bee8
.quad 0x3ec43f643f793f16,0x3f7f3f353da1bf16,0xbf6dbee83e6f3f4f,0x3da13f353f7f3f4f,0xbf6dbf64be6f3f16,0x3da1bf35bf7fbf16,0x3ec4bee8bf79bf4f,0x3f7f3f35bda1bf4f,0x3f7b3f5a3e8bbee8,0x3f683ec4beb1bf64,0xbe483f063f763f64,0x3ed63f6d3f703ee8,0xbf55bda13f3c3f7d,0xbe8bbf6dbf5fbe20,0xbf0ebf7fbf2e3e20,0x3f763ec4befabf7d
.quad 0x3f4f3e9ebe9ebf4f,0xbf80bf4fbe9e3e9e,0x3f163f733f733f16,0xa50dbf16bf73bf73,0xbf35248d3f353f80,0xbf35248d3f353f80,0xbf35bf80bf358000,0xbf35bf80bf358000,0x3df1bf06bf70bf73,0xbf7bbf26bd213f16,0x3f7e3f5a3eb1be9e,0xbe48bf43bf80bf4f,0x3d213f433f7e3f16,0xbf0e3e6f3f5f3f73,0xbf80bf263df13f4f,0xbf55bf79befa3e9e
.quad 0xbf26bf7dbf5abe9e,0xbf6dbee83e6f3f4f,0x3f433e20bf06bf73,0xbec4bf64bf79bf16,0x3f433f7d3f06be9e,0xbec43ee83f793f4f,0xbf263e203f5a3f73,0xbf6dbf64be6f3f16,0xbf80bf43bdf13f16,0xbf55be6f3efa3f73,0x3d21bf26bf7ebf4f,0xbf0ebf79bf5fbe9e,0x3f7e3f06beb1bf73,0xbe483f263f803f16,0x3df13f5a3f703e9e,0xbf7bbf433d213f4f
.quad 0xbe9e3e9e3f4f3f80,0x3f4f3e9ebe9ebf4f,0xbf73bf73bf168000,0x3f163f733f733f16,0x3f35a554bf35bf80,0x3f35a554bf35bf80,0x3f353f803f35a50d,0x3f353f803f35a50d,0x3eb13f5a3f7e3f35,0x3f493e6fbed6bf64,0xbf70bf063df13f35,0x3f1e3f793f683ee8,0x3df1bf26bf80bf35,0x3f2ebda1bf49bf7d,0x3f7e3f433d21bf35,0x3f3c3f7f3f1ebe20
.quad 0x3f5a3f7d3f26a554,0x3f433e20bf06bf73,0xbf063e203f433f80,0x3f263f7d3f5a3e9e,0xbf06bf7dbf43248d,0x3f26be20bf5abf73,0x3f5a3e20bf26bf80,0x3f433f7d3f06be9e,0x3f7e3f26bd21bf35,0x3f3c3da1bf1ebf7d,0x3df13f433f803f35,0x3f2e3f7f3f493e20,0xbf70bf5abdf13f35,0x3f1ebe6fbf68bf64,0x3eb1bf06bf7ebf35,0x3f493f793ed6bee8
.quad 0xbf73be9e3f163f80,0x3f16be9ebf73bf4f,0xbe9ebf73bf4f8000,0x3f4f3f733e9ebf16,0xbf7dbf163ee83f80,0xbee83f163f7d3e9e,0x3e20bf4fbf648000,0xbf64bf4f3e203f73,0xbf7bbec43f0e3f80,0x3f7b3ec4bf0ebf80,0xbe48bf6dbf558000,0x3e483f6d3f55a50d,0xbf76bf263ed63f80,0xbf70bda13f5f3f4f,0x3e8bbf43bf688000,0xbeb1bf7fbefa3f16
.quad 0xbf7fbee83f063f80,0x3f5a3f643da1bf4f,0xbda1bf64bf5a8000,0xbf063ee83f7f3f16,0xbf6dbf353ec43f80,0xbf6dbf353ec43f80,0x3ec4bf35bf6d8000,0x3ec4bf35bf6d8000,0xbf80bf063efa3f80,0x3e8b3f793f2ebe9e,0x3d21bf5abf5f8000,0xbf76be6f3f3c3f73,0xbf5fbf433eb13f80,0xbed6bf7fbe8b3f4f,0x3efabf26bf708000,0x3f68bda1bf76bf16
.quad 0x3f733f4fa554bf4f,0xbf73be9e3f163f80,0xbe9e3f163f803f16,0xbe9ebf73bf4f8000,0x3e203f733f35be9e,0x3f7d3f16bee8bf80,0xbf7dbe9e3f353f73,0xbe203f4f3f64a50d,0x3f553f6d3e48bf35,0xbf55bf6dbe483f35,0xbf0e3ec43f7b3f35,0x3f0ebec4bf7bbf35,0xbdf13f5a3f55be20,0x3efa3f7f3eb1bf35,0xbf7ebf063f0e3f7d,0xbf5f3da13f703f35
.quad 0x3f263f7d3ec4bf16,0xbda1bf64bf5a248d,0xbf433e203f6d3f4f,0x3f7f3ee8bf06bf80,0xbec43f353f6da554,0xbec43f353f6da554,0xbf6dbf353ec43f80,0xbf6dbf353ec43f80,0x3ed63f7f3f0ebee8,0x3f3cbe6fbf76bf35,0xbf68bda13f553f64,0x3f2e3f793e8bbf35,0xbf1e3f063f7b3e20,0xbf76bda13f683f35,0xbf49bf5a3e483f7d,0xbe8bbf7fbed63f35
.quad 0xbf16bf80bf163e9e,0x3f733f4fa554bf4f,0x3f4fa50dbf4fbf73,0xbe9e3f163f803f16,0x3f64a554bf64bf4f,0xbe20bf73bf353e9e,0x3ee83f803ee8bf16,0x3f7d3e9ebf35bf73,0xbe48bf6dbf55248d,0x3e483f6d3f55a554,0x3f7b3ec4bf0ebf80,0xbf7bbec43f0e3f80,0x3f803ec4bf2ebf73,0x3f49be6fbf7bbf16,0x3d213f6d3f3cbe9e,0x3f1e3f793e48bf4f
.quad 0x3e6fbf35bf79be9e,0xbf433e203f6d3f4f,0x3f793f35be6fbf73,0xbf26bf7dbec43f16,0x3f6d3f35bec4bf80,0x3f6d3f35bec4bf80,0xbec43f353f6da50d,0xbec43f353f6da50d,0x3f1ebec4bf7ebf16,0xbf70bf433e483f73,0x3f493f6d3df1bf4f,0x3eb1bf26bf7bbe9e,0x3f2e3f6dbd21bf73,0x3df13f793f0ebf16,0xbf3c3ec43f803e9e,0xbf7ebe6f3f553f4f
.quad 0x248d3f4f3f733e9e,0xbf16bf80bf163e9e,0xbf80bf163e9e3f73,0x3f4fa50dbf4fbf73,0xbf35bf73be203f4f,0xbf64248d3f643f4f,0x3f35be9ebf7dbf16,0xbee8bf80bee83f16,0xbf0e3ec43f7b3f35,0x3f0ebec4bf7bbf35,0xbf55bf6dbe483f35,0x3f553f6d3e48bf35,0xbe48bf79bf1e3ee8,0xbf3cbf6dbd213f64,0x3f7b3e6fbf49bf64,0x3f2ebec4bf80bee8
.quad 0xbf6dbe203f433f73,0x3f793f35be6fbf73,0xbec4bf7dbf263e9e,0xbe6f3f353f793e9e,0x3ec4bf35bf6d248d,0x3ec4bf35bf6d248d,0x3f6d3f35bec4bf80,0x3f6d3f35bec4bf80,0xbf7bbf263eb13f7d,0x3df13f6d3f49be20,0x3e48bf43bf70be20,0xbf7ebec43f1e3f7d,0x3f55be6fbf7ebee8,0x3f803ec4bf3cbf64,0x3f0e3f793df1bf64,0xbd213f6d3f2ebee8
.quad 0x248d3f4f3f733e9e,0xbf16bf80bf163e9e,0xbf80bf163e9e3f73,0x3f4fa50dbf4fbf73,0x3f353f733e20bf4f,0x3f64a554bf64bf4f,0xbf353e9e3f7d3f16,0x3ee83f803ee8bf16,0xbf7bbec43f0e3f80,0x3f7b3ec4bf0ebf80,0xbe48bf6dbf558000,0x3e483f6d3f55a50d,0xbf0e3f063f7e3e9e,0x3d213f6d3f3cbe9e,0xbf55bf5a3df13f73,0xbf80bec43f2e3f73
.quad 0xbec4bf7dbf263e9e,0xbe6f3f353f793e9e,0x3f6d3e20bf43bf73,0xbf79bf353e6f3f73,0xbf6dbf353ec43f80,0xbf6dbf353ec43f80,0x3ec4bf35bf6d8000,0x3ec4bf35bf6d8000,0x3f55bda1bf68bf4f,0xbf49bf6dbdf13f4f,0x3f0e3f7f3ed6bf16,0x3f1ebec4bf7ebf16,0x3e48bf5abf493e9e,0x3f3cbec4bf80be9e,0x3f7b3f06bf1ebf73,0x3f2e3f6dbd21bf73
.quad 0x3f16be9ebf73bf4f,0x248d3f4f3f733e9e,0x3f4f3f733e9ebf16,0xbf80bf163e9e3f73,0x3ee8bf16bf7dbe9e,0xbf35bf73be203f4f,0x3f643f4fbe20bf73,0x3f35be9ebf7dbf16,0x3f553f6d3e48bf35,0xbf55bf6dbe483f35,0xbf0e3ec43f7b3f35,0x3f0ebec4bf7bbf35,0x3f683f43be8bbf7d,0x3f7b3e6fbf49bf64,0xbed63f263f763e20,0x3e483f793f1ebee8
.quad 0xbf063ee83f7f3f16,0x3f6d3e20bf43bf73,0xbf5abf64bda13f4f,0x3ec43f7d3f26be9e,0xbec43f353f6da554,0xbec43f353f6da554,0xbf6dbf353ec43f80,0xbf6dbf353ec43f80,0xbf5fbf5a3d213f64,0xbe483f433f703e20,0x3efabf06bf80bee8,0xbf7bbf263eb13f7d,0xbf70bf263efa3f7d,0xbf0ebf79bdf13f64,0x3eb1bf43bf5f3e20,0x3f55be6fbf7ebee8
.quad 0xbf73be9e3f163f80,0x3f16be9ebf73bf4f,0xbe9ebf73bf4f8000,0x3f4f3f733e9ebf16,0xbf7dbf163ee83f80,0xbee83f163f7d3e9e,0x3e20bf4fbf648000,0xbf64bf4f3e203f73,0xbe48bf6dbf55248d,0x3e483f6d3f55a554,0x3f7b3ec4bf0ebf80,0xbf7bbec43f0e3f80,0x3e8bbf43bf68248d,0xbeb1bf7fbefa3f16,0x3f763f26bed6bf80,0x3f703da1bf5fbf4f
.quad 0x3f7f3ee8bf06bf80,0xbf5abf64bda13f4f,0x3da13f643f5aa50d,0x3f06bee8bf7fbf16,0x3f6d3f35bec4bf80,0x3f6d3f35bec4bf80,0xbec43f353f6da50d,0xbec43f353f6da50d,0xbd213f5a3f5fa554,0x3f763e6fbf3cbf73,0xbf80bf063efa3f80,0x3e8b3f793f2ebe9e,0xbefa3f263f70a554,0xbf683da13f763f16,0xbf5fbf433eb13f80,0xbed6bf7fbe8b3f4f
.quad 0x3f733f4fa554bf4f,0xbf73be9e3f163f80,0xbe9e3f163f803f16,0xbe9ebf73bf4f8000,0x3e203f733f35be9e,0x3f7d3f16bee8bf80,0xbf7dbe9e3f353f73,0xbe203f4f3f64a50d,0xbf0e3ec43f7b3f35,0x3f0ebec4bf7bbf35,0xbf55bf6dbe483f35,0x3f553f6d3e48bf35,0xbf7ebf063f0e3f7d,0xbf5f3da13f703f35,0x3df1bf5abf553e20,0xbefabf7fbeb13f35
.quad 0xbf26bf7dbec43f16,0x3da13f643f5aa554,0x3f43be20bf6dbf4f,0xbf7fbee83f063f80,0x3ec4bf35bf6d248d,0x3ec4bf35bf6d248d,0x3f6d3f35bec4bf80,0x3f6d3f35bec4bf80,0x3f683da1bf55bf64,0xbf2ebf79be8b3f35,0x3ed63f7f3f0ebee8,0x3f3cbe6fbf76bf35,0x3f493f5abe48bf7d,0x3e8b3f7f3ed6bf35,0xbf1e3f063f7b3e20,0xbf76bda13f683f35
.quad 0x3f733f4fa554bf4f,0xbf73be9e3f163f80,0xbe9e3f163f803f16,0xbe9ebf73bf4f8000,0xbe20bf73bf353e9e,0xbf7dbf163ee83f80,0x3f7d3e9ebf35bf73,0x3e20bf4fbf648000,0xbf7bbec43f0e3f80,0x3f7b3ec4bf0ebf80,0xbe48bf6dbf558000,0x3e483f6d3f55a50d,0x3f1e3f793e48bf4f,0x3f763f26bed6bf80,0xbf493e6f3f7b3f16,0xbe8b3f433f68a50d
.quad 0x3f43be20bf6dbf4f,0xbf7fbee83f063f80,0x3f263f7d3ec4bf16,0xbda1bf64bf5a8000,0xbf6dbf353ec43f80,0xbf6dbf353ec43f80,0x3ec4bf35bf6d8000,0x3ec4bf35bf6d8000,0xbeb13f263f7b3e9e,0x3f803f06befabf80,0xbf70bf433e483f73,0xbd213f5a3f5fa50d,0x3f7e3e6fbf55bf4f,0x3f5f3f43beb1bf80,0x3df13f793f0ebf16,0xbefa3f263f70a50d
.quad 0xbf16bf80bf163e9e,0x3f733f4fa554bf4f,0x3f4fa50dbf4fbf73,0xbe9e3f163f803f16,0xbf64248d3f643f4f,0x3e203f733f35be9e,0xbee8bf80bee83f16,0xbf7dbe9e3f353f73,0x3f553f6d3e48bf35,0xbf55bf6dbe483f35,0xbf0e3ec43f7b3f35,0x3f0ebec4bf7bbf35,0x3f2ebec4bf80bee8,0x3df1bf5abf553e20,0x3f3c3f6d3d21bf64,0x3f7e3f06bf0ebf7d
.quad 0xbf79bf353e6f3f73,0x3f263f7d3ec4bf16,0x3e6fbf35bf79be9e,0xbf433e203f6d3f4f,0xbec43f353f6da554,0xbec43f353f6da554,0xbf6dbf353ec43f80,0xbf6dbf353ec43f80,0x3f7e3ec4bf1ebf7d,0xbed6bf7fbf0e3ee8,0x3df13f6d3f49be20,0x3f683da1bf55bf64,0x3d21bf6dbf2e3ee8,0x3f1ebf06bf7bbe20,0x3f803ec4bf3cbf64,0x3f493f5abe48bf7d
.quad 0x248d3f4f3f733e9e,0xbf16bf80bf163e9e,0xbf80bf163e9e3f73,0x3f4fa50dbf4fbf73,0x3f353f733e20bf4f,0x3f64a554bf64bf4f,0xbf353e9e3f7d3f16,0x3ee83f803ee8bf16,0xbe48bf6dbf55248d,0x3e483f6d3f55a554,0x3f7b3ec4bf0ebf80,0xbf7bbec43f0e3f80,0xbf55bf5a3df13f73,0xbf80bec43f2e3f73,0x3f0ebf06bf7ebe9e,0xbd21bf6dbf3c3e9e
.quad 0x3ec43f7d3f26be9e,0x3e6fbf35bf79be9e,0xbf6dbe203f433f73,0x3f793f35be6fbf73,0x3f6d3f35bec4bf80,0x3f6d3f35bec4bf80,0xbec43f353f6da50d,0xbec43f353f6da50d,0xbf0ebf7fbed63f16,0xbf1e3ec43f7e3f16,0x3f55bda1bf68bf4f,0xbf49bf6dbdf13f4f,0xbf7bbf063f1e3f73,0xbf2ebf6d3d213f73,0x3e48bf5abf493e9e,0x3f3cbec4bf80be9e
.quad 0x3f16be9ebf73bf4f,0x248d3f4f3f733e9e,0x3f4f3f733e9ebf16,0xbf80bf163e9e3f73,0x3ee8bf16bf7dbe9e,0xbf35bf73be203f4f,0x3f643f4fbe20bf73,0x3f35be9ebf7dbf16,0xbf0e3ec43f7b3f35,0x3f0ebec4bf7bbf35,0xbf55bf6dbe483f35,0x3f553f6d3e48bf35,0xbed63f263f763e20,0x3e483f793f1ebee8,0xbf68bf433e8b3f7d,0xbf7bbe6f3f493f64
.quad 0x3f06bee8bf7fbf16,0xbf6dbe203f433f73,0x3f5a3f643da1bf4f,0xbec4bf7dbf263e9e,0x3ec4bf35bf6d248d,0x3ec4bf35bf6d248d,0x3f6d3f35bec4bf80,0x3f6d3f35bec4bf80,0xbefa3f063f803ee8,0x3f7b3f26beb1bf7d,0xbf5fbf5a3d213f64,0xbe483f433f703e20,0xbeb13f433f5fbe20,0xbf553e6f3f7e3ee8,0xbf70bf263efa3f7d,0xbf0ebf79bdf13f64
.quad 0x3f16be9ebf73bf4f,0x248d3f4f3f733e9e,0x3f4f3f733e9ebf16,0xbf80bf163e9e3f73,0xbee83f163f7d3e9e,0x3f353f733e20bf4f,0xbf64bf4f3e203f73,0xbf353e9e3f7d3f16,0xbf7bbec43f0e3f80,0x3f7b3ec4bf0ebf80,0xbe48bf6dbf558000,0x3e483f6d3f55a50d,0x3f703da1bf5fbf4f,0x3f0ebf06bf7ebe9e,0x3eb13f7f3efabf16,0x3f553f5abdf1bf73
.quad 0x3f5a3f643da1bf4f,0xbec4bf7dbf263e9e,0xbf063ee83f7f3f16,0x3f6d3e20bf43bf73,0xbf6dbf353ec43f80,0xbf6dbf353ec43f80,0x3ec4bf35bf6d8000,0x3ec4bf35bf6d8000,0xbe8bbf79bf2e3e9e,0xbf553da13f683f4f,0x3f763e6fbf3cbf73,0xbf0ebf7fbed63f16,0x3ed63f7f3e8bbf4f,0xbe483f5a3f49be9e,0xbf683da13f763f16,0xbf7bbf063f1e3f73
.quad 0xbf73be9e3f163f80,0x3f16be9ebf73bf4f,0xbe9ebf73bf4f8000,0x3f4f3f733e9ebf16,0x3f7d3f16bee8bf80,0x3ee8bf16bf7dbe9e,0xbe203f4f3f64a50d,0x3f643f4fbe20bf73,0x3f553f6d3e48bf35,0xbf55bf6dbe483f35,0xbf0e3ec43f7b3f35,0x3f0ebec4bf7bbf35,0xbefabf7fbeb13f35,0xbf68bf433e8b3f7d,0x3f5fbda1bf70bf35,0x3ed6bf26bf76be20
.quad 0xbda1bf64bf5a248d,0xbf063ee83f7f3f16,0x3f7f3ee8bf06bf80,0xbf5abf64bda13f4f,0xbec43f353f6da554,0xbec43f353f6da554,0xbf6dbf353ec43f80,0xbf6dbf353ec43f80,0xbf3c3e6f3f763f35,0x3f5f3f5abd21bf64,0xbf2ebf79be8b3f35,0xbefa3f063f803ee8,0x3f763da1bf68bf35,0x3f703f26befabf7d,0x3e8b3f7f3ed6bf35,0xbeb13f433f5fbe20
.quad 0x3f733f4fa554bf4f,0xbf73be9e3f163f80,0xbe9e3f163f803f16,0xbe9ebf73bf4f8000,0xbe20bf73bf353e9e,0xbf7dbf163ee83f80,0x3f7d3e9ebf35bf73,0x3e20bf4fbf648000,0xbe48bf6dbf55248d,0x3e483f6d3f55a554,0x3f7b3ec4bf0ebf80,0xbf7bbec43f0e3f80,0xbf493e6f3f7b3f16,0xbe8b3f433f68a554,0xbf1ebf79be483f4f,0xbf76bf263ed63f80
.quad 0xbf433e203f6d3f4f,0x3f7f3ee8bf06bf80,0xbf26bf7dbec43f16,0x3da13f643f5aa50d,0x3f6d3f35bec4bf80,0x3f6d3f35bec4bf80,0xbec43f353f6da50d,0xbec43f353f6da50d,0x3f703f43be48bf73,0x3d21bf5abf5f248d,0xbeb13f263f7b3e9e,0x3f803f06befabf80,0xbdf1bf79bf0e3f16,0x3efabf26bf70248d,0x3f7e3e6fbf55bf4f,0x3f5f3f43beb1bf80
.quad 0xbf16bf80bf163e9e,0x3f733f4fa554bf4f,0x3f4fa50dbf4fbf73,0xbe9e3f163f803f16,0xbf64248d3f643f4f,0x3e203f733f35be9e,0xbee8bf80bee83f16,0xbf7dbe9e3f353f73,0xbf0e3ec43f7b3f35,0x3f0ebec4bf7bbf35,0xbf55bf6dbe483f35,0x3f553f6d3e48bf35,0x3f3c3f6d3d21bf64,0x3f7e3f06bf0ebf7d,0xbf2e3ec43f803ee8,0xbdf13f5a3f55be20
.quad 0x3f793f35be6fbf73,0xbf26bf7dbec43f16,0xbe6f3f353f793e9e,0x3f43be20bf6dbf4f,0x3ec4bf35bf6d248d,0x3ec4bf35bf6d248d,0x3f6d3f35bec4bf80,0x3f6d3f35bec4bf80,0xbdf1bf6dbf493e20,0xbf68bda13f553f64,0x3f7e3ec4bf1ebf7d,0xbed6bf7fbf0e3ee8,0xbf80bec43f3c3f64,0xbf49bf5a3e483f7d,0x3d21bf6dbf2e3ee8,0x3f1ebf06bf7bbe20
.quad 0xbf16bf80bf163e9e,0x3f733f4fa554bf4f,0x3f4fa50dbf4fbf73,0xbe9e3f163f803f16,0x3f64a554bf64bf4f,0xbe20bf73bf353e9e,0x3ee83f803ee8bf16,0x3f7d3e9ebf35bf73,0xbf7bbec43f0e3f80,0x3f7b3ec4bf0ebf80,0xbe48bf6dbf558000,0x3e483f6d3f55a50d,0xbd21bf6dbf3c3e9e,0xbf1ebf79be483f4f,0x3f803ec4bf2ebf73,0x3f49be6fbf7bbf16
.quad 0xbe6f3f353f793e9e,0x3f43be20bf6dbf4f,0xbf79bf353e6f3f73,0x3f263f7d3ec4bf16,0xbf6dbf353ec43f80,0xbf6dbf353ec43f80,0x3ec4bf35bf6d8000,0x3ec4bf35bf6d8000,0x3f493f6d3df1bf4f,0x3eb1bf26bf7bbe9e,0xbf1e3ec43f7e3f16,0x3f703f43be48bf73,0xbf3c3ec43f803e9e,0xbf7ebe6f3f553f4f,0xbf2ebf6d3d213f73,0xbdf1bf79bf0e3f16
.quad 0x248d3f4f3f733e9e,0xbf16bf80bf163e9e,0xbf80bf163e9e3f73,0x3f4fa50dbf4fbf73,0xbf35bf73be203f4f,0xbf64248d3f643f4f,0x3f35be9ebf7dbf16,0xbee8bf80bee83f16,0x3f553f6d3e48bf35,0xbf55bf6dbe483f35,0xbf0e3ec43f7b3f35,0x3f0ebec4bf7bbf35,0xbf7bbe6f3f493f64,0xbf2e3ec43f803ee8,0xbe48bf79bf1e3ee8,0xbf3cbf6dbd213f64
.quad 0x3f6d3e20bf43bf73,0xbf79bf353e6f3f73,0x3ec43f7d3f26be9e,0x3e6fbf35bf79be9e,0xbec43f353f6da554,0xbec43f353f6da554,0xbf6dbf353ec43f80,0xbf6dbf353ec43f80,0x3e48bf43bf70be20,0xbf7ebec43f1e3f7d,0x3f7b3f26beb1bf7d,0xbdf1bf6dbf493e20,0x3f0e3f793df1bf64,0xbd213f6d3f2ebee8,0xbf553e6f3f7e3ee8,0xbf80bec43f3c3f64
.quad 0x3f16be9ebf73bf4f,0x248d3f4f3f733e9e,0x3f4f3f733e9ebf16,0xbf80bf163e9e3f73,0xbee83f163f7d3e9e,0x3f353f733e20bf4f,0xbf64bf4f3e203f73,0xbf353e9e3f7d3f16,0xbe48bf6dbf55248d,0x3e483f6d3f55a554,0x3f7b3ec4bf0ebf80,0xbf7bbec43f0e3f80,0x3eb13f7f3efabf16,0x3f553f5abdf1bf73,0xbf70bda13f5f3f4f,0xbf0e3f063f7e3e9e
.quad 0xbf5abf64bda13f4f,0x3ec43f7d3f26be9e,0x3f06bee8bf7fbf16,0xbf6dbe203f433f73,0x3f6d3f35bec4bf80,0x3f6d3f35bec4bf80,0xbec43f353f6da50d,0xbec43f353f6da50d,0xbf76be6f3f3c3f73,0x3f0e3f7f3ed6bf16,0xbe8bbf79bf2e3e9e,0xbf553da13f683f4f,0x3f68bda1bf76bf16,0x3f7b3f06bf1ebf73,0x3ed63f7f3e8bbf4f,0xbe483f5a3f49be9e
.quad 0xbf73be9e3f163f80,0x3f16be9ebf73bf4f,0xbe9ebf73bf4f8000,0x3f4f3f733e9ebf16,0x3f7d3f16bee8bf80,0x3ee8bf16bf7dbe9e,0xbe203f4f3f64a50d,0x3f643f4fbe20bf73,0xbf0e3ec43f7b3f35,0x3f0ebec4bf7bbf35,0xbf55bf6dbe483f35,0x3f553f6d3e48bf35,0x3f5fbda1bf70bf35,0x3ed6bf26bf76be20,0x3efa3f7f3eb1bf35,0x3f683f43be8bbf7d
.quad 0x3da13f643f5aa554,0x3f06bee8bf7fbf16,0xbf7fbee83f063f80,0x3f5a3f643da1bf4f,0x3ec4bf35bf6d248d,0x3ec4bf35bf6d248d,0x3f6d3f35bec4bf80,0x3f6d3f35bec4bf80,0x3f2e3f793e8bbf35,0x3efabf06bf80bee8,0xbf3c3e6f3f763f35,0x3f5f3f5abd21bf64,0xbe8bbf7fbed63f35,0x3eb1bf43bf5f3e20,0x3f763da1bf68bf35,0x3f703f26befabf7d
.quad 0xbf4fbf4f3e9e3f80,0x3e9ebf4fbf4f3e9e,0x3f16bf16bf738000,0x3f733f16bf16bf73,0xbee8bf733e203f80,0xbe203f733ee8bf4f,0x3f64be9ebf7d8000,0xbf7dbe9e3f643f16,0xbf3cbf5a3e8b3f80,0x3f5fbe6fbf80be9e,0x3f2ebf06bf768000,0x3efa3f793d21bf73,0xbeb1bf793df13f80,0xbf493f063f68be9e,0x3f70be6fbf7e8000,0xbf1ebf5a3ed63f73
.quad 0xbf26bf643e6f3f80,0x3f793ee8bf43bf4f,0x3f43bee8bf798000,0xbe6f3f643f26bf16,0xbe6fbf7d3da13f80,0xbf7fbe203f793e9e,0x3f79be20bf7f8000,0x3da1bf7dbe6f3f73,0xbf0ebf6d3e483f80,0x3f0e3f6dbe48bf80,0x3f55bec4bf7b8000,0xbf553ec43f7ba50d,0xbdf1bf7f3d213f80,0xbf2ebf433f1e3f4f,0x3f7ebda1bf808000,0x3f3cbf26bf493f16
.quad 0xbf4f3e9e3f803e9e,0xbf4fbf4f3e9e3f80,0xbf16bf7380003f73,0x3f16bf16bf738000,0xbf64bf163f353f4f,0x3ee83f73be20bf80,0x3ee8bf4fbf353f16,0xbf643e9e3f7da50d,0xbf703da13f7b3ee8,0xbd21bf79befa3f35,0xbeb1bf7fbe483f64,0x3f803e6fbf5fbf35,0xbf3cbf433f0e3f64,0xbed63f5a3f1ebf35,0x3f2ebf26bf553ee8,0xbf68bf063f493f35
.quad 0xbf7fbe203f6d3f16,0x3f43bee8bf79248d,0xbda1bf7dbec43f4f,0x3f263f64be6fbf80,0xbf06bf643ec43f73,0xbf793e203f7fa554,0x3f5abee8bf6d3e9e,0xbe6fbf7d3da13f80,0xbf7bbec43f553f35,0x3f7b3ec4bf55bf35,0x3e48bf6dbf0e3f35,0xbe483f6d3f0ebf35,0xbe8bbf793e483f7d,0xbf49bf263f3c3f35,0x3f76be6fbf7b3e20,0x3f1ebf43bf2e3f35
.quad 0x3e9e3f803e9ebf4f,0xbf4f3e9e3f803e9e,0xbf7380003f733f16,0xbf16bf7380003f73,0xbf7d248d3f7d3e9e,0x3f643f16bf35bf4f,0xbe20bf80be203f73,0xbee83f4f3f35bf16,0xbdf13f6d3f1ebf16,0xbf68bf263f0e3f73,0xbf7ebec43f493f4f,0x3ed6bf43bf553e9e,0xbf76bec43f5f3f16,0x3d213f7f3e48bf73,0x3e8bbf6dbefa3f4f,0xbf80bda13f7b3e9e
.quad 0xbf063f353f5abe9e,0xbda1bf7dbec43f4f,0xbf5abf353f063f73,0x3f7f3e20bf6dbf16,0xbf43bf353f263f4f,0xbf5a3ee83f6dbe9e,0x3f26bf35bf433f16,0xbf06bf643ec43f73,0xbf553ec43f7ba554,0x3f55bec4bf7b248d,0xbf0ebf6d3e483f80,0x3f0e3f6dbe48bf80,0xbed6bf6d3eb13f73,0xbf5fbf063f553f16,0x3f68bec4bf703e9e,0x3efabf5abf0e3f4f
.quad 0x3f803e9ebf4fbf4f,0x3e9e3f803e9ebf4f,0x80003f733f16bf16,0xbf7380003f733f16,0xbf353f163f64be9e,0x3f7da554bf7dbe9e,0xbf35bf4f3ee83f73,0x3e203f803e20bf73,0x3f553f43bed6bf7d,0xbf493ec43f7e3e20,0xbf0e3f263f68be20,0xbf1ebf6d3df13f7d,0xbf7b3da13f803e20,0x3efa3f6dbe8bbf7d,0xbe48bf7fbd213f7d,0xbf5f3ec43f76be20
.quad 0x3ec43f7d3da1bf73,0xbf5abf353f063f73,0xbf6d3e203f7f3e9e,0x3f06bf35bf5a3e9e,0xbf6dbee83f5a3f16,0xbf263f353f43bf16,0x3ec4bf64bf063f4f,0xbf43bf353f263f4f,0xbe483f6d3f0ebf35,0x3e48bf6dbf0e3f35,0xbf7bbec43f553f35,0x3f7b3ec4bf55bf35,0xbf0ebf5a3efa3f64,0xbf70bec43f683ee8,0x3f55bf06bf5f3ee8,0x3eb1bf6dbed63f64
.quad 0x3f803e9ebf4fbf4f,0x3e9e3f803e9ebf4f,0x80003f733f16bf16,0xbf7380003f733f16,0x3f35bf16bf643e9e,0xbf7d248d3f7d3e9e,0x3f353f4fbee8bf73,0xbe20bf80be203f73,0x3e483f7f3eb1bf4f,0xbf7ebec43f493f4f,0xbf7bbda13f703f16,0x3df1bf6dbf1e3f16,0x3f553f26bf2ebf4f,0x3e8bbf6dbefa3f4f,0xbf0e3f433f3cbf16,0x3f763ec4bf5fbf16
.quad 0xbf6d3e203f7f3e9e,0x3f06bf35bf5a3e9e,0xbec4bf7dbda13f73,0x3f5a3f35bf06bf73,0xbec43f643f06bf4f,0x3f433f35bf26bf4f,0xbf6dbee83f5a3f16,0xbf263f353f43bf16,0xbf0ebf6d3e483f80,0x3f0e3f6dbe48bf80,0x3f55bec4bf7b8000,0xbf553ec43f7ba50d,0xbf7bbe6f3f763e9e,0xbf683ec43f70be9e,0x3e48bf79be8b3f73,0xbed6bf6d3eb13f73
.quad 0x3e9ebf4fbf4f3e9e,0x3f803e9ebf4fbf4f,0x3f733f16bf16bf73,0x80003f733f16bf16,0x3e20bf73bee83f4f,0xbf353f163f64be9e,0x3f7d3e9ebf64bf16,0xbf35bf4f3ee83f73,0x3f763f06bf2ebf64,0xbf0e3f263f68be20,0xbe8b3f5a3f3cbee8,0xbf55bf433ed63f7d,0x3f7e3e6fbf70bee8,0xbe48bf7fbd213f7d,0xbdf13f793eb1bf64,0x3f7bbda1bf80be20
.quad 0xbe6f3f643f26bf16,0xbec4bf7dbda13f73,0xbf79bee83f433f4f,0x3f6dbe20bf7fbe9e,0xbda13f7d3e6fbf73,0x3f6d3ee8bf5abf16,0xbf7fbe203f793e9e,0xbec43f643f06bf4f,0xbf7bbec43f553f35,0x3f7b3ec4bf55bf35,0x3e48bf6dbf0e3f35,0xbe483f6d3f0ebf35,0xbf80bda13f7e3e20,0xbf553f063f5fbee8,0x3d21bf7fbdf13f7d,0xbf0ebf5a3efa3f64
.quad 0xbf4fbf4f3e9e3f80,0x3e9ebf4fbf4f3e9e,0x3f16bf16bf738000,0x3f733f16bf16bf73,0xbee8bf733e203f80,0xbe203f733ee8bf4f,0x3f64be9ebf7d8000,0xbf7dbe9e3f643f16,0x3f2ebf06bf76248d,0x3efa3f793d21bf73,0x3f3c3f5abe8bbf80,0xbf5f3e6f3f803e9e,0x3f70be6fbf7e248d,0xbf1ebf5a3ed63f73,0x3eb13f79bdf1bf80,0x3f49bf06bf683e9e
.quad 0x3f263f64be6fbf80,0xbf79bee83f433f4f,0xbf433ee83f79a50d,0x3e6fbf64bf263f16,0x3e6f3f7dbda1bf80,0x3f7f3e20bf79be9e,0xbf793e203f7fa50d,0xbda13f7d3e6fbf73,0xbf553ec43f7ba554,0x3f55bec4bf7b248d,0xbf0ebf6d3e483f80,0x3f0e3f6dbe48bf80,0xbf7e3da13f80a554,0xbf3c3f263f49bf16,0xbdf1bf7f3d213f80,0xbf2ebf433f1e3f4f
.quad 0xbf4f3e9e3f803e9e,0xbf4fbf4f3e9e3f80,0xbf16bf7380003f73,0x3f16bf16bf738000,0xbf64bf163f353f4f,0x3ee83f73be20bf80,0x3ee8bf4fbf353f16,0xbf643e9e3f7da50d,0xbeb1bf7fbe483f64,0x3f803e6fbf5fbf35,0x3f70bda1bf7bbee8,0x3d213f793efabf35,0x3f2ebf26bf553ee8,0xbf68bf063f493f35,0x3f3c3f43bf0ebf64,0x3ed6bf5abf1e3f35
.quad 0x3f7f3e20bf6dbf16,0xbf433ee83f79a554,0x3da13f7d3ec4bf4f,0xbf26bf643e6f3f80,0x3f063f64bec4bf73,0x3f79be20bf7f248d,0xbf5a3ee83f6dbe9e,0x3e6f3f7dbda1bf80,0xbe483f6d3f0ebf35,0x3e48bf6dbf0e3f35,0xbf7bbec43f553f35,0x3f7b3ec4bf55bf35,0xbf763e6f3f7bbe20,0xbf1e3f433f2ebf35,0xbe8bbf793e483f7d,0xbf49bf263f3c3f35
.quad 0xbf4f3e9e3f803e9e,0xbf4fbf4f3e9e3f80,0xbf16bf7380003f73,0x3f16bf16bf738000,0x3f643f16bf35bf4f,0xbee8bf733e203f80,0xbee83f4f3f35bf16,0x3f64be9ebf7d8000,0x3ed6bf43bf553e9e,0x3f3c3f5abe8bbf80,0x3f683f26bf0ebf73,0xbf2e3f063f76a50d,0xbf80bda13f7b3e9e,0x3eb13f79bdf1bf80,0xbd21bf7fbe483f73,0xbf703e6f3f7ea50d
.quad 0x3da13f7d3ec4bf4f,0xbf26bf643e6f3f80,0xbf7fbe203f6d3f16,0x3f43bee8bf798000,0x3f5abee8bf6d3e9e,0xbe6fbf7d3da13f80,0x3f063f64bec4bf73,0x3f79be20bf7f8000,0xbf0ebf6d3e483f80,0x3f0e3f6dbe48bf80,0x3f55bec4bf7b8000,0xbf553ec43f7ba50d,0xbefa3f5a3f0ebf4f,0x3df13f7fbd21bf80,0xbf5fbf063f553f16,0xbf7e3da13f80a50d
.quad 0x3e9e3f803e9ebf4f,0xbf4f3e9e3f803e9e,0xbf7380003f733f16,0xbf16bf7380003f73,0x3f7da554bf7dbe9e,0xbf64bf163f353f4f,0x3e203f803e20bf73,0x3ee8bf4fbf353f16,0xbf1ebf6d3df13f7d,0x3f70bda1bf7bbee8,0x3f49bec4bf7ebe20,0x3eb13f7f3e48bf64,0xbf5f3ec43f76be20,0x3f3c3f43bf0ebf64,0xbefabf6d3e8b3f7d,0xbf2e3f263f55bee8
.quad 0x3f5a3f35bf06bf73,0xbf7fbe203f6d3f16,0xbf063f353f5abe9e,0xbda1bf7dbec43f4f,0x3f26bf35bf433f16,0xbf06bf643ec43f73,0x3f433f35bf26bf4f,0x3f5abee8bf6d3e9e,0xbf7bbec43f553f35,0x3f7b3ec4bf55bf35,0x3e48bf6dbf0e3f35,0xbe483f6d3f0ebf35,0xbeb13f6d3ed6bf64,0x3e8b3f79be48bf7d,0xbf70bec43f683ee8,0xbf763e6f3f7bbe20
.quad 0x3f803e9ebf4fbf4f,0x3e9e3f803e9ebf4f,0x80003f733f16bf16,0xbf7380003f733f16,0x3f35bf16bf643e9e,0xbf7d248d3f7d3e9e,0x3f353f4fbee8bf73,0xbe20bf80be203f73,0xbf7bbda13f703f16,0x3df1bf6dbf1e3f16,0xbe48bf7fbeb13f4f,0x3f7e3ec4bf49bf4f,0xbf0e3f433f3cbf16,0x3f763ec4bf5fbf16,0xbf55bf263f2e3f4f,0xbe8b3f6d3efabf4f
.quad 0x3f6dbe20bf7fbe9e,0xbf063f353f5abe9e,0x3ec43f7d3da1bf73,0xbf5abf353f063f73,0x3ec4bf64bf063f4f,0xbf43bf353f263f4f,0x3f6d3ee8bf5abf16,0x3f26bf35bf433f16,0xbf553ec43f7ba554,0x3f55bec4bf7b248d,0xbf0ebf6d3e483f80,0x3f0e3f6dbe48bf80,0xbe483f793e8bbf73,0x3ed63f6dbeb1bf73,0xbf7bbe6f3f763e9e,0xbf683ec43f70be9e
.quad 0x3e9ebf4fbf4f3e9e,0x3f803e9ebf4fbf4f,0x3f733f16bf16bf73,0x80003f733f16bf16,0x3e20bf73bee83f4f,0xbf353f163f64be9e,0x3f7d3e9ebf64bf16,0xbf35bf4f3ee83f73,0xbe8b3f5a3f3cbee8,0xbf55bf433ed63f7d,0xbf76bf063f2e3f64,0x3f0ebf26bf683e20,0xbdf13f793eb1bf64,0x3f7bbda1bf80be20,0xbf7ebe6f3f703ee8,0x3e483f7f3d21bf7d
.quad 0x3e6fbf64bf263f16,0x3ec43f7d3da1bf73,0x3f793ee8bf43bf4f,0xbf6d3e203f7f3e9e,0x3da1bf7dbe6f3f73,0xbf6dbee83f5a3f16,0x3f7f3e20bf79be9e,0x3ec4bf64bf063f4f,0xbe483f6d3f0ebf35,0x3e48bf6dbf0e3f35,0xbf7bbec43f553f35,0x3f7b3ec4bf55bf35,0xbd213f7f3df1bf7d,0x3f0e3f5abefabf64,0xbf80bda13f7e3e20,0xbf553f063f5fbee8
.quad 0x3e9ebf4fbf4f3e9e,0x3f803e9ebf4fbf4f,0x3f733f16bf16bf73,0x80003f733f16bf16,0xbe203f733ee8bf4f,0x3f35bf16bf643e9e,0xbf7dbe9e3f643f16,0x3f353f4fbee8bf73,0xbf5f3e6f3f803e9e,0xbe48bf7fbeb13f4f,0xbefabf79bd213f73,0x3f7b3da1bf70bf16,0x3f49bf06bf683e9e,0xbf55bf263f2e3f4f,0x3f1e3f5abed6bf73,0x3f0ebf43bf3c3f16
.quad 0x3f793ee8bf43bf4f,0xbf6d3e203f7f3e9e,0xbe6f3f643f26bf16,0xbec4bf7dbda13f73,0xbf7fbe203f793e9e,0xbec43f643f06bf4f,0x3da1bf7dbe6f3f73,0xbf6dbee83f5a3f16,0xbf0ebf6d3e483f80,0x3f0e3f6dbe48bf80,0x3f55bec4bf7b8000,0xbf553ec43f7ba50d,0x3f2e3f43bf1ebf4f,0x3f7b3e6fbf76be9e,0xbf3c3f263f49bf16,0xbe483f793e8bbf73
.quad 0xbf4fbf4f3e9e3f80,0x3e9ebf4fbf4f3e9e,0x3f16bf16bf738000,0x3f733f16bf16bf73,0x3ee83f73be20bf80,0x3e20bf73bee83f4f,0xbf643e9e3f7da50d,0x3f7d3e9ebf64bf16,0x3d213f793efabf35,0xbf76bf063f2e3f64,0xbf80be6f3f5f3f35,0x3e8bbf5abf3c3ee8,0x3ed6bf5abf1e3f35,0xbf7ebe6f3f703ee8,0x3f683f06bf49bf35,0x3df1bf79beb13f64
.quad 0x3f43bee8bf79248d,0xbe6f3f643f26bf16,0x3f263f64be6fbf80,0xbf79bee83f433f4f,0xbf793e203f7fa554,0xbda13f7d3e6fbf73,0xbe6fbf7d3da13f80,0xbf7fbe203f793e9e,0xbf7bbec43f553f35,0x3f7b3ec4bf55bf35,0x3e48bf6dbf0e3f35,0xbe483f6d3f0ebf35,0x3f493f26bf3cbf35,0x3f803da1bf7ebe20,0xbf1e3f433f2ebf35,0xbd213f7f3df1bf7d
.quad 0xbf4f3e9e3f803e9e,0xbf4fbf4f3e9e3f80,0xbf16bf7380003f73,0x3f16bf16bf738000,0x3f643f16bf35bf4f,0xbee8bf733e203f80,0xbee83f4f3f35bf16,0x3f64be9ebf7d8000,0x3f683f26bf0ebf73,0xbf2e3f063f76a554,0xbed63f433f55be9e,0xbf3cbf5a3e8b3f80,0xbd21bf7fbe483f73,0xbf703e6f3f7ea554,0x3f803da1bf7bbe9e,0xbeb1bf793df13f80
.quad 0xbda1bf7dbec43f4f,0x3f263f64be6fbf80,0x3f7f3e20bf6dbf16,0xbf433ee83f79a50d,0xbf5a3ee83f6dbe9e,0x3e6f3f7dbda1bf80,0xbf06bf643ec43f73,0xbf793e203f7fa50d,0xbf553ec43f7ba554,0x3f55bec4bf7b248d,0xbf0ebf6d3e483f80,0x3f0e3f6dbe48bf80,0x3f5f3f06bf55bf16,0x3f7ebda1bf80248d,0xbefa3f5a3f0ebf4f,0x3df13f7fbd21bf80
.quad 0x3e9e3f803e9ebf4f,0xbf4f3e9e3f803e9e,0xbf7380003f733f16,0xbf16bf7380003f73,0x3f7da554bf7dbe9e,0xbf64bf163f353f4f,0x3e203f803e20bf73,0x3ee8bf4fbf353f16,0x3f49bec4bf7ebe20,0x3eb13f7f3e48bf64,0x3f1e3f6dbdf1bf7d,0xbf703da13f7b3ee8,0xbefabf6d3e8b3f7d,0xbf2e3f263f55bee8,0x3f5fbec4bf763e20,0xbf3cbf433f0e3f64
.quad 0xbf5abf353f063f73,0x3f7f3e20bf6dbf16,0x3f06bf35bf5a3e9e,0x3da13f7d3ec4bf4f,0xbf263f353f43bf16,0x3f063f64bec4bf73,0xbf43bf353f263f4f,0xbf5a3ee83f6dbe9e,0xbe483f6d3f0ebf35,0x3e48bf6dbf0e3f35,0xbf7bbec43f553f35,0x3f7b3ec4bf55bf35,0x3f703ec4bf68bee8,0x3f76be6fbf7b3e20,0xbeb13f6d3ed6bf64,0x3e8b3f79be48bf7d
.quad 0x3e9e3f803e9ebf4f,0xbf4f3e9e3f803e9e,0xbf7380003f733f16,0xbf16bf7380003f73,0xbf7d248d3f7d3e9e,0x3f643f16bf35bf4f,0xbe20bf80be203f73,0xbee83f4f3f35bf16,0x3f7e3ec4bf49bf4f,0xbed63f433f55be9e,0xbdf13f6d3f1ebf16,0xbf68bf263f0e3f73,0xbe8b3f6d3efabf4f,0x3f803da1bf7bbe9e,0xbf76bec43f5f3f16,0x3d213f7f3e48bf73
.quad 0x3f06bf35bf5a3e9e,0x3da13f7d3ec4bf4f,0x3f5a3f35bf06bf73,0xbf7fbe203f6d3f16,0x3f433f35bf26bf4f,0x3f5abee8bf6d3e9e,0xbf263f353f43bf16,0x3f063f64bec4bf73,0xbf0ebf6d3e483f80,0x3f0e3f6dbe48bf80,0x3f55bec4bf7b8000,0xbf553ec43f7ba50d,0x3f68bec4bf703e9e,0x3efabf5abf0e3f4f,0x3ed63f6dbeb1bf73,0x3f5f3f06bf55bf16
.quad 0x3f803e9ebf4fbf4f,0x3e9e3f803e9ebf4f,0x80003f733f16bf16,0xbf7380003f733f16,0xbf353f163f64be9e,0x3f7da554bf7dbe9e,0xbf35bf4f3ee83f73,0x3e203f803e20bf73,0x3f0ebf26bf683e20,0x3f1e3f6dbdf1bf7d,0x3f553f43bed6bf7d,0xbf493ec43f7e3e20,0x3e483f7f3d21bf7d,0x3f5fbec4bf763e20,0xbf7b3da13f803e20,0x3efa3f6dbe8bbf7d
.quad 0xbec4bf7dbda13f73,0x3f5a3f35bf06bf73,0x3f6dbe20bf7fbe9e,0xbf063f353f5abe9e,0x3f6d3ee8bf5abf16,0x3f26bf35bf433f16,0xbec43f643f06bf4f,0x3f433f35bf26bf4f,0xbf7bbec43f553f35,0x3f7b3ec4bf55bf35,0x3e48bf6dbf0e3f35,0xbe483f6d3f0ebf35,0x3f55bf06bf5f3ee8,0x3eb1bf6dbed63f64,0x3f0e3f5abefabf64,0x3f703ec4bf68bee8
.quad 0x3e9ebf4fbf4f3e9e,0x3f803e9ebf4fbf4f,0x3f733f16bf16bf73,0x80003f733f16bf16,0xbe203f733ee8bf4f,0x3f35bf16bf643e9e,0xbf7dbe9e3f643f16,0x3f353f4fbee8bf73,0xbefabf79bd213f73,0x3f7b3da1bf70bf16,0x3f5fbe6fbf80be9e,0x3e483f7f3eb1bf4f,0x3f1e3f5abed6bf73,0x3f0ebf43bf3c3f16,0xbf493f063f68be9e,0x3f553f26bf2ebf4f
.quad 0xbf79bee83f433f4f,0x3f6dbe20bf7fbe9e,0x3e6fbf64bf263f16,0x3ec43f7d3da1bf73,0x3f7f3e20bf79be9e,0x3ec4bf64bf063f4f,0xbda13f7d3e6fbf73,0x3f6d3ee8bf5abf16,0xbf553ec43f7ba554,0x3f55bec4bf7b248d,0xbf0ebf6d3e483f80,0x3f0e3f6dbe48bf80,0x3f3cbf26bf493f16,0x3e48bf79be8b3f73,0x3f2e3f43bf1ebf4f,0x3f7b3e6fbf76be9e
.quad 0xbf4fbf4f3e9e3f80,0x3e9ebf4fbf4f3e9e,0x3f16bf16bf738000,0x3f733f16bf16bf73,0x3ee83f73be20bf80,0x3e20bf73bee83f4f,0xbf643e9e3f7da50d,0x3f7d3e9ebf64bf16,0xbf80be6f3f5f3f35,0x3e8bbf5abf3c3ee8,0xbd21bf79befa3f35,0x3f763f06bf2ebf64,0x3f683f06bf49bf35,0x3df1bf79beb13f64,0xbed63f5a3f1ebf35,0x3f7e3e6fbf70bee8
.quad 0xbf433ee83f79a554,0x3e6fbf64bf263f16,0xbf26bf643e6f3f80,0x3f793ee8bf43bf4f,0x3f79be20bf7f248d,0x3da1bf7dbe6f3f73,0x3e6f3f7dbda1bf80,0x3f7f3e20bf79be9e,0xbe483f6d3f0ebf35,0x3e48bf6dbf0e3f35,0xbf7bbec43f553f35,0x3f7b3ec4bf55bf35,0x3f1ebf43bf2e3f35,0x3d21bf7fbdf13f7d,0x3f493f26bf3cbf35,0x3f803da1bf7ebe20
.quad 0xa554bf80248d3f80,0xa554bf80248d3f80,0x3f80a50dbf808000,0x3f80a50dbf808000,0x3ee8bf73be203f80,0x3e203f73bee8bf4f,0x3f643e9ebf7d8000,0xbf7d3e9e3f64bf16,0x3df1bf7fbd213f80,0x3f2ebf43bf1e3f4f,0x3f7e3da1bf808000,0x3f3c3f26bf49bf16,0x3f0ebf6dbe483f80,0xbf0e3f6d3e48bf80,0x3f553ec4bf7b8000,0xbf55bec43f7ba50d
.quad 0x3e6fbf7dbda13f80,0x3f7fbe20bf793e9e,0x3f793e20bf7f8000,0x3da13f7dbe6fbf73,0x3f26bf64be6f3f80,0xbf793ee83f43bf4f,0x3f433ee8bf798000,0xbe6fbf643f263f16,0x3eb1bf79bdf13f80,0x3f493f06bf68be9e,0x3f703e6fbf7e8000,0xbf1e3f5a3ed6bf73,0x3f3cbf5abe8b3f80,0xbf5fbe6f3f80be9e,0x3f2e3f06bf768000,0x3efabf793d213f73
.quad 0xa554bf80248d3f80,0xa554bf80248d3f80,0x3f80a50dbf808000,0x3f80a50dbf808000,0x3f64bf16bf353f4f,0xbee83f733e20bf80,0x3ee83f4fbf35bf16,0xbf64be9e3f7da50d,0x3e8bbf79be483f7d,0x3f49bf26bf3c3f35,0x3f763e6fbf7bbe20,0x3f1e3f43bf2ebf35,0x3f7bbec4bf553f35,0xbf7b3ec43f55bf35,0x3e483f6dbf0ebf35,0xbe48bf6d3f0e3f35
.quad 0x3f06bf64bec43f73,0x3f793e20bf7f248d,0x3f5a3ee8bf6dbe9e,0xbe6f3f7d3da1bf80,0x3f7fbe20bf6d3f16,0xbf43bee83f79a554,0xbda13f7dbec4bf4f,0x3f26bf64be6f3f80,0x3f3cbf43bf0e3f64,0x3ed63f5abf1ebf35,0x3f2e3f26bf55bee8,0xbf683f063f49bf35,0x3f703da1bf7b3ee8,0x3d21bf793efa3f35,0xbeb13f7fbe48bf64,0x3f80be6fbf5f3f35
.quad 0xa554bf80248d3f80,0xa554bf80248d3f80,0x3f80a50dbf808000,0x3f80a50dbf808000,0x3f7da554bf7d3e9e,0xbf643f163f35bf4f,0xbe203f80be20bf73,0xbee8bf4f3f353f16,0x3ed6bf6dbeb13f73,0x3f5fbf06bf553f16,0x3f683ec4bf70be9e,0x3efa3f5abf0ebf4f,0x3f553ec4bf7b248d,0xbf55bec43f7ba554,0xbf0e3f6d3e48bf80,0x3f0ebf6dbe483f80
.quad 0x3f43bf35bf263f4f,0x3f5a3ee8bf6dbe9e,0x3f263f35bf43bf16,0xbf063f643ec4bf73,0x3f063f35bf5abe9e,0x3da1bf7d3ec43f4f,0xbf5a3f353f06bf73,0x3f7fbe20bf6d3f16,0x3f76bec4bf5f3f16,0xbd213f7fbe48bf73,0x3e8b3f6dbefabf4f,0xbf803da13f7bbe9e,0x3df13f6dbf1ebf16,0x3f68bf26bf0e3f73,0xbf7e3ec43f49bf4f,0x3ed63f43bf55be9e
.quad 0xa554bf80248d3f80,0xa554bf80248d3f80,0x3f80a50dbf808000,0x3f80a50dbf808000,0x3f353f16bf64be9e,0xbf7d248d3f7dbe9e,0xbf353f4f3ee8bf73,0x3e20bf803e203f73,0x3f0ebf5abefa3f64,0x3f70bec4bf683ee8,0x3f553f06bf5fbee8,0x3eb13f6dbed6bf64,0x3e483f6dbf0ebf35,0xbe48bf6d3f0e3f35,0xbf7b3ec43f55bf35,0x3f7bbec4bf553f35
.quad 0x3f6dbee8bf5a3f16,0x3f263f35bf43bf16,0x3ec43f64bf06bf4f,0xbf433f353f26bf4f,0xbec43f7dbda1bf73,0x3f5abf35bf063f73,0xbf6dbe203f7fbe9e,0x3f063f35bf5abe9e,0x3f7b3da1bf803e20,0xbefa3f6d3e8bbf7d,0xbe483f7fbd21bf7d,0xbf5fbec43f763e20,0xbf553f433ed6bf7d,0x3f493ec4bf7e3e20,0xbf0ebf263f683e20,0xbf1e3f6d3df1bf7d
.quad 0xa554bf80248d3f80,0xa554bf80248d3f80,0x3f80a50dbf808000,0x3f80a50dbf808000,0xbf35bf163f643e9e,0x3f7da554bf7d3e9e,0x3f35bf4fbee83f73,0xbe203f80be20bf73,0x3f7bbe6fbf763e9e,0x3f683ec4bf70be9e,0x3e483f79be8bbf73,0xbed63f6d3eb1bf73,0x3f0ebf6dbe483f80,0xbf0e3f6d3e48bf80,0x3f553ec4bf7b8000,0xbf55bec43f7ba50d
.quad 0x3ec43f64bf06bf4f,0xbf433f353f26bf4f,0xbf6d3ee83f5abf16,0xbf26bf353f433f16,0x3f6d3e20bf7f3e9e,0xbf06bf353f5a3e9e,0xbec43f7dbda1bf73,0x3f5abf35bf063f73,0xbf553f263f2ebf4f,0xbe8bbf6d3efa3f4f,0xbf0ebf433f3c3f16,0x3f76bec4bf5f3f16,0xbe483f7fbeb1bf4f,0x3f7ebec4bf493f4f,0xbf7b3da13f70bf16,0x3df13f6dbf1ebf16
.quad 0xa554bf80248d3f80,0xa554bf80248d3f80,0x3f80a50dbf808000,0x3f80a50dbf808000,0xbe20bf733ee83f4f,0x3f353f16bf64be9e,0x3f7dbe9ebf643f16,0xbf353f4f3ee8bf73,0x3f80bda1bf7e3e20,0x3f553f06bf5fbee8,0x3d213f7fbdf1bf7d,0xbf0e3f5a3efabf64,0x3f7bbec4bf553f35,0xbf7b3ec43f55bf35,0x3e483f6dbf0ebf35,0xbe48bf6d3f0e3f35
.quad 0x3da13f7dbe6fbf73,0xbf6d3ee83f5abf16,0xbf7f3e203f79be9e,0xbec4bf643f063f4f,0x3e6f3f64bf26bf16,0x3ec4bf7d3da13f73,0xbf793ee83f43bf4f,0x3f6d3e20bf7f3e9e,0xbf7e3e6f3f70bee8,0x3e48bf7f3d213f7d,0xbdf1bf793eb13f64,0x3f7b3da1bf803e20,0xbf763f063f2ebf64,0x3f0e3f26bf68be20,0xbe8bbf5a3f3c3ee8,0xbf553f433ed6bf7d
.quad 0xa554bf80248d3f80,0xa554bf80248d3f80,0x3f80a50dbf808000,0x3f80a50dbf808000,0x3ee8bf73be203f80,0x3e203f73bee8bf4f,0x3f643e9ebf7d8000,0xbf7d3e9e3f64bf16,0x3f7e3da1bf80248d,0x3f3c3f26bf49bf16,0xbdf13f7f3d21bf80,0xbf2e3f433f1ebf4f,0x3f553ec4bf7b248d,0xbf55bec43f7ba554,0xbf0e3f6d3e48bf80,0x3f0ebf6dbe483f80
.quad 0xbe6f3f7d3da1bf80,0xbf7f3e203f79be9e,0xbf79be203f7fa50d,0xbda1bf7d3e6f3f73,0xbf263f643e6fbf80,0x3f79bee8bf433f4f,0xbf43bee83f79a50d,0x3e6f3f64bf26bf16,0xbf70be6f3f7ea554,0x3f1ebf5abed63f73,0x3eb1bf79bdf13f80,0x3f493f06bf68be9e,0xbf2ebf063f76a554,0xbefa3f79bd21bf73,0x3f3cbf5abe8b3f80,0xbf5fbe6f3f80be9e
.quad 0xa554bf80248d3f80,0xa554bf80248d3f80,0x3f80a50dbf808000,0x3f80a50dbf808000,0x3f64bf16bf353f4f,0xbee83f733e20bf80,0x3ee83f4fbf35bf16,0xbf64be9e3f7da50d,0x3f763e6fbf7bbe20,0x3f1e3f43bf2ebf35,0xbe8b3f793e48bf7d,0xbf493f263f3cbf35,0x3e483f6dbf0ebf35,0xbe48bf6d3f0e3f35,0xbf7b3ec43f55bf35,0x3f7bbec4bf553f35
.quad 0xbf063f643ec4bf73,0xbf79be203f7fa554,0xbf5abee83f6d3e9e,0x3e6fbf7dbda13f80,0xbf7f3e203f6dbf16,0x3f433ee8bf79248d,0x3da1bf7d3ec43f4f,0xbf263f643e6fbf80,0xbf2ebf263f553ee8,0x3f68bf06bf493f35,0x3f3cbf43bf0e3f64,0x3ed63f5abf1ebf35,0x3eb1bf7f3e483f64,0xbf803e6f3f5fbf35,0x3f703da1bf7b3ee8,0x3d21bf793efa3f35
.quad 0xa554bf80248d3f80,0xa554bf80248d3f80,0x3f80a50dbf808000,0x3f80a50dbf808000,0xbf643f163f35bf4f,0x3ee8bf73be203f80,0xbee8bf4f3f353f16,0x3f643e9ebf7d8000,0x3efa3f5abf0ebf4f,0xbdf13f7f3d21bf80,0xbf5f3f063f55bf16,0xbf7ebda13f80a50d,0x3f0ebf6dbe483f80,0xbf0e3f6d3e48bf80,0x3f553ec4bf7b8000,0xbf55bec43f7ba50d
.quad 0xbf5abee83f6d3e9e,0x3e6fbf7dbda13f80,0x3f06bf64bec43f73,0x3f793e20bf7f8000,0xbda13f7dbec4bf4f,0x3f26bf64be6f3f80,0xbf7f3e203f6dbf16,0x3f433ee8bf798000,0x3f80bda1bf7b3e9e,0xbeb13f793df1bf80,0xbd213f7fbe48bf73,0xbf70be6f3f7ea50d,0xbed6bf433f553e9e,0xbf3c3f5a3e8bbf80,0x3f68bf26bf0e3f73,0xbf2ebf063f76a50d
.quad 0xa554bf80248d3f80,0xa554bf80248d3f80,0x3f80a50dbf808000,0x3f80a50dbf808000,0xbf7d248d3f7dbe9e,0x3f64bf16bf353f4f,0x3e20bf803e203f73,0x3ee83f4fbf35bf16,0x3eb13f6dbed6bf64,0xbe8b3f793e48bf7d,0xbf703ec43f68bee8,0xbf76be6f3f7b3e20,0x3f7bbec4bf553f35,0xbf7b3ec43f55bf35,0x3e483f6dbf0ebf35,0xbe48bf6d3f0e3f35
.quad 0xbf26bf353f433f16,0x3f06bf64bec43f73,0x3f43bf35bf263f4f,0x3f5a3ee8bf6dbe9e,0xbf5a3f353f06bf73,0x3f7fbe20bf6d3f16,0xbf06bf353f5a3e9e,0xbda13f7dbec4bf4f,0x3f5f3ec4bf76be20,0xbf3c3f433f0ebf64,0xbefa3f6d3e8bbf7d,0xbf2ebf263f553ee8,0x3f1ebf6dbdf13f7d,0xbf70bda13f7bbee8,0x3f493ec4bf7e3e20,0x3eb1bf7f3e483f64
.quad 0xa554bf80248d3f80,0xa554bf80248d3f80,0x3f80a50dbf808000,0x3f80a50dbf808000,0xbf35bf163f643e9e,0x3f7da554bf7d3e9e,0x3f35bf4fbee83f73,0xbe203f80be20bf73,0x3e483f79be8bbf73,0xbed63f6d3eb1bf73,0xbf7b3e6f3f76be9e,0xbf68bec43f703e9e,0x3f553ec4bf7b248d,0xbf55bec43f7ba554,0xbf0e3f6d3e48bf80,0x3f0ebf6dbe483f80
.quad 0xbec4bf643f063f4f,0x3f43bf35bf263f4f,0x3f6dbee8bf5a3f16,0x3f263f35bf43bf16,0xbf6dbe203f7fbe9e,0x3f063f35bf5abe9e,0x3ec4bf7d3da13f73,0xbf5a3f353f06bf73,0x3f0e3f43bf3cbf16,0xbf763ec43f5fbf16,0xbf553f263f2ebf4f,0xbe8bbf6d3efa3f4f,0x3f7bbda1bf703f16,0xbdf1bf6d3f1e3f16,0xbe483f7fbeb1bf4f,0x3f7ebec4bf493f4f
.quad 0xa554bf80248d3f80,0xa554bf80248d3f80,0x3f80a50dbf808000,0x3f80a50dbf808000,0xbe20bf733ee83f4f,0x3f353f16bf64be9e,0x3f7dbe9ebf643f16,0xbf353f4f3ee8bf73,0x3d213f7fbdf1bf7d,0xbf0e3f5a3efabf64,0xbf803da13f7ebe20,0xbf55bf063f5f3ee8,0x3e483f6dbf0ebf35,0xbe48bf6d3f0e3f35,0xbf7b3ec43f55bf35,0x3f7bbec4bf553f35
.quad 0xbda1bf7d3e6f3f73,0x3f6dbee8bf5a3f16,0x3f7fbe20bf793e9e,0x3ec43f64bf06bf4f,0xbe6fbf643f263f16,0xbec43f7dbda1bf73,0x3f79bee8bf433f4f,0xbf6dbe203f7fbe9e,0x3df13f79beb1bf64,0xbf7bbda13f80be20,0xbf7e3e6f3f70bee8,0x3e48bf7f3d213f7d,0x3e8b3f5abf3cbee8,0x3f55bf43bed63f7d,0xbf763f063f2ebf64,0x3f0e3f26bf68be20
.quad 0xa554bf80248d3f80,0xa554bf80248d3f80,0x3f80a50dbf808000,0x3f80a50dbf808000,0x3e203f73bee8bf4f,0xbf35bf163f643e9e,0xbf7d3e9e3f64bf16,0x3f35bf4fbee83f73,0xbf2e3f433f1ebf4f,0xbf7b3e6f3f76be9e,0xbf3cbf263f493f16,0xbe48bf793e8b3f73,0x3f0ebf6dbe483f80,0xbf0e3f6d3e48bf80,0x3f553ec4bf7b8000,0xbf55bec43f7ba50d
.quad 0x3f7fbe20bf793e9e,0x3ec43f64bf06bf4f,0x3da13f7dbe6fbf73,0xbf6d3ee83f5abf16,0xbf793ee83f43bf4f,0x3f6d3e20bf7f3e9e,0xbe6fbf643f263f16,0xbec43f7dbda1bf73,0xbf49bf063f683e9e,0x3f55bf26bf2e3f4f,0x3f1ebf5abed63f73,0x3f0e3f43bf3cbf16,0x3f5f3e6fbf803e9e,0x3e48bf7f3eb13f4f,0xbefa3f79bd21bf73,0x3f7bbda1bf703f16
.quad 0xa554bf80248d3f80,0xa554bf80248d3f80,0x3f80a50dbf808000,0x3f80a50dbf808000,0xbee83f733e20bf80,0xbe20bf733ee83f4f,0xbf64be9e3f7da50d,0x3f7dbe9ebf643f16,0xbf493f263f3cbf35,0xbf803da13f7ebe20,0xbf1ebf433f2e3f35,0xbd21bf7f3df13f7d,0x3f7bbec4bf553f35,0xbf7b3ec43f55bf35,0x3e483f6dbf0ebf35,0xbe48bf6d3f0e3f35
.quad 0x3f793e20bf7f248d,0x3da13f7dbe6fbf73,0xbe6f3f7d3da1bf80,0xbf7f3e203f79be9e,0xbf43bee83f79a554,0x3e6f3f64bf26bf16,0x3f26bf64be6f3f80,0xbf793ee83f43bf4f,0xbed6bf5a3f1e3f35,0x3f7ebe6fbf703ee8,0x3f68bf06bf493f35,0x3df13f79beb1bf64,0xbd213f79befabf35,0x3f76bf06bf2e3f64,0xbf803e6f3f5fbf35,0x3e8b3f5abf3cbee8
.quad 0xa554bf80248d3f80,0xa554bf80248d3f80,0x3f80a50dbf808000,0x3f80a50dbf808000,0xbf643f163f35bf4f,0x3ee8bf73be203f80,0xbee8bf4f3f353f16,0x3f643e9ebf7d8000,0xbf5f3f063f55bf16,0xbf7ebda13f80a554,0xbefabf5a3f0e3f4f,0x3df1bf7fbd213f80,0x3f553ec4bf7b248d,0xbf55bec43f7ba554,0xbf0e3f6d3e48bf80,0x3f0ebf6dbe483f80
.quad 0x3f5a3ee8bf6dbe9e,0xbe6f3f7d3da1bf80,0xbf063f643ec4bf73,0xbf79be203f7fa50d,0x3da1bf7d3ec43f4f,0xbf263f643e6fbf80,0x3f7fbe20bf6d3f16,0xbf43bee83f79a50d,0x3d21bf7f3e483f73,0x3f703e6fbf7e248d,0x3f80bda1bf7b3e9e,0xbeb13f793df1bf80,0xbf683f263f0ebf73,0x3f2e3f06bf76248d,0xbed6bf433f553e9e,0xbf3c3f5a3e8bbf80
.quad 0xa554bf80248d3f80,0xa554bf80248d3f80,0x3f80a50dbf808000,0x3f80a50dbf808000,0xbf7d248d3f7dbe9e,0x3f64bf16bf353f4f,0x3e20bf803e203f73,0x3ee83f4fbf35bf16,0xbf703ec43f68bee8,0xbf76be6f3f7b3e20,0xbeb1bf6d3ed63f64,0x3e8bbf79be483f7d,0x3e483f6dbf0ebf35,0xbe48bf6d3f0e3f35,0xbf7b3ec43f55bf35,0x3f7bbec4bf553f35
.quad 0x3f263f35bf43bf16,0xbf063f643ec4bf73,0xbf433f353f26bf4f,0xbf5abee83f6d3e9e,0x3f5abf35bf063f73,0xbf7f3e203f6dbf16,0x3f063f35bf5abe9e,0x3da1bf7d3ec43f4f,0x3efabf6dbe8b3f7d,0x3f2e3f26bf55bee8,0x3f5f3ec4bf76be20,0xbf3c3f433f0ebf64,0xbf49bec43f7ebe20,0xbeb13f7fbe48bf64,0x3f1ebf6dbdf13f7d,0xbf70bda13f7bbee8
.quad 0xa554bf80248d3f80,0xa554bf80248d3f80,0x3f80a50dbf808000,0x3f80a50dbf808000,0x3f7da554bf7d3e9e,0xbf643f163f35bf4f,0xbe203f80be20bf73,0xbee8bf4f3f353f16,0xbf68bec43f703e9e,0xbefabf5a3f0e3f4f,0x3ed6bf6dbeb13f73,0x3f5fbf06bf553f16,0x3f0ebf6dbe483f80,0xbf0e3f6d3e48bf80,0x3f553ec4bf7b8000,0xbf55bec43f7ba50d
.quad 0xbf433f353f26bf4f,0xbf5abee83f6d3e9e,0xbf26bf353f433f16,0x3f06bf64bec43f73,0xbf06bf353f5a3e9e,0xbda13f7dbec4bf4f,0x3f5abf35bf063f73,0xbf7f3e203f6dbf16,0x3e8b3f6dbefabf4f,0xbf803da13f7bbe9e,0xbf763ec43f5fbf16,0x3d21bf7f3e483f73,0xbf7e3ec43f49bf4f,0x3ed63f43bf55be9e,0xbdf1bf6d3f1e3f16,0xbf683f263f0ebf73
.quad 0xa554bf80248d3f80,0xa554bf80248d3f80,0x3f80a50dbf808000,0x3f80a50dbf808000,0x3f353f16bf64be9e,0xbf7d248d3f7dbe9e,0xbf353f4f3ee8bf73,0x3e20bf803e203f73,0xbf55bf063f5f3ee8,0xbeb1bf6d3ed63f64,0x3f0ebf5abefa3f64,0x3f70bec4bf683ee8,0x3f7bbec4bf553f35,0xbf7b3ec43f55bf35,0x3e483f6dbf0ebf35,0xbe48bf6d3f0e3f35
.quad 0xbf6d3ee83f5abf16,0xbf26bf353f433f16,0xbec4bf643f063f4f,0x3f43bf35bf263f4f,0x3ec4bf7d3da13f73,0xbf5a3f353f06bf73,0x3f6d3e20bf7f3e9e,0xbf06bf353f5a3e9e,0xbe483f7fbd21bf7d,0xbf5fbec43f763e20,0xbf7bbda13f80be20,0x3efabf6dbe8b3f7d,0xbf0ebf263f683e20,0xbf1e3f6d3df1bf7d,0x3f55bf43bed63f7d,0xbf49bec43f7ebe20
.quad 0xa554bf80248d3f80,0xa554bf80248d3f80,0x3f80a50dbf808000,0x3f80a50dbf808000,0x3e203f73bee8bf4f,0xbf35bf163f643e9e,0xbf7d3e9e3f64bf16,0x3f35bf4fbee83f73,0xbf3cbf263f493f16,0xbe48bf793e8b3f73,0x3f2ebf43bf1e3f4f,0x3f7bbe6fbf763e9e,0x3f553ec4bf7b248d,0xbf55bec43f7ba554,0xbf0e3f6d3e48bf80,0x3f0ebf6dbe483f80
.quad 0xbf7f3e203f79be9e,0xbec4bf643f063f4f,0xbda1bf7d3e6f3f73,0x3f6dbee8bf5a3f16,0x3f79bee8bf433f4f,0xbf6dbe203f7fbe9e,0x3e6f3f64bf26bf16,0x3ec4bf7d3da13f73,0xbf1e3f5a3ed6bf73,0xbf0ebf433f3c3f16,0xbf49bf063f683e9e,0x3f55bf26bf2e3f4f,0x3efabf793d213f73,0xbf7b3da13f70bf16,0x3f5f3e6fbf803e9e,0x3e48bf7f3eb13f4f
.quad 0xa554bf80248d3f80,0xa554bf80248d3f80,0x3f80a50dbf808000,0x3f80a50dbf808000,0xbee83f733e20bf80,0xbe20bf733ee83f4f,0xbf64be9e3f7da50d,0x3f7dbe9ebf643f16,0xbf1ebf433f2e3f35,0xbd21bf7f3df13f7d,0x3f49bf26bf3c3f35,0x3f80bda1bf7e3e20,0x3e483f6dbf0ebf35,0xbe48bf6d3f0e3f35,0xbf7b3ec43f55bf35,0x3f7bbec4bf553f35
.quad 0xbf79be203f7fa554,0xbda1bf7d3e6f3f73,0x3e6fbf7dbda13f80,0x3f7fbe20bf793e9e,0x3f433ee8bf79248d,0xbe6fbf643f263f16,0xbf263f643e6fbf80,0x3f79bee8bf433f4f,0xbf683f063f49bf35,0xbdf1bf793eb13f64,0xbed6bf5a3f1e3f35,0x3f7ebe6fbf703ee8,0x3f80be6fbf5f3f35,0xbe8bbf5a3f3c3ee8,0xbd213f79befabf35,0x3f76bf06bf2e3f64
.quad 0x3f4fbf4fbe9e3f80,0xbe9ebf4f3f4f3e9e,0x3f163f16bf738000,0x3f73bf16bf163f73,0x3f7dbf16bee83f80,0x3ee83f16bf7d3e9e,0x3e203f4fbf648000,0xbf643f4f3e20bf73,0x3f5fbf43beb13f80,0x3ed6bf7f3e8b3f4f,0x3efa3f26bf708000,0x3f683da1bf763f16,0x3f80bf06befa3f80,0xbe8b3f79bf2ebe9e,0x3d213f5abf5f8000,0xbf763e6f3f3cbf73
.quad 0x3f6dbf35bec43f80,0x3f6dbf35bec43f80,0x3ec43f35bf6d8000,0x3ec43f35bf6d8000,0x3f7fbee8bf063f80,0xbf5a3f64bda1bf4f,0xbda13f64bf5a8000,0xbf06bee83f7fbf16,0x3f76bf26bed63f80,0x3f70bda1bf5f3f4f,0x3e8b3f43bf688000,0xbeb13f7fbefabf16,0x3f7bbec4bf0e3f80,0xbf7b3ec43f0ebf80,0xbe483f6dbf558000,0x3e48bf6d3f55a50d
.quad 0x3f4f3e9ebf803e9e,0x3f4fbf4fbe9e3f80,0xbf163f73a50dbf73,0x3f163f16bf738000,0xbe203f73bf35be9e,0xbf7d3f163ee8bf80,0xbf7d3e9e3f35bf73,0xbe20bf4f3f64a50d,0x3f1e3f06bf7b3e20,0x3f76bda1bf683f35,0xbf493f5a3e48bf7d,0xbe8b3f7fbed6bf35,0xbed63f7fbf0ebee8,0xbf3cbe6f3f76bf35,0xbf683da13f55bf64,0x3f2ebf793e8b3f35
.quad 0x3ec43f35bf6d248d,0x3ec43f35bf6d248d,0xbf6d3f353ec4bf80,0xbf6d3f353ec4bf80,0xbf263f7dbec4bf16,0x3da1bf643f5aa554,0xbf43be203f6dbf4f,0x3f7fbee8bf063f80,0x3df13f5abf55be20,0xbefa3f7fbeb1bf35,0xbf7e3f063f0ebf7d,0xbf5fbda13f70bf35,0xbf553f6dbe48bf35,0x3f55bf6d3e483f35,0xbf0ebec43f7bbf35,0x3f0e3ec4bf7b3f35
.quad 0xbe9e3f80be9ebf4f,0x3f4f3e9ebf803e9e,0xbf7380003f73bf16,0xbf163f73a50dbf73,0xbf64248d3f64bf4f,0x3e20bf733f353e9e,0x3ee8bf803ee83f16,0x3f7dbe9ebf353f73,0xbf2e3f6d3d21bf73,0xbdf13f79bf0ebf16,0xbf3cbec43f80be9e,0xbf7e3e6f3f55bf4f,0xbf1ebec43f7ebf16,0x3f70bf43be483f73,0x3f49bf6d3df13f4f,0x3eb13f26bf7b3e9e
.quad 0xbf6d3f353ec4bf80,0xbf6d3f353ec4bf80,0xbec4bf353f6da50d,0xbec4bf353f6da50d,0xbe6fbf353f79be9e,0x3f433e20bf6d3f4f,0x3f79bf35be6f3f73,0xbf263f7dbec4bf16,0xbf803ec43f2ebf73,0xbf49be6f3f7bbf16,0x3d21bf6d3f3c3e9e,0x3f1ebf793e483f4f,0x3e48bf6d3f55a554,0xbe483f6dbf55248d,0x3f7bbec4bf0e3f80,0xbf7b3ec43f0ebf80
.quad 0xbf803e9e3f4fbf4f,0xbe9e3f80be9ebf4f,0xa50dbf733f163f16,0xbf7380003f73bf16,0x3f35bf733e203f4f,0x3f64a554bf643f4f,0x3f353e9ebf7d3f16,0xbee83f80bee8bf16,0xbf55be6f3f7ebee8,0xbf803ec43f3cbf64,0x3f0ebf793df13f64,0xbd21bf6d3f2e3ee8,0x3f7bbf26beb13f7d,0xbdf13f6dbf49be20,0x3e483f43bf703e20,0xbf7e3ec43f1ebf7d
.quad 0xbec4bf353f6da554,0xbec4bf353f6da554,0x3f6dbf35bec43f80,0x3f6dbf35bec43f80,0x3f6dbe20bf433f73,0xbf793f353e6fbf73,0xbec43f7dbf26be9e,0xbe6fbf353f79be9e,0x3e48bf793f1e3ee8,0x3f3cbf6d3d213f64,0x3f7bbe6fbf493f64,0x3f2e3ec4bf803ee8,0x3f0e3ec4bf7b3f35,0xbf0ebec43f7bbf35,0xbf553f6dbe48bf35,0x3f55bf6d3e483f35
.quad 0xbf803e9e3f4fbf4f,0xbe9e3f80be9ebf4f,0xa50dbf733f163f16,0xbf7380003f73bf16,0xbf353f73be20bf4f,0xbf64248d3f64bf4f,0xbf35be9e3f7dbf16,0x3ee8bf803ee83f16,0xbe48bf5a3f493e9e,0xbf3cbec43f80be9e,0x3f7bbf06bf1e3f73,0x3f2ebf6dbd213f73,0xbf55bda13f68bf4f,0x3f49bf6d3df13f4f,0x3f0ebf7f3ed63f16,0x3f1e3ec4bf7e3f16
.quad 0x3f6dbf35bec43f80,0x3f6dbf35bec43f80,0x3ec43f35bf6d8000,0x3ec43f35bf6d8000,0x3ec4bf7d3f263e9e,0x3e6f3f35bf793e9e,0x3f6dbe20bf433f73,0xbf793f353e6fbf73,0x3f0e3f06bf7e3e9e,0xbd213f6dbf3cbe9e,0xbf553f5a3df1bf73,0xbf803ec43f2ebf73,0x3f7bbec4bf0e3f80,0xbf7b3ec43f0ebf80,0xbe483f6dbf558000,0x3e48bf6d3f55a50d
.quad 0xbe9ebf4f3f4f3e9e,0xbf803e9e3f4fbf4f,0x3f73bf16bf163f73,0xa50dbf733f163f16,0xbee8bf163f7dbe9e,0x3f35bf733e203f4f,0x3f64bf4fbe203f73,0x3f353e9ebf7d3f16,0x3f70bf26befa3f7d,0x3f0ebf793df13f64,0x3eb13f43bf5fbe20,0x3f553e6fbf7e3ee8,0x3f5fbf5abd213f64,0x3e483f43bf703e20,0x3efa3f06bf803ee8,0xbf7b3f263eb1bf7d
.quad 0x3ec43f35bf6d248d,0x3ec43f35bf6d248d,0xbf6d3f353ec4bf80,0xbf6d3f353ec4bf80,0x3f063ee8bf7f3f16,0xbf6d3e203f43bf73,0xbf5a3f64bda1bf4f,0x3ec4bf7d3f263e9e,0xbf683f433e8bbf7d,0xbf7b3e6f3f49bf64,0xbed6bf263f76be20,0x3e48bf793f1e3ee8,0xbf553f6dbe48bf35,0x3f55bf6d3e483f35,0xbf0ebec43f7bbf35,0x3f0e3ec4bf7b3f35
.quad 0x3f4fbf4fbe9e3f80,0xbe9ebf4f3f4f3e9e,0x3f163f16bf738000,0x3f73bf16bf163f73,0x3f7dbf16bee83f80,0x3ee83f16bf7d3e9e,0x3e203f4fbf648000,0xbf643f4f3e20bf73,0x3efa3f26bf70248d,0x3f683da1bf763f16,0xbf5f3f433eb1bf80,0xbed63f7fbe8bbf4f,0x3d213f5abf5f248d,0xbf763e6f3f3cbf73,0xbf803f063efabf80,0x3e8bbf793f2e3e9e
.quad 0xbf6d3f353ec4bf80,0xbf6d3f353ec4bf80,0xbec4bf353f6da50d,0xbec4bf353f6da50d,0xbf7f3ee83f06bf80,0x3f5abf643da13f4f,0x3da1bf643f5aa50d,0x3f063ee8bf7f3f16,0xbe8bbf433f68a554,0x3eb1bf7f3efa3f16,0x3f76bf26bed63f80,0x3f70bda1bf5f3f4f,0x3e48bf6d3f55a554,0xbe483f6dbf55248d,0x3f7bbec4bf0e3f80,0xbf7b3ec43f0ebf80
.quad 0x3f4f3e9ebf803e9e,0x3f4fbf4fbe9e3f80,0xbf163f73a50dbf73,0x3f163f16bf738000,0xbe203f73bf35be9e,0xbf7d3f163ee8bf80,0xbf7d3e9e3f35bf73,0xbe20bf4f3f64a50d,0xbf493f5a3e48bf7d,0xbe8b3f7fbed6bf35,0xbf1ebf063f7bbe20,0xbf763da13f68bf35,0xbf683da13f55bf64,0x3f2ebf793e8b3f35,0x3ed6bf7f3f0e3ee8,0x3f3c3e6fbf763f35
.quad 0xbec4bf353f6da554,0xbec4bf353f6da554,0x3f6dbf35bec43f80,0x3f6dbf35bec43f80,0x3f26bf7d3ec43f16,0xbda13f64bf5a248d,0x3f433e20bf6d3f4f,0xbf7f3ee83f06bf80,0x3f7ebf06bf0e3f7d,0x3f5f3da1bf703f35,0x3df13f5abf55be20,0xbefa3f7fbeb1bf35,0x3f0e3ec4bf7b3f35,0xbf0ebec43f7bbf35,0xbf553f6dbe48bf35,0x3f55bf6d3e483f35
.quad 0x3f4f3e9ebf803e9e,0x3f4fbf4fbe9e3f80,0xbf163f73a50dbf73,0x3f163f16bf738000,0x3e20bf733f353e9e,0x3f7dbf16bee83f80,0x3f7dbe9ebf353f73,0x3e203f4fbf648000,0xbf7e3e6f3f55bf4f,0xbf5f3f433eb1bf80,0x3df1bf793f0e3f16,0xbefabf263f70a50d,0x3eb13f26bf7b3e9e,0xbf803f063efabf80,0xbf703f433e48bf73,0xbd21bf5a3f5fa50d
.quad 0x3f6dbf35bec43f80,0x3f6dbf35bec43f80,0x3ec43f35bf6d8000,0x3ec43f35bf6d8000,0xbf43be203f6dbf4f,0x3f7fbee8bf063f80,0x3f26bf7d3ec43f16,0xbda13f64bf5a8000,0xbf1e3f79be48bf4f,0xbf763f263ed6bf80,0xbf49be6f3f7bbf16,0xbe8bbf433f68a50d,0x3f7bbec4bf0e3f80,0xbf7b3ec43f0ebf80,0xbe483f6dbf558000,0x3e48bf6d3f55a50d
.quad 0xbe9e3f80be9ebf4f,0x3f4f3e9ebf803e9e,0xbf7380003f73bf16,0xbf163f73a50dbf73,0x3f64a554bf643f4f,0xbe203f73bf35be9e,0xbee83f80bee8bf16,0xbf7d3e9e3f35bf73,0xbd21bf6d3f2e3ee8,0xbf1ebf063f7bbe20,0x3f80bec4bf3c3f64,0x3f49bf5abe483f7d,0xbf7e3ec43f1ebf7d,0x3ed6bf7f3f0e3ee8,0x3df1bf6d3f493e20,0x3f68bda1bf553f64
.quad 0x3ec43f35bf6d248d,0x3ec43f35bf6d248d,0xbf6d3f353ec4bf80,0xbf6d3f353ec4bf80,0x3f79bf35be6f3f73,0xbf263f7dbec4bf16,0x3e6f3f35bf793e9e,0xbf43be203f6dbf4f,0xbf2ebec43f80bee8,0xbdf1bf5a3f553e20,0x3f3cbf6d3d213f64,0x3f7ebf06bf0e3f7d,0xbf553f6dbe48bf35,0x3f55bf6d3e483f35,0xbf0ebec43f7bbf35,0x3f0e3ec4bf7b3f35
.quad 0xbf803e9e3f4fbf4f,0xbe9e3f80be9ebf4f,0xa50dbf733f163f16,0xbf7380003f73bf16,0xbf353f73be20bf4f,0xbf64248d3f64bf4f,0xbf35be9e3f7dbf16,0x3ee8bf803ee83f16,0x3f7bbf06bf1e3f73,0x3f2ebf6dbd213f73,0x3e483f5abf49be9e,0x3f3c3ec4bf803e9e,0x3f0ebf7f3ed63f16,0x3f1e3ec4bf7e3f16,0x3f553da1bf683f4f,0xbf493f6dbdf1bf4f
.quad 0xbf6d3f353ec4bf80,0xbf6d3f353ec4bf80,0xbec4bf353f6da50d,0xbec4bf353f6da50d,0xbec43f7dbf26be9e,0xbe6fbf353f79be9e,0xbf6d3e203f43bf73,0x3f79bf35be6f3f73,0x3f55bf5abdf13f73,0x3f80bec4bf2e3f73,0x3f0e3f06bf7e3e9e,0xbd213f6dbf3cbe9e,0x3e48bf6d3f55a554,0xbe483f6dbf55248d,0x3f7bbec4bf0e3f80,0xbf7b3ec43f0ebf80
.quad 0xbe9ebf4f3f4f3e9e,0xbf803e9e3f4fbf4f,0x3f73bf16bf163f73,0xa50dbf733f163f16,0xbee8bf163f7dbe9e,0x3f35bf733e203f4f,0x3f64bf4fbe203f73,0x3f353e9ebf7d3f16,0x3eb13f43bf5fbe20,0x3f553e6fbf7e3ee8,0xbf703f263efabf7d,0xbf0e3f79bdf1bf64,0x3efa3f06bf803ee8,0xbf7b3f263eb1bf7d,0xbf5f3f5a3d21bf64,0xbe48bf433f70be20
.quad 0xbec4bf353f6da554,0xbec4bf353f6da554,0x3f6dbf35bec43f80,0x3f6dbf35bec43f80,0xbf06bee83f7fbf16,0x3f6dbe20bf433f73,0x3f5abf643da13f4f,0xbec43f7dbf26be9e,0x3ed63f26bf763e20,0xbe483f79bf1ebee8,0xbf683f433e8bbf7d,0xbf7b3e6f3f49bf64,0x3f0e3ec4bf7b3f35,0xbf0ebec43f7bbf35,0xbf553f6dbe48bf35,0x3f55bf6d3e483f35
.quad 0xbe9ebf4f3f4f3e9e,0xbf803e9e3f4fbf4f,0x3f73bf16bf163f73,0xa50dbf733f163f16,0x3ee83f16bf7d3e9e,0xbf353f73be20bf4f,0xbf643f4f3e20bf73,0xbf35be9e3f7dbf16,0xbed63f7fbe8bbf4f,0x3e483f5abf49be9e,0xbf68bda13f76bf16,0xbf7b3f063f1ebf73,0x3e8bbf793f2e3e9e,0x3f553da1bf683f4f,0x3f76be6fbf3c3f73,0xbf0e3f7fbed6bf16
.quad 0x3f6dbf35bec43f80,0x3f6dbf35bec43f80,0x3ec43f35bf6d8000,0x3ec43f35bf6d8000,0xbf5a3f64bda1bf4f,0x3ec4bf7d3f263e9e,0xbf06bee83f7fbf16,0x3f6dbe20bf433f73,0xbf703da13f5fbf4f,0xbf0ebf063f7ebe9e,0x3eb1bf7f3efa3f16,0x3f55bf5abdf13f73,0x3f7bbec4bf0e3f80,0xbf7b3ec43f0ebf80,0xbe483f6dbf558000,0x3e48bf6d3f55a50d
.quad 0x3f4fbf4fbe9e3f80,0xbe9ebf4f3f4f3e9e,0x3f163f16bf738000,0x3f73bf16bf163f73,0xbf7d3f163ee8bf80,0xbee8bf163f7dbe9e,0xbe20bf4f3f64a50d,0x3f64bf4fbe203f73,0xbf763da13f68bf35,0xbf703f263efabf7d,0x3e8bbf7f3ed63f35,0xbeb1bf433f5f3e20,0x3f3c3e6fbf763f35,0xbf5f3f5a3d21bf64,0xbf2e3f79be8bbf35,0xbefabf063f80bee8
.quad 0x3ec43f35bf6d248d,0x3ec43f35bf6d248d,0xbf6d3f353ec4bf80,0xbf6d3f353ec4bf80,0x3da1bf643f5aa554,0x3f063ee8bf7f3f16,0x3f7fbee8bf063f80,0xbf5a3f64bda1bf4f,0x3efabf7f3eb13f35,0x3f68bf43be8b3f7d,0x3f5f3da1bf703f35,0x3ed63f26bf763e20,0xbf553f6dbe48bf35,0x3f55bf6d3e483f35,0xbf0ebec43f7bbf35,0x3f0e3ec4bf7b3f35
.quad 0x3f4f3e9ebf803e9e,0x3f4fbf4fbe9e3f80,0xbf163f73a50dbf73,0x3f163f16bf738000,0x3e20bf733f353e9e,0x3f7dbf16bee83f80,0x3f7dbe9ebf353f73,0x3e203f4fbf648000,0x3df1bf793f0e3f16,0xbefabf263f70a554,0x3f7ebe6fbf553f4f,0x3f5fbf43beb13f80,0xbf703f433e48bf73,0xbd21bf5a3f5fa554,0xbeb1bf263f7bbe9e,0x3f80bf06befa3f80
.quad 0xbf6d3f353ec4bf80,0xbf6d3f353ec4bf80,0xbec4bf353f6da50d,0xbec4bf353f6da50d,0x3f433e20bf6d3f4f,0xbf7f3ee83f06bf80,0xbf263f7dbec4bf16,0x3da1bf643f5aa50d,0x3f493e6fbf7b3f16,0x3e8b3f43bf68248d,0xbf1e3f79be48bf4f,0xbf763f263ed6bf80,0x3e48bf6d3f55a554,0xbe483f6dbf55248d,0x3f7bbec4bf0e3f80,0xbf7b3ec43f0ebf80
.quad 0xbe9e3f80be9ebf4f,0x3f4f3e9ebf803e9e,0xbf7380003f73bf16,0xbf163f73a50dbf73,0x3f64a554bf643f4f,0xbe203f73bf35be9e,0xbee83f80bee8bf16,0xbf7d3e9e3f35bf73,0x3f80bec4bf3c3f64,0x3f49bf5abe483f7d,0x3d213f6dbf2ebee8,0x3f1e3f06bf7b3e20,0x3df1bf6d3f493e20,0x3f68bda1bf553f64,0x3f7ebec4bf1e3f7d,0xbed63f7fbf0ebee8
.quad 0xbec4bf353f6da554,0xbec4bf353f6da554,0x3f6dbf35bec43f80,0x3f6dbf35bec43f80,0xbf793f353e6fbf73,0x3f26bf7d3ec43f16,0xbe6fbf353f79be9e,0x3f433e20bf6d3f4f,0xbf3c3f6dbd21bf64,0xbf7e3f063f0ebf7d,0xbf2ebec43f80bee8,0xbdf1bf5a3f553e20,0x3f0e3ec4bf7b3f35,0xbf0ebec43f7bbf35,0xbf553f6dbe48bf35,0x3f55bf6d3e483f35
.quad 0xbe9e3f80be9ebf4f,0x3f4f3e9ebf803e9e,0xbf7380003f73bf16,0xbf163f73a50dbf73,0xbf64248d3f64bf4f,0x3e20bf733f353e9e,0x3ee8bf803ee83f16,0x3f7dbe9ebf353f73,0x3f3c3ec4bf803e9e,0x3f7ebe6fbf553f4f,0xbf2e3f6d3d21bf73,0xbdf13f79bf0ebf16,0xbf493f6dbdf1bf4f,0xbeb1bf263f7bbe9e,0xbf1ebec43f7ebf16,0x3f70bf43be483f73
.quad 0x3f6dbf35bec43f80,0x3f6dbf35bec43f80,0x3ec43f35bf6d8000,0x3ec43f35bf6d8000,0x3e6f3f35bf793e9e,0xbf43be203f6dbf4f,0xbf793f353e6fbf73,0x3f26bf7d3ec43f16,0x3d21bf6d3f3c3e9e,0x3f1ebf793e483f4f,0x3f80bec4bf2e3f73,0x3f493e6fbf7b3f16,0x3f7bbec4bf0e3f80,0xbf7b3ec43f0ebf80,0xbe483f6dbf558000,0x3e48bf6d3f55a50d
.quad 0xbf803e9e3f4fbf4f,0xbe9e3f80be9ebf4f,0xa50dbf733f163f16,0xbf7380003f73bf16,0x3f35bf733e203f4f,0x3f64a554bf643f4f,0x3f353e9ebf7d3f16,0xbee83f80bee8bf16,0xbf0e3f79bdf1bf64,0x3d213f6dbf2ebee8,0xbf55be6f3f7ebee8,0xbf803ec43f3cbf64,0xbe48bf433f70be20,0x3f7ebec4bf1e3f7d,0x3f7bbf26beb13f7d,0xbdf13f6dbf49be20
.quad 0x3ec43f35bf6d248d,0x3ec43f35bf6d248d,0xbf6d3f353ec4bf80,0xbf6d3f353ec4bf80,0xbf6d3e203f43bf73,0x3f79bf35be6f3f73,0x3ec4bf7d3f263e9e,0x3e6f3f35bf793e9e,0x3f7bbe6fbf493f64,0x3f2e3ec4bf803ee8,0xbe483f79bf1ebee8,0xbf3c3f6dbd21bf64,0xbf553f6dbe48bf35,0x3f55bf6d3e483f35,0xbf0ebec43f7bbf35,0x3f0e3ec4bf7b3f35
.quad 0xbe9ebf4f3f4f3e9e,0xbf803e9e3f4fbf4f,0x3f73bf16bf163f73,0xa50dbf733f163f16,0x3ee83f16bf7d3e9e,0xbf353f73be20bf4f,0xbf643f4f3e20bf73,0xbf35be9e3f7dbf16,0xbf68bda13f76bf16,0xbf7b3f063f1ebf73,0x3ed6bf7f3e8b3f4f,0xbe48bf5a3f493e9e,0x3f76be6fbf3c3f73,0xbf0e3f7fbed6bf16,0xbe8b3f79bf2ebe9e,0xbf55bda13f68bf4f
.quad 0xbf6d3f353ec4bf80,0xbf6d3f353ec4bf80,0xbec4bf353f6da50d,0xbec4bf353f6da50d,0x3f5abf643da13f4f,0xbec43f7dbf26be9e,0x3f063ee8bf7f3f16,0xbf6d3e203f43bf73,0xbeb13f7fbefabf16,0xbf553f5a3df1bf73,0xbf703da13f5fbf4f,0xbf0ebf063f7ebe9e,0x3e48bf6d3f55a554,0xbe483f6dbf55248d,0x3f7bbec4bf0e3f80,0xbf7b3ec43f0ebf80
.quad 0x3f4fbf4fbe9e3f80,0xbe9ebf4f3f4f3e9e,0x3f163f16bf738000,0x3f73bf16bf163f73,0xbf7d3f163ee8bf80,0xbee8bf163f7dbe9e,0xbe20bf4f3f64a50d,0x3f64bf4fbe203f73,0x3e8bbf7f3ed63f35,0xbeb1bf433f5f3e20,0x3f76bda1bf683f35,0x3f70bf26befa3f7d,0xbf2e3f79be8bbf35,0xbefabf063f80bee8,0xbf3cbe6f3f76bf35,0x3f5fbf5abd213f64
.quad 0xbec4bf353f6da554,0xbec4bf353f6da554,0x3f6dbf35bec43f80,0x3f6dbf35bec43f80,0xbda13f64bf5a248d,0xbf06bee83f7fbf16,0xbf7f3ee83f06bf80,0x3f5abf643da13f4f,0xbf5fbda13f70bf35,0xbed6bf263f76be20,0x3efabf7f3eb13f35,0x3f68bf43be8b3f7d,0x3f0e3ec4bf7b3f35,0xbf0ebec43f7bbf35,0xbf553f6dbe48bf35,0x3f55bf6d3e483f35
.quad 0x3f73be9ebf163f80,0xbf16be9e3f73bf4f,0xbe9e3f73bf4f8000,0x3f4fbf733e9e3f16,0x3f35a554bf353f80,0x3f35a554bf353f80,0xbf353f80bf358000,0xbf353f80bf358000,0x3f68be6fbf1e3f80,0x3df1bf5a3f70be9e,0xbed63f79bf498000,0x3f7ebf06beb13f73,0x3f1e3da1bf3c3f80,0x3d213f26bf7e3f4f,0xbf493f7fbf2e8000,0xbf803f43bdf1bf16
.quad 0x3f5abe20bf263f80,0x3f43bf7d3f063e9e,0xbf063f7dbf438000,0x3f263e20bf5a3f73,0x3f063e20bf433f80,0xbf263f7dbf5a3e9e,0xbf5a3f7dbf268000,0xbf433e203f06bf73,0x3f49bda1bf2e3f80,0x3f80bf26bdf13f4f,0xbf1e3f7fbf3c8000,0xbd213f43bf7e3f16,0x3ed63e6fbf493f80,0xbf7e3f5abeb1be9e,0xbf683f79bf1e8000,0xbdf1bf063f70bf73
.quad 0xbf733f4fa554bf4f,0x3f73be9ebf163f80,0xbe9ebf163f80bf16,0xbe9e3f73bf4f8000,0xbf35248d3f35bf80,0xbf35248d3f35bf80,0x3f35bf803f35a50d,0x3f35bf803f35a50d,0xbf803f263e48bf64,0x3eb13f06bf7e3f35,0xbd21bf433f7bbee8,0xbf703f5abdf1bf35,0xbefabe6f3f55bf7d,0x3df1bf433f80bf35,0x3f5fbf793f0e3e20,0x3f7ebf26bd213f35
.quad 0xbf793ee83ec4bf73,0xbf063f7dbf43248d,0x3e6fbf643f6dbe9e,0xbf5a3e203f26bf80,0xbe6fbee83f6dbf73,0x3f5abf7d3f26a554,0x3f79bf643ec43e9e,0x3f063e20bf433f80,0xbf5f3e6f3f0ebf7d,0xbf7e3f43bd21bf35,0x3efabf793f55be20,0xbdf1bf263f80bf35,0x3d21bf263f7bbf64,0x3f70bf06bdf13f35,0x3f80bf433e483ee8,0xbeb13f5abf7e3f35
.quad 0x3f16bf803f163e9e,0xbf733f4fa554bf4f,0x3f4fa50dbf4f3f73,0xbe9ebf163f80bf16,0x3f35a554bf353f80,0x3f35a554bf353f80,0xbf353f80bf358000,0xbf353f80bf358000,0x3f5fbf6d3e8b3f16,0xbf3cbda13f55bf73,0x3efa3ec4bf763f4f,0x3f2ebf7f3f0e3e9e,0x3eb13ec4bf683f73,0xbe8b3f5abf7b3f16,0xbf703f6dbed6be9e,0xbf763f063e48bf4f
.quad 0x3f7fbf35bda13f4f,0x3e6fbf643f6dbe9e,0x3da13f35bf7f3f16,0x3f79bee8bec43f73,0xbda13f35bf7f3f4f,0xbf793f64bec4be9e,0xbf7f3f35bda1bf16,0xbe6fbee83f6dbf73,0x3f70bec4bed63f73,0x3f76bf5a3e483f16,0xbeb13f6dbf683e9e,0x3e8b3f06bf7b3f4f,0xbefa3f6dbf763f16,0xbf2e3da13f0ebf73,0xbf5f3ec43e8bbf4f,0x3f3cbf7f3f55be9e
.quad 0x248d3f4fbf733e9e,0x3f16bf803f163e9e,0xbf803f163e9ebf73,0x3f4fa50dbf4f3f73,0xbf35248d3f35bf80,0xbf35248d3f35bf80,0x3f35bf803f35a50d,0x3f35bf803f35a50d,0xbf0e3f7fbf2ebe20,0x3f76bec4befa3f7d,0xbf553da13f3cbf7d,0xbe8b3f6dbf5f3e20,0xbe48bf063f76bf64,0x3ed6bf6d3f70bee8,0x3f7bbf5a3e8b3ee8,0x3f68bec4beb13f64
.quad 0xbf6d3f64be6fbf16,0x3da13f35bf7f3f16,0xbec4bee83f79bf4f,0xbf7f3f353da1bf4f,0x3ec4bf643f79bf16,0x3f7fbf353da13f16,0x3f6dbee8be6f3f4f,0xbda13f35bf7f3f4f,0xbf7b3f063e8bbf64,0xbf683f6dbeb1bee8,0x3e48bf5a3f76bee8,0xbed6bec43f70bf64,0x3f55bf7f3f3cbe20,0x3e8b3ec4bf5f3f7d,0x3f0e3da1bf2e3f7d,0xbf763f6dbefabe20
.quad 0x248d3f4fbf733e9e,0x3f16bf803f163e9e,0xbf803f163e9ebf73,0x3f4fa50dbf4f3f73,0x3f35a554bf353f80,0x3f35a554bf353f80,0xbf353f80bf358000,0xbf353f80bf358000,0xbf7b3f433d21bf4f,0x3efa3ec4bf763f4f,0xbe48bf263f80bf16,0xbf5f3f6dbe8bbf16,0xbf0e3f79bf5f3e9e,0xbf703f6dbed6be9e,0xbf553e6f3efabf73,0xbeb1bec43f68bf73
.quad 0xbec4bee83f79bf4f,0xbf7f3f353da1bf4f,0x3f6dbf643e6f3f16,0xbda1bf353f7fbf16,0xbf6d3ee83e6fbf4f,0x3da1bf353f7fbf4f,0x3ec4bf643f79bf16,0x3f7fbf353da13f16,0x3f55bf793efa3e9e,0x3eb1bf6d3f68be9e,0x3f0e3e6fbf5f3f73,0x3f70bec4bed63f73,0x3e48bf433f80bf4f,0x3f5fbec4be8b3f4f,0x3f7bbf263d213f16,0xbefa3f6dbf763f16
.quad 0xbf16be9e3f73bf4f,0x248d3f4fbf733e9e,0x3f4fbf733e9e3f16,0xbf803f163e9ebf73,0xbf35248d3f35bf80,0xbf35248d3f35bf80,0x3f35bf803f35a50d,0x3f35bf803f35a50d,0x3f49bf793ed63ee8,0xbf553da13f3cbf7d,0x3f1e3e6fbf683f64,0x3f0ebf7f3f2e3e20,0x3f2ebf7f3f49be20,0x3f7bbf5a3e8b3ee8,0x3f3cbda1bf1e3f7d,0x3e483f06bf763f64
.quad 0x3f263e20bf5a3f73,0x3f6dbf643e6f3f16,0xbf433f7dbf06be9e,0x3ec43ee8bf793f4f,0x3f43be20bf063f73,0xbec43f64bf793f16,0xbf263f7dbf5a3e9e,0xbf6d3ee83e6fbf4f,0xbf3c3f7fbf1ebe20,0xbe483f5abf763ee8,0xbf2ebda13f49bf7d,0xbf7b3f063e8bbf64,0xbf1e3f79bf683ee8,0xbf0ebda13f2ebf7d,0xbf493e6f3ed6bf64,0x3f55bf7f3f3cbe20
.quad 0x3f73be9ebf163f80,0xbf16be9e3f73bf4f,0xbe9e3f73bf4f8000,0x3f4fbf733e9e3f16,0x3f35a554bf353f80,0x3f35a554bf353f80,0xbf353f80bf358000,0xbf353f80bf358000,0xbed63f79bf49248d,0x3f7ebf06beb13f73,0xbf683e6f3f1ebf80,0xbdf13f5abf703e9e,0xbf493f7fbf2e248d,0xbf803f43bdf1bf16,0xbf1ebda13f3cbf80,0xbd21bf263f7ebf4f
.quad 0xbf5a3e203f26bf80,0xbf433f7dbf06be9e,0x3f06bf7d3f43a50d,0xbf26be203f5abf73,0xbf06be203f43bf80,0x3f26bf7d3f5abe9e,0x3f5abf7d3f26a50d,0x3f43be20bf063f73,0x3f1ebf7f3f3ca554,0x3d21bf433f7ebf16,0x3f49bda1bf2e3f80,0x3f80bf26bdf13f4f,0x3f68bf793f1ea554,0x3df13f06bf703f73,0x3ed63e6fbf493f80,0xbf7e3f5abeb1be9e
.quad 0xbf733f4fa554bf4f,0x3f73be9ebf163f80,0xbe9ebf163f80bf16,0xbe9e3f73bf4f8000,0xbf35248d3f35bf80,0xbf35248d3f35bf80,0x3f35bf803f35a50d,0x3f35bf803f35a50d,0xbd21bf433f7bbee8,0xbf703f5abdf1bf35,0x3f80bf26be483f64,0xbeb1bf063f7ebf35,0x3f5fbf793f0e3e20,0x3f7ebf26bd213f35,0x3efa3e6fbf553f7d,0xbdf13f43bf803f35
.quad 0x3f79bee8bec43f73,0x3f06bf7d3f43a554,0xbe6f3f64bf6d3e9e,0x3f5abe20bf263f80,0x3e6f3ee8bf6d3f73,0xbf5a3f7dbf26248d,0xbf793f64bec4be9e,0xbf06be203f43bf80,0xbefa3f79bf553e20,0x3df13f26bf803f35,0xbf5f3e6f3f0ebf7d,0xbf7e3f43bd21bf35,0xbf803f43be48bee8,0x3eb1bf5a3f7ebf35,0x3d21bf263f7bbf64,0x3f70bf06bdf13f35
.quad 0xbf733f4fa554bf4f,0x3f73be9ebf163f80,0xbe9ebf163f80bf16,0xbe9e3f73bf4f8000,0x3f35a554bf353f80,0x3f35a554bf353f80,0xbf353f80bf358000,0xbf353f80bf358000,0x3f2ebf7f3f0e3e9e,0xbf683e6f3f1ebf80,0x3f3c3da1bf553f73,0x3ed6bf793f49a50d,0xbf763f063e48bf4f,0xbf1ebda13f3cbf80,0x3e8bbf5a3f7bbf16,0x3f49bf7f3f2ea50d
.quad 0xbe6f3f64bf6d3e9e,0x3f5abe20bf263f80,0xbf793ee83ec4bf73,0xbf063f7dbf438000,0x3f79bf643ec43e9e,0x3f063e20bf433f80,0x3e6f3ee8bf6d3f73,0xbf5a3f7dbf268000,0xbe8bbf063f7bbf4f,0xbf493da13f2ebf80,0x3f76bf5a3e483f16,0x3f1ebf7f3f3ca50d,0xbf3c3f7fbf553e9e,0xbed6be6f3f49bf80,0xbf2e3da13f0ebf73,0x3f68bf793f1ea50d
.quad 0x3f16bf803f163e9e,0xbf733f4fa554bf4f,0x3f4fa50dbf4f3f73,0xbe9ebf163f80bf16,0xbf35248d3f35bf80,0xbf35248d3f35bf80,0x3f35bf803f35a50d,0x3f35bf803f35a50d,0xbe8b3f6dbf5f3e20,0x3f80bf26be483f64,0xbf763ec43efabf7d,0x3d213f43bf7b3ee8,0x3f68bec4beb13f64,0x3efa3e6fbf553f7d,0xbed63f6dbf703ee8,0xbf5f3f79bf0ebe20
.quad 0xbda1bf353f7fbf16,0xbf793ee83ec4bf73,0x3f7fbf35bda13f4f,0x3e6fbf643f6dbe9e,0xbf7f3f35bda1bf16,0xbe6fbee83f6dbf73,0x3da1bf353f7fbf4f,0x3f79bf643ec43e9e,0x3ed63ec4bf703f64,0x3f5fbe6fbf0e3f7d,0xbf683f6dbeb1bee8,0xbefa3f79bf553e20,0x3f76bf6d3efa3e20,0xbd213f26bf7b3f64,0x3e8b3ec4bf5f3f7d,0xbf803f43be48bee8
.quad 0x248d3f4fbf733e9e,0x3f16bf803f163e9e,0xbf803f163e9ebf73,0x3f4fa50dbf4f3f73,0x3f35a554bf353f80,0x3f35a554bf353f80,0xbf353f80bf358000,0xbf353f80bf358000,0xbe48bf263f80bf16,0xbf5f3f6dbe8bbf16,0x3f7bbf43bd213f4f,0xbefabec43f76bf4f,0xbf553e6f3efabf73,0xbeb1bec43f68bf73,0x3f0ebf793f5fbe9e,0x3f70bf6d3ed63e9e
.quad 0x3ec43ee8bf793f4f,0x3f7fbf35bda13f4f,0xbf6d3f64be6fbf16,0x3da13f35bf7f3f16,0x3f6dbee8be6f3f4f,0xbda13f35bf7f3f4f,0xbec43f64bf793f16,0xbf7f3f35bda1bf16,0xbf0ebe6f3f5fbf73,0xbf703ec43ed6bf73,0x3f55bf793efa3e9e,0x3eb1bf6d3f68be9e,0xbf7b3f26bd21bf16,0x3efabf6d3f76bf16,0x3e48bf433f80bf4f,0x3f5fbec4be8b3f4f
.quad 0xbf16be9e3f73bf4f,0x248d3f4fbf733e9e,0x3f4fbf733e9e3f16,0xbf803f163e9ebf73,0xbf35248d3f35bf80,0xbf35248d3f35bf80,0x3f35bf803f35a50d,0x3f35bf803f35a50d,0x3f1e3e6fbf683f64,0x3f0ebf7f3f2e3e20,0xbf493f79bed6bee8,0x3f55bda1bf3c3f7d,0x3f3cbda1bf1e3f7d,0x3e483f06bf763f64,0xbf2e3f7fbf493e20,0xbf7b3f5abe8bbee8
.quad 0xbf26be203f5abf73,0xbf6d3f64be6fbf16,0x3f43bf7d3f063e9e,0xbec4bee83f79bf4f,0xbf433e203f06bf73,0x3ec4bf643f79bf16,0x3f26bf7d3f5abe9e,0x3f6dbee8be6f3f4f,0x3f2e3da1bf493f7d,0x3f7bbf06be8b3f64,0xbf3c3f7fbf1ebe20,0xbe483f5abf763ee8,0x3f49be6fbed63f64,0xbf553f7fbf3c3e20,0xbf1e3f79bf683ee8,0xbf0ebda13f2ebf7d
.quad 0xbf16be9e3f73bf4f,0x248d3f4fbf733e9e,0x3f4fbf733e9e3f16,0xbf803f163e9ebf73,0x3f35a554bf353f80,0x3f35a554bf353f80,0xbf353f80bf358000,0xbf353f80bf358000,0xbdf13f5abf703e9e,0x3f7bbf43bd213f4f,0xbf7e3f063eb1bf73,0x3e483f26bf803f16,0xbd21bf263f7ebf4f,0x3f0ebf793f5fbe9e,0x3f80bf433df13f16,0x3f55be6fbefa3f73
.quad 0x3f43bf7d3f063e9e,0xbec4bee83f79bf4f,0x3f263e20bf5a3f73,0x3f6dbf643e6f3f16,0xbf263f7dbf5a3e9e,0xbf6d3ee83e6fbf4f,0xbf433e203f06bf73,0x3ec4bf643f79bf16,0xbf803f263df1bf4f,0xbf553f79befabe9e,0x3d21bf433f7ebf16,0xbf0ebe6f3f5fbf73,0x3f7ebf5a3eb13e9e,0xbe483f43bf803f4f,0x3df13f06bf703f73,0xbf7b3f26bd21bf16
.quad 0x3f73be9ebf163f80,0xbf16be9e3f73bf4f,0xbe9e3f73bf4f8000,0x3f4fbf733e9e3f16,0xbf35248d3f35bf80,0xbf35248d3f35bf80,0x3f35bf803f35a50d,0x3f35bf803f35a50d,0xbeb1bf063f7ebf35,0xbf493f79bed6bee8,0x3f70bf5a3df13f35,0xbf1ebe6f3f68bf64,0xbdf13f43bf803f35,0xbf2e3f7fbf493e20,0xbf7e3f263d21bf35,0xbf3c3da13f1ebf7d
.quad 0xbf063f7dbf43248d,0x3f263e20bf5a3f73,0xbf5a3e203f26bf80,0xbf433f7dbf06be9e,0x3f5abf7d3f26a554,0x3f43be20bf063f73,0x3f063e20bf433f80,0xbf263f7dbf5a3e9e,0x3f7ebf433d213f35,0x3f3cbf7f3f1e3e20,0x3df13f26bf803f35,0x3f2e3da1bf493f7d,0xbf703f063df1bf35,0x3f1ebf793f68bee8,0x3eb1bf5a3f7ebf35,0x3f49be6fbed63f64
.quad 0xbf733f4fa554bf4f,0x3f73be9ebf163f80,0xbe9ebf163f80bf16,0xbe9e3f73bf4f8000,0x3f35a554bf353f80,0x3f35a554bf353f80,0xbf353f80bf358000,0xbf353f80bf358000,0x3f3c3da1bf553f73,0x3ed6bf793f49a554,0xbf2e3f7fbf0ebe9e,0x3f68be6fbf1e3f80,0x3e8bbf5a3f7bbf16,0x3f49bf7f3f2ea554,0x3f76bf06be483f4f,0x3f1e3da1bf3c3f80
.quad 0x3e6fbf643f6dbe9e,0xbf5a3e203f26bf80,0x3f79bee8bec43f73,0x3f06bf7d3f43a50d,0xbf793f64bec4be9e,0xbf06be203f43bf80,0xbe6fbee83f6dbf73,0x3f5abf7d3f26a50d,0xbf763f5abe48bf16,0xbf1e3f7fbf3c248d,0xbe8bbf063f7bbf4f,0xbf493da13f2ebf80,0x3f2ebda1bf0e3f73,0xbf683f79bf1e248d,0xbf3c3f7fbf553e9e,0xbed6be6f3f49bf80
.quad 0x3f16bf803f163e9e,0xbf733f4fa554bf4f,0x3f4fa50dbf4f3f73,0xbe9ebf163f80bf16,0xbf35248d3f35bf80,0xbf35248d3f35bf80,0x3f35bf803f35a50d,0x3f35bf803f35a50d,0xbf763ec43efabf7d,0x3d213f43bf7b3ee8,0x3e8bbf6d3f5fbe20,0xbf803f263e48bf64,0xbed63f6dbf703ee8,0xbf5f3f79bf0ebe20,0xbf683ec43eb1bf64,0xbefabe6f3f55bf7d
.quad 0x3da13f35bf7f3f16,0x3f79bee8bec43f73,0xbf7f3f353da1bf4f,0xbe6f3f64bf6d3e9e,0x3f7fbf353da13f16,0x3e6f3ee8bf6d3f73,0xbda13f35bf7f3f4f,0xbf793f64bec4be9e,0x3f68bf6d3eb13ee8,0x3efabf793f55be20,0x3ed63ec4bf703f64,0x3f5fbe6fbf0e3f7d,0xbe8bbec43f5fbf7d,0x3f80bf433e483ee8,0x3f76bf6d3efa3e20,0xbd213f26bf7b3f64
.quad 0x3f16bf803f163e9e,0xbf733f4fa554bf4f,0x3f4fa50dbf4f3f73,0xbe9ebf163f80bf16,0x3f35a554bf353f80,0x3f35a554bf353f80,0xbf353f80bf358000,0xbf353f80bf358000,0xbefabec43f76bf4f,0xbf2e3f7fbf0ebe9e,0x3f5fbf6d3e8b3f16,0xbf3cbda13f55bf73,0x3f70bf6d3ed63e9e,0x3f76bf06be483f4f,0x3eb13ec4bf683f73,0xbe8b3f5abf7b3f16
.quad 0xbf7f3f353da1bf4f,0xbe6f3f64bf6d3e9e,0xbda1bf353f7fbf16,0xbf793ee83ec4bf73,0x3da1bf353f7fbf4f,0x3f79bf643ec43e9e,0x3f7fbf353da13f16,0x3e6f3ee8bf6d3f73,0xbeb13f6dbf683e9e,0x3e8b3f06bf7b3f4f,0xbf703ec43ed6bf73,0xbf763f5abe48bf16,0xbf5f3ec43e8bbf4f,0x3f3cbf7f3f55be9e,0x3efabf6d3f76bf16,0x3f2ebda1bf0e3f73
.quad 0x248d3f4fbf733e9e,0x3f16bf803f163e9e,0xbf803f163e9ebf73,0x3f4fa50dbf4f3f73,0xbf35248d3f35bf80,0xbf35248d3f35bf80,0x3f35bf803f35a50d,0x3f35bf803f35a50d,0x3f55bda1bf3c3f7d,0x3e8bbf6d3f5fbe20,0xbf0e3f7fbf2ebe20,0x3f76bec4befa3f7d,0xbf7b3f5abe8bbee8,0xbf683ec43eb1bf64,0xbe48bf063f76bf64,0x3ed6bf6d3f70bee8
.quad 0x3f6dbf643e6f3f16,0xbda1bf353f7fbf16,0x3ec43ee8bf793f4f,0x3f7fbf35bda13f4f,0xbec43f64bf793f16,0xbf7f3f35bda1bf16,0xbf6d3ee83e6fbf4f,0x3da1bf353f7fbf4f,0x3e48bf5a3f76bee8,0xbed6bec43f70bf64,0x3f7bbf06be8b3f64,0x3f68bf6d3eb13ee8,0x3f0e3da1bf2e3f7d,0xbf763f6dbefabe20,0xbf553f7fbf3c3e20,0xbe8bbec43f5fbf7d
.quad 0xbf16be9e3f73bf4f,0x248d3f4fbf733e9e,0x3f4fbf733e9e3f16,0xbf803f163e9ebf73,0x3f35a554bf353f80,0x3f35a554bf353f80,0xbf353f80bf358000,0xbf353f80bf358000,0xbf7e3f063eb1bf73,0x3e483f26bf803f16,0x3df1bf5a3f70be9e,0xbf7b3f433d21bf4f,0x3f80bf433df13f16,0x3f55be6fbefa3f73,0x3d213f26bf7e3f4f,0xbf0e3f79bf5f3e9e
.quad 0xbf433f7dbf06be9e,0x3ec43ee8bf793f4f,0xbf26be203f5abf73,0xbf6d3f64be6fbf16,0x3f26bf7d3f5abe9e,0x3f6dbee8be6f3f4f,0x3f43be20bf063f73,0xbec43f64bf793f16,0xbd213f43bf7e3f16,0x3f0e3e6fbf5f3f73,0xbf803f263df1bf4f,0xbf553f79befabe9e,0xbdf1bf063f70bf73,0x3f7bbf263d213f16,0x3f7ebf5a3eb13e9e,0xbe483f43bf803f4f
.quad 0x3f73be9ebf163f80,0xbf16be9e3f73bf4f,0xbe9e3f73bf4f8000,0x3f4fbf733e9e3f16,0xbf35248d3f35bf80,0xbf35248d3f35bf80,0x3f35bf803f35a50d,0x3f35bf803f35a50d,0x3f70bf5a3df13f35,0xbf1ebe6f3f68bf64,0x3eb13f06bf7e3f35,0x3f49bf793ed63ee8,0xbf7e3f263d21bf35,0xbf3c3da13f1ebf7d,0x3df1bf433f80bf35,0x3f2ebf7f3f49be20
.quad 0x3f06bf7d3f43a554,0xbf26be203f5abf73,0x3f5abe20bf263f80,0x3f43bf7d3f063e9e,0xbf5a3f7dbf26248d,0xbf433e203f06bf73,0xbf06be203f43bf80,0x3f26bf7d3f5abe9e,0xbdf1bf263f80bf35,0xbf2ebda13f49bf7d,0x3f7ebf433d213f35,0x3f3cbf7f3f1e3e20,0xbeb13f5abf7e3f35,0xbf493e6f3ed6bf64,0xbf703f063df1bf35,0x3f1ebf793f68bee8
.quad 0x3e9e3e9ebf4f3f80,0xbf4f3e9e3e9ebf4f,0xbf733f73bf168000,0x3f16bf733f73bf16,0xbe203f16bf643f80,0x3f64bf163e203e9e,0xbf7d3f4fbee88000,0xbee83f4fbf7d3f73,0x3e483ec4bf553f80,0xbe48bec43f55bf80,0xbf7b3f6dbf0e8000,0x3f7bbf6d3f0ea50d,0xbe8b3f26bf683f80,0x3eb13da1befa3f4f,0xbf763f43bed68000,0xbf703f7fbf5f3f16
.quad 0x3da13ee8bf5a3f80,0x3f06bf643f7fbf4f,0xbf7f3f64bf068000,0x3f5abee8bda13f16,0xbec43f35bf6d3f80,0xbec43f35bf6d3f80,0xbf6d3f35bec48000,0xbf6d3f35bec48000,0xbd213f06bf5f3f80,0x3f76bf793f3cbe9e,0xbf803f5abefa8000,0x3e8b3e6fbf2e3f73,0xbefa3f43bf703f80,0xbf683f7fbf763f4f,0xbf5f3f26beb18000,0xbed63da13e8bbf16
.quad 0x3e9ebf4f3f80bf4f,0x3e9e3e9ebf4f3f80,0x3f73bf1680003f16,0xbf733f73bf168000,0x3f7dbf733f35be9e,0x3e20bf163f64bf80,0x3e203e9ebf353f73,0x3f7dbf4f3ee8a50d,0x3f0ebf6d3f7bbf35,0xbf0e3f6dbf7b3f35,0x3f55bec4be483f35,0xbf553ec43e48bf35,0x3f7ebf5a3f0ebe20,0x3f5fbf7f3f70bf35,0xbdf13f06bf553f7d,0x3efabda1beb13f35
.quad 0x3f43bf7d3f6dbf16,0xbf7f3f64bf06248d,0x3f26be20bec43f4f,0xbda1bee83f5abf80,0x3f6dbf353ec4a554,0x3f6dbf353ec4a554,0xbec43f35bf6d3f80,0xbec43f35bf6d3f80,0x3f68bf7f3f55bee8,0xbf2e3e6f3e8bbf35,0x3ed63da1bf0e3f64,0x3f3cbf793f76bf35,0x3f49bf063e483e20,0x3e8b3da1bed63f35,0xbf1e3f5abf7b3f7d,0xbf763f7fbf683f35
.quad 0xbf4f3f80bf4f3e9e,0x3e9ebf4f3f80bf4f,0xbf1680003f16bf73,0x3f73bf1680003f16,0xbee8248d3ee8bf4f,0xbf7d3f73bf353e9e,0x3f64bf803f64bf16,0xbe20be9e3f35bf73,0xbf7b3f6dbf0e248d,0x3f7bbf6d3f0ea554,0xbe48bec43f55bf80,0x3e483ec4bf553f80,0xbd21bec43f3cbf73,0xbf1e3e6f3e48bf16,0x3f80bf6d3f2ebe9e,0x3f49bf793f7bbf4f
.quad 0xbf793f35be6fbe9e,0x3f26be20bec43f4f,0x3e6fbf353f79bf73,0xbf433f7dbf6d3f16,0x3ec4bf353f6dbf80,0x3ec4bf353f6dbf80,0x3f6dbf353ec4a50d,0x3f6dbf353ec4a50d,0xbf493ec43df1bf16,0xbeb13f43bf7b3f73,0x3f1ebf6d3f7ebf4f,0xbf703f26be48be9e,0x3f3cbf6d3f80bf73,0x3f7ebf793f55bf16,0x3f2ebec43d213e9e,0x3df13e6fbf0e3f4f
.quad 0x3f80bf4f3e9e3e9e,0xbf4f3f80bf4f3e9e,0x80003f16bf733f73,0xbf1680003f16bf73,0xbf353f73bf7d3f4f,0x3ee8a554bee83f4f,0xbf353e9e3e20bf16,0xbf643f80bf643f16,0x3f55bec4be483f35,0xbf553ec43e48bf35,0xbf0e3f6dbf7b3f35,0x3f0ebf6d3f7bbf35,0xbf7b3f79bf493ee8,0xbf2e3f6dbf803f64,0xbe48be6f3f1ebf64,0xbf3c3ec43d21bee8
.quad 0x3ec43e20bf263f73,0x3e6fbf353f79bf73,0xbf6d3f7dbf433e9e,0x3f79bf353e6f3e9e,0xbf6d3f35bec4248d,0xbf6d3f35bec4248d,0x3ec4bf353f6dbf80,0x3ec4bf353f6dbf80,0xbe483f26bf703f7d,0x3f7ebf6d3f1ebe20,0xbf7b3f43beb1be20,0x3df13ec4bf493f7d,0xbf0e3e6f3df1bee8,0x3d21bec43f2ebf64,0x3f55bf793f7ebf64,0x3f80bf6d3f3cbee8
.quad 0x3f80bf4f3e9e3e9e,0xbf4f3f80bf4f3e9e,0x80003f16bf733f73,0xbf1680003f16bf73,0x3f35bf733f7dbf4f,0xbee8248d3ee8bf4f,0x3f35be9ebe203f16,0x3f64bf803f64bf16,0x3e483ec4bf553f80,0xbe48bec43f55bf80,0xbf7b3f6dbf0e8000,0x3f7bbf6d3f0ea50d,0x3f55bf063df13e9e,0x3f80bf6d3f2ebe9e,0xbf0e3f5abf7e3f73,0x3d213ec4bf3c3f73
.quad 0xbf6d3f7dbf433e9e,0x3f79bf353e6f3e9e,0xbec4be203f26bf73,0xbe6f3f35bf793f73,0xbec43f35bf6d3f80,0xbec43f35bf6d3f80,0xbf6d3f35bec48000,0xbf6d3f35bec48000,0xbf0e3da13ed6bf4f,0xbf1e3f6dbf7e3f4f,0x3f55bf7f3f68bf16,0xbf493ec43df1bf16,0xbf7b3f5abf1e3e9e,0xbf2e3ec4bd21be9e,0x3e48bf063f49bf73,0x3f3cbf6d3f80bf73
.quad 0xbf4f3e9e3e9ebf4f,0x3f80bf4f3e9e3e9e,0x3f16bf733f73bf16,0x80003f16bf733f73,0xbf643f16be20be9e,0xbf353f73bf7d3f4f,0x3ee8bf4f3f7dbf73,0xbf353e9e3e20bf16,0x3f0ebf6d3f7bbf35,0xbf0e3f6dbf7b3f35,0x3f55bec4be483f35,0xbf553ec43e48bf35,0x3ed6bf433f76bf7d,0xbe48be6f3f1ebf64,0x3f68bf263e8b3e20,0x3f7bbf793f49bee8
.quad 0x3f5abee8bda13f16,0xbec4be203f26bf73,0xbf063f64bf7f3f4f,0x3f6dbf7d3f43be9e,0x3f6dbf353ec4a554,0x3f6dbf353ec4a554,0xbec43f35bf6d3f80,0xbec43f35bf6d3f80,0xbefa3f5abf803f64,0x3f7bbf433eb13e20,0xbf5f3f06bd21bee8,0xbe483f26bf703f7d,0xbeb13f26bf5f3f7d,0xbf553f79bf7e3f64,0xbf703f43befa3e20,0xbf0e3e6f3df1bee8
.quad 0x3e9e3e9ebf4f3f80,0xbf4f3e9e3e9ebf4f,0xbf733f73bf168000,0x3f16bf733f73bf16,0xbe203f16bf643f80,0x3f64bf163e203e9e,0xbf7d3f4fbee88000,0xbee83f4fbf7d3f73,0xbf7b3f6dbf0e248d,0x3f7bbf6d3f0ea554,0xbe48bec43f55bf80,0x3e483ec4bf553f80,0xbf763f43bed6248d,0xbf703f7fbf5f3f16,0x3e8bbf263f68bf80,0xbeb1bda13efabf4f
.quad 0xbda1bee83f5abf80,0xbf063f64bf7f3f4f,0x3f7fbf643f06a50d,0xbf5a3ee83da1bf16,0x3ec4bf353f6dbf80,0x3ec4bf353f6dbf80,0x3f6dbf353ec4a50d,0x3f6dbf353ec4a50d,0x3f80bf5a3efaa554,0xbe8bbe6f3f2ebf73,0xbd213f06bf5f3f80,0x3f76bf793f3cbe9e,0x3f5fbf263eb1a554,0x3ed6bda1be8b3f16,0xbefa3f43bf703f80,0xbf683f7fbf763f4f
.quad 0x3e9ebf4f3f80bf4f,0x3e9e3e9ebf4f3f80,0x3f73bf1680003f16,0xbf733f73bf168000,0x3f7dbf733f35be9e,0x3e20bf163f64bf80,0x3e203e9ebf353f73,0x3f7dbf4f3ee8a50d,0x3f55bec4be483f35,0xbf553ec43e48bf35,0xbf0e3f6dbf7b3f35,0x3f0ebf6d3f7bbf35,0xbdf13f06bf553f7d,0x3efabda1beb13f35,0xbf7e3f5abf0e3e20,0xbf5f3f7fbf703f35
.quad 0xbf433f7dbf6d3f16,0x3f7fbf643f06a554,0xbf263e203ec4bf4f,0x3da13ee8bf5a3f80,0xbf6d3f35bec4248d,0xbf6d3f35bec4248d,0x3ec4bf353f6dbf80,0x3ec4bf353f6dbf80,0xbed6bda13f0ebf64,0xbf3c3f79bf763f35,0x3f68bf7f3f55bee8,0xbf2e3e6f3e8bbf35,0x3f1ebf5a3f7bbf7d,0x3f76bf7f3f68bf35,0x3f49bf063e483e20,0x3e8b3da1bed63f35
.quad 0x3e9ebf4f3f80bf4f,0x3e9e3e9ebf4f3f80,0x3f73bf1680003f16,0xbf733f73bf168000,0xbf7d3f73bf353e9e,0xbe203f16bf643f80,0xbe20be9e3f35bf73,0xbf7d3f4fbee88000,0x3e483ec4bf553f80,0xbe48bec43f55bf80,0xbf7b3f6dbf0e8000,0x3f7bbf6d3f0ea50d,0x3f49bf793f7bbf4f,0x3e8bbf263f68bf80,0x3f1ebe6fbe483f16,0x3f76bf433ed6a50d
.quad 0xbf263e203ec4bf4f,0x3da13ee8bf5a3f80,0x3f43bf7d3f6dbf16,0xbf7f3f64bf068000,0xbec43f35bf6d3f80,0xbec43f35bf6d3f80,0xbf6d3f35bec48000,0xbf6d3f35bec48000,0x3f70bf263e483e9e,0x3d21bf063f5fbf80,0xbeb13f43bf7b3f73,0x3f80bf5a3efaa50d,0xbdf1be6f3f0ebf4f,0x3efabf433f70bf80,0x3f7ebf793f55bf16,0x3f5fbf263eb1a50d
.quad 0xbf4f3f80bf4f3e9e,0x3e9ebf4f3f80bf4f,0xbf1680003f16bf73,0x3f73bf1680003f16,0x3ee8a554bee83f4f,0x3f7dbf733f35be9e,0xbf643f80bf643f16,0x3e203e9ebf353f73,0x3f0ebf6d3f7bbf35,0xbf0e3f6dbf7b3f35,0x3f55bec4be483f35,0xbf553ec43e48bf35,0xbf3c3ec43d21bee8,0xbf7e3f5abf0e3e20,0x3f2ebf6d3f80bf64,0x3df1bf063f55bf7d
.quad 0xbe6f3f35bf793f73,0x3f43bf7d3f6dbf16,0xbf793f35be6fbe9e,0x3f26be20bec43f4f,0x3f6dbf353ec4a554,0x3f6dbf353ec4a554,0xbec43f35bf6d3f80,0xbec43f35bf6d3f80,0xbdf1bec43f49bf7d,0xbf683f7fbf553ee8,0x3f7ebf6d3f1ebe20,0xbed6bda13f0ebf64,0xbf803f6dbf3c3ee8,0xbf493f06be48be20,0x3d21bec43f2ebf64,0x3f1ebf5a3f7bbf7d
.quad 0x3f80bf4f3e9e3e9e,0xbf4f3f80bf4f3e9e,0x80003f16bf733f73,0xbf1680003f16bf73,0x3f35bf733f7dbf4f,0xbee8248d3ee8bf4f,0x3f35be9ebe203f16,0x3f64bf803f64bf16,0xbf7b3f6dbf0e248d,0x3f7bbf6d3f0ea554,0xbe48bec43f55bf80,0x3e483ec4bf553f80,0xbf0e3f5abf7e3f73,0x3d213ec4bf3c3f73,0xbf553f06bdf1be9e,0xbf803f6dbf2e3e9e
.quad 0x3f6dbf7d3f43be9e,0xbf793f35be6fbe9e,0x3ec43e20bf263f73,0x3e6fbf353f79bf73,0x3ec4bf353f6dbf80,0x3ec4bf353f6dbf80,0x3f6dbf353ec4a50d,0x3f6dbf353ec4a50d,0xbf553f7fbf683f16,0x3f49bec4bdf13f16,0xbf0e3da13ed6bf4f,0xbf1e3f6dbf7e3f4f,0xbe483f06bf493f73,0xbf3c3f6dbf803f73,0xbf7b3f5abf1e3e9e,0xbf2e3ec4bd21be9e
.quad 0xbf4f3e9e3e9ebf4f,0x3f80bf4f3e9e3e9e,0x3f16bf733f73bf16,0x80003f16bf733f73,0xbf643f16be20be9e,0xbf353f73bf7d3f4f,0x3ee8bf4f3f7dbf73,0xbf353e9e3e20bf16,0x3f55bec4be483f35,0xbf553ec43e48bf35,0xbf0e3f6dbf7b3f35,0x3f0ebf6d3f7bbf35,0x3f68bf263e8b3e20,0x3f7bbf793f49bee8,0xbed63f43bf763f7d,0x3e483e6fbf1e3f64
.quad 0xbf5a3ee83da1bf16,0x3ec43e20bf263f73,0x3f06bf643f7fbf4f,0xbf6d3f7dbf433e9e,0xbf6d3f35bec4248d,0xbf6d3f35bec4248d,0x3ec4bf353f6dbf80,0x3ec4bf353f6dbf80,0x3f5fbf063d213ee8,0x3e48bf263f70bf7d,0xbefa3f5abf803f64,0x3f7bbf433eb13e20,0x3f70bf433efabe20,0x3f0ebe6fbdf13ee8,0xbeb13f26bf5f3f7d,0xbf553f79bf7e3f64
.quad 0xbf4f3e9e3e9ebf4f,0x3f80bf4f3e9e3e9e,0x3f16bf733f73bf16,0x80003f16bf733f73,0x3f64bf163e203e9e,0x3f35bf733f7dbf4f,0xbee83f4fbf7d3f73,0x3f35be9ebe203f16,0x3e483ec4bf553f80,0xbe48bec43f55bf80,0xbf7b3f6dbf0e8000,0x3f7bbf6d3f0ea50d,0xbeb1bda13efabf4f,0xbf553f06bdf1be9e,0x3f70bf7f3f5fbf16,0x3f0ebf5a3f7ebf73
.quad 0x3f06bf643f7fbf4f,0xbf6d3f7dbf433e9e,0x3f5abee8bda13f16,0xbec4be203f26bf73,0xbec43f35bf6d3f80,0xbec43f35bf6d3f80,0xbf6d3f35bec48000,0xbf6d3f35bec48000,0xbf763f79bf3c3e9e,0x3f0ebda1bed63f4f,0xbe8bbe6f3f2ebf73,0xbf553f7fbf683f16,0x3f68bf7f3f76bf4f,0x3f7bbf5a3f1ebe9e,0x3ed6bda1be8b3f16,0xbe483f06bf493f73
.quad 0x3e9e3e9ebf4f3f80,0xbf4f3e9e3e9ebf4f,0xbf733f73bf168000,0x3f16bf733f73bf16,0x3e20bf163f64bf80,0xbf643f16be20be9e,0x3f7dbf4f3ee8a50d,0x3ee8bf4f3f7dbf73,0x3f0ebf6d3f7bbf35,0xbf0e3f6dbf7b3f35,0x3f55bec4be483f35,0xbf553ec43e48bf35,0xbf5f3f7fbf703f35,0xbed63f43bf763f7d,0xbefa3da13eb1bf35,0xbf683f26be8bbe20
.quad 0xbf7f3f64bf06248d,0x3f5abee8bda13f16,0xbda1bee83f5abf80,0xbf063f64bf7f3f4f,0x3f6dbf353ec4a554,0x3f6dbf353ec4a554,0xbec43f35bf6d3f80,0xbec43f35bf6d3f80,0x3f2ebe6fbe8b3f35,0x3efabf5a3f80bf64,0xbf3c3f79bf763f35,0x3f5fbf063d213ee8,0xbe8bbda13ed6bf35,0x3eb1bf263f5fbf7d,0x3f76bf7f3f68bf35,0x3f70bf433efabe20
.quad 0x3e9ebf4f3f80bf4f,0x3e9e3e9ebf4f3f80,0x3f73bf1680003f16,0xbf733f73bf168000,0xbf7d3f73bf353e9e,0xbe203f16bf643f80,0xbe20be9e3f35bf73,0xbf7d3f4fbee88000,0xbf7b3f6dbf0e248d,0x3f7bbf6d3f0ea554,0xbe48bec43f55bf80,0x3e483ec4bf553f80,0x3f1ebe6fbe483f16,0x3f76bf433ed6a554,0xbf493f79bf7b3f4f,0xbe8b3f26bf683f80
.quad 0x3f26be20bec43f4f,0xbda1bee83f5abf80,0xbf433f7dbf6d3f16,0x3f7fbf643f06a50d,0x3ec4bf353f6dbf80,0x3ec4bf353f6dbf80,0x3f6dbf353ec4a50d,0x3f6dbf353ec4a50d,0x3eb1bf433f7bbf73,0xbf803f5abefa248d,0x3f70bf263e483e9e,0x3d21bf063f5fbf80,0xbf7e3f79bf553f16,0xbf5f3f26beb1248d,0xbdf1be6f3f0ebf4f,0x3efabf433f70bf80
.quad 0xbf4f3f80bf4f3e9e,0x3e9ebf4f3f80bf4f,0xbf1680003f16bf73,0x3f73bf1680003f16,0x3ee8a554bee83f4f,0x3f7dbf733f35be9e,0xbf643f80bf643f16,0x3e203e9ebf353f73,0x3f55bec4be483f35,0xbf553ec43e48bf35,0xbf0e3f6dbf7b3f35,0x3f0ebf6d3f7bbf35,0x3f2ebf6d3f80bf64,0x3df1bf063f55bf7d,0x3f3cbec4bd213ee8,0x3f7ebf5a3f0ebe20
.quad 0x3e6fbf353f79bf73,0xbf433f7dbf6d3f16,0x3f79bf353e6f3e9e,0xbf263e203ec4bf4f,0xbf6d3f35bec4248d,0xbf6d3f35bec4248d,0x3ec4bf353f6dbf80,0x3ec4bf353f6dbf80,0xbf7e3f6dbf1e3e20,0x3ed63da1bf0e3f64,0xbdf1bec43f49bf7d,0xbf683f7fbf553ee8,0xbd213ec4bf2e3f64,0xbf1e3f5abf7b3f7d,0xbf803f6dbf3c3ee8,0xbf493f06be48be20
.quad 0xbf4f3f80bf4f3e9e,0x3e9ebf4f3f80bf4f,0xbf1680003f16bf73,0x3f73bf1680003f16,0xbee8248d3ee8bf4f,0xbf7d3f73bf353e9e,0x3f64bf803f64bf16,0xbe20be9e3f35bf73,0x3e483ec4bf553f80,0xbe48bec43f55bf80,0xbf7b3f6dbf0e8000,0x3f7bbf6d3f0ea50d,0xbf803f6dbf2e3e9e,0xbf493f79bf7b3f4f,0xbd21bec43f3cbf73,0xbf1e3e6f3e48bf16
.quad 0x3f79bf353e6f3e9e,0xbf263e203ec4bf4f,0xbe6f3f35bf793f73,0x3f43bf7d3f6dbf16,0xbec43f35bf6d3f80,0xbec43f35bf6d3f80,0xbf6d3f35bec48000,0xbf6d3f35bec48000,0x3f1ebf6d3f7ebf4f,0xbf703f26be48be9e,0x3f49bec4bdf13f16,0x3eb1bf433f7bbf73,0x3f2ebec43d213e9e,0x3df13e6fbf0e3f4f,0xbf3c3f6dbf803f73,0xbf7e3f79bf553f16
.quad 0x3f80bf4f3e9e3e9e,0xbf4f3f80bf4f3e9e,0x80003f16bf733f73,0xbf1680003f16bf73,0xbf353f73bf7d3f4f,0x3ee8a554bee83f4f,0xbf353e9e3e20bf16,0xbf643f80bf643f16,0x3f0ebf6d3f7bbf35,0xbf0e3f6dbf7b3f35,0x3f55bec4be483f35,0xbf553ec43e48bf35,0x3e483e6fbf1e3f64,0x3f3cbec4bd213ee8,0xbf7b3f79bf493ee8,0xbf2e3f6dbf803f64
.quad 0xbec4be203f26bf73,0xbe6f3f35bf793f73,0x3f6dbf7d3f43be9e,0xbf793f35be6fbe9e,0x3f6dbf353ec4a554,0x3f6dbf353ec4a554,0xbec43f35bf6d3f80,0xbec43f35bf6d3f80,0xbf7b3f43beb1be20,0x3df13ec4bf493f7d,0x3e48bf263f70bf7d,0xbf7e3f6dbf1e3e20,0x3f55bf793f7ebf64,0x3f80bf6d3f3cbee8,0x3f0ebe6fbdf13ee8,0xbd213ec4bf2e3f64
.quad 0xbf4f3e9e3e9ebf4f,0x3f80bf4f3e9e3e9e,0x3f16bf733f73bf16,0x80003f16bf733f73,0x3f64bf163e203e9e,0x3f35bf733f7dbf4f,0xbee83f4fbf7d3f73,0x3f35be9ebe203f16,0xbf7b3f6dbf0e248d,0x3f7bbf6d3f0ea554,0xbe48bec43f55bf80,0x3e483ec4bf553f80,0x3f70bf7f3f5fbf16,0x3f0ebf5a3f7ebf73,0x3eb13da1befa3f4f,0x3f55bf063df13e9e
.quad 0xbf063f64bf7f3f4f,0x3f6dbf7d3f43be9e,0xbf5a3ee83da1bf16,0x3ec43e20bf263f73,0x3ec4bf353f6dbf80,0x3ec4bf353f6dbf80,0x3f6dbf353ec4a50d,0x3f6dbf353ec4a50d,0x3e8b3e6fbf2e3f73,0x3f55bf7f3f68bf16,0xbf763f79bf3c3e9e,0x3f0ebda1bed63f4f,0xbed63da13e8bbf16,0x3e48bf063f49bf73,0x3f68bf7f3f76bf4f,0x3f7bbf5a3f1ebe9e
.quad 0x3e9e3e9ebf4f3f80,0xbf4f3e9e3e9ebf4f,0xbf733f73bf168000,0x3f16bf733f73bf16,0x3e20bf163f64bf80,0xbf643f16be20be9e,0x3f7dbf4f3ee8a50d,0x3ee8bf4f3f7dbf73,0x3f55bec4be483f35,0xbf553ec43e48bf35,0xbf0e3f6dbf7b3f35,0x3f0ebf6d3f7bbf35,0xbefa3da13eb1bf35,0xbf683f26be8bbe20,0x3f5fbf7f3f70bf35,0x3ed6bf433f76bf7d
.quad 0x3f7fbf643f06a554,0xbf5a3ee83da1bf16,0x3da13ee8bf5a3f80,0x3f06bf643f7fbf4f,0xbf6d3f35bec4248d,0xbf6d3f35bec4248d,0x3ec4bf353f6dbf80,0x3ec4bf353f6dbf80,0x3f3cbf793f76bf35,0xbf5f3f06bd21bee8,0x3f2ebe6fbe8b3f35,0x3efabf5a3f80bf64,0xbf763f7fbf683f35,0xbf703f43befa3e20,0xbe8bbda13ed6bf35,0x3eb1bf263f5fbf7d
.quad 0xbf163f4fbf733f80,0xbf733f4fbf163e9e,0xbf4f3f16be9e8000,0x3e9ebf163f4fbf73,0xbf643f73bf7d3f80,0x3f7dbf733f64bf4f,0xbee83e9ebe208000,0xbe203e9ebee83f16,0xbf2e3f5abf763f80,0xbefa3e6f3d21be9e,0xbf3c3f06be8b8000,0x3f5fbf793f80bf73,0xbf703f79bf7e3f80,0x3f1ebf063ed6be9e,0xbeb13e6fbdf18000,0xbf493f5abf683f73
.quad 0xbf433f64bf793f80,0x3e6fbee83f26bf4f,0xbf263ee8be6f8000,0x3f79bf643f43bf16,0xbf793f7dbf7f3f80,0xbda13e20be6f3e9e,0xbe6f3e20bda18000,0xbf7f3f7dbf793f73,0xbf553f6dbf7b3f80,0x3f55bf6d3f7bbf80,0xbf0e3ec4be488000,0x3f0ebec43e48a50d,0xbf7e3f7fbf803f80,0xbf3c3f43bf493f4f,0xbdf13da1bd218000,0xbf2e3f26bf1e3f16
.quad 0x3f16be9e248d3e9e,0xbf163f4fbf733f80,0xbf4f3f73bf803f73,0xbf4f3f16be9e8000,0xbee83f16bf353f4f,0x3f64bf733f7dbf80,0xbf643f4fbf353f16,0x3ee8be9e3e20a50d,0x3eb1bda1be483ee8,0xbf803f79bf5f3f35,0xbf703f7fbf7b3f64,0xbd21be6f3efabf35,0xbf2e3f43bf553f64,0x3f68bf5a3f49bf35,0xbf3c3f26bf0e3ee8,0xbed63f06bf1e3f35
.quad 0x3da13e20bec43f16,0xbf263ee8be6f248d,0xbf7f3f7dbf6d3f4f,0x3f43bf643f79bf80,0xbf5a3f64bf6d3f73,0x3e6fbe203da1a554,0xbf063ee8bec43e9e,0xbf793f7dbf7f3f80,0xbe483ec4bf0e3f35,0x3e48bec43f0ebf35,0xbf7b3f6dbf553f35,0x3f7bbf6d3f55bf35,0xbf763f79bf7b3f7d,0xbf1e3f26bf2e3f35,0xbe8b3e6fbe483e20,0xbf493f43bf3c3f35
.quad 0x3f73bf803f73bf4f,0x3f16be9e248d3e9e,0x3e9ea50dbe9e3f16,0xbf4f3f73bf803f73,0x3e20a554be203e9e,0x3ee8bf163f35bf4f,0xbf7d3f80bf7d3f73,0x3f64bf4f3f35bf16,0x3f7ebf6d3f49bf16,0xbed63f26bf553f73,0xbdf13ec4bf1e3f4f,0xbf683f43bf0e3e9e,0xbe8b3ec4befa3f16,0x3f80bf7f3f7bbf73,0xbf763f6dbf5f3f4f,0x3d213da1be483e9e
.quad 0x3f5abf353f06be9e,0xbf7f3f7dbf6d3f4f,0xbf063f35bf5a3f73,0xbda1be203ec4bf16,0xbf263f35bf433f4f,0x3f06bee83ec4be9e,0xbf433f35bf263f16,0xbf5a3f64bf6d3f73,0x3f0ebec43e48a554,0xbf0e3ec4be48248d,0xbf553f6dbf7b3f80,0x3f55bf6d3f7bbf80,0xbf683f6dbf703f73,0xbefa3f06bf0e3f16,0xbed63ec4beb13e9e,0xbf5f3f5abf553f4f
.quad 0xa554be9e3f16bf4f,0x3f73bf803f73bf4f,0x3f80bf733f4fbf16,0x3e9ea50dbe9e3f16,0x3f35bf163ee8be9e,0xbe20248d3e20be9e,0xbf353f4fbf643f73,0x3f7dbf803f7dbf73,0x3f0ebf433f68bf7d,0x3f1ebec43df13e20,0x3f55bf263ed6be20,0xbf493f6dbf7e3f7d,0x3e48bda1bd213e20,0x3f5fbf6d3f76bf7d,0xbf7b3f7fbf803f7d,0x3efabec43e8bbe20
.quad 0x3f6dbf7d3f7fbf73,0xbf063f35bf5a3f73,0x3ec4be20bda13e9e,0xbf5a3f35bf063e9e,0xbec43ee8bf063f16,0x3f43bf353f26bf16,0xbf6d3f64bf5a3f4f,0xbf263f35bf433f4f,0x3f7bbf6d3f55bf35,0xbf7b3f6dbf553f35,0xbe483ec4bf0e3f35,0x3e48bec43f0ebf35,0xbf553f5abf5f3f64,0xbeb13ec4bed63ee8,0xbf0e3f06befa3ee8,0xbf703f6dbf683f64
.quad 0xa554be9e3f16bf4f,0x3f73bf803f73bf4f,0x3f80bf733f4fbf16,0x3e9ea50dbe9e3f16,0xbf353f16bee83e9e,0x3e20a554be203e9e,0x3f35bf4f3f64bf73,0xbf7d3f80bf7d3f73,0x3f7bbf7f3f70bf4f,0xbdf13ec4bf1e3f4f,0x3e483da1beb13f16,0xbf7e3f6dbf493f16,0x3f0ebf263f3cbf4f,0xbf763f6dbf5f3f4f,0x3f55bf433f2ebf16,0x3e8bbec43efabf16
.quad 0x3ec4be20bda13e9e,0xbf5a3f35bf063e9e,0xbf6d3f7dbf7f3f73,0x3f06bf353f5abf73,0x3f6dbf643f5abf4f,0x3f26bf353f43bf4f,0xbec43ee8bf063f16,0x3f43bf353f26bf16,0xbf553f6dbf7b3f80,0x3f55bf6d3f7bbf80,0xbf0e3ec4be488000,0x3f0ebec43e48a50d,0xbe483e6fbe8b3e9e,0x3ed6bec43eb1be9e,0xbf7b3f79bf763f73,0xbf683f6dbf703f73
.quad 0xbf733f4fbf163e9e,0xa554be9e3f16bf4f,0x3e9ebf163f4fbf73,0x3f80bf733f4fbf16,0xbf7d3f73bf643f4f,0x3f35bf163ee8be9e,0x3e20be9e3ee8bf16,0xbf353f4fbf643f73,0x3e8bbf063f3cbf64,0x3f55bf263ed6be20,0x3f76bf5a3f2ebee8,0xbf0e3f43bf683f7d,0x3df1be6f3eb1bee8,0xbf7b3f7fbf803f7d,0x3f7ebf793f70bf64,0xbe483da13d21be20
.quad 0x3f79bf643f43bf16,0xbf6d3f7dbf7f3f73,0xbe6f3ee8bf263f4f,0xbec43e203da1be9e,0x3f7fbf7d3f79bf73,0x3ec4bee83f06bf16,0xbda13e20be6f3e9e,0x3f6dbf643f5abf4f,0xbe483ec4bf0e3f35,0x3e48bec43f0ebf35,0xbf7b3f6dbf553f35,0x3f7bbf6d3f55bf35,0xbd213da1bdf13e20,0x3f0ebf063efabee8,0xbf803f7fbf7e3f7d,0xbf553f5abf5f3f64
.quad 0xbf163f4fbf733f80,0xbf733f4fbf163e9e,0xbf4f3f16be9e8000,0x3e9ebf163f4fbf73,0xbf643f73bf7d3f80,0x3f7dbf733f64bf4f,0xbee83e9ebe208000,0xbe203e9ebee83f16,0xbf3c3f06be8b248d,0x3f5fbf793f80bf73,0x3f2ebf5a3f76bf80,0x3efabe6fbd213e9e,0xbeb13e6fbdf1248d,0xbf493f5abf683f73,0x3f70bf793f7ebf80,0xbf1e3f06bed63e9e
.quad 0x3f43bf643f79bf80,0xbe6f3ee8bf263f4f,0x3f26bee83e6fa50d,0xbf793f64bf433f16,0x3f79bf7d3f7fbf80,0x3da1be203e6fbe9e,0x3e6fbe203da1a50d,0x3f7fbf7d3f79bf73,0x3f0ebec43e48a554,0xbf0e3ec4be48248d,0xbf553f6dbf7b3f80,0x3f55bf6d3f7bbf80,0x3df1bda13d21a554,0x3f2ebf263f1ebf16,0xbf7e3f7fbf803f80,0xbf3c3f43bf493f4f
.quad 0x3f16be9e248d3e9e,0xbf163f4fbf733f80,0xbf4f3f73bf803f73,0xbf4f3f16be9e8000,0xbee83f16bf353f4f,0x3f64bf733f7dbf80,0xbf643f4fbf353f16,0x3ee8be9e3e20a50d,0xbf703f7fbf7b3f64,0xbd21be6f3efabf35,0xbeb13da13e48bee8,0x3f80bf793f5fbf35,0xbf3c3f26bf0e3ee8,0xbed63f06bf1e3f35,0x3f2ebf433f55bf64,0xbf683f5abf493f35
.quad 0xbda1be203ec4bf16,0x3f26bee83e6fa554,0x3f7fbf7d3f6dbf4f,0xbf433f64bf793f80,0x3f5abf643f6dbf73,0xbe6f3e20bda1248d,0x3f06bee83ec4be9e,0x3f79bf7d3f7fbf80,0x3f7bbf6d3f55bf35,0xbf7b3f6dbf553f35,0xbe483ec4bf0e3f35,0x3e48bec43f0ebf35,0x3e8bbe6f3e48be20,0x3f49bf433f3cbf35,0xbf763f79bf7b3f7d,0xbf1e3f26bf2e3f35
.quad 0x3f16be9e248d3e9e,0xbf163f4fbf733f80,0xbf4f3f73bf803f73,0xbf4f3f16be9e8000,0x3ee8bf163f35bf4f,0xbf643f73bf7d3f80,0x3f64bf4f3f35bf16,0xbee83e9ebe208000,0xbf683f43bf0e3e9e,0x3f2ebf5a3f76bf80,0x3ed6bf263f55bf73,0x3f3cbf063e8ba50d,0x3d213da1be483e9e,0x3f70bf793f7ebf80,0xbf803f7fbf7b3f73,0x3eb1be6f3df1a50d
.quad 0x3f7fbf7d3f6dbf4f,0xbf433f64bf793f80,0x3da13e20bec43f16,0xbf263ee8be6f8000,0xbf063ee8bec43e9e,0xbf793f7dbf7f3f80,0x3f5abf643f6dbf73,0xbe6f3e20bda18000,0xbf553f6dbf7b3f80,0x3f55bf6d3f7bbf80,0xbf0e3ec4be488000,0x3f0ebec43e48a50d,0x3f5fbf5a3f55bf4f,0x3f7ebf7f3f80bf80,0xbefa3f06bf0e3f16,0x3df1bda13d21a50d
.quad 0x3f73bf803f73bf4f,0x3f16be9e248d3e9e,0x3e9ea50dbe9e3f16,0xbf4f3f73bf803f73,0xbe20248d3e20be9e,0xbee83f16bf353f4f,0x3f7dbf803f7dbf73,0xbf643f4fbf353f16,0xbf493f6dbf7e3f7d,0xbeb13da13e48bee8,0xbf1e3ec4bdf1be20,0x3f70bf7f3f7bbf64,0x3efabec43e8bbe20,0x3f2ebf433f55bf64,0xbf5f3f6dbf763f7d,0x3f3cbf263f0ebee8
.quad 0x3f06bf353f5abf73,0x3da13e20bec43f16,0x3f5abf353f06be9e,0xbf7f3f7dbf6d3f4f,0xbf433f35bf263f16,0xbf5a3f64bf6d3f73,0x3f26bf353f43bf4f,0xbf063ee8bec43e9e,0xbe483ec4bf0e3f35,0x3e48bec43f0ebf35,0xbf7b3f6dbf553f35,0x3f7bbf6d3f55bf35,0x3f70bf6d3f68bf64,0x3f76bf793f7bbf7d,0xbeb13ec4bed63ee8,0x3e8bbe6f3e48be20
.quad 0xa554be9e3f16bf4f,0x3f73bf803f73bf4f,0x3f80bf733f4fbf16,0x3e9ea50dbe9e3f16,0xbf353f16bee83e9e,0x3e20a554be203e9e,0x3f35bf4f3f64bf73,0xbf7d3f80bf7d3f73,0x3e483da1beb13f16,0xbf7e3f6dbf493f16,0xbf7b3f7fbf703f4f,0x3df1bec43f1ebf4f,0x3f55bf433f2ebf16,0x3e8bbec43efabf16,0xbf0e3f26bf3c3f4f,0x3f76bf6d3f5fbf4f
.quad 0xbec43e203da1be9e,0x3f5abf353f06be9e,0x3f6dbf7d3f7fbf73,0xbf063f35bf5a3f73,0xbf6d3f64bf5a3f4f,0xbf263f35bf433f4f,0x3ec4bee83f06bf16,0xbf433f35bf263f16,0x3f0ebec43e48a554,0xbf0e3ec4be48248d,0xbf553f6dbf7b3f80,0x3f55bf6d3f7bbf80,0x3f7bbf793f76bf73,0x3f68bf6d3f70bf73,0xbe483e6fbe8b3e9e,0x3ed6bec43eb1be9e
.quad 0xbf733f4fbf163e9e,0xa554be9e3f16bf4f,0x3e9ebf163f4fbf73,0x3f80bf733f4fbf16,0xbf7d3f73bf643f4f,0x3f35bf163ee8be9e,0x3e20be9e3ee8bf16,0xbf353f4fbf643f73,0x3f76bf5a3f2ebee8,0xbf0e3f43bf683f7d,0xbe8b3f06bf3c3f64,0xbf553f26bed63e20,0x3f7ebf793f70bf64,0xbe483da13d21be20,0xbdf13e6fbeb13ee8,0x3f7bbf7f3f80bf7d
.quad 0xbf793f64bf433f16,0x3f6dbf7d3f7fbf73,0x3e6fbee83f26bf4f,0x3ec4be20bda13e9e,0xbf7f3f7dbf793f73,0xbec43ee8bf063f16,0x3da1be203e6fbe9e,0xbf6d3f64bf5a3f4f,0x3f7bbf6d3f55bf35,0xbf7b3f6dbf553f35,0xbe483ec4bf0e3f35,0x3e48bec43f0ebf35,0x3f80bf7f3f7ebf7d,0x3f55bf5a3f5fbf64,0xbd213da1bdf13e20,0x3f0ebf063efabee8
.quad 0xbf733f4fbf163e9e,0xa554be9e3f16bf4f,0x3e9ebf163f4fbf73,0x3f80bf733f4fbf16,0x3f7dbf733f64bf4f,0xbf353f16bee83e9e,0xbe203e9ebee83f16,0x3f35bf4f3f64bf73,0x3efabe6fbd213e9e,0xbf7b3f7fbf703f4f,0xbf5f3f79bf803f73,0xbe48bda13eb1bf16,0xbf1e3f06bed63e9e,0xbf0e3f26bf3c3f4f,0x3f49bf5a3f68bf73,0xbf553f43bf2e3f16
.quad 0x3e6fbee83f26bf4f,0x3ec4be20bda13e9e,0x3f79bf643f43bf16,0xbf6d3f7dbf7f3f73,0xbda13e20be6f3e9e,0x3f6dbf643f5abf4f,0xbf7f3f7dbf793f73,0xbec43ee8bf063f16,0xbf553f6dbf7b3f80,0x3f55bf6d3f7bbf80,0xbf0e3ec4be488000,0x3f0ebec43e48a50d,0x3f3cbf433f49bf4f,0x3e48be6f3e8bbe9e,0x3f2ebf263f1ebf16,0x3f7bbf793f76bf73
.quad 0xbf163f4fbf733f80,0xbf733f4fbf163e9e,0xbf4f3f16be9e8000,0x3e9ebf163f4fbf73,0x3f64bf733f7dbf80,0xbf7d3f73bf643f4f,0x3ee8be9e3e20a50d,0x3e20be9e3ee8bf16,0x3f80bf793f5fbf35,0xbe8b3f06bf3c3f64,0x3d213e6fbefa3f35,0xbf763f5abf2e3ee8,0xbf683f5abf493f35,0xbdf13e6fbeb13ee8,0x3ed6bf063f1ebf35,0xbf7e3f79bf703f64
.quad 0xbf263ee8be6f248d,0x3f79bf643f43bf16,0x3f43bf643f79bf80,0xbe6f3ee8bf263f4f,0x3e6fbe203da1a554,0x3f7fbf7d3f79bf73,0xbf793f7dbf7f3f80,0xbda13e20be6f3e9e,0xbe483ec4bf0e3f35,0x3e48bec43f0ebf35,0xbf7b3f6dbf553f35,0x3f7bbf6d3f55bf35,0x3f1ebf263f2ebf35,0x3d21bda13df1be20,0x3f49bf433f3cbf35,0x3f80bf7f3f7ebf7d
.quad 0x3f16be9e248d3e9e,0xbf163f4fbf733f80,0xbf4f3f73bf803f73,0xbf4f3f16be9e8000,0x3ee8bf163f35bf4f,0xbf643f73bf7d3f80,0x3f64bf4f3f35bf16,0xbee83e9ebe208000,0x3ed6bf263f55bf73,0x3f3cbf063e8ba554,0x3f68bf433f0ebe9e,0xbf2e3f5abf763f80,0xbf803f7fbf7b3f73,0x3eb1be6f3df1a554,0xbd21bda13e48be9e,0xbf703f79bf7e3f80
.quad 0xbf7f3f7dbf6d3f4f,0x3f43bf643f79bf80,0xbda1be203ec4bf16,0x3f26bee83e6fa50d,0x3f06bee83ec4be9e,0x3f79bf7d3f7fbf80,0xbf5a3f64bf6d3f73,0x3e6fbe203da1a50d,0x3f0ebec43e48a554,0xbf0e3ec4be48248d,0xbf553f6dbf7b3f80,0x3f55bf6d3f7bbf80,0x3efabf063f0ebf16,0xbdf13da1bd21248d,0x3f5fbf5a3f55bf4f,0x3f7ebf7f3f80bf80
.quad 0x3f73bf803f73bf4f,0x3f16be9e248d3e9e,0x3e9ea50dbe9e3f16,0xbf4f3f73bf803f73,0xbe20248d3e20be9e,0xbee83f16bf353f4f,0x3f7dbf803f7dbf73,0xbf643f4fbf353f16,0xbf1e3ec4bdf1be20,0x3f70bf7f3f7bbf64,0x3f49bf6d3f7ebf7d,0x3eb1bda1be483ee8,0xbf5f3f6dbf763f7d,0x3f3cbf263f0ebee8,0xbefa3ec4be8b3e20,0xbf2e3f43bf553f64
.quad 0xbf063f35bf5a3f73,0xbda1be203ec4bf16,0xbf5a3f35bf063e9e,0x3f7fbf7d3f6dbf4f,0x3f43bf353f26bf16,0x3f5abf643f6dbf73,0xbf263f35bf433f4f,0x3f06bee83ec4be9e,0x3f7bbf6d3f55bf35,0xbf7b3f6dbf553f35,0xbe483ec4bf0e3f35,0x3e48bec43f0ebf35,0x3eb1bec43ed6bee8,0xbe8b3e6fbe483e20,0x3f70bf6d3f68bf64,0x3f76bf793f7bbf7d
.quad 0x3f73bf803f73bf4f,0x3f16be9e248d3e9e,0x3e9ea50dbe9e3f16,0xbf4f3f73bf803f73,0x3e20a554be203e9e,0x3ee8bf163f35bf4f,0xbf7d3f80bf7d3f73,0x3f64bf4f3f35bf16,0x3df1bec43f1ebf4f,0x3f68bf433f0ebe9e,0x3f7ebf6d3f49bf16,0xbed63f26bf553f73,0x3f76bf6d3f5fbf4f,0xbd21bda13e48be9e,0xbe8b3ec4befa3f16,0x3f80bf7f3f7bbf73
.quad 0xbf5a3f35bf063e9e,0x3f7fbf7d3f6dbf4f,0x3f06bf353f5abf73,0x3da13e20bec43f16,0x3f26bf353f43bf4f,0xbf063ee8bec43e9e,0x3f43bf353f26bf16,0x3f5abf643f6dbf73,0xbf553f6dbf7b3f80,0x3f55bf6d3f7bbf80,0xbf0e3ec4be488000,0x3f0ebec43e48a50d,0xbed63ec4beb13e9e,0xbf5f3f5abf553f4f,0x3f68bf6d3f70bf73,0x3efabf063f0ebf16
.quad 0xa554be9e3f16bf4f,0x3f73bf803f73bf4f,0x3f80bf733f4fbf16,0x3e9ea50dbe9e3f16,0x3f35bf163ee8be9e,0xbe20248d3e20be9e,0xbf353f4fbf643f73,0x3f7dbf803f7dbf73,0xbf553f26bed63e20,0x3f49bf6d3f7ebf7d,0x3f0ebf433f68bf7d,0x3f1ebec43df13e20,0x3f7bbf7f3f80bf7d,0xbefa3ec4be8b3e20,0x3e48bda1bd213e20,0x3f5fbf6d3f76bf7d
.quad 0xbf6d3f7dbf7f3f73,0x3f06bf353f5abf73,0xbec43e203da1be9e,0x3f5abf353f06be9e,0x3ec4bee83f06bf16,0xbf433f35bf263f16,0x3f6dbf643f5abf4f,0x3f26bf353f43bf4f,0xbe483ec4bf0e3f35,0x3e48bec43f0ebf35,0xbf7b3f6dbf553f35,0x3f7bbf6d3f55bf35,0xbf0e3f06befa3ee8,0xbf703f6dbf683f64,0x3f55bf5a3f5fbf64,0x3eb1bec43ed6bee8
.quad 0xbf733f4fbf163e9e,0xa554be9e3f16bf4f,0x3e9ebf163f4fbf73,0x3f80bf733f4fbf16,0x3f7dbf733f64bf4f,0xbf353f16bee83e9e,0xbe203e9ebee83f16,0x3f35bf4f3f64bf73,0xbf5f3f79bf803f73,0xbe48bda13eb1bf16,0xbefa3e6f3d21be9e,0x3f7bbf7f3f70bf4f,0x3f49bf5a3f68bf73,0xbf553f43bf2e3f16,0x3f1ebf063ed6be9e,0x3f0ebf263f3cbf4f
.quad 0xbe6f3ee8bf263f4f,0xbec43e203da1be9e,0xbf793f64bf433f16,0x3f6dbf7d3f7fbf73,0x3da1be203e6fbe9e,0xbf6d3f64bf5a3f4f,0x3f7fbf7d3f79bf73,0x3ec4bee83f06bf16,0x3f0ebec43e48a554,0xbf0e3ec4be48248d,0xbf553f6dbf7b3f80,0x3f55bf6d3f7bbf80,0xbf2e3f26bf1e3f16,0xbf7b3f79bf763f73,0x3f3cbf433f49bf4f,0x3e48be6f3e8bbe9e
.quad 0xbf163f4fbf733f80,0xbf733f4fbf163e9e,0xbf4f3f16be9e8000,0x3e9ebf163f4fbf73,0x3f64bf733f7dbf80,0xbf7d3f73bf643f4f,0x3ee8be9e3e20a50d,0x3e20be9e3ee8bf16,0x3d213e6fbefa3f35,0xbf763f5abf2e3ee8,0xbf803f79bf5f3f35,0x3e8bbf063f3cbf64,0x3ed6bf063f1ebf35,0xbf7e3f79bf703f64,0x3f68bf5a3f49bf35,0x3df1be6f3eb1bee8
.quad 0x3f26bee83e6fa554,0xbf793f64bf433f16,0xbf433f64bf793f80,0x3e6fbee83f26bf4f,0xbe6f3e20bda1248d,0xbf7f3f7dbf793f73,0x3f79bf7d3f7fbf80,0x3da1be203e6fbe9e,0x3f7bbf6d3f55bf35,0xbf7b3f6dbf553f35,0xbe483ec4bf0e3f35,0x3e48bec43f0ebf35,0xbf493f43bf3c3f35,0xbf803f7fbf7e3f7d,0x3f1ebf263f2ebf35,0x3d21bda13df1be20
.quad 0xbf803f80bf803f80,0xbf803f80bf803f80,0xa50d8000a50d8000,0xa50d8000a50d8000,0xbf643f73bf7d3f80,0x3f7dbf733f64bf4f,0x3ee8be9e3e208000,0x3e20be9e3ee8bf16,0xbf7e3f7fbf803f80,0xbf3c3f43bf493f4f,0x3df1bda13d218000,0x3f2ebf263f1ebf16,0xbf553f6dbf7b3f80,0x3f55bf6d3f7bbf80,0x3f0ebec43e488000,0xbf0e3ec4be48a50d
.quad 0xbf793f7dbf7f3f80,0xbda13e20be6f3e9e,0x3e6fbe203da18000,0x3f7fbf7d3f79bf73,0xbf433f64bf793f80,0x3e6fbee83f26bf4f,0x3f26bee83e6f8000,0xbf793f64bf433f16,0xbf703f79bf7e3f80,0x3f1ebf063ed6be9e,0x3eb1be6f3df18000,0x3f49bf5a3f68bf73,0xbf2e3f5abf763f80,0xbefa3e6f3d21be9e,0x3f3cbf063e8b8000,0xbf5f3f79bf803f73
.quad 0xbf803f80bf803f80,0xbf803f80bf803f80,0xa50d8000a50d8000,0xa50d8000a50d8000,0xbee83f16bf353f4f,0x3f64bf733f7dbf80,0x3f64bf4f3f35bf16,0xbee83e9ebe20a50d,0xbf763f79bf7b3f7d,0xbf1e3f26bf2e3f35,0x3e8bbe6f3e48be20,0x3f49bf433f3cbf35,0xbe483ec4bf0e3f35,0x3e48bec43f0ebf35,0x3f7bbf6d3f55bf35,0xbf7b3f6dbf553f35
.quad 0xbf5a3f64bf6d3f73,0x3e6fbe203da1248d,0x3f06bee83ec4be9e,0x3f79bf7d3f7fbf80,0x3da13e20bec43f16,0xbf263ee8be6fa554,0x3f7fbf7d3f6dbf4f,0xbf433f64bf793f80,0xbf2e3f43bf553f64,0x3f68bf5a3f49bf35,0x3f3cbf263f0ebee8,0x3ed6bf063f1ebf35,0x3eb1bda1be483ee8,0xbf803f79bf5f3f35,0x3f70bf7f3f7bbf64,0x3d213e6fbefa3f35
.quad 0xbf803f80bf803f80,0xbf803f80bf803f80,0xa50d8000a50d8000,0xa50d8000a50d8000,0x3e20248dbe203e9e,0x3ee8bf163f35bf4f,0x3f7dbf803f7dbf73,0xbf643f4fbf353f16,0xbf683f6dbf703f73,0xbefa3f06bf0e3f16,0x3ed6bec43eb1be9e,0x3f5fbf5a3f55bf4f,0x3f0ebec43e48248d,0xbf0e3ec4be48a554,0x3f55bf6d3f7bbf80,0xbf553f6dbf7b3f80
.quad 0xbf263f35bf433f4f,0x3f06bee83ec4be9e,0x3f43bf353f26bf16,0x3f5abf643f6dbf73,0x3f5abf353f06be9e,0xbf7f3f7dbf6d3f4f,0x3f06bf353f5abf73,0x3da13e20bec43f16,0xbe8b3ec4befa3f16,0x3f80bf7f3f7bbf73,0x3f76bf6d3f5fbf4f,0xbd21bda13e48be9e,0x3f7ebf6d3f49bf16,0xbed63f26bf553f73,0x3df1bec43f1ebf4f,0x3f68bf433f0ebe9e
.quad 0xbf803f80bf803f80,0xbf803f80bf803f80,0xa50d8000a50d8000,0xa50d8000a50d8000,0x3f35bf163ee8be9e,0xbe20a5543e20be9e,0x3f35bf4f3f64bf73,0xbf7d3f80bf7d3f73,0xbf553f5abf5f3f64,0xbeb13ec4bed63ee8,0x3f0ebf063efabee8,0x3f70bf6d3f68bf64,0x3f7bbf6d3f55bf35,0xbf7b3f6dbf553f35,0x3e48bec43f0ebf35,0xbe483ec4bf0e3f35
.quad 0xbec43ee8bf063f16,0x3f43bf353f26bf16,0x3f6dbf643f5abf4f,0x3f26bf353f43bf4f,0x3f6dbf7d3f7fbf73,0xbf063f35bf5a3f73,0xbec43e203da1be9e,0x3f5abf353f06be9e,0x3e48bda1bd213e20,0x3f5fbf6d3f76bf7d,0x3f7bbf7f3f80bf7d,0xbefa3ec4be8b3e20,0x3f0ebf433f68bf7d,0x3f1ebec43df13e20,0xbf553f26bed63e20,0x3f49bf6d3f7ebf7d
.quad 0xbf803f80bf803f80,0xbf803f80bf803f80,0xa50d8000a50d8000,0xa50d8000a50d8000,0xbf353f16bee83e9e,0x3e20248dbe203e9e,0xbf353f4fbf643f73,0x3f7dbf803f7dbf73,0xbe483e6fbe8b3e9e,0x3ed6bec43eb1be9e,0x3f7bbf793f76bf73,0x3f68bf6d3f70bf73,0xbf553f6dbf7b3f80,0x3f55bf6d3f7bbf80,0x3f0ebec43e488000,0xbf0e3ec4be48a50d
.quad 0x3f6dbf643f5abf4f,0x3f26bf353f43bf4f,0x3ec4bee83f06bf16,0xbf433f35bf263f16,0x3ec4be20bda13e9e,0xbf5a3f35bf063e9e,0x3f6dbf7d3f7fbf73,0xbf063f35bf5a3f73,0x3f0ebf263f3cbf4f,0xbf763f6dbf5f3f4f,0xbf553f43bf2e3f16,0xbe8b3ec4befa3f16,0x3f7bbf7f3f70bf4f,0xbdf13ec4bf1e3f4f,0xbe48bda13eb1bf16,0x3f7ebf6d3f49bf16
.quad 0xbf803f80bf803f80,0xbf803f80bf803f80,0xa50d8000a50d8000,0xa50d8000a50d8000,0xbf7d3f73bf643f4f,0x3f35bf163ee8be9e,0xbe203e9ebee83f16,0x3f35bf4f3f64bf73,0xbd213da1bdf13e20,0x3f0ebf063efabee8,0x3f80bf7f3f7ebf7d,0x3f55bf5a3f5fbf64,0xbe483ec4bf0e3f35,0x3e48bec43f0ebf35,0x3f7bbf6d3f55bf35,0xbf7b3f6dbf553f35
.quad 0x3f7fbf7d3f79bf73,0x3ec4bee83f06bf16,0x3da1be203e6fbe9e,0xbf6d3f64bf5a3f4f,0x3f79bf643f43bf16,0xbf6d3f7dbf7f3f73,0x3e6fbee83f26bf4f,0x3ec4be20bda13e9e,0x3df1be6f3eb1bee8,0xbf7b3f7fbf803f7d,0xbf7e3f79bf703f64,0x3e48bda1bd213e20,0x3e8bbf063f3cbf64,0x3f55bf263ed6be20,0xbf763f5abf2e3ee8,0x3f0ebf433f68bf7d
.quad 0xbf803f80bf803f80,0xbf803f80bf803f80,0xa50d8000a50d8000,0xa50d8000a50d8000,0xbf643f73bf7d3f80,0x3f7dbf733f64bf4f,0x3ee8be9e3e208000,0x3e20be9e3ee8bf16,0x3df1bda13d21248d,0x3f2ebf263f1ebf16,0x3f7ebf7f3f80bf80,0x3f3cbf433f49bf4f,0x3f0ebec43e48248d,0xbf0e3ec4be48a554,0x3f55bf6d3f7bbf80,0xbf553f6dbf7b3f80
.quad 0x3f79bf7d3f7fbf80,0x3da1be203e6fbe9e,0xbe6f3e20bda1a50d,0xbf7f3f7dbf793f73,0x3f43bf643f79bf80,0xbe6f3ee8bf263f4f,0xbf263ee8be6fa50d,0x3f79bf643f43bf16,0xbeb13e6fbdf1a554,0xbf493f5abf683f73,0xbf703f79bf7e3f80,0x3f1ebf063ed6be9e,0xbf3c3f06be8ba554,0x3f5fbf793f80bf73,0xbf2e3f5abf763f80,0xbefa3e6f3d21be9e
.quad 0xbf803f80bf803f80,0xbf803f80bf803f80,0xa50d8000a50d8000,0xa50d8000a50d8000,0xbee83f16bf353f4f,0x3f64bf733f7dbf80,0x3f64bf4f3f35bf16,0xbee83e9ebe20a50d,0x3e8bbe6f3e48be20,0x3f49bf433f3cbf35,0x3f76bf793f7bbf7d,0x3f1ebf263f2ebf35,0x3f7bbf6d3f55bf35,0xbf7b3f6dbf553f35,0x3e48bec43f0ebf35,0xbe483ec4bf0e3f35
.quad 0x3f5abf643f6dbf73,0xbe6f3e20bda1a554,0xbf063ee8bec43e9e,0xbf793f7dbf7f3f80,0xbda1be203ec4bf16,0x3f26bee83e6f248d,0xbf7f3f7dbf6d3f4f,0x3f43bf643f79bf80,0xbf3c3f26bf0e3ee8,0xbed63f06bf1e3f35,0xbf2e3f43bf553f64,0x3f68bf5a3f49bf35,0xbf703f7fbf7b3f64,0xbd21be6f3efabf35,0x3eb1bda1be483ee8,0xbf803f79bf5f3f35
.quad 0xbf803f80bf803f80,0xbf803f80bf803f80,0xa50d8000a50d8000,0xa50d8000a50d8000,0x3ee8bf163f35bf4f,0xbf643f73bf7d3f80,0xbf643f4fbf353f16,0x3ee8be9e3e208000,0x3f5fbf5a3f55bf4f,0x3f7ebf7f3f80bf80,0x3efabf063f0ebf16,0xbdf13da1bd21a50d,0xbf553f6dbf7b3f80,0x3f55bf6d3f7bbf80,0x3f0ebec43e488000,0xbf0e3ec4be48a50d
.quad 0xbf063ee8bec43e9e,0xbf793f7dbf7f3f80,0xbf5a3f64bf6d3f73,0x3e6fbe203da18000,0x3f7fbf7d3f6dbf4f,0xbf433f64bf793f80,0xbda1be203ec4bf16,0x3f26bee83e6f8000,0x3d213da1be483e9e,0x3f70bf793f7ebf80,0x3f80bf7f3f7bbf73,0xbeb13e6fbdf1a50d,0xbf683f43bf0e3e9e,0x3f2ebf5a3f76bf80,0xbed63f26bf553f73,0xbf3c3f06be8ba50d
.quad 0xbf803f80bf803f80,0xbf803f80bf803f80,0xa50d8000a50d8000,0xa50d8000a50d8000,0xbe20a5543e20be9e,0xbee83f16bf353f4f,0xbf7d3f80bf7d3f73,0x3f64bf4f3f35bf16,0x3f70bf6d3f68bf64,0x3f76bf793f7bbf7d,0x3eb1bec43ed6bee8,0xbe8b3e6fbe483e20,0xbe483ec4bf0e3f35,0x3e48bec43f0ebf35,0x3f7bbf6d3f55bf35,0xbf7b3f6dbf553f35
.quad 0xbf433f35bf263f16,0xbf5a3f64bf6d3f73,0xbf263f35bf433f4f,0x3f06bee83ec4be9e,0x3f06bf353f5abf73,0x3da13e20bec43f16,0xbf5a3f35bf063e9e,0x3f7fbf7d3f6dbf4f,0x3efabec43e8bbe20,0x3f2ebf433f55bf64,0x3f5fbf6d3f76bf7d,0xbf3c3f26bf0e3ee8,0xbf493f6dbf7e3f7d,0xbeb13da13e48bee8,0x3f1ebec43df13e20,0xbf703f7fbf7b3f64
.quad 0xbf803f80bf803f80,0xbf803f80bf803f80,0xa50d8000a50d8000,0xa50d8000a50d8000,0xbf353f16bee83e9e,0x3e20248dbe203e9e,0xbf353f4fbf643f73,0x3f7dbf803f7dbf73,0x3f7bbf793f76bf73,0x3f68bf6d3f70bf73,0x3e48be6f3e8bbe9e,0xbed63ec4beb13e9e,0x3f0ebec43e48248d,0xbf0e3ec4be48a554,0x3f55bf6d3f7bbf80,0xbf553f6dbf7b3f80
.quad 0xbf6d3f64bf5a3f4f,0xbf263f35bf433f4f,0xbec43ee8bf063f16,0x3f43bf353f26bf16,0xbec43e203da1be9e,0x3f5abf353f06be9e,0xbf6d3f7dbf7f3f73,0x3f06bf353f5abf73,0x3f55bf433f2ebf16,0x3e8bbec43efabf16,0x3f0ebf263f3cbf4f,0xbf763f6dbf5f3f4f,0x3e483da1beb13f16,0xbf7e3f6dbf493f16,0x3f7bbf7f3f70bf4f,0xbdf13ec4bf1e3f4f
.quad 0xbf803f80bf803f80,0xbf803f80bf803f80,0xa50d8000a50d8000,0xa50d8000a50d8000,0xbf7d3f73bf643f4f,0x3f35bf163ee8be9e,0xbe203e9ebee83f16,0x3f35bf4f3f64bf73,0x3f80bf7f3f7ebf7d,0x3f55bf5a3f5fbf64,0x3d21bda13df1be20,0xbf0e3f06befa3ee8,0x3f7bbf6d3f55bf35,0xbf7b3f6dbf553f35,0x3e48bec43f0ebf35,0xbe483ec4bf0e3f35
.quad 0xbf7f3f7dbf793f73,0xbec43ee8bf063f16,0xbda13e20be6f3e9e,0x3f6dbf643f5abf4f,0xbf793f64bf433f16,0x3f6dbf7d3f7fbf73,0xbe6f3ee8bf263f4f,0xbec43e203da1be9e,0x3f7ebf793f70bf64,0xbe483da13d21be20,0x3df1be6f3eb1bee8,0xbf7b3f7fbf803f7d,0x3f76bf5a3f2ebee8,0xbf0e3f43bf683f7d,0x3e8bbf063f3cbf64,0x3f55bf263ed6be20
.quad 0xbf803f80bf803f80,0xbf803f80bf803f80,0xa50d8000a50d8000,0xa50d8000a50d8000,0x3f7dbf733f64bf4f,0xbf353f16bee83e9e,0x3e20be9e3ee8bf16,0xbf353f4fbf643f73,0x3f3cbf433f49bf4f,0x3e48be6f3e8bbe9e,0xbf2e3f26bf1e3f16,0xbf7b3f79bf763f73,0xbf553f6dbf7b3f80,0x3f55bf6d3f7bbf80,0x3f0ebec43e488000,0xbf0e3ec4be48a50d
.quad 0xbda13e20be6f3e9e,0x3f6dbf643f5abf4f,0x3f7fbf7d3f79bf73,0x3ec4bee83f06bf16,0x3e6fbee83f26bf4f,0x3ec4be20bda13e9e,0xbf793f64bf433f16,0x3f6dbf7d3f7fbf73,0xbf1e3f06bed63e9e,0xbf0e3f26bf3c3f4f,0xbf493f5abf683f73,0x3f55bf433f2ebf16,0x3efabe6fbd213e9e,0xbf7b3f7fbf703f4f,0x3f5fbf793f80bf73,0x3e483da1beb13f16
.quad 0xbf803f80bf803f80,0xbf803f80bf803f80,0xa50d8000a50d8000,0xa50d8000a50d8000,0x3f64bf733f7dbf80,0xbf7d3f73bf643f4f,0xbee83e9ebe20a50d,0xbe203e9ebee83f16,0x3f1ebf263f2ebf35,0x3d21bda13df1be20,0xbf493f43bf3c3f35,0xbf803f7fbf7e3f7d,0xbe483ec4bf0e3f35,0x3e48bec43f0ebf35,0x3f7bbf6d3f55bf35,0xbf7b3f6dbf553f35
.quad 0x3e6fbe203da1248d,0x3f7fbf7d3f79bf73,0x3f79bf7d3f7fbf80,0x3da1be203e6fbe9e,0xbf263ee8be6fa554,0x3f79bf643f43bf16,0xbf433f64bf793f80,0x3e6fbee83f26bf4f,0xbf683f5abf493f35,0xbdf13e6fbeb13ee8,0xbed63f06bf1e3f35,0x3f7ebf793f70bf64,0x3f80bf793f5fbf35,0xbe8b3f06bf3c3f64,0xbd21be6f3efabf35,0x3f76bf5a3f2ebee8
.quad 0xbf803f80bf803f80,0xbf803f80bf803f80,0xa50d8000a50d8000,0xa50d8000a50d8000,0x3ee8bf163f35bf4f,0xbf643f73bf7d3f80,0xbf643f4fbf353f16,0x3ee8be9e3e208000,0x3efabf063f0ebf16,0xbdf13da1bd21a554,0xbf5f3f5abf553f4f,0xbf7e3f7fbf803f80,0x3f0ebec43e48248d,0xbf0e3ec4be48a554,0x3f55bf6d3f7bbf80,0xbf553f6dbf7b3f80
.quad 0x3f06bee83ec4be9e,0x3f79bf7d3f7fbf80,0x3f5abf643f6dbf73,0xbe6f3e20bda1a50d,0xbf7f3f7dbf6d3f4f,0x3f43bf643f79bf80,0x3da13e20bec43f16,0xbf263ee8be6fa50d,0xbf803f7fbf7b3f73,0x3eb1be6f3df1248d,0x3d213da1be483e9e,0x3f70bf793f7ebf80,0x3ed6bf263f55bf73,0x3f3cbf063e8b248d,0xbf683f43bf0e3e9e,0x3f2ebf5a3f76bf80
.quad 0xbf803f80bf803f80,0xbf803f80bf803f80,0xa50d8000a50d8000,0xa50d8000a50d8000,0xbe20a5543e20be9e,0xbee83f16bf353f4f,0xbf7d3f80bf7d3f73,0x3f64bf4f3f35bf16,0x3eb1bec43ed6bee8,0xbe8b3e6fbe483e20,0xbf703f6dbf683f64,0xbf763f79bf7b3f7d,0x3f7bbf6d3f55bf35,0xbf7b3f6dbf553f35,0x3e48bec43f0ebf35,0xbe483ec4bf0e3f35
.quad 0x3f43bf353f26bf16,0x3f5abf643f6dbf73,0x3f26bf353f43bf4f,0xbf063ee8bec43e9e,0xbf063f35bf5a3f73,0xbda1be203ec4bf16,0x3f5abf353f06be9e,0xbf7f3f7dbf6d3f4f,0xbf5f3f6dbf763f7d,0x3f3cbf263f0ebee8,0x3efabec43e8bbe20,0x3f2ebf433f55bf64,0xbf1e3ec4bdf1be20,0x3f70bf7f3f7bbf64,0xbf493f6dbf7e3f7d,0xbeb13da13e48bee8
.quad 0xbf803f80bf803f80,0xbf803f80bf803f80,0xa50d8000a50d8000,0xa50d8000a50d8000,0x3e20248dbe203e9e,0x3ee8bf163f35bf4f,0x3f7dbf803f7dbf73,0xbf643f4fbf353f16,0xbed63ec4beb13e9e,0xbf5f3f5abf553f4f,0xbf683f6dbf703f73,0xbefa3f06bf0e3f16,0xbf553f6dbf7b3f80,0x3f55bf6d3f7bbf80,0x3f0ebec43e488000,0xbf0e3ec4be48a50d
.quad 0x3f26bf353f43bf4f,0xbf063ee8bec43e9e,0xbf433f35bf263f16,0xbf5a3f64bf6d3f73,0xbf5a3f35bf063e9e,0x3f7fbf7d3f6dbf4f,0xbf063f35bf5a3f73,0xbda1be203ec4bf16,0x3f76bf6d3f5fbf4f,0xbd21bda13e48be9e,0x3e8bbec43efabf16,0xbf803f7fbf7b3f73,0x3df1bec43f1ebf4f,0x3f68bf433f0ebe9e,0xbf7e3f6dbf493f16,0x3ed6bf263f55bf73
.quad 0xbf803f80bf803f80,0xbf803f80bf803f80,0xa50d8000a50d8000,0xa50d8000a50d8000,0x3f35bf163ee8be9e,0xbe20a5543e20be9e,0x3f35bf4f3f64bf73,0xbf7d3f80bf7d3f73,0xbf0e3f06befa3ee8,0xbf703f6dbf683f64,0xbf553f5abf5f3f64,0xbeb13ec4bed63ee8,0xbe483ec4bf0e3f35,0x3e48bec43f0ebf35,0x3f7bbf6d3f55bf35,0xbf7b3f6dbf553f35
.quad 0x3ec4bee83f06bf16,0xbf433f35bf263f16,0xbf6d3f64bf5a3f4f,0xbf263f35bf433f4f,0xbf6d3f7dbf7f3f73,0x3f06bf353f5abf73,0x3ec4be20bda13e9e,0xbf5a3f35bf063e9e,0x3f7bbf7f3f80bf7d,0xbefa3ec4be8b3e20,0xbe483da13d21be20,0xbf5f3f6dbf763f7d,0xbf553f26bed63e20,0x3f49bf6d3f7ebf7d,0xbf0e3f43bf683f7d,0xbf1e3ec4bdf1be20
.quad 0xbf803f80bf803f80,0xbf803f80bf803f80,0xa50d8000a50d8000,0xa50d8000a50d8000,0x3f7dbf733f64bf4f,0xbf353f16bee83e9e,0x3e20be9e3ee8bf16,0xbf353f4fbf643f73,0xbf2e3f26bf1e3f16,0xbf7b3f79bf763f73,0xbf3c3f43bf493f4f,0xbe483e6fbe8b3e9e,0x3f0ebec43e48248d,0xbf0e3ec4be48a554,0x3f55bf6d3f7bbf80,0xbf553f6dbf7b3f80
.quad 0x3da1be203e6fbe9e,0xbf6d3f64bf5a3f4f,0xbf7f3f7dbf793f73,0xbec43ee8bf063f16,0xbe6f3ee8bf263f4f,0xbec43e203da1be9e,0x3f79bf643f43bf16,0xbf6d3f7dbf7f3f73,0x3f49bf5a3f68bf73,0xbf553f43bf2e3f16,0xbf1e3f06bed63e9e,0xbf0e3f26bf3c3f4f,0xbf5f3f79bf803f73,0xbe48bda13eb1bf16,0x3efabe6fbd213e9e,0xbf7b3f7fbf703f4f
.quad 0xbf803f80bf803f80,0xbf803f80bf803f80,0xa50d8000a50d8000,0xa50d8000a50d8000,0x3f64bf733f7dbf80,0xbf7d3f73bf643f4f,0xbee83e9ebe20a50d,0xbe203e9ebee83f16,0xbf493f43bf3c3f35,0xbf803f7fbf7e3f7d,0xbf1e3f26bf2e3f35,0xbd213da1bdf13e20,0x3f7bbf6d3f55bf35,0xbf7b3f6dbf553f35,0x3e48bec43f0ebf35,0xbe483ec4bf0e3f35
.quad 0xbe6f3e20bda1a554,0xbf7f3f7dbf793f73,0xbf793f7dbf7f3f80,0xbda13e20be6f3e9e,0x3f26bee83e6f248d,0xbf793f64bf433f16,0x3f43bf643f79bf80,0xbe6f3ee8bf263f4f,0x3ed6bf063f1ebf35,0xbf7e3f79bf703f64,0xbf683f5abf493f35,0xbdf13e6fbeb13ee8,0x3d213e6fbefa3f35,0xbf763f5abf2e3ee8,0x3f80bf793f5fbf35,0xbe8b3f06bf3c3f64
```
